```python
import torch

def _softmax(x, axis=-1):
    return torch.softmax(x, dim=axis)
def _gelu(x):
    return torch.nn.functional.gelu(x, approximate="tanh")
def _silu(x):
    return torch.nn.functional.silu(x)
def _sigmoid(x):
    return torch.sigmoid(x)
def _layernorm(x, axis=-1, eps=1e-5):
    m = x.mean(dim=axis, keepdim=True)
    v = x.var(dim=axis, keepdim=True, unbiased=False)
    return (x - m) / torch.sqrt(v + eps)
def _scatter_add(tgt, idx, src, axis=0):
    return tgt.clone().index_add_(axis, idx, src)
def _segment_sum(src, seg, n):
    out = torch.zeros((n,) + src.shape[1:], dtype=src.dtype)
    return out.index_add_(0, seg, src)
def _pad(x, pw):
    flat = tuple(v for pair in reversed(pw) for v in pair)
    return torch.nn.functional.pad(x, flat)

kernel_name = 'gated_mix__mha_block__mixer_s_mlp__prompt'

def setup_inputs():

    _w = (lambda a: (lambda t: t.to(torch.bfloat16) if t.is_floating_point() else t)(torch.as_tensor(a)))
    def _A_setup():
        B, S, D, H = 1, 2048, 1024, 32
        return {
            "x": _w((lambda *s: torch.randn(*s, dtype=torch.bfloat16) * 0.1)(B, S, D)),
            "wqkv": _w((lambda *s: torch.randn(*s, dtype=torch.bfloat16) * 0.4)(D, 3 * D)),
            "wo": _w((lambda *s: torch.randn(*s, dtype=torch.bfloat16) * 0.4)(D, D)),
        }
    _A_in = _A_setup()

    def _B_setup():
        B, S, D, F = 1, 2048, 1024, 3584
        return {
            "x":  _w((lambda *s: torch.randn(*s, dtype=torch.bfloat16) * 0.1)(B, S, D)),
            "w1": _w((lambda *s: torch.randn(*s, dtype=torch.bfloat16) * 3.2)(D, D) * (D ** -0.5)),
            "w2": _w((lambda *s: torch.randn(*s, dtype=torch.bfloat16) * 3.2)(D, D) * (D ** -0.5)),
            "w3": _w((lambda *s: torch.randn(*s, dtype=torch.bfloat16) * 3.2)(D, F) * (D ** -0.5)),
            "w4": _w((lambda *s: torch.randn(*s, dtype=torch.bfloat16) * 3.2)(F, D) * (F ** -0.5)),
        }
    _B_in = _B_setup()

    return {
        "A_x": _A_in["x"],
        "A_wqkv": _A_in["wqkv"],
        "A_wo": _A_in["wo"],
        "B_x": _B_in["x"],
        "B_w1": _B_in["w1"],
        "B_w2": _B_in["w2"],
        "B_w3": _B_in["w3"],
        "B_w4": _B_in["w4"],
        "gate_w": _w((lambda *s: torch.randn(*s, dtype=torch.bfloat16) * 0.4)(1024) * 16.0),
    }

def reference(A_x, A_wqkv, A_wo, B_x, B_w1, B_w2, B_w3, B_w4, gate_w):
    def _A_ref(x, wqkv, wo):
        B, S, D = x.shape
        H = 32
        Dh = D // H
        qkv = (lambda x, *d: x.permute(*d))((x @ wqkv).reshape(B, S, 3, H, Dh), 2, 0, 3, 1, 4)
        q, k, v = qkv[0], qkv[1], qkv[2]
        scores = torch.einsum("bhqd,bhkd->bhqk", q, k) * (Dh ** -0.5)
        p = _softmax(scores, axis=-1)
        o = torch.einsum("bhqk,bhkd->bhqd", p, v)
        return (lambda x, *d: x.permute(*d))(o, 0, 2, 1, 3).reshape(B, S, D) @ wo

    def _B_ref(x, w1, w2, w3, w4):
        B, S, D = x.shape
        h = _gelu(_layernorm(x, axis=-1) @ w1)
        c = D // 4
        g0 = _pad(h[:, :, 0*c:1*c], ((0, 0), (1, 0), (0, 0)))[:, :S, :]
        g1 = _pad(h[:, :, 1*c:2*c], ((0, 0), (0, 1), (0, 0)))[:, 1:, :]
        g2 = _pad(h[:, :, 2*c:3*c], ((0, 0), (2, 0), (0, 0)))[:, :S, :]
        g3 = _pad(h[:, :, 3*c:   ], ((0, 0), (0, 2), (0, 0)))[:, 2:, :]
        hs = torch.concatenate([g0, g1, g2, g3], axis=-1) @ w2
        x1 = x + hs
        h2 = _gelu(_layernorm(x1, axis=-1) @ w3) @ w4
        return x1 + h2

    x = A_x
    g = _sigmoid((x * gate_w).sum(-1, keepdims=True))
    a = _A_ref(x, A_wqkv, A_wo)
    b = _B_ref(x, B_w1, B_w2, B_w3, B_w4)
    return g * a + (1 - g) * b
```

```asm
; @launch grid=(256,1,1) block=(512,1,1) lds=163840
.amdgcn_target "amdgcn-amd-amdhsa--gfx950"
.text
.globl gated_mix__mha_block__mixer_s_mlp__prompt_kernel
.p2align 8
.type gated_mix__mha_block__mixer_s_mlp__prompt_kernel,@function
gated_mix__mha_block__mixer_s_mlp__prompt_kernel:
    s_cmp_ge_u32 s2, 256
    s_cbranch_scc1 L_ka_end
    s_load_dwordx4 s[4:7], s[0:1], 0
    s_load_dwordx4 s[36:39], s[0:1], 32
    s_load_dwordx4 s[60:63], s[0:1], 80
    s_load_dwordx2 s[72:73], s[0:1], 64
    s_getpc_b64 s[92:93]
L_pc_gated_mix__mha_block__mixer_s_mlp__prompt_kernel:
    s_mov_b32 s94, L_code_end-L_pc_gated_mix__mha_block__mixer_s_mlp__prompt_kernel
    s_mov_b32 s95, 0x00020000
    v_lshlrev_b32 v30, 6, v0
    s_bfe_u32 s91, s2, 0x20003
    s_lshl_b32 s91, s91, 15
    buffer_load_dword v29, v30, s[92:95], s91 offen
    v_and_b32 v1, 63, v0
    v_lshrrev_b32 v2, 6, v0
    s_nop 0
    v_readfirstlane_b32 s20, v2
    v_and_b32 v2, 15, v1
    v_lshrrev_b32 v3, 4, v1
    s_lshr_b32 s21, s20, 1
    s_and_b32 s22, s20, 1
    s_and_b32 s40, s2, 7
    s_lshr_b32 s41, s2, 3
    s_and_b32 s42, s40, 1
    s_lshl_b32 s42, s42, 2
    s_and_b32 s43, s41, 3
    s_add_u32 s42, s42, s43
    s_lshr_b32 s43, s40, 1
    s_lshr_b32 s44, s41, 2
    s_cmp_eq_u32 s43, 3
    s_movk_i32 s23, 6144
    s_cselect_b32 s23, 2048, s23
    s_cselect_b32 s45, 0, s43
    s_lshl_b32 s58, s45, 11
    s_lshl_b32 s45, s44, 8
    s_add_u32 s45, s45, s58
    s_lshl_b32 s46, s42, 8
    s_lshl_b32 s47, s42, 3
    s_add_u32 s47, s47, s44
    v_lshlrev_b32 v18, 1, v3
    v_xor_b32 v17, v2, v18
    s_and_b32 s33, s20, 1
    s_lshl_b32 s33, s33, 3
    v_xor_b32 v17, s33, v17
    v_mov_b32 v18, v17
    s_lshl_b32 s33, s20, 3
    v_add_u32 v16, s33, v3
    v_mul_lo_u32 v16, v16, s23
    v_add_u32 v16, s45, v16
    v_lshl_add_u32 v8, v17, 4, v16
    s_lshl_b32 s33, s23, 2
    s_sub_u32 s33, s33, 1024
    v_lshl_add_u32 v18, v18, 4, v16
    v_add_u32 v9, s33, v18
    s_lshl_b32 s31, s23, 6
    s_lshl_b32 s29, s20, 12
    s_lshl_b32 s30, s20, 11
    s_add_u32 s30, s30, 32768
    s_mov_b32 s24, 0
    s_mov_b32 s25, 0
    v_lshrrev_b32 v16, 3, v1
    s_lshl_b32 s33, s20, 5
    s_add_u32 s33, s33, s46
    v_add_u32 v16, s33, v16
    v_lshlrev_b32 v16, 11, v16
    v_and_b32 v17, 7, v1
    v_xor_b32 v17, v17, v3
    v_xor_b32 v18, 4, v17
    v_lshl_add_u32 v17, v17, 4, v16
    v_lshl_add_u32 v18, v18, 4, v16
    v_add_u32 v4, 4096, v17
    v_add_u32 v5, 19456, v18
    v_add_u32 v6, 34816, v17
    v_add_u32 v7, 50176, v18
    v_bfe_u32 v17, v1, 2, 2
    v_lshl_add_u32 v18, v3, 3, v17
    v_and_b32 v19, 1, v3
    v_lshl_add_u32 v19, v19, 2, v17
    s_lshl_b32 s33, s22, 2
    v_xor_b32 v19, s33, v19
    v_lshlrev_b32 v18, 8, v18
    v_lshl_add_u32 v18, v19, 5, v18
    v_and_b32 v20, 3, v1
    v_lshl_add_u32 v18, v20, 3, v18
    v_add_u32 v12, 32768, v18
    v_xor_b32 v13, 32, v12
    v_xor_b32 v14, 64, v12
    v_xor_b32 v15, 96, v12
    s_lshl_b32 s33, s21, 6
    v_add_u32 v16, s33, v2
    v_lshlrev_b32 v16, 7, v16
    v_lshrrev_b32 v17, 1, v2
    v_xor_b32 v17, v17, v3
    v_lshl_add_u32 v10, v17, 4, v16
    v_xor_b32 v11, 64, v10
    s_mov_b32 s26, 0
    s_waitcnt lgkmcnt(0)
    s_sub_u32 s8, s4, 4096
    s_subb_u32 s9, s5, 0
    s_mov_b32 s10, 4198400
    s_mov_b32 s11, 0x00020000
    s_cmp_eq_u32 s43, 3
    s_cselect_b32 s12, s36, s6
    s_cselect_b32 s13, s37, s7
    s_mov_b32 s14, 6291456
    s_cselect_b32 s14, 2097152, s14
    s_mov_b32 s15, 0x00020000
    s_add_u32 m0, s26, s30
    s_nop 0
    buffer_load_dwordx4 v8, s[12:15], s25 offen offset:0 lds
    buffer_load_dwordx4 v9, s[12:15], s25 offen offset:1024 lds
    s_add_u32 m0, s26, s29
    s_nop 0
    buffer_load_dwordx4 v4, s[8:11], s24 offen offset:0 lds
    buffer_load_dwordx4 v5, s[8:11], s24 offen offset:1024 lds
    buffer_load_dwordx4 v6, s[8:11], s24 offen offset:2048 lds
    buffer_load_dwordx4 v7, s[8:11], s24 offen offset:3072 lds
    s_add_u32 s24, s24, 128
    s_add_u32 s25, s25, s31
    s_add_u32 s26, s26, 49152
    s_add_u32 m0, s26, s30
    s_nop 0
    buffer_load_dwordx4 v8, s[12:15], s25 offen offset:0 lds
    buffer_load_dwordx4 v9, s[12:15], s25 offen offset:1024 lds
    s_add_u32 m0, s26, s29
    s_nop 0
    buffer_load_dwordx4 v4, s[8:11], s24 offen offset:0 lds
    buffer_load_dwordx4 v5, s[8:11], s24 offen offset:1024 lds
    buffer_load_dwordx4 v6, s[8:11], s24 offen offset:2048 lds
    buffer_load_dwordx4 v7, s[8:11], s24 offen offset:3072 lds
    s_add_u32 s24, s24, 128
    s_add_u32 s25, s25, s31
    s_add_u32 s26, s26, 49152
    s_mov_b32 s16, s62
    s_mov_b32 s17, s63
    s_mov_b32 s18, 58720256
    s_mov_b32 s19, 0x00020000
    s_mov_b32 s64, s60
    s_mov_b32 s65, s61
    s_mov_b32 s66, 256
    s_mov_b32 s67, 0x00020000
    s_cmp_lg_u32 s20, 7
    s_cbranch_scc1 L_k1_nozero
    s_lshl_b32 s48, s2, 8
    s_add_u32 s48, s48, 42860544
    v_lshlrev_b32 v16, 2, v1
    v_mov_b32 v17, 0
    buffer_store_dword v17, v16, s[16:19], s48 offen sc1
L_k1_nozero:
    s_cmp_eq_u32 s43, 1
    s_cbranch_scc1 L_k1_p1S
    s_cmp_eq_u32 s43, 2
    s_cbranch_scc1 L_k1_p2S
    s_cmp_eq_u32 s43, 3
    s_cbranch_scc1 L_k1_p3S
    s_mov_b32 s68, s36
    s_mov_b32 s69, s37
    s_mov_b32 s70, 2097152
    s_mov_b32 s71, 0x00020000
    s_lshl_b32 s48, s42, 7
    s_lshl_b32 s49, s20, 4
    s_add_u32 s48, s48, s49
    s_lshl_b32 s48, s48, 11
    s_lshl_b32 s49, s44, 8
    s_add_u32 s48, s48, s49
    v_lshlrev_b32 v16, 11, v3
    v_lshl_add_u32 v16, v2, 4, v16
    buffer_load_dwordx4 v[192:195], v16, s[68:71], s48 offen
    s_add_u32 s48, s48, 8192
    buffer_load_dwordx4 v[196:199], v16, s[68:71], s48 offen
    s_add_u32 s48, s48, 8192
    buffer_load_dwordx4 v[200:203], v16, s[68:71], s48 offen
    s_add_u32 s48, s48, 8192
    buffer_load_dwordx4 v[204:207], v16, s[68:71], s48 offen
    s_mov_b32 s32, 4294868992
    s_mov_b32 s33, 49152
    s_waitcnt vmcnt(10)
    s_barrier
    ds_read_b128 v[128:131], v10 offset:0
    ds_read_b64_tr_b16 v[32:33], v12 offset:0
    ds_read_b64_tr_b16 v[34:35], v12 offset:1024
    ds_read_b128 v[132:135], v11 offset:0
    ds_read_b64_tr_b16 v[36:37], v12 offset:8192
    ds_read_b64_tr_b16 v[38:39], v12 offset:9216
    ds_read_b128 v[136:139], v10 offset:2048
    ds_read_b128 v[140:143], v11 offset:2048
    ds_read_b128 v[144:147], v10 offset:4096
    ds_read_b128 v[148:151], v11 offset:4096
    ds_read_b128 v[152:155], v10 offset:6144
    ds_read_b128 v[156:159], v11 offset:6144
    s_add_u32 m0, s26, s30
    s_nop 0
    buffer_load_dwordx4 v8, s[12:15], s25 offen offset:0 lds
    buffer_load_dwordx4 v9, s[12:15], s25 offen offset:1024 lds
    s_add_u32 m0, s26, s29
    s_nop 0
    buffer_load_dwordx4 v4, s[8:11], s24 offen offset:0 lds
    buffer_load_dwordx4 v5, s[8:11], s24 offen offset:1024 lds
    buffer_load_dwordx4 v6, s[8:11], s24 offen offset:2048 lds
    buffer_load_dwordx4 v7, s[8:11], s24 offen offset:3072 lds
    s_add_u32 s24, s24, 128
    s_add_u32 s25, s25, s31
    s_waitcnt lgkmcnt(9)
    v_mfma_f32_16x16x32_bf16 v[64:67], v[32:35], v[128:131], 0
    ds_read_b64_tr_b16 v[40:41], v13 offset:0
    s_waitcnt lgkmcnt(7)
    v_mfma_f32_16x16x32_bf16 v[64:67], v[36:39], v[132:135], v[64:67]
    ds_read_b64_tr_b16 v[42:43], v13 offset:1024
    s_waitcnt lgkmcnt(7)
    v_mfma_f32_16x16x32_bf16 v[68:71], v[32:35], v[136:139], 0
    ds_read_b64_tr_b16 v[44:45], v13 offset:8192
    s_waitcnt lgkmcnt(7)
    v_mfma_f32_16x16x32_bf16 v[68:71], v[36:39], v[140:143], v[68:71]
    ds_read_b64_tr_b16 v[46:47], v13 offset:9216
    s_waitcnt lgkmcnt(7)
    v_mfma_f32_16x16x32_bf16 v[72:75], v[32:35], v[144:147], 0
    ds_read_b64_tr_b16 v[48:49], v14 offset:0
    s_waitcnt lgkmcnt(7)
    v_mfma_f32_16x16x32_bf16 v[72:75], v[36:39], v[148:151], v[72:75]
    ds_read_b64_tr_b16 v[50:51], v14 offset:1024
    s_waitcnt lgkmcnt(7)
    v_mfma_f32_16x16x32_bf16 v[76:79], v[32:35], v[152:155], 0
    ds_read_b64_tr_b16 v[52:53], v14 offset:8192
    s_waitcnt lgkmcnt(7)
    v_mfma_f32_16x16x32_bf16 v[76:79], v[36:39], v[156:159], v[76:79]
    ds_read_b64_tr_b16 v[54:55], v14 offset:9216
    s_waitcnt lgkmcnt(6)
    v_mfma_f32_16x16x32_bf16 v[80:83], v[40:43], v[128:131], 0
    ds_read_b64_tr_b16 v[56:57], v15 offset:0
    s_waitcnt lgkmcnt(5)
    v_mfma_f32_16x16x32_bf16 v[80:83], v[44:47], v[132:135], v[80:83]
    ds_read_b64_tr_b16 v[58:59], v15 offset:1024
    v_mfma_f32_16x16x32_bf16 v[84:87], v[40:43], v[136:139], 0
    ds_read_b64_tr_b16 v[60:61], v15 offset:8192
    v_mfma_f32_16x16x32_bf16 v[84:87], v[44:47], v[140:143], v[84:87]
    ds_read_b64_tr_b16 v[62:63], v15 offset:9216
    v_mfma_f32_16x16x32_bf16 v[88:91], v[40:43], v[144:147], 0
    s_add_u32 s26, s26, 49152
    s_cmp_eq_u32 s26, 147456
    s_cselect_b32 s26, 0, s26
    s_cmp_eq_u32 s26, 98304
    s_cselect_b32 s27, s32, s33
    v_mfma_f32_16x16x32_bf16 v[88:91], v[44:47], v[148:151], v[88:91]
    v_add_u32 v10, s27, v10
    v_add_u32 v11, s27, v11
    v_add_u32 v12, s27, v12
    v_mfma_f32_16x16x32_bf16 v[92:95], v[40:43], v[152:155], 0
    v_add_u32 v13, s27, v13
    v_add_u32 v14, s27, v14
    v_add_u32 v15, s27, v15
    v_mfma_f32_16x16x32_bf16 v[92:95], v[44:47], v[156:159], v[92:95]
    s_waitcnt vmcnt(10) lgkmcnt(0)
    s_barrier
    s_add_u32 m0, s26, s30
    v_mfma_f32_16x16x32_bf16 v[96:99], v[48:51], v[128:131], 0
    ds_read_b128 v[160:163], v10 offset:0
    buffer_load_dwordx4 v8, s[12:15], s25 offen offset:0 lds
    v_mfma_f32_16x16x32_bf16 v[96:99], v[52:55], v[132:135], v[96:99]
    ds_read_b64_tr_b16 v[32:33], v12 offset:0
    v_mfma_f32_16x16x32_bf16 v[100:103], v[48:51], v[136:139], 0
    ds_read_b64_tr_b16 v[34:35], v12 offset:1024
    v_mfma_f32_16x16x32_bf16 v[100:103], v[52:55], v[140:143], v[100:103]
    ds_read_b128 v[164:167], v11 offset:0
    v_mfma_f32_16x16x32_bf16 v[104:107], v[48:51], v[144:147], 0
    ds_read_b64_tr_b16 v[36:37], v12 offset:8192
    buffer_load_dwordx4 v9, s[12:15], s25 offen offset:1024 lds
    v_mfma_f32_16x16x32_bf16 v[104:107], v[52:55], v[148:151], v[104:107]
    ds_read_b64_tr_b16 v[38:39], v12 offset:9216
    v_mfma_f32_16x16x32_bf16 v[108:111], v[48:51], v[152:155], 0
    ds_read_b128 v[168:171], v10 offset:2048
    v_mfma_f32_16x16x32_bf16 v[108:111], v[52:55], v[156:159], v[108:111]
    ds_read_b128 v[172:175], v11 offset:2048
    v_mfma_f32_16x16x32_bf16 v[112:115], v[56:59], v[128:131], 0
    ds_read_b128 v[176:179], v10 offset:4096
    s_add_u32 m0, s26, s29
    v_mfma_f32_16x16x32_bf16 v[112:115], v[60:63], v[132:135], v[112:115]
    ds_read_b128 v[180:183], v11 offset:4096
    buffer_load_dwordx4 v4, s[8:11], s24 offen offset:0 lds
    v_mfma_f32_16x16x32_bf16 v[116:119], v[56:59], v[136:139], 0
    ds_read_b128 v[184:187], v10 offset:6144
    v_mfma_f32_16x16x32_bf16 v[116:119], v[60:63], v[140:143], v[116:119]
    ds_read_b128 v[188:191], v11 offset:6144
    v_mfma_f32_16x16x32_bf16 v[120:123], v[56:59], v[144:147], 0
    ds_read_b64_tr_b16 v[40:41], v13 offset:0
    v_mfma_f32_16x16x32_bf16 v[120:123], v[60:63], v[148:151], v[120:123]
    ds_read_b64_tr_b16 v[42:43], v13 offset:1024
    v_mfma_f32_16x16x32_bf16 v[124:127], v[56:59], v[152:155], 0
    ds_read_b64_tr_b16 v[44:45], v13 offset:8192
    buffer_load_dwordx4 v5, s[8:11], s24 offen offset:1024 lds
    v_mfma_f32_16x16x32_bf16 v[124:127], v[60:63], v[156:159], v[124:127]
    ds_read_b64_tr_b16 v[46:47], v13 offset:9216
    s_waitcnt lgkmcnt(13)
    v_mfma_f32_16x16x32_bf16 v[64:67], v[32:35], v[160:163], v[64:67]
    ds_read_b64_tr_b16 v[48:49], v14 offset:0
    s_waitcnt lgkmcnt(11)
    v_mfma_f32_16x16x32_bf16 v[64:67], v[36:39], v[164:167], v[64:67]
    ds_read_b64_tr_b16 v[50:51], v14 offset:1024
    s_waitcnt lgkmcnt(11)
    v_mfma_f32_16x16x32_bf16 v[68:71], v[32:35], v[168:171], v[68:71]
    ds_read_b64_tr_b16 v[52:53], v14 offset:8192
    s_waitcnt lgkmcnt(11)
    v_mfma_f32_16x16x32_bf16 v[68:71], v[36:39], v[172:175], v[68:71]
    ds_read_b64_tr_b16 v[54:55], v14 offset:9216
    s_waitcnt lgkmcnt(11)
    v_mfma_f32_16x16x32_bf16 v[72:75], v[32:35], v[176:179], v[72:75]
    ds_read_b64_tr_b16 v[56:57], v15 offset:0
    buffer_load_dwordx4 v6, s[8:11], s24 offen offset:2048 lds
    s_waitcnt lgkmcnt(11)
    v_mfma_f32_16x16x32_bf16 v[72:75], v[36:39], v[180:183], v[72:75]
    ds_read_b64_tr_b16 v[58:59], v15 offset:1024
    s_waitcnt lgkmcnt(11)
    v_mfma_f32_16x16x32_bf16 v[76:79], v[32:35], v[184:187], v[76:79]
    ds_read_b64_tr_b16 v[60:61], v15 offset:8192
    s_waitcnt lgkmcnt(11)
    v_mfma_f32_16x16x32_bf16 v[76:79], v[36:39], v[188:191], v[76:79]
    ds_read_b64_tr_b16 v[62:63], v15 offset:9216
    s_waitcnt lgkmcnt(10)
    v_mfma_f32_16x16x32_bf16 v[80:83], v[40:43], v[160:163], v[80:83]
    s_waitcnt lgkmcnt(8)
    v_mfma_f32_16x16x32_bf16 v[80:83], v[44:47], v[164:167], v[80:83]
    v_mfma_f32_16x16x32_bf16 v[84:87], v[40:43], v[168:171], v[84:87]
    buffer_load_dwordx4 v7, s[8:11], s24 offen offset:3072 lds
    v_mfma_f32_16x16x32_bf16 v[84:87], v[44:47], v[172:175], v[84:87]
    s_add_u32 s24, s24, 128
    s_add_u32 s25, s25, s31
    v_mfma_f32_16x16x32_bf16 v[88:91], v[40:43], v[176:179], v[88:91]
    s_add_u32 s26, s26, 49152
    s_cmp_eq_u32 s26, 147456
    s_cselect_b32 s26, 0, s26
    s_cmp_eq_u32 s26, 98304
    s_cselect_b32 s27, s32, s33
    v_mfma_f32_16x16x32_bf16 v[88:91], v[44:47], v[180:183], v[88:91]
    v_add_u32 v10, s27, v10
    v_add_u32 v11, s27, v11
    v_add_u32 v12, s27, v12
    v_mfma_f32_16x16x32_bf16 v[92:95], v[40:43], v[184:187], v[92:95]
    v_add_u32 v13, s27, v13
    v_add_u32 v14, s27, v14
    v_add_u32 v15, s27, v15
    v_mfma_f32_16x16x32_bf16 v[92:95], v[44:47], v[188:191], v[92:95]
    s_waitcnt vmcnt(6) lgkmcnt(0)
    s_barrier
    s_add_u32 m0, s26, s30
    v_mfma_f32_16x16x32_bf16 v[96:99], v[48:51], v[160:163], v[96:99]
    ds_read_b128 v[128:131], v10 offset:0
    buffer_load_dwordx4 v8, s[12:15], s25 offen offset:0 lds
    v_lshlrev_b32 v208, 16, v192
    v_and_b32 v209, 0xffff0000, v192
    v_mfma_f32_16x16x32_bf16 v[96:99], v[52:55], v[164:167], v[96:99]
    ds_read_b64_tr_b16 v[32:33], v12 offset:0
    v_lshlrev_b32 v210, 16, v193
    v_and_b32 v211, 0xffff0000, v193
    v_mfma_f32_16x16x32_bf16 v[100:103], v[48:51], v[168:171], v[100:103]
    ds_read_b64_tr_b16 v[34:35], v12 offset:1024
    v_lshlrev_b32 v212, 16, v194
    v_and_b32 v213, 0xffff0000, v194
    v_lshlrev_b32 v214, 16, v195
    v_mfma_f32_16x16x32_bf16 v[100:103], v[52:55], v[172:175], v[100:103]
    ds_read_b128 v[132:135], v11 offset:0
    v_and_b32 v215, 0xffff0000, v195
    v_lshlrev_b32 v216, 16, v196
    v_mfma_f32_16x16x32_bf16 v[104:107], v[48:51], v[176:179], v[104:107]
    ds_read_b64_tr_b16 v[36:37], v12 offset:8192
    buffer_load_dwordx4 v9, s[12:15], s25 offen offset:1024 lds
    v_and_b32 v217, 0xffff0000, v196
    v_add_f32 v208, v208, v216
    v_mfma_f32_16x16x32_bf16 v[104:107], v[52:55], v[180:183], v[104:107]
    ds_read_b64_tr_b16 v[38:39], v12 offset:9216
    v_add_f32 v209, v209, v217
    v_lshlrev_b32 v216, 16, v197
    v_and_b32 v217, 0xffff0000, v197
    v_mfma_f32_16x16x32_bf16 v[108:111], v[48:51], v[184:187], v[108:111]
    ds_read_b128 v[136:139], v10 offset:2048
    v_add_f32 v210, v210, v216
    v_add_f32 v211, v211, v217
    v_mfma_f32_16x16x32_bf16 v[108:111], v[52:55], v[188:191], v[108:111]
    ds_read_b128 v[140:143], v11 offset:2048
    v_lshlrev_b32 v216, 16, v198
    v_and_b32 v217, 0xffff0000, v198
    v_mfma_f32_16x16x32_bf16 v[112:115], v[56:59], v[160:163], v[112:115]
    ds_read_b128 v[144:147], v10 offset:4096
    s_add_u32 m0, s26, s29
    v_add_f32 v212, v212, v216
    v_add_f32 v213, v213, v217
    v_lshlrev_b32 v216, 16, v199
    v_mfma_f32_16x16x32_bf16 v[112:115], v[60:63], v[164:167], v[112:115]
    ds_read_b128 v[148:151], v11 offset:4096
    buffer_load_dwordx4 v4, s[8:11], s24 offen offset:0 lds
    v_and_b32 v217, 0xffff0000, v199
    v_add_f32 v214, v214, v216
    v_mfma_f32_16x16x32_bf16 v[116:119], v[56:59], v[168:171], v[116:119]
    ds_read_b128 v[152:155], v10 offset:6144
    v_add_f32 v215, v215, v217
    v_lshlrev_b32 v216, 16, v200
    v_and_b32 v217, 0xffff0000, v200
    v_mfma_f32_16x16x32_bf16 v[116:119], v[60:63], v[172:175], v[116:119]
    ds_read_b128 v[156:159], v11 offset:6144
    v_add_f32 v208, v208, v216
    v_add_f32 v209, v209, v217
    v_mfma_f32_16x16x32_bf16 v[120:123], v[56:59], v[176:179], v[120:123]
    ds_read_b64_tr_b16 v[40:41], v13 offset:0
    v_lshlrev_b32 v216, 16, v201
    v_and_b32 v217, 0xffff0000, v201
    v_mfma_f32_16x16x32_bf16 v[120:123], v[60:63], v[180:183], v[120:123]
    ds_read_b64_tr_b16 v[42:43], v13 offset:1024
    v_add_f32 v210, v210, v216
    v_add_f32 v211, v211, v217
    v_lshlrev_b32 v216, 16, v202
    v_mfma_f32_16x16x32_bf16 v[124:127], v[56:59], v[184:187], v[124:127]
    ds_read_b64_tr_b16 v[44:45], v13 offset:8192
    buffer_load_dwordx4 v5, s[8:11], s24 offen offset:1024 lds
    v_and_b32 v217, 0xffff0000, v202
    v_add_f32 v212, v212, v216
    v_mfma_f32_16x16x32_bf16 v[124:127], v[60:63], v[188:191], v[124:127]
    ds_read_b64_tr_b16 v[46:47], v13 offset:9216
    v_add_f32 v213, v213, v217
    v_lshlrev_b32 v216, 16, v203
    s_waitcnt lgkmcnt(13)
    v_mfma_f32_16x16x32_bf16 v[64:67], v[32:35], v[128:131], v[64:67]
    ds_read_b64_tr_b16 v[48:49], v14 offset:0
    v_and_b32 v217, 0xffff0000, v203
    v_add_f32 v214, v214, v216
    v_add_f32 v215, v215, v217
    s_waitcnt lgkmcnt(11)
    v_mfma_f32_16x16x32_bf16 v[64:67], v[36:39], v[132:135], v[64:67]
    ds_read_b64_tr_b16 v[50:51], v14 offset:1024
    v_lshlrev_b32 v216, 16, v204
    v_and_b32 v217, 0xffff0000, v204
    s_waitcnt lgkmcnt(11)
    v_mfma_f32_16x16x32_bf16 v[68:71], v[32:35], v[136:139], v[68:71]
    ds_read_b64_tr_b16 v[52:53], v14 offset:8192
    v_add_f32 v208, v208, v216
    v_add_f32 v209, v209, v217
    v_lshlrev_b32 v216, 16, v205
    s_waitcnt lgkmcnt(11)
    v_mfma_f32_16x16x32_bf16 v[68:71], v[36:39], v[140:143], v[68:71]
    ds_read_b64_tr_b16 v[54:55], v14 offset:9216
    v_and_b32 v217, 0xffff0000, v205
    v_add_f32 v210, v210, v216
    s_waitcnt lgkmcnt(11)
    v_mfma_f32_16x16x32_bf16 v[72:75], v[32:35], v[144:147], v[72:75]
    ds_read_b64_tr_b16 v[56:57], v15 offset:0
    buffer_load_dwordx4 v6, s[8:11], s24 offen offset:2048 lds
    v_add_f32 v211, v211, v217
    v_lshlrev_b32 v216, 16, v206
    s_waitcnt lgkmcnt(11)
    v_mfma_f32_16x16x32_bf16 v[72:75], v[36:39], v[148:151], v[72:75]
    ds_read_b64_tr_b16 v[58:59], v15 offset:1024
    v_and_b32 v217, 0xffff0000, v206
    v_add_f32 v212, v212, v216
    v_add_f32 v213, v213, v217
    s_waitcnt lgkmcnt(11)
    v_mfma_f32_16x16x32_bf16 v[76:79], v[32:35], v[152:155], v[76:79]
    ds_read_b64_tr_b16 v[60:61], v15 offset:8192
    v_lshlrev_b32 v216, 16, v207
    v_and_b32 v217, 0xffff0000, v207
    s_waitcnt lgkmcnt(11)
    v_mfma_f32_16x16x32_bf16 v[76:79], v[36:39], v[156:159], v[76:79]
    ds_read_b64_tr_b16 v[62:63], v15 offset:9216
    v_add_f32 v214, v214, v216
    v_add_f32 v215, v215, v217
    s_waitcnt lgkmcnt(10)
    v_mfma_f32_16x16x32_bf16 v[80:83], v[40:43], v[128:131], v[80:83]
    s_lshl_b32 s48, s20, 11
    s_add_u32 s48, s48, 147456
    v_lshlrev_b32 v16, 9, v3
    s_waitcnt lgkmcnt(8)
    v_mfma_f32_16x16x32_bf16 v[80:83], v[44:47], v[132:135], v[80:83]
    v_lshl_add_u32 v16, v2, 5, v16
    v_add_u32 v16, s48, v16
    v_mfma_f32_16x16x32_bf16 v[84:87], v[40:43], v[136:139], v[84:87]
    buffer_load_dwordx4 v7, s[8:11], s24 offen offset:3072 lds
    ds_write_b128 v16, v[208:211]
    ds_write_b128 v16, v[212:215] offset:16
    v_mfma_f32_16x16x32_bf16 v[84:87], v[44:47], v[140:143], v[84:87]
    s_add_u32 s24, s24, 128
    s_add_u32 s25, s25, s31
    v_mfma_f32_16x16x32_bf16 v[88:91], v[40:43], v[144:147], v[88:91]
    s_add_u32 s26, s26, 49152
    s_cmp_eq_u32 s26, 147456
    s_cselect_b32 s26, 0, s26
    s_cmp_eq_u32 s26, 98304
    s_cselect_b32 s27, s32, s33
    v_mfma_f32_16x16x32_bf16 v[88:91], v[44:47], v[148:151], v[88:91]
    v_add_u32 v10, s27, v10
    v_add_u32 v11, s27, v11
    v_add_u32 v12, s27, v12
    v_mfma_f32_16x16x32_bf16 v[92:95], v[40:43], v[152:155], v[92:95]
    v_add_u32 v13, s27, v13
    v_add_u32 v14, s27, v14
    v_add_u32 v15, s27, v15
    v_mfma_f32_16x16x32_bf16 v[92:95], v[44:47], v[156:159], v[92:95]
    s_waitcnt vmcnt(6) lgkmcnt(0)
    s_barrier
    s_add_u32 m0, s26, s30
    v_mfma_f32_16x16x32_bf16 v[96:99], v[48:51], v[128:131], v[96:99]
    ds_read_b128 v[160:163], v10 offset:0
    buffer_load_dwordx4 v8, s[12:15], s25 offen offset:0 lds
    v_and_b32 v16, 127, v0
    v_lshrrev_b32 v17, 7, v0
    v_mfma_f32_16x16x32_bf16 v[96:99], v[52:55], v[132:135], v[96:99]
    ds_read_b64_tr_b16 v[32:33], v12 offset:0
    v_lshlrev_b32 v18, 12, v17
    v_mfma_f32_16x16x32_bf16 v[100:103], v[48:51], v[136:139], v[100:103]
    ds_read_b64_tr_b16 v[34:35], v12 offset:1024
    v_lshl_add_u32 v18, v16, 2, v18
    v_mfma_f32_16x16x32_bf16 v[100:103], v[52:55], v[140:143], v[100:103]
    ds_read_b128 v[164:167], v11 offset:0
    v_add_u32 v19, 147456, v18
    v_mfma_f32_16x16x32_bf16 v[104:107], v[48:51], v[144:147], v[104:107]
    ds_read_b64_tr_b16 v[36:37], v12 offset:8192
    buffer_load_dwordx4 v9, s[12:15], s25 offen offset:1024 lds
    ds_read_b32 v192, v19 offset:0
    v_mfma_f32_16x16x32_bf16 v[104:107], v[52:55], v[148:151], v[104:107]
    ds_read_b64_tr_b16 v[38:39], v12 offset:9216
    ds_read_b32 v193, v19 offset:512
    v_mfma_f32_16x16x32_bf16 v[108:111], v[48:51], v[152:155], v[108:111]
    ds_read_b128 v[168:171], v10 offset:2048
    ds_read_b32 v194, v19 offset:1024
    v_mfma_f32_16x16x32_bf16 v[108:111], v[52:55], v[156:159], v[108:111]
    ds_read_b128 v[172:175], v11 offset:2048
    ds_read_b32 v195, v19 offset:1536
    v_mfma_f32_16x16x32_bf16 v[112:115], v[56:59], v[128:131], v[112:115]
    ds_read_b128 v[176:179], v10 offset:4096
    s_add_u32 m0, s26, s29
    ds_read_b32 v196, v19 offset:2048
    v_mfma_f32_16x16x32_bf16 v[112:115], v[60:63], v[132:135], v[112:115]
    ds_read_b128 v[180:183], v11 offset:4096
    buffer_load_dwordx4 v4, s[8:11], s24 offen offset:0 lds
    ds_read_b32 v197, v19 offset:2560
    ds_read_b32 v198, v19 offset:3072
    v_mfma_f32_16x16x32_bf16 v[116:119], v[56:59], v[136:139], v[116:119]
    ds_read_b128 v[184:187], v10 offset:6144
    ds_read_b32 v199, v19 offset:3584
    v_mfma_f32_16x16x32_bf16 v[116:119], v[60:63], v[140:143], v[116:119]
    ds_read_b128 v[188:191], v11 offset:6144
    s_lshl_b32 s48, s42, 14
    v_mfma_f32_16x16x32_bf16 v[120:123], v[56:59], v[144:147], v[120:123]
    ds_read_b64_tr_b16 v[40:41], v13 offset:0
    s_lshl_b32 s49, s44, 9
    v_mfma_f32_16x16x32_bf16 v[120:123], v[60:63], v[148:151], v[120:123]
    ds_read_b64_tr_b16 v[42:43], v13 offset:1024
    s_add_u32 s48, s48, s49
    v_mfma_f32_16x16x32_bf16 v[124:127], v[56:59], v[152:155], v[124:127]
    ds_read_b64_tr_b16 v[44:45], v13 offset:8192
    buffer_load_dwordx4 v5, s[8:11], s24 offen offset:1024 lds
    s_add_u32 s48, s48, 42663936
    v_mfma_f32_16x16x32_bf16 v[124:127], v[60:63], v[156:159], v[124:127]
    ds_read_b64_tr_b16 v[46:47], v13 offset:9216
    s_nop 0
    s_waitcnt lgkmcnt(15)
    v_mfma_f32_16x16x32_bf16 v[64:67], v[32:35], v[160:163], v[64:67]
    ds_read_b64_tr_b16 v[48:49], v14 offset:0
    s_nop 0
    v_mfma_f32_16x16x32_bf16 v[64:67], v[36:39], v[164:167], v[64:67]
    ds_read_b64_tr_b16 v[50:51], v14 offset:1024
    s_nop 0
    v_mfma_f32_16x16x32_bf16 v[68:71], v[32:35], v[168:171], v[68:71]
    ds_read_b64_tr_b16 v[52:53], v14 offset:8192
    s_nop 0
    s_waitcnt lgkmcnt(8)
    v_mfma_f32_16x16x32_bf16 v[68:71], v[36:39], v[172:175], v[68:71]
    ds_read_b64_tr_b16 v[54:55], v14 offset:9216
    v_add_f32 v192, v192, v193
    v_mfma_f32_16x16x32_bf16 v[72:75], v[32:35], v[176:179], v[72:75]
    ds_read_b64_tr_b16 v[56:57], v15 offset:0
    buffer_load_dwordx4 v6, s[8:11], s24 offen offset:2048 lds
    v_add_f32 v192, v192, v194
    v_mfma_f32_16x16x32_bf16 v[72:75], v[36:39], v[180:183], v[72:75]
    ds_read_b64_tr_b16 v[58:59], v15 offset:1024
    v_add_f32 v192, v192, v195
    v_mfma_f32_16x16x32_bf16 v[76:79], v[32:35], v[184:187], v[76:79]
    ds_read_b64_tr_b16 v[60:61], v15 offset:8192
    v_add_f32 v192, v192, v196
    s_waitcnt lgkmcnt(11)
    v_mfma_f32_16x16x32_bf16 v[76:79], v[36:39], v[188:191], v[76:79]
    ds_read_b64_tr_b16 v[62:63], v15 offset:9216
    v_add_f32 v192, v192, v197
    s_waitcnt lgkmcnt(10)
    v_mfma_f32_16x16x32_bf16 v[80:83], v[40:43], v[160:163], v[80:83]
    v_add_f32 v192, v192, v198
    s_waitcnt lgkmcnt(8)
    v_mfma_f32_16x16x32_bf16 v[80:83], v[44:47], v[164:167], v[80:83]
    v_add_f32 v192, v192, v199
    v_mfma_f32_16x16x32_bf16 v[84:87], v[40:43], v[168:171], v[84:87]
    buffer_load_dwordx4 v7, s[8:11], s24 offen offset:3072 lds
    buffer_store_dword v192, v18, s[16:19], s48 offen sc1
    v_mfma_f32_16x16x32_bf16 v[84:87], v[44:47], v[172:175], v[84:87]
    s_add_u32 s24, s24, 128
    s_add_u32 s25, s25, s31
    v_mfma_f32_16x16x32_bf16 v[88:91], v[40:43], v[176:179], v[88:91]
    s_add_u32 s26, s26, 49152
    s_cmp_eq_u32 s26, 147456
    s_cselect_b32 s26, 0, s26
    s_cmp_eq_u32 s26, 98304
    s_cselect_b32 s27, s32, s33
    v_mfma_f32_16x16x32_bf16 v[88:91], v[44:47], v[180:183], v[88:91]
    v_add_u32 v10, s27, v10
    v_add_u32 v11, s27, v11
    v_add_u32 v12, s27, v12
    v_mfma_f32_16x16x32_bf16 v[92:95], v[40:43], v[184:187], v[92:95]
    v_add_u32 v13, s27, v13
    v_add_u32 v14, s27, v14
    v_add_u32 v15, s27, v15
    v_mfma_f32_16x16x32_bf16 v[92:95], v[44:47], v[188:191], v[92:95]
    s_waitcnt vmcnt(7) lgkmcnt(0)
    s_barrier
    s_add_u32 m0, s26, s30
    v_mfma_f32_16x16x32_bf16 v[96:99], v[48:51], v[160:163], v[96:99]
    ds_read_b128 v[128:131], v10 offset:0
    buffer_load_dwordx4 v8, s[12:15], s25 offen offset:0 lds
    v_mfma_f32_16x16x32_bf16 v[96:99], v[52:55], v[164:167], v[96:99]
    ds_read_b64_tr_b16 v[32:33], v12 offset:0
    v_mfma_f32_16x16x32_bf16 v[100:103], v[48:51], v[168:171], v[100:103]
    ds_read_b64_tr_b16 v[34:35], v12 offset:1024
    v_mfma_f32_16x16x32_bf16 v[100:103], v[52:55], v[172:175], v[100:103]
    ds_read_b128 v[132:135], v11 offset:0
    v_mfma_f32_16x16x32_bf16 v[104:107], v[48:51], v[176:179], v[104:107]
    ds_read_b64_tr_b16 v[36:37], v12 offset:8192
    buffer_load_dwordx4 v9, s[12:15], s25 offen offset:1024 lds
    v_mfma_f32_16x16x32_bf16 v[104:107], v[52:55], v[180:183], v[104:107]
    ds_read_b64_tr_b16 v[38:39], v12 offset:9216
    v_mfma_f32_16x16x32_bf16 v[108:111], v[48:51], v[184:187], v[108:111]
    ds_read_b128 v[136:139], v10 offset:2048
    v_mfma_f32_16x16x32_bf16 v[108:111], v[52:55], v[188:191], v[108:111]
    ds_read_b128 v[140:143], v11 offset:2048
    v_mfma_f32_16x16x32_bf16 v[112:115], v[56:59], v[160:163], v[112:115]
    ds_read_b128 v[144:147], v10 offset:4096
    s_add_u32 m0, s26, s29
    v_mfma_f32_16x16x32_bf16 v[112:115], v[60:63], v[164:167], v[112:115]
    ds_read_b128 v[148:151], v11 offset:4096
    buffer_load_dwordx4 v4, s[8:11], s24 offen offset:0 lds
    v_mfma_f32_16x16x32_bf16 v[116:119], v[56:59], v[168:171], v[116:119]
    ds_read_b128 v[152:155], v10 offset:6144
    v_mfma_f32_16x16x32_bf16 v[116:119], v[60:63], v[172:175], v[116:119]
    ds_read_b128 v[156:159], v11 offset:6144
    v_mfma_f32_16x16x32_bf16 v[120:123], v[56:59], v[176:179], v[120:123]
    ds_read_b64_tr_b16 v[40:41], v13 offset:0
    v_mfma_f32_16x16x32_bf16 v[120:123], v[60:63], v[180:183], v[120:123]
    ds_read_b64_tr_b16 v[42:43], v13 offset:1024
    v_mfma_f32_16x16x32_bf16 v[124:127], v[56:59], v[184:187], v[124:127]
    ds_read_b64_tr_b16 v[44:45], v13 offset:8192
    buffer_load_dwordx4 v5, s[8:11], s24 offen offset:1024 lds
    v_mfma_f32_16x16x32_bf16 v[124:127], v[60:63], v[188:191], v[124:127]
    ds_read_b64_tr_b16 v[46:47], v13 offset:9216
    s_waitcnt lgkmcnt(13)
    v_mfma_f32_16x16x32_bf16 v[64:67], v[32:35], v[128:131], v[64:67]
    ds_read_b64_tr_b16 v[48:49], v14 offset:0
    s_waitcnt lgkmcnt(11)
    v_mfma_f32_16x16x32_bf16 v[64:67], v[36:39], v[132:135], v[64:67]
    ds_read_b64_tr_b16 v[50:51], v14 offset:1024
    s_waitcnt lgkmcnt(11)
    v_mfma_f32_16x16x32_bf16 v[68:71], v[32:35], v[136:139], v[68:71]
    ds_read_b64_tr_b16 v[52:53], v14 offset:8192
    s_waitcnt lgkmcnt(11)
    v_mfma_f32_16x16x32_bf16 v[68:71], v[36:39], v[140:143], v[68:71]
    ds_read_b64_tr_b16 v[54:55], v14 offset:9216
    s_waitcnt lgkmcnt(11)
    v_mfma_f32_16x16x32_bf16 v[72:75], v[32:35], v[144:147], v[72:75]
    ds_read_b64_tr_b16 v[56:57], v15 offset:0
    buffer_load_dwordx4 v6, s[8:11], s24 offen offset:2048 lds
    s_waitcnt lgkmcnt(11)
    v_mfma_f32_16x16x32_bf16 v[72:75], v[36:39], v[148:151], v[72:75]
    ds_read_b64_tr_b16 v[58:59], v15 offset:1024
    s_waitcnt lgkmcnt(11)
    v_mfma_f32_16x16x32_bf16 v[76:79], v[32:35], v[152:155], v[76:79]
    ds_read_b64_tr_b16 v[60:61], v15 offset:8192
    s_waitcnt lgkmcnt(11)
    v_mfma_f32_16x16x32_bf16 v[76:79], v[36:39], v[156:159], v[76:79]
    ds_read_b64_tr_b16 v[62:63], v15 offset:9216
    s_waitcnt lgkmcnt(10)
    v_mfma_f32_16x16x32_bf16 v[80:83], v[40:43], v[128:131], v[80:83]
    s_waitcnt lgkmcnt(8)
    v_mfma_f32_16x16x32_bf16 v[80:83], v[44:47], v[132:135], v[80:83]
    v_mfma_f32_16x16x32_bf16 v[84:87], v[40:43], v[136:139], v[84:87]
    buffer_load_dwordx4 v7, s[8:11], s24 offen offset:3072 lds
    v_mfma_f32_16x16x32_bf16 v[84:87], v[44:47], v[140:143], v[84:87]
    s_add_u32 s24, s24, 128
    s_add_u32 s25, s25, s31
    v_mfma_f32_16x16x32_bf16 v[88:91], v[40:43], v[144:147], v[88:91]
    s_add_u32 s26, s26, 49152
    s_cmp_eq_u32 s26, 147456
    s_cselect_b32 s26, 0, s26
    s_cmp_eq_u32 s26, 98304
    s_cselect_b32 s27, s32, s33
    v_mfma_f32_16x16x32_bf16 v[88:91], v[44:47], v[148:151], v[88:91]
    v_add_u32 v10, s27, v10
    v_add_u32 v11, s27, v11
    v_add_u32 v12, s27, v12
    v_mfma_f32_16x16x32_bf16 v[92:95], v[40:43], v[152:155], v[92:95]
    v_add_u32 v13, s27, v13
    v_add_u32 v14, s27, v14
    v_add_u32 v15, s27, v15
    v_mfma_f32_16x16x32_bf16 v[92:95], v[44:47], v[156:159], v[92:95]
    s_waitcnt vmcnt(7) lgkmcnt(0)
    s_barrier
    s_add_u32 m0, s26, s30
    v_mfma_f32_16x16x32_bf16 v[96:99], v[48:51], v[128:131], v[96:99]
    ds_read_b128 v[160:163], v10 offset:0
    buffer_load_dwordx4 v8, s[12:15], s25 offen offset:0 lds
    v_mfma_f32_16x16x32_bf16 v[96:99], v[52:55], v[132:135], v[96:99]
    ds_read_b64_tr_b16 v[32:33], v12 offset:0
    buffer_load_dwordx4 v9, s[12:15], s25 offen offset:1024 lds
    v_mfma_f32_16x16x32_bf16 v[100:103], v[48:51], v[136:139], v[100:103]
    ds_read_b64_tr_b16 v[34:35], v12 offset:1024
    v_mfma_f32_16x16x32_bf16 v[100:103], v[52:55], v[140:143], v[100:103]
    ds_read_b128 v[164:167], v11 offset:0
    s_add_u32 m0, s26, s29
    v_mfma_f32_16x16x32_bf16 v[104:107], v[48:51], v[144:147], v[104:107]
    ds_read_b64_tr_b16 v[36:37], v12 offset:8192
    buffer_load_dwordx4 v4, s[8:11], s24 offen offset:0 lds
    v_mfma_f32_16x16x32_bf16 v[104:107], v[52:55], v[148:151], v[104:107]
    ds_read_b64_tr_b16 v[38:39], v12 offset:9216
    buffer_load_dwordx4 v5, s[8:11], s24 offen offset:1024 lds
    v_mfma_f32_16x16x32_bf16 v[108:111], v[48:51], v[152:155], v[108:111]
    ds_read_b128 v[168:171], v10 offset:2048
    buffer_load_dwordx4 v6, s[8:11], s24 offen offset:2048 lds
    v_mfma_f32_16x16x32_bf16 v[108:111], v[52:55], v[156:159], v[108:111]
    ds_read_b128 v[172:175], v11 offset:2048
    v_mfma_f32_16x16x32_bf16 v[112:115], v[56:59], v[128:131], v[112:115]
    ds_read_b128 v[176:179], v10 offset:4096
    buffer_load_dwordx4 v7, s[8:11], s24 offen offset:3072 lds
    v_mfma_f32_16x16x32_bf16 v[112:115], v[60:63], v[132:135], v[112:115]
    ds_read_b128 v[180:183], v11 offset:4096
    s_add_u32 s24, s24, 128
    s_add_u32 s25, s25, s31
    v_mfma_f32_16x16x32_bf16 v[116:119], v[56:59], v[136:139], v[116:119]
    ds_read_b128 v[184:187], v10 offset:6144
    v_mfma_f32_16x16x32_bf16 v[116:119], v[60:63], v[140:143], v[116:119]
    ds_read_b128 v[188:191], v11 offset:6144
    v_mfma_f32_16x16x32_bf16 v[120:123], v[56:59], v[144:147], v[120:123]
    ds_read_b64_tr_b16 v[40:41], v13 offset:0
    v_mfma_f32_16x16x32_bf16 v[120:123], v[60:63], v[148:151], v[120:123]
    ds_read_b64_tr_b16 v[42:43], v13 offset:1024
    v_mfma_f32_16x16x32_bf16 v[124:127], v[56:59], v[152:155], v[124:127]
    ds_read_b64_tr_b16 v[44:45], v13 offset:8192
    v_mfma_f32_16x16x32_bf16 v[124:127], v[60:63], v[156:159], v[124:127]
    ds_read_b64_tr_b16 v[46:47], v13 offset:9216
    s_waitcnt lgkmcnt(13)
    v_mfma_f32_16x16x32_bf16 v[64:67], v[32:35], v[160:163], v[64:67]
    ds_read_b64_tr_b16 v[48:49], v14 offset:0
    s_waitcnt lgkmcnt(11)
    v_mfma_f32_16x16x32_bf16 v[64:67], v[36:39], v[164:167], v[64:67]
    ds_read_b64_tr_b16 v[50:51], v14 offset:1024
    s_waitcnt lgkmcnt(11)
    v_mfma_f32_16x16x32_bf16 v[68:71], v[32:35], v[168:171], v[68:71]
    ds_read_b64_tr_b16 v[52:53], v14 offset:8192
    s_waitcnt lgkmcnt(11)
    v_mfma_f32_16x16x32_bf16 v[68:71], v[36:39], v[172:175], v[68:71]
    ds_read_b64_tr_b16 v[54:55], v14 offset:9216
    s_waitcnt lgkmcnt(11)
    v_mfma_f32_16x16x32_bf16 v[72:75], v[32:35], v[176:179], v[72:75]
    ds_read_b64_tr_b16 v[56:57], v15 offset:0
    s_waitcnt lgkmcnt(11)
    v_mfma_f32_16x16x32_bf16 v[72:75], v[36:39], v[180:183], v[72:75]
    ds_read_b64_tr_b16 v[58:59], v15 offset:1024
    s_waitcnt lgkmcnt(11)
    v_mfma_f32_16x16x32_bf16 v[76:79], v[32:35], v[184:187], v[76:79]
    ds_read_b64_tr_b16 v[60:61], v15 offset:8192
    s_waitcnt lgkmcnt(11)
    v_mfma_f32_16x16x32_bf16 v[76:79], v[36:39], v[188:191], v[76:79]
    ds_read_b64_tr_b16 v[62:63], v15 offset:9216
    s_waitcnt lgkmcnt(10)
    v_mfma_f32_16x16x32_bf16 v[80:83], v[40:43], v[160:163], v[80:83]
    s_waitcnt lgkmcnt(8)
    v_mfma_f32_16x16x32_bf16 v[80:83], v[44:47], v[164:167], v[80:83]
    v_mfma_f32_16x16x32_bf16 v[84:87], v[40:43], v[168:171], v[84:87]
    v_mfma_f32_16x16x32_bf16 v[84:87], v[44:47], v[172:175], v[84:87]
    v_mfma_f32_16x16x32_bf16 v[88:91], v[40:43], v[176:179], v[88:91]
    s_add_u32 s26, s26, 49152
    s_cmp_eq_u32 s26, 147456
    s_cselect_b32 s26, 0, s26
    s_cmp_eq_u32 s26, 98304
    s_cselect_b32 s27, s32, s33
    v_mfma_f32_16x16x32_bf16 v[88:91], v[44:47], v[180:183], v[88:91]
    v_add_u32 v10, s27, v10
    v_add_u32 v11, s27, v11
    v_add_u32 v12, s27, v12
    v_mfma_f32_16x16x32_bf16 v[92:95], v[40:43], v[184:187], v[92:95]
    v_add_u32 v13, s27, v13
    v_add_u32 v14, s27, v14
    v_add_u32 v15, s27, v15
    v_mfma_f32_16x16x32_bf16 v[92:95], v[44:47], v[188:191], v[92:95]
    s_waitcnt vmcnt(0) lgkmcnt(0)
    s_barrier
    s_cmp_lg_u32 s20, 0
    s_cbranch_scc1 L_nosig_6001
    v_mov_b32 v16, 0
    v_mov_b32 v17, 1
    s_mov_b64 s[50:51], exec
    s_mov_b64 exec, 1
    buffer_atomic_add v17, v16, s[64:67], 0 offen
    s_mov_b64 exec, s[50:51]
L_nosig_6001:
    s_mov_b32 s28, 3
.p2align 6
L_loopk10S_6002:
    s_add_u32 m0, s26, s30
    v_mfma_f32_16x16x32_bf16 v[96:99], v[48:51], v[160:163], v[96:99]
    ds_read_b128 v[128:131], v10 offset:0
    buffer_load_dwordx4 v8, s[12:15], s25 offen offset:0 lds
    v_mfma_f32_16x16x32_bf16 v[96:99], v[52:55], v[164:167], v[96:99]
    ds_read_b64_tr_b16 v[32:33], v12 offset:0
    v_mfma_f32_16x16x32_bf16 v[100:103], v[48:51], v[168:171], v[100:103]
    ds_read_b64_tr_b16 v[34:35], v12 offset:1024
    v_mfma_f32_16x16x32_bf16 v[100:103], v[52:55], v[172:175], v[100:103]
    ds_read_b128 v[132:135], v11 offset:0
    v_mfma_f32_16x16x32_bf16 v[104:107], v[48:51], v[176:179], v[104:107]
    ds_read_b64_tr_b16 v[36:37], v12 offset:8192
    buffer_load_dwordx4 v9, s[12:15], s25 offen offset:1024 lds
    v_mfma_f32_16x16x32_bf16 v[104:107], v[52:55], v[180:183], v[104:107]
    ds_read_b64_tr_b16 v[38:39], v12 offset:9216
    v_mfma_f32_16x16x32_bf16 v[108:111], v[48:51], v[184:187], v[108:111]
    ds_read_b128 v[136:139], v10 offset:2048
    v_mfma_f32_16x16x32_bf16 v[108:111], v[52:55], v[188:191], v[108:111]
    ds_read_b128 v[140:143], v11 offset:2048
    v_mfma_f32_16x16x32_bf16 v[112:115], v[56:59], v[160:163], v[112:115]
    ds_read_b128 v[144:147], v10 offset:4096
    s_add_u32 m0, s26, s29
    v_mfma_f32_16x16x32_bf16 v[112:115], v[60:63], v[164:167], v[112:115]
    ds_read_b128 v[148:151], v11 offset:4096
    buffer_load_dwordx4 v4, s[8:11], s24 offen offset:0 lds
    v_mfma_f32_16x16x32_bf16 v[116:119], v[56:59], v[168:171], v[116:119]
    ds_read_b128 v[152:155], v10 offset:6144
    v_mfma_f32_16x16x32_bf16 v[116:119], v[60:63], v[172:175], v[116:119]
    ds_read_b128 v[156:159], v11 offset:6144
    v_mfma_f32_16x16x32_bf16 v[120:123], v[56:59], v[176:179], v[120:123]
    ds_read_b64_tr_b16 v[40:41], v13 offset:0
    v_mfma_f32_16x16x32_bf16 v[120:123], v[60:63], v[180:183], v[120:123]
    ds_read_b64_tr_b16 v[42:43], v13 offset:1024
    v_mfma_f32_16x16x32_bf16 v[124:127], v[56:59], v[184:187], v[124:127]
    ds_read_b64_tr_b16 v[44:45], v13 offset:8192
    buffer_load_dwordx4 v5, s[8:11], s24 offen offset:1024 lds
    v_mfma_f32_16x16x32_bf16 v[124:127], v[60:63], v[188:191], v[124:127]
    ds_read_b64_tr_b16 v[46:47], v13 offset:9216
    s_waitcnt lgkmcnt(13)
    v_mfma_f32_16x16x32_bf16 v[64:67], v[32:35], v[128:131], v[64:67]
    ds_read_b64_tr_b16 v[48:49], v14 offset:0
    s_waitcnt lgkmcnt(11)
    v_mfma_f32_16x16x32_bf16 v[64:67], v[36:39], v[132:135], v[64:67]
    ds_read_b64_tr_b16 v[50:51], v14 offset:1024
    s_waitcnt lgkmcnt(11)
    v_mfma_f32_16x16x32_bf16 v[68:71], v[32:35], v[136:139], v[68:71]
    ds_read_b64_tr_b16 v[52:53], v14 offset:8192
    s_waitcnt lgkmcnt(11)
    v_mfma_f32_16x16x32_bf16 v[68:71], v[36:39], v[140:143], v[68:71]
    ds_read_b64_tr_b16 v[54:55], v14 offset:9216
    s_waitcnt lgkmcnt(11)
    v_mfma_f32_16x16x32_bf16 v[72:75], v[32:35], v[144:147], v[72:75]
    ds_read_b64_tr_b16 v[56:57], v15 offset:0
    buffer_load_dwordx4 v6, s[8:11], s24 offen offset:2048 lds
    s_waitcnt lgkmcnt(11)
    v_mfma_f32_16x16x32_bf16 v[72:75], v[36:39], v[148:151], v[72:75]
    ds_read_b64_tr_b16 v[58:59], v15 offset:1024
    s_waitcnt lgkmcnt(11)
    v_mfma_f32_16x16x32_bf16 v[76:79], v[32:35], v[152:155], v[76:79]
    ds_read_b64_tr_b16 v[60:61], v15 offset:8192
    s_waitcnt lgkmcnt(11)
    v_mfma_f32_16x16x32_bf16 v[76:79], v[36:39], v[156:159], v[76:79]
    ds_read_b64_tr_b16 v[62:63], v15 offset:9216
    s_waitcnt lgkmcnt(10)
    v_mfma_f32_16x16x32_bf16 v[80:83], v[40:43], v[128:131], v[80:83]
    s_waitcnt lgkmcnt(8)
    v_mfma_f32_16x16x32_bf16 v[80:83], v[44:47], v[132:135], v[80:83]
    v_mfma_f32_16x16x32_bf16 v[84:87], v[40:43], v[136:139], v[84:87]
    buffer_load_dwordx4 v7, s[8:11], s24 offen offset:3072 lds
    v_mfma_f32_16x16x32_bf16 v[84:87], v[44:47], v[140:143], v[84:87]
    s_add_u32 s24, s24, 128
    s_add_u32 s25, s25, s31
    v_mfma_f32_16x16x32_bf16 v[88:91], v[40:43], v[144:147], v[88:91]
    s_add_u32 s26, s26, 49152
    s_cmp_eq_u32 s26, 147456
    s_cselect_b32 s26, 0, s26
    s_cmp_eq_u32 s26, 98304
    s_cselect_b32 s27, s32, s33
    v_mfma_f32_16x16x32_bf16 v[88:91], v[44:47], v[148:151], v[88:91]
    v_add_u32 v10, s27, v10
    v_add_u32 v11, s27, v11
    v_add_u32 v12, s27, v12
    v_mfma_f32_16x16x32_bf16 v[92:95], v[40:43], v[152:155], v[92:95]
    v_add_u32 v13, s27, v13
    v_add_u32 v14, s27, v14
    v_add_u32 v15, s27, v15
    v_mfma_f32_16x16x32_bf16 v[92:95], v[44:47], v[156:159], v[92:95]
    s_waitcnt vmcnt(6) lgkmcnt(0)
    s_barrier
    s_add_u32 m0, s26, s30
    v_mfma_f32_16x16x32_bf16 v[96:99], v[48:51], v[128:131], v[96:99]
    ds_read_b128 v[160:163], v10 offset:0
    buffer_load_dwordx4 v8, s[12:15], s25 offen offset:0 lds
    v_mfma_f32_16x16x32_bf16 v[96:99], v[52:55], v[132:135], v[96:99]
    ds_read_b64_tr_b16 v[32:33], v12 offset:0
    v_mfma_f32_16x16x32_bf16 v[100:103], v[48:51], v[136:139], v[100:103]
    ds_read_b64_tr_b16 v[34:35], v12 offset:1024
    v_mfma_f32_16x16x32_bf16 v[100:103], v[52:55], v[140:143], v[100:103]
    ds_read_b128 v[164:167], v11 offset:0
    v_mfma_f32_16x16x32_bf16 v[104:107], v[48:51], v[144:147], v[104:107]
    ds_read_b64_tr_b16 v[36:37], v12 offset:8192
    buffer_load_dwordx4 v9, s[12:15], s25 offen offset:1024 lds
    v_mfma_f32_16x16x32_bf16 v[104:107], v[52:55], v[148:151], v[104:107]
    ds_read_b64_tr_b16 v[38:39], v12 offset:9216
    v_mfma_f32_16x16x32_bf16 v[108:111], v[48:51], v[152:155], v[108:111]
    ds_read_b128 v[168:171], v10 offset:2048
    v_mfma_f32_16x16x32_bf16 v[108:111], v[52:55], v[156:159], v[108:111]
    ds_read_b128 v[172:175], v11 offset:2048
    v_mfma_f32_16x16x32_bf16 v[112:115], v[56:59], v[128:131], v[112:115]
    ds_read_b128 v[176:179], v10 offset:4096
    s_add_u32 m0, s26, s29
    v_mfma_f32_16x16x32_bf16 v[112:115], v[60:63], v[132:135], v[112:115]
    ds_read_b128 v[180:183], v11 offset:4096
    buffer_load_dwordx4 v4, s[8:11], s24 offen offset:0 lds
    v_mfma_f32_16x16x32_bf16 v[116:119], v[56:59], v[136:139], v[116:119]
    ds_read_b128 v[184:187], v10 offset:6144
    v_mfma_f32_16x16x32_bf16 v[116:119], v[60:63], v[140:143], v[116:119]
    ds_read_b128 v[188:191], v11 offset:6144
    v_mfma_f32_16x16x32_bf16 v[120:123], v[56:59], v[144:147], v[120:123]
    ds_read_b64_tr_b16 v[40:41], v13 offset:0
    v_mfma_f32_16x16x32_bf16 v[120:123], v[60:63], v[148:151], v[120:123]
    ds_read_b64_tr_b16 v[42:43], v13 offset:1024
    v_mfma_f32_16x16x32_bf16 v[124:127], v[56:59], v[152:155], v[124:127]
    ds_read_b64_tr_b16 v[44:45], v13 offset:8192
    buffer_load_dwordx4 v5, s[8:11], s24 offen offset:1024 lds
    v_mfma_f32_16x16x32_bf16 v[124:127], v[60:63], v[156:159], v[124:127]
    ds_read_b64_tr_b16 v[46:47], v13 offset:9216
    s_waitcnt lgkmcnt(13)
    v_mfma_f32_16x16x32_bf16 v[64:67], v[32:35], v[160:163], v[64:67]
    ds_read_b64_tr_b16 v[48:49], v14 offset:0
    s_waitcnt lgkmcnt(11)
    v_mfma_f32_16x16x32_bf16 v[64:67], v[36:39], v[164:167], v[64:67]
    ds_read_b64_tr_b16 v[50:51], v14 offset:1024
    s_waitcnt lgkmcnt(11)
    v_mfma_f32_16x16x32_bf16 v[68:71], v[32:35], v[168:171], v[68:71]
    ds_read_b64_tr_b16 v[52:53], v14 offset:8192
    s_waitcnt lgkmcnt(11)
    v_mfma_f32_16x16x32_bf16 v[68:71], v[36:39], v[172:175], v[68:71]
    ds_read_b64_tr_b16 v[54:55], v14 offset:9216
    s_waitcnt lgkmcnt(11)
    v_mfma_f32_16x16x32_bf16 v[72:75], v[32:35], v[176:179], v[72:75]
    ds_read_b64_tr_b16 v[56:57], v15 offset:0
    buffer_load_dwordx4 v6, s[8:11], s24 offen offset:2048 lds
    s_waitcnt lgkmcnt(11)
    v_mfma_f32_16x16x32_bf16 v[72:75], v[36:39], v[180:183], v[72:75]
    ds_read_b64_tr_b16 v[58:59], v15 offset:1024
    s_waitcnt lgkmcnt(11)
    v_mfma_f32_16x16x32_bf16 v[76:79], v[32:35], v[184:187], v[76:79]
    ds_read_b64_tr_b16 v[60:61], v15 offset:8192
    s_waitcnt lgkmcnt(11)
    v_mfma_f32_16x16x32_bf16 v[76:79], v[36:39], v[188:191], v[76:79]
    ds_read_b64_tr_b16 v[62:63], v15 offset:9216
    s_waitcnt lgkmcnt(10)
    v_mfma_f32_16x16x32_bf16 v[80:83], v[40:43], v[160:163], v[80:83]
    s_waitcnt lgkmcnt(8)
    v_mfma_f32_16x16x32_bf16 v[80:83], v[44:47], v[164:167], v[80:83]
    v_mfma_f32_16x16x32_bf16 v[84:87], v[40:43], v[168:171], v[84:87]
    buffer_load_dwordx4 v7, s[8:11], s24 offen offset:3072 lds
    v_mfma_f32_16x16x32_bf16 v[84:87], v[44:47], v[172:175], v[84:87]
    s_add_u32 s24, s24, 128
    s_add_u32 s25, s25, s31
    v_mfma_f32_16x16x32_bf16 v[88:91], v[40:43], v[176:179], v[88:91]
    s_add_u32 s26, s26, 49152
    s_cmp_eq_u32 s26, 147456
    s_cselect_b32 s26, 0, s26
    s_cmp_eq_u32 s26, 98304
    s_cselect_b32 s27, s32, s33
    v_mfma_f32_16x16x32_bf16 v[88:91], v[44:47], v[180:183], v[88:91]
    v_add_u32 v10, s27, v10
    v_add_u32 v11, s27, v11
    v_add_u32 v12, s27, v12
    v_mfma_f32_16x16x32_bf16 v[92:95], v[40:43], v[184:187], v[92:95]
    v_add_u32 v13, s27, v13
    v_add_u32 v14, s27, v14
    v_add_u32 v15, s27, v15
    s_sub_u32 s28, s28, 1
    s_cmp_lg_u32 s28, 0
    v_mfma_f32_16x16x32_bf16 v[92:95], v[44:47], v[188:191], v[92:95]
    s_waitcnt vmcnt(6) lgkmcnt(0)
    s_barrier
    s_cbranch_scc1 L_loopk10S_6002
    s_add_u32 m0, s26, s30
    v_mfma_f32_16x16x32_bf16 v[96:99], v[48:51], v[160:163], v[96:99]
    ds_read_b128 v[128:131], v10 offset:0
    buffer_load_dwordx4 v8, s[12:15], s25 offen offset:0 lds
    v_mfma_f32_16x16x32_bf16 v[96:99], v[52:55], v[164:167], v[96:99]
    ds_read_b64_tr_b16 v[32:33], v12 offset:0
    v_mfma_f32_16x16x32_bf16 v[100:103], v[48:51], v[168:171], v[100:103]
    ds_read_b64_tr_b16 v[34:35], v12 offset:1024
    v_mfma_f32_16x16x32_bf16 v[100:103], v[52:55], v[172:175], v[100:103]
    ds_read_b128 v[132:135], v11 offset:0
    v_mfma_f32_16x16x32_bf16 v[104:107], v[48:51], v[176:179], v[104:107]
    ds_read_b64_tr_b16 v[36:37], v12 offset:8192
    buffer_load_dwordx4 v9, s[12:15], s25 offen offset:1024 lds
    v_mfma_f32_16x16x32_bf16 v[104:107], v[52:55], v[180:183], v[104:107]
    ds_read_b64_tr_b16 v[38:39], v12 offset:9216
    v_mfma_f32_16x16x32_bf16 v[108:111], v[48:51], v[184:187], v[108:111]
    ds_read_b128 v[136:139], v10 offset:2048
    v_mfma_f32_16x16x32_bf16 v[108:111], v[52:55], v[188:191], v[108:111]
    ds_read_b128 v[140:143], v11 offset:2048
    v_mfma_f32_16x16x32_bf16 v[112:115], v[56:59], v[160:163], v[112:115]
    ds_read_b128 v[144:147], v10 offset:4096
    s_add_u32 m0, s26, s29
    v_mfma_f32_16x16x32_bf16 v[112:115], v[60:63], v[164:167], v[112:115]
    ds_read_b128 v[148:151], v11 offset:4096
    buffer_load_dwordx4 v4, s[8:11], s24 offen offset:0 lds
    v_mfma_f32_16x16x32_bf16 v[116:119], v[56:59], v[168:171], v[116:119]
    ds_read_b128 v[152:155], v10 offset:6144
    v_mfma_f32_16x16x32_bf16 v[116:119], v[60:63], v[172:175], v[116:119]
    ds_read_b128 v[156:159], v11 offset:6144
    v_mfma_f32_16x16x32_bf16 v[120:123], v[56:59], v[176:179], v[120:123]
    ds_read_b64_tr_b16 v[40:41], v13 offset:0
    v_mfma_f32_16x16x32_bf16 v[120:123], v[60:63], v[180:183], v[120:123]
    ds_read_b64_tr_b16 v[42:43], v13 offset:1024
    v_mfma_f32_16x16x32_bf16 v[124:127], v[56:59], v[184:187], v[124:127]
    ds_read_b64_tr_b16 v[44:45], v13 offset:8192
    buffer_load_dwordx4 v5, s[8:11], s24 offen offset:1024 lds
    v_mfma_f32_16x16x32_bf16 v[124:127], v[60:63], v[188:191], v[124:127]
    ds_read_b64_tr_b16 v[46:47], v13 offset:9216
    s_waitcnt lgkmcnt(13)
    v_mfma_f32_16x16x32_bf16 v[64:67], v[32:35], v[128:131], v[64:67]
    ds_read_b64_tr_b16 v[48:49], v14 offset:0
    s_waitcnt lgkmcnt(11)
    v_mfma_f32_16x16x32_bf16 v[64:67], v[36:39], v[132:135], v[64:67]
    ds_read_b64_tr_b16 v[50:51], v14 offset:1024
    s_waitcnt lgkmcnt(11)
    v_mfma_f32_16x16x32_bf16 v[68:71], v[32:35], v[136:139], v[68:71]
    ds_read_b64_tr_b16 v[52:53], v14 offset:8192
    s_waitcnt lgkmcnt(11)
    v_mfma_f32_16x16x32_bf16 v[68:71], v[36:39], v[140:143], v[68:71]
    ds_read_b64_tr_b16 v[54:55], v14 offset:9216
    s_waitcnt lgkmcnt(11)
    v_mfma_f32_16x16x32_bf16 v[72:75], v[32:35], v[144:147], v[72:75]
    ds_read_b64_tr_b16 v[56:57], v15 offset:0
    buffer_load_dwordx4 v6, s[8:11], s24 offen offset:2048 lds
    s_waitcnt lgkmcnt(11)
    v_mfma_f32_16x16x32_bf16 v[72:75], v[36:39], v[148:151], v[72:75]
    ds_read_b64_tr_b16 v[58:59], v15 offset:1024
    s_waitcnt lgkmcnt(11)
    v_mfma_f32_16x16x32_bf16 v[76:79], v[32:35], v[152:155], v[76:79]
    ds_read_b64_tr_b16 v[60:61], v15 offset:8192
    s_waitcnt lgkmcnt(11)
    v_mfma_f32_16x16x32_bf16 v[76:79], v[36:39], v[156:159], v[76:79]
    ds_read_b64_tr_b16 v[62:63], v15 offset:9216
    s_waitcnt lgkmcnt(10)
    v_mfma_f32_16x16x32_bf16 v[80:83], v[40:43], v[128:131], v[80:83]
    s_waitcnt lgkmcnt(8)
    v_mfma_f32_16x16x32_bf16 v[80:83], v[44:47], v[132:135], v[80:83]
    v_mfma_f32_16x16x32_bf16 v[84:87], v[40:43], v[136:139], v[84:87]
    buffer_load_dwordx4 v7, s[8:11], s24 offen offset:3072 lds
    v_mfma_f32_16x16x32_bf16 v[84:87], v[44:47], v[140:143], v[84:87]
    s_add_u32 s24, s24, 128
    s_add_u32 s25, s25, s31
    v_mfma_f32_16x16x32_bf16 v[88:91], v[40:43], v[144:147], v[88:91]
    s_add_u32 s26, s26, 49152
    s_cmp_eq_u32 s26, 147456
    s_cselect_b32 s26, 0, s26
    s_cmp_eq_u32 s26, 98304
    s_cselect_b32 s27, s32, s33
    v_mfma_f32_16x16x32_bf16 v[88:91], v[44:47], v[148:151], v[88:91]
    v_add_u32 v10, s27, v10
    v_add_u32 v11, s27, v11
    v_add_u32 v12, s27, v12
    v_mfma_f32_16x16x32_bf16 v[92:95], v[40:43], v[152:155], v[92:95]
    v_add_u32 v13, s27, v13
    v_add_u32 v14, s27, v14
    v_add_u32 v15, s27, v15
    v_mfma_f32_16x16x32_bf16 v[92:95], v[44:47], v[156:159], v[92:95]
    v_mov_b32 v16, 0
    s_cmp_lg_u32 s20, 0
    s_cbranch_scc1 L_np1_6003
    buffer_load_dword v27, v16, s[64:67], 0 offen sc1
L_np1_6003:
    s_waitcnt vmcnt(6) lgkmcnt(0)
    s_barrier
    s_add_u32 m0, s26, s30
    v_mfma_f32_16x16x32_bf16 v[96:99], v[48:51], v[128:131], v[96:99]
    ds_read_b128 v[160:163], v10 offset:0
    buffer_load_dwordx4 v8, s[12:15], s25 offen offset:0 lds
    v_mfma_f32_16x16x32_bf16 v[96:99], v[52:55], v[132:135], v[96:99]
    ds_read_b64_tr_b16 v[32:33], v12 offset:0
    v_mfma_f32_16x16x32_bf16 v[100:103], v[48:51], v[136:139], v[100:103]
    ds_read_b64_tr_b16 v[34:35], v12 offset:1024
    v_mfma_f32_16x16x32_bf16 v[100:103], v[52:55], v[140:143], v[100:103]
    ds_read_b128 v[164:167], v11 offset:0
    v_mfma_f32_16x16x32_bf16 v[104:107], v[48:51], v[144:147], v[104:107]
    ds_read_b64_tr_b16 v[36:37], v12 offset:8192
    buffer_load_dwordx4 v9, s[12:15], s25 offen offset:1024 lds
    v_mfma_f32_16x16x32_bf16 v[104:107], v[52:55], v[148:151], v[104:107]
    ds_read_b64_tr_b16 v[38:39], v12 offset:9216
    v_mfma_f32_16x16x32_bf16 v[108:111], v[48:51], v[152:155], v[108:111]
    ds_read_b128 v[168:171], v10 offset:2048
    v_mfma_f32_16x16x32_bf16 v[108:111], v[52:55], v[156:159], v[108:111]
    ds_read_b128 v[172:175], v11 offset:2048
    v_mfma_f32_16x16x32_bf16 v[112:115], v[56:59], v[128:131], v[112:115]
    ds_read_b128 v[176:179], v10 offset:4096
    s_add_u32 m0, s26, s29
    v_mfma_f32_16x16x32_bf16 v[112:115], v[60:63], v[132:135], v[112:115]
    ds_read_b128 v[180:183], v11 offset:4096
    buffer_load_dwordx4 v4, s[8:11], s24 offen offset:0 lds
    v_mfma_f32_16x16x32_bf16 v[116:119], v[56:59], v[136:139], v[116:119]
    ds_read_b128 v[184:187], v10 offset:6144
    v_mfma_f32_16x16x32_bf16 v[116:119], v[60:63], v[140:143], v[116:119]
    ds_read_b128 v[188:191], v11 offset:6144
    v_mfma_f32_16x16x32_bf16 v[120:123], v[56:59], v[144:147], v[120:123]
    ds_read_b64_tr_b16 v[40:41], v13 offset:0
    v_mfma_f32_16x16x32_bf16 v[120:123], v[60:63], v[148:151], v[120:123]
    ds_read_b64_tr_b16 v[42:43], v13 offset:1024
    v_mfma_f32_16x16x32_bf16 v[124:127], v[56:59], v[152:155], v[124:127]
    ds_read_b64_tr_b16 v[44:45], v13 offset:8192
    buffer_load_dwordx4 v5, s[8:11], s24 offen offset:1024 lds
    v_mfma_f32_16x16x32_bf16 v[124:127], v[60:63], v[156:159], v[124:127]
    ds_read_b64_tr_b16 v[46:47], v13 offset:9216
    s_waitcnt lgkmcnt(13)
    v_mfma_f32_16x16x32_bf16 v[64:67], v[32:35], v[160:163], v[64:67]
    ds_read_b64_tr_b16 v[48:49], v14 offset:0
    s_waitcnt lgkmcnt(11)
    v_mfma_f32_16x16x32_bf16 v[64:67], v[36:39], v[164:167], v[64:67]
    ds_read_b64_tr_b16 v[50:51], v14 offset:1024
    s_waitcnt lgkmcnt(11)
    v_mfma_f32_16x16x32_bf16 v[68:71], v[32:35], v[168:171], v[68:71]
    ds_read_b64_tr_b16 v[52:53], v14 offset:8192
    s_waitcnt lgkmcnt(11)
    v_mfma_f32_16x16x32_bf16 v[68:71], v[36:39], v[172:175], v[68:71]
    ds_read_b64_tr_b16 v[54:55], v14 offset:9216
    s_waitcnt lgkmcnt(11)
    v_mfma_f32_16x16x32_bf16 v[72:75], v[32:35], v[176:179], v[72:75]
    ds_read_b64_tr_b16 v[56:57], v15 offset:0
    buffer_load_dwordx4 v6, s[8:11], s24 offen offset:2048 lds
    s_waitcnt lgkmcnt(11)
    v_mfma_f32_16x16x32_bf16 v[72:75], v[36:39], v[180:183], v[72:75]
    ds_read_b64_tr_b16 v[58:59], v15 offset:1024
    s_waitcnt lgkmcnt(11)
    v_mfma_f32_16x16x32_bf16 v[76:79], v[32:35], v[184:187], v[76:79]
    ds_read_b64_tr_b16 v[60:61], v15 offset:8192
    s_waitcnt lgkmcnt(11)
    v_mfma_f32_16x16x32_bf16 v[76:79], v[36:39], v[188:191], v[76:79]
    ds_read_b64_tr_b16 v[62:63], v15 offset:9216
    s_waitcnt lgkmcnt(10)
    v_mfma_f32_16x16x32_bf16 v[80:83], v[40:43], v[160:163], v[80:83]
    s_waitcnt lgkmcnt(8)
    v_mfma_f32_16x16x32_bf16 v[80:83], v[44:47], v[164:167], v[80:83]
    v_mfma_f32_16x16x32_bf16 v[84:87], v[40:43], v[168:171], v[84:87]
    buffer_load_dwordx4 v7, s[8:11], s24 offen offset:3072 lds
    v_mfma_f32_16x16x32_bf16 v[84:87], v[44:47], v[172:175], v[84:87]
    s_add_u32 s24, s24, 128
    s_add_u32 s25, s25, s31
    v_mfma_f32_16x16x32_bf16 v[88:91], v[40:43], v[176:179], v[88:91]
    s_add_u32 s26, s26, 49152
    s_cmp_eq_u32 s26, 147456
    s_cselect_b32 s26, 0, s26
    s_cmp_eq_u32 s26, 98304
    s_cselect_b32 s27, s32, s33
    v_mfma_f32_16x16x32_bf16 v[88:91], v[44:47], v[180:183], v[88:91]
    v_add_u32 v10, s27, v10
    v_add_u32 v11, s27, v11
    v_add_u32 v12, s27, v12
    v_mfma_f32_16x16x32_bf16 v[92:95], v[40:43], v[184:187], v[92:95]
    v_add_u32 v13, s27, v13
    v_add_u32 v14, s27, v14
    v_add_u32 v15, s27, v15
    v_mfma_f32_16x16x32_bf16 v[92:95], v[44:47], v[188:191], v[92:95]
    s_cmp_lg_u32 s20, 0
    s_cbranch_scc1 L_pollok_6005
    s_waitcnt vmcnt(6)
    s_mov_b32 s49, 0
L_poll_6004:
    v_readfirstlane_b32 s48, v27
    s_cmp_ge_u32 s48, 256
    s_cbranch_scc1 L_pollok_6005
    s_add_u32 s49, s49, 1
    s_cmp_ge_u32 s49, 4194304
    s_cbranch_scc1 L_pollok_6005
    s_sleep 4
    buffer_load_dword v27, v16, s[64:67], 0 offen sc1
    s_waitcnt vmcnt(0)
    s_branch L_poll_6004
L_pollok_6005:
    s_waitcnt vmcnt(6) lgkmcnt(0)
    s_barrier
    v_mfma_f32_16x16x32_bf16 v[96:99], v[48:51], v[160:163], v[96:99]
    ds_read_b128 v[128:131], v10 offset:0
    v_mfma_f32_16x16x32_bf16 v[96:99], v[52:55], v[164:167], v[96:99]
    ds_read_b64_tr_b16 v[32:33], v12 offset:0
    v_mfma_f32_16x16x32_bf16 v[100:103], v[48:51], v[168:171], v[100:103]
    ds_read_b64_tr_b16 v[34:35], v12 offset:1024
    v_mfma_f32_16x16x32_bf16 v[100:103], v[52:55], v[172:175], v[100:103]
    ds_read_b128 v[132:135], v11 offset:0
    v_mfma_f32_16x16x32_bf16 v[104:107], v[48:51], v[176:179], v[104:107]
    ds_read_b64_tr_b16 v[36:37], v12 offset:8192
    v_mfma_f32_16x16x32_bf16 v[104:107], v[52:55], v[180:183], v[104:107]
    ds_read_b64_tr_b16 v[38:39], v12 offset:9216
    v_mfma_f32_16x16x32_bf16 v[108:111], v[48:51], v[184:187], v[108:111]
    ds_read_b128 v[136:139], v10 offset:2048
    v_mfma_f32_16x16x32_bf16 v[108:111], v[52:55], v[188:191], v[108:111]
    ds_read_b128 v[140:143], v11 offset:2048
    v_mfma_f32_16x16x32_bf16 v[112:115], v[56:59], v[160:163], v[112:115]
    ds_read_b128 v[144:147], v10 offset:4096
    v_mfma_f32_16x16x32_bf16 v[112:115], v[60:63], v[164:167], v[112:115]
    ds_read_b128 v[148:151], v11 offset:4096
    v_mfma_f32_16x16x32_bf16 v[116:119], v[56:59], v[168:171], v[116:119]
    ds_read_b128 v[152:155], v10 offset:6144
    v_mfma_f32_16x16x32_bf16 v[116:119], v[60:63], v[172:175], v[116:119]
    ds_read_b128 v[156:159], v11 offset:6144
    v_mfma_f32_16x16x32_bf16 v[120:123], v[56:59], v[176:179], v[120:123]
    ds_read_b64_tr_b16 v[40:41], v13 offset:0
    v_mfma_f32_16x16x32_bf16 v[120:123], v[60:63], v[180:183], v[120:123]
    ds_read_b64_tr_b16 v[42:43], v13 offset:1024
    v_mfma_f32_16x16x32_bf16 v[124:127], v[56:59], v[184:187], v[124:127]
    ds_read_b64_tr_b16 v[44:45], v13 offset:8192
    v_mfma_f32_16x16x32_bf16 v[124:127], v[60:63], v[188:191], v[124:127]
    ds_read_b64_tr_b16 v[46:47], v13 offset:9216
    s_waitcnt lgkmcnt(13)
    v_mfma_f32_16x16x32_bf16 v[64:67], v[32:35], v[128:131], v[64:67]
    ds_read_b64_tr_b16 v[48:49], v14 offset:0
    s_waitcnt lgkmcnt(11)
    v_mfma_f32_16x16x32_bf16 v[64:67], v[36:39], v[132:135], v[64:67]
    ds_read_b64_tr_b16 v[50:51], v14 offset:1024
    s_waitcnt lgkmcnt(11)
    v_mfma_f32_16x16x32_bf16 v[68:71], v[32:35], v[136:139], v[68:71]
    ds_read_b64_tr_b16 v[52:53], v14 offset:8192
    s_waitcnt lgkmcnt(11)
    v_mfma_f32_16x16x32_bf16 v[68:71], v[36:39], v[140:143], v[68:71]
    ds_read_b64_tr_b16 v[54:55], v14 offset:9216
    s_waitcnt lgkmcnt(11)
    v_mfma_f32_16x16x32_bf16 v[72:75], v[32:35], v[144:147], v[72:75]
    ds_read_b64_tr_b16 v[56:57], v15 offset:0
    s_waitcnt lgkmcnt(11)
    v_mfma_f32_16x16x32_bf16 v[72:75], v[36:39], v[148:151], v[72:75]
    ds_read_b64_tr_b16 v[58:59], v15 offset:1024
    s_waitcnt lgkmcnt(11)
    v_mfma_f32_16x16x32_bf16 v[76:79], v[32:35], v[152:155], v[76:79]
    ds_read_b64_tr_b16 v[60:61], v15 offset:8192
    s_waitcnt lgkmcnt(11)
    v_mfma_f32_16x16x32_bf16 v[76:79], v[36:39], v[156:159], v[76:79]
    ds_read_b64_tr_b16 v[62:63], v15 offset:9216
    s_waitcnt lgkmcnt(10)
    v_mfma_f32_16x16x32_bf16 v[80:83], v[40:43], v[128:131], v[80:83]
    s_waitcnt lgkmcnt(8)
    v_mfma_f32_16x16x32_bf16 v[80:83], v[44:47], v[132:135], v[80:83]
    v_mfma_f32_16x16x32_bf16 v[84:87], v[40:43], v[136:139], v[84:87]
    v_mfma_f32_16x16x32_bf16 v[84:87], v[44:47], v[140:143], v[84:87]
    v_mfma_f32_16x16x32_bf16 v[88:91], v[40:43], v[144:147], v[88:91]
    s_add_u32 s26, s26, 49152
    s_cmp_eq_u32 s26, 147456
    s_cselect_b32 s26, 0, s26
    s_cmp_eq_u32 s26, 98304
    s_cselect_b32 s27, s32, s33
    v_mfma_f32_16x16x32_bf16 v[88:91], v[44:47], v[148:151], v[88:91]
    v_add_u32 v10, s27, v10
    v_add_u32 v11, s27, v11
    v_add_u32 v12, s27, v12
    v_mfma_f32_16x16x32_bf16 v[92:95], v[40:43], v[152:155], v[92:95]
    v_add_u32 v13, s27, v13
    v_add_u32 v14, s27, v14
    v_add_u32 v15, s27, v15
    v_mfma_f32_16x16x32_bf16 v[92:95], v[44:47], v[156:159], v[92:95]
    s_waitcnt vmcnt(0) lgkmcnt(0)
    s_barrier
    v_mfma_f32_16x16x32_bf16 v[96:99], v[48:51], v[128:131], v[96:99]
    ds_read_b128 v[160:163], v10 offset:0
    v_mfma_f32_16x16x32_bf16 v[96:99], v[52:55], v[132:135], v[96:99]
    ds_read_b64_tr_b16 v[32:33], v12 offset:0
    v_mfma_f32_16x16x32_bf16 v[100:103], v[48:51], v[136:139], v[100:103]
    ds_read_b64_tr_b16 v[34:35], v12 offset:1024
    v_mfma_f32_16x16x32_bf16 v[100:103], v[52:55], v[140:143], v[100:103]
    ds_read_b128 v[164:167], v11 offset:0
    v_mfma_f32_16x16x32_bf16 v[104:107], v[48:51], v[144:147], v[104:107]
    ds_read_b64_tr_b16 v[36:37], v12 offset:8192
    v_mfma_f32_16x16x32_bf16 v[104:107], v[52:55], v[148:151], v[104:107]
    ds_read_b64_tr_b16 v[38:39], v12 offset:9216
    v_mfma_f32_16x16x32_bf16 v[108:111], v[48:51], v[152:155], v[108:111]
    ds_read_b128 v[168:171], v10 offset:2048
    v_mfma_f32_16x16x32_bf16 v[108:111], v[52:55], v[156:159], v[108:111]
    ds_read_b128 v[172:175], v11 offset:2048
    v_mfma_f32_16x16x32_bf16 v[112:115], v[56:59], v[128:131], v[112:115]
    ds_read_b128 v[176:179], v10 offset:4096
    v_mfma_f32_16x16x32_bf16 v[112:115], v[60:63], v[132:135], v[112:115]
    ds_read_b128 v[180:183], v11 offset:4096
    v_mfma_f32_16x16x32_bf16 v[116:119], v[56:59], v[136:139], v[116:119]
    ds_read_b128 v[184:187], v10 offset:6144
    v_mfma_f32_16x16x32_bf16 v[116:119], v[60:63], v[140:143], v[116:119]
    ds_read_b128 v[188:191], v11 offset:6144
    v_mfma_f32_16x16x32_bf16 v[120:123], v[56:59], v[144:147], v[120:123]
    ds_read_b64_tr_b16 v[40:41], v13 offset:0
    v_mfma_f32_16x16x32_bf16 v[120:123], v[60:63], v[148:151], v[120:123]
    ds_read_b64_tr_b16 v[42:43], v13 offset:1024
    v_mfma_f32_16x16x32_bf16 v[124:127], v[56:59], v[152:155], v[124:127]
    ds_read_b64_tr_b16 v[44:45], v13 offset:8192
    v_mfma_f32_16x16x32_bf16 v[124:127], v[60:63], v[156:159], v[124:127]
    ds_read_b64_tr_b16 v[46:47], v13 offset:9216
    s_waitcnt lgkmcnt(13)
    v_mfma_f32_16x16x32_bf16 v[64:67], v[32:35], v[160:163], v[64:67]
    ds_read_b64_tr_b16 v[48:49], v14 offset:0
    s_waitcnt lgkmcnt(11)
    v_mfma_f32_16x16x32_bf16 v[64:67], v[36:39], v[164:167], v[64:67]
    ds_read_b64_tr_b16 v[50:51], v14 offset:1024
    s_waitcnt lgkmcnt(11)
    v_mfma_f32_16x16x32_bf16 v[68:71], v[32:35], v[168:171], v[68:71]
    ds_read_b64_tr_b16 v[52:53], v14 offset:8192
    s_waitcnt lgkmcnt(11)
    v_mfma_f32_16x16x32_bf16 v[68:71], v[36:39], v[172:175], v[68:71]
    ds_read_b64_tr_b16 v[54:55], v14 offset:9216
    s_waitcnt lgkmcnt(11)
    v_mfma_f32_16x16x32_bf16 v[72:75], v[32:35], v[176:179], v[72:75]
    ds_read_b64_tr_b16 v[56:57], v15 offset:0
    s_waitcnt lgkmcnt(11)
    v_mfma_f32_16x16x32_bf16 v[72:75], v[36:39], v[180:183], v[72:75]
    ds_read_b64_tr_b16 v[58:59], v15 offset:1024
    s_waitcnt lgkmcnt(11)
    v_mfma_f32_16x16x32_bf16 v[76:79], v[32:35], v[184:187], v[76:79]
    ds_read_b64_tr_b16 v[60:61], v15 offset:8192
    s_waitcnt lgkmcnt(11)
    v_mfma_f32_16x16x32_bf16 v[76:79], v[36:39], v[188:191], v[76:79]
    ds_read_b64_tr_b16 v[62:63], v15 offset:9216
    s_waitcnt lgkmcnt(10)
    v_mfma_f32_16x16x32_bf16 v[80:83], v[40:43], v[160:163], v[80:83]
    s_waitcnt lgkmcnt(8)
    v_mfma_f32_16x16x32_bf16 v[80:83], v[44:47], v[164:167], v[80:83]
    v_mfma_f32_16x16x32_bf16 v[84:87], v[40:43], v[168:171], v[84:87]
    v_mfma_f32_16x16x32_bf16 v[84:87], v[44:47], v[172:175], v[84:87]
    v_mfma_f32_16x16x32_bf16 v[88:91], v[40:43], v[176:179], v[88:91]
    v_mfma_f32_16x16x32_bf16 v[88:91], v[44:47], v[180:183], v[88:91]
    v_mfma_f32_16x16x32_bf16 v[92:95], v[40:43], v[184:187], v[92:95]
    v_mfma_f32_16x16x32_bf16 v[92:95], v[44:47], v[188:191], v[92:95]
    s_waitcnt lgkmcnt(6)
    v_mfma_f32_16x16x32_bf16 v[96:99], v[48:51], v[160:163], v[96:99]
    s_waitcnt lgkmcnt(4)
    v_mfma_f32_16x16x32_bf16 v[96:99], v[52:55], v[164:167], v[96:99]
    v_mfma_f32_16x16x32_bf16 v[100:103], v[48:51], v[168:171], v[100:103]
    v_mfma_f32_16x16x32_bf16 v[100:103], v[52:55], v[172:175], v[100:103]
    v_mfma_f32_16x16x32_bf16 v[104:107], v[48:51], v[176:179], v[104:107]
    v_mfma_f32_16x16x32_bf16 v[104:107], v[52:55], v[180:183], v[104:107]
    v_mfma_f32_16x16x32_bf16 v[108:111], v[48:51], v[184:187], v[108:111]
    v_mfma_f32_16x16x32_bf16 v[108:111], v[52:55], v[188:191], v[108:111]
    s_waitcnt lgkmcnt(2)
    v_mfma_f32_16x16x32_bf16 v[112:115], v[56:59], v[160:163], v[112:115]
    s_waitcnt lgkmcnt(0)
    v_mfma_f32_16x16x32_bf16 v[112:115], v[60:63], v[164:167], v[112:115]
    v_mfma_f32_16x16x32_bf16 v[116:119], v[56:59], v[168:171], v[116:119]
    v_mfma_f32_16x16x32_bf16 v[116:119], v[60:63], v[172:175], v[116:119]
    v_mfma_f32_16x16x32_bf16 v[120:123], v[56:59], v[176:179], v[120:123]
    v_mfma_f32_16x16x32_bf16 v[120:123], v[60:63], v[180:183], v[120:123]
    v_mfma_f32_16x16x32_bf16 v[124:127], v[56:59], v[184:187], v[124:127]
    v_mfma_f32_16x16x32_bf16 v[124:127], v[60:63], v[188:191], v[124:127]
    s_branch L_k1_ep0
L_k1_p1S:
    s_add_u32 s48, s47, 0
    s_lshl_b32 s48, s48, 4
    s_lshl_b32 s49, s20, 1
    s_add_u32 s59, s48, s49
    s_lshl_b32 s49, s59, 11
    s_add_u32 s49, s49, 4096
    v_lshlrev_b32 v16, 5, v1
    buffer_load_dwordx4 v[192:195], v16, s[8:11], s49 offen offset:0
    buffer_load_dwordx4 v[196:199], v16, s[8:11], s49 offen offset:16
    buffer_load_dwordx4 v[200:203], v16, s[8:11], s49 offen offset:2048
    buffer_load_dwordx4 v[204:207], v16, s[8:11], s49 offen offset:2064
    s_mov_b32 s68, s72
    s_mov_b32 s69, s73
    s_mov_b32 s70, 2048
    s_mov_b32 s71, 0x00020000
    buffer_load_dwordx4 v[216:219], v16, s[68:71], 0 offen offset:0
    buffer_load_dwordx4 v[220:223], v16, s[68:71], 0 offen offset:16
    s_mov_b32 s32, 4294868992
    s_mov_b32 s33, 49152
    s_waitcnt vmcnt(12)
    s_barrier
    ds_read_b128 v[128:131], v10 offset:0
    ds_read_b64_tr_b16 v[32:33], v12 offset:0
    ds_read_b64_tr_b16 v[34:35], v12 offset:1024
    ds_read_b128 v[132:135], v11 offset:0
    ds_read_b64_tr_b16 v[36:37], v12 offset:8192
    ds_read_b64_tr_b16 v[38:39], v12 offset:9216
    ds_read_b128 v[136:139], v10 offset:2048
    ds_read_b128 v[140:143], v11 offset:2048
    ds_read_b128 v[144:147], v10 offset:4096
    ds_read_b128 v[148:151], v11 offset:4096
    ds_read_b128 v[152:155], v10 offset:6144
    ds_read_b128 v[156:159], v11 offset:6144
    s_add_u32 m0, s26, s30
    s_nop 0
    buffer_load_dwordx4 v8, s[12:15], s25 offen offset:0 lds
    buffer_load_dwordx4 v9, s[12:15], s25 offen offset:1024 lds
    s_add_u32 m0, s26, s29
    s_nop 0
    buffer_load_dwordx4 v4, s[8:11], s24 offen offset:0 lds
    buffer_load_dwordx4 v5, s[8:11], s24 offen offset:1024 lds
    buffer_load_dwordx4 v6, s[8:11], s24 offen offset:2048 lds
    buffer_load_dwordx4 v7, s[8:11], s24 offen offset:3072 lds
    s_add_u32 s24, s24, 128
    s_add_u32 s25, s25, s31
    s_waitcnt lgkmcnt(9)
    v_mfma_f32_16x16x32_bf16 v[64:67], v[32:35], v[128:131], 0
    ds_read_b64_tr_b16 v[40:41], v13 offset:0
    s_waitcnt lgkmcnt(7)
    v_mfma_f32_16x16x32_bf16 v[64:67], v[36:39], v[132:135], v[64:67]
    ds_read_b64_tr_b16 v[42:43], v13 offset:1024
    s_waitcnt lgkmcnt(7)
    v_mfma_f32_16x16x32_bf16 v[68:71], v[32:35], v[136:139], 0
    ds_read_b64_tr_b16 v[44:45], v13 offset:8192
    s_waitcnt lgkmcnt(7)
    v_mfma_f32_16x16x32_bf16 v[68:71], v[36:39], v[140:143], v[68:71]
    ds_read_b64_tr_b16 v[46:47], v13 offset:9216
    s_waitcnt lgkmcnt(7)
    v_mfma_f32_16x16x32_bf16 v[72:75], v[32:35], v[144:147], 0
    ds_read_b64_tr_b16 v[48:49], v14 offset:0
    s_waitcnt lgkmcnt(7)
    v_mfma_f32_16x16x32_bf16 v[72:75], v[36:39], v[148:151], v[72:75]
    ds_read_b64_tr_b16 v[50:51], v14 offset:1024
    s_waitcnt lgkmcnt(7)
    v_mfma_f32_16x16x32_bf16 v[76:79], v[32:35], v[152:155], 0
    ds_read_b64_tr_b16 v[52:53], v14 offset:8192
    s_waitcnt lgkmcnt(7)
    v_mfma_f32_16x16x32_bf16 v[76:79], v[36:39], v[156:159], v[76:79]
    ds_read_b64_tr_b16 v[54:55], v14 offset:9216
    s_waitcnt lgkmcnt(6)
    v_mfma_f32_16x16x32_bf16 v[80:83], v[40:43], v[128:131], 0
    ds_read_b64_tr_b16 v[56:57], v15 offset:0
    s_waitcnt lgkmcnt(5)
    v_mfma_f32_16x16x32_bf16 v[80:83], v[44:47], v[132:135], v[80:83]
    ds_read_b64_tr_b16 v[58:59], v15 offset:1024
    v_mfma_f32_16x16x32_bf16 v[84:87], v[40:43], v[136:139], 0
    ds_read_b64_tr_b16 v[60:61], v15 offset:8192
    v_mfma_f32_16x16x32_bf16 v[84:87], v[44:47], v[140:143], v[84:87]
    ds_read_b64_tr_b16 v[62:63], v15 offset:9216
    v_mfma_f32_16x16x32_bf16 v[88:91], v[40:43], v[144:147], 0
    s_add_u32 s26, s26, 49152
    s_cmp_eq_u32 s26, 147456
    s_cselect_b32 s26, 0, s26
    s_cmp_eq_u32 s26, 98304
    s_cselect_b32 s27, s32, s33
    v_mfma_f32_16x16x32_bf16 v[88:91], v[44:47], v[148:151], v[88:91]
    v_add_u32 v10, s27, v10
    v_add_u32 v11, s27, v11
    v_add_u32 v12, s27, v12
    v_mfma_f32_16x16x32_bf16 v[92:95], v[40:43], v[152:155], 0
    v_add_u32 v13, s27, v13
    v_add_u32 v14, s27, v14
    v_add_u32 v15, s27, v15
    v_mfma_f32_16x16x32_bf16 v[92:95], v[44:47], v[156:159], v[92:95]
    s_waitcnt vmcnt(12) lgkmcnt(0)
    s_barrier
    s_add_u32 m0, s26, s30
    v_mfma_f32_16x16x32_bf16 v[96:99], v[48:51], v[128:131], 0
    ds_read_b128 v[160:163], v10 offset:0
    buffer_load_dwordx4 v8, s[12:15], s25 offen offset:0 lds
    v_mfma_f32_16x16x32_bf16 v[96:99], v[52:55], v[132:135], v[96:99]
    ds_read_b64_tr_b16 v[32:33], v12 offset:0
    v_mfma_f32_16x16x32_bf16 v[100:103], v[48:51], v[136:139], 0
    ds_read_b64_tr_b16 v[34:35], v12 offset:1024
    v_mfma_f32_16x16x32_bf16 v[100:103], v[52:55], v[140:143], v[100:103]
    ds_read_b128 v[164:167], v11 offset:0
    v_mfma_f32_16x16x32_bf16 v[104:107], v[48:51], v[144:147], 0
    ds_read_b64_tr_b16 v[36:37], v12 offset:8192
    buffer_load_dwordx4 v9, s[12:15], s25 offen offset:1024 lds
    v_mfma_f32_16x16x32_bf16 v[104:107], v[52:55], v[148:151], v[104:107]
    ds_read_b64_tr_b16 v[38:39], v12 offset:9216
    v_mfma_f32_16x16x32_bf16 v[108:111], v[48:51], v[152:155], 0
    ds_read_b128 v[168:171], v10 offset:2048
    v_mfma_f32_16x16x32_bf16 v[108:111], v[52:55], v[156:159], v[108:111]
    ds_read_b128 v[172:175], v11 offset:2048
    v_mfma_f32_16x16x32_bf16 v[112:115], v[56:59], v[128:131], 0
    ds_read_b128 v[176:179], v10 offset:4096
    s_add_u32 m0, s26, s29
    v_mfma_f32_16x16x32_bf16 v[112:115], v[60:63], v[132:135], v[112:115]
    ds_read_b128 v[180:183], v11 offset:4096
    buffer_load_dwordx4 v4, s[8:11], s24 offen offset:0 lds
    v_mfma_f32_16x16x32_bf16 v[116:119], v[56:59], v[136:139], 0
    ds_read_b128 v[184:187], v10 offset:6144
    v_mfma_f32_16x16x32_bf16 v[116:119], v[60:63], v[140:143], v[116:119]
    ds_read_b128 v[188:191], v11 offset:6144
    v_mfma_f32_16x16x32_bf16 v[120:123], v[56:59], v[144:147], 0
    ds_read_b64_tr_b16 v[40:41], v13 offset:0
    v_mfma_f32_16x16x32_bf16 v[120:123], v[60:63], v[148:151], v[120:123]
    ds_read_b64_tr_b16 v[42:43], v13 offset:1024
    v_mfma_f32_16x16x32_bf16 v[124:127], v[56:59], v[152:155], 0
    ds_read_b64_tr_b16 v[44:45], v13 offset:8192
    buffer_load_dwordx4 v5, s[8:11], s24 offen offset:1024 lds
    v_mfma_f32_16x16x32_bf16 v[124:127], v[60:63], v[156:159], v[124:127]
    ds_read_b64_tr_b16 v[46:47], v13 offset:9216
    s_waitcnt lgkmcnt(13)
    v_mfma_f32_16x16x32_bf16 v[64:67], v[32:35], v[160:163], v[64:67]
    ds_read_b64_tr_b16 v[48:49], v14 offset:0
    s_waitcnt lgkmcnt(11)
    v_mfma_f32_16x16x32_bf16 v[64:67], v[36:39], v[164:167], v[64:67]
    ds_read_b64_tr_b16 v[50:51], v14 offset:1024
    s_waitcnt lgkmcnt(11)
    v_mfma_f32_16x16x32_bf16 v[68:71], v[32:35], v[168:171], v[68:71]
    ds_read_b64_tr_b16 v[52:53], v14 offset:8192
    s_waitcnt lgkmcnt(11)
    v_mfma_f32_16x16x32_bf16 v[68:71], v[36:39], v[172:175], v[68:71]
    ds_read_b64_tr_b16 v[54:55], v14 offset:9216
    s_waitcnt lgkmcnt(11)
    v_mfma_f32_16x16x32_bf16 v[72:75], v[32:35], v[176:179], v[72:75]
    ds_read_b64_tr_b16 v[56:57], v15 offset:0
    buffer_load_dwordx4 v6, s[8:11], s24 offen offset:2048 lds
    s_waitcnt lgkmcnt(11)
    v_mfma_f32_16x16x32_bf16 v[72:75], v[36:39], v[180:183], v[72:75]
    ds_read_b64_tr_b16 v[58:59], v15 offset:1024
    s_waitcnt lgkmcnt(11)
    v_mfma_f32_16x16x32_bf16 v[76:79], v[32:35], v[184:187], v[76:79]
    ds_read_b64_tr_b16 v[60:61], v15 offset:8192
    s_waitcnt lgkmcnt(11)
    v_mfma_f32_16x16x32_bf16 v[76:79], v[36:39], v[188:191], v[76:79]
    ds_read_b64_tr_b16 v[62:63], v15 offset:9216
    s_waitcnt lgkmcnt(10)
    v_mfma_f32_16x16x32_bf16 v[80:83], v[40:43], v[160:163], v[80:83]
    s_waitcnt lgkmcnt(8)
    v_mfma_f32_16x16x32_bf16 v[80:83], v[44:47], v[164:167], v[80:83]
    v_mfma_f32_16x16x32_bf16 v[84:87], v[40:43], v[168:171], v[84:87]
    buffer_load_dwordx4 v7, s[8:11], s24 offen offset:3072 lds
    v_mfma_f32_16x16x32_bf16 v[84:87], v[44:47], v[172:175], v[84:87]
    s_add_u32 s24, s24, 128
    s_add_u32 s25, s25, s31
    v_mfma_f32_16x16x32_bf16 v[88:91], v[40:43], v[176:179], v[88:91]
    s_add_u32 s26, s26, 49152
    s_cmp_eq_u32 s26, 147456
    s_cselect_b32 s26, 0, s26
    s_cmp_eq_u32 s26, 98304
    s_cselect_b32 s27, s32, s33
    v_mfma_f32_16x16x32_bf16 v[88:91], v[44:47], v[180:183], v[88:91]
    v_add_u32 v10, s27, v10
    v_add_u32 v11, s27, v11
    v_add_u32 v12, s27, v12
    v_mfma_f32_16x16x32_bf16 v[92:95], v[40:43], v[184:187], v[92:95]
    v_add_u32 v13, s27, v13
    v_add_u32 v14, s27, v14
    v_add_u32 v15, s27, v15
    v_mfma_f32_16x16x32_bf16 v[92:95], v[44:47], v[188:191], v[92:95]
    s_waitcnt vmcnt(6) lgkmcnt(0)
    s_barrier
    s_add_u32 m0, s26, s30
    v_mfma_f32_16x16x32_bf16 v[96:99], v[48:51], v[160:163], v[96:99]
    ds_read_b128 v[128:131], v10 offset:0
    buffer_load_dwordx4 v8, s[12:15], s25 offen offset:0 lds
    v_mov_b32 v208, 0
    v_mov_b32 v209, 0
    v_mfma_f32_16x16x32_bf16 v[96:99], v[52:55], v[164:167], v[96:99]
    ds_read_b64_tr_b16 v[32:33], v12 offset:0
    v_mov_b32 v210, 0
    v_mov_b32 v211, 0
    v_mov_b32 v212, 0
    v_mfma_f32_16x16x32_bf16 v[100:103], v[48:51], v[168:171], v[100:103]
    ds_read_b64_tr_b16 v[34:35], v12 offset:1024
    v_mov_b32 v213, 0
    v_lshlrev_b32 v224, 16, v216
    v_and_b32 v225, 0xffff0000, v216
    v_mfma_f32_16x16x32_bf16 v[100:103], v[52:55], v[172:175], v[100:103]
    ds_read_b128 v[132:135], v11 offset:0
    v_lshlrev_b32 v226, 16, v192
    v_and_b32 v227, 0xffff0000, v192
    v_lshlrev_b32 v228, 16, v200
    v_mfma_f32_16x16x32_bf16 v[104:107], v[48:51], v[176:179], v[104:107]
    ds_read_b64_tr_b16 v[36:37], v12 offset:8192
    buffer_load_dwordx4 v9, s[12:15], s25 offen offset:1024 lds
    v_and_b32 v229, 0xffff0000, v200
    v_add_f32 v208, v208, v226
    v_fma_f32 v209, v226, v226, v209
    v_mfma_f32_16x16x32_bf16 v[104:107], v[52:55], v[180:183], v[104:107]
    ds_read_b64_tr_b16 v[38:39], v12 offset:9216
    v_mul_f32 v226, v226, v224
    v_add_f32 v208, v208, v227
    v_fma_f32 v209, v227, v227, v209
    v_mfma_f32_16x16x32_bf16 v[108:111], v[48:51], v[184:187], v[108:111]
    ds_read_b128 v[136:139], v10 offset:2048
    v_mul_f32 v227, v227, v225
    v_add_f32 v210, v210, v228
    v_mfma_f32_16x16x32_bf16 v[108:111], v[52:55], v[188:191], v[108:111]
    ds_read_b128 v[140:143], v11 offset:2048
    v_fma_f32 v211, v228, v228, v211
    v_mul_f32 v228, v228, v224
    v_add_f32 v210, v210, v229
    v_mfma_f32_16x16x32_bf16 v[112:115], v[56:59], v[160:163], v[112:115]
    ds_read_b128 v[144:147], v10 offset:4096
    s_add_u32 m0, s26, s29
    v_fma_f32 v211, v229, v229, v211
    v_mul_f32 v229, v229, v225
    v_cvt_pk_bf16_f32 v226, v226, v227
    v_mfma_f32_16x16x32_bf16 v[112:115], v[60:63], v[164:167], v[112:115]
    ds_read_b128 v[148:151], v11 offset:4096
    buffer_load_dwordx4 v4, s[8:11], s24 offen offset:0 lds
    v_cvt_pk_bf16_f32 v228, v228, v229
    v_lshlrev_b32 v227, 16, v226
    v_and_b32 v226, 0xffff0000, v226
    v_mfma_f32_16x16x32_bf16 v[116:119], v[56:59], v[168:171], v[116:119]
    ds_read_b128 v[152:155], v10 offset:6144
    v_add_f32 v212, v212, v227
    v_add_f32 v212, v212, v226
    v_lshlrev_b32 v229, 16, v228
    v_mfma_f32_16x16x32_bf16 v[116:119], v[60:63], v[172:175], v[116:119]
    ds_read_b128 v[156:159], v11 offset:6144
    v_and_b32 v228, 0xffff0000, v228
    v_add_f32 v213, v213, v229
    v_add_f32 v213, v213, v228
    v_mfma_f32_16x16x32_bf16 v[120:123], v[56:59], v[176:179], v[120:123]
    ds_read_b64_tr_b16 v[40:41], v13 offset:0
    v_lshlrev_b32 v224, 16, v217
    v_and_b32 v225, 0xffff0000, v217
    v_lshlrev_b32 v226, 16, v193
    v_mfma_f32_16x16x32_bf16 v[120:123], v[60:63], v[180:183], v[120:123]
    ds_read_b64_tr_b16 v[42:43], v13 offset:1024
    v_and_b32 v227, 0xffff0000, v193
    v_lshlrev_b32 v228, 16, v201
    v_mfma_f32_16x16x32_bf16 v[124:127], v[56:59], v[184:187], v[124:127]
    ds_read_b64_tr_b16 v[44:45], v13 offset:8192
    buffer_load_dwordx4 v5, s[8:11], s24 offen offset:1024 lds
    v_and_b32 v229, 0xffff0000, v201
    v_add_f32 v208, v208, v226
    v_fma_f32 v209, v226, v226, v209
    v_mfma_f32_16x16x32_bf16 v[124:127], v[60:63], v[188:191], v[124:127]
    ds_read_b64_tr_b16 v[46:47], v13 offset:9216
    v_mul_f32 v226, v226, v224
    v_add_f32 v208, v208, v227
    v_fma_f32 v209, v227, v227, v209
    s_waitcnt lgkmcnt(13)
    v_mfma_f32_16x16x32_bf16 v[64:67], v[32:35], v[128:131], v[64:67]
    ds_read_b64_tr_b16 v[48:49], v14 offset:0
    v_mul_f32 v227, v227, v225
    v_add_f32 v210, v210, v228
    v_fma_f32 v211, v228, v228, v211
    s_waitcnt lgkmcnt(11)
    v_mfma_f32_16x16x32_bf16 v[64:67], v[36:39], v[132:135], v[64:67]
    ds_read_b64_tr_b16 v[50:51], v14 offset:1024
    v_mul_f32 v228, v228, v224
    v_add_f32 v210, v210, v229
    v_fma_f32 v211, v229, v229, v211
    s_waitcnt lgkmcnt(11)
    v_mfma_f32_16x16x32_bf16 v[68:71], v[32:35], v[136:139], v[68:71]
    ds_read_b64_tr_b16 v[52:53], v14 offset:8192
    v_mul_f32 v229, v229, v225
    v_cvt_pk_bf16_f32 v226, v226, v227
    v_cvt_pk_bf16_f32 v228, v228, v229
    s_waitcnt lgkmcnt(11)
    v_mfma_f32_16x16x32_bf16 v[68:71], v[36:39], v[140:143], v[68:71]
    ds_read_b64_tr_b16 v[54:55], v14 offset:9216
    v_lshlrev_b32 v227, 16, v226
    v_and_b32 v226, 0xffff0000, v226
    v_add_f32 v212, v212, v227
    s_waitcnt lgkmcnt(11)
    v_mfma_f32_16x16x32_bf16 v[72:75], v[32:35], v[144:147], v[72:75]
    ds_read_b64_tr_b16 v[56:57], v15 offset:0
    buffer_load_dwordx4 v6, s[8:11], s24 offen offset:2048 lds
    v_add_f32 v212, v212, v226
    v_lshlrev_b32 v229, 16, v228
    s_waitcnt lgkmcnt(11)
    v_mfma_f32_16x16x32_bf16 v[72:75], v[36:39], v[148:151], v[72:75]
    ds_read_b64_tr_b16 v[58:59], v15 offset:1024
    v_and_b32 v228, 0xffff0000, v228
    v_add_f32 v213, v213, v229
    v_add_f32 v213, v213, v228
    s_waitcnt lgkmcnt(11)
    v_mfma_f32_16x16x32_bf16 v[76:79], v[32:35], v[152:155], v[76:79]
    ds_read_b64_tr_b16 v[60:61], v15 offset:8192
    v_lshlrev_b32 v224, 16, v218
    v_and_b32 v225, 0xffff0000, v218
    v_lshlrev_b32 v226, 16, v194
    s_waitcnt lgkmcnt(11)
    v_mfma_f32_16x16x32_bf16 v[76:79], v[36:39], v[156:159], v[76:79]
    ds_read_b64_tr_b16 v[62:63], v15 offset:9216
    v_and_b32 v227, 0xffff0000, v194
    v_lshlrev_b32 v228, 16, v202
    v_and_b32 v229, 0xffff0000, v202
    s_waitcnt lgkmcnt(10)
    v_mfma_f32_16x16x32_bf16 v[80:83], v[40:43], v[128:131], v[80:83]
    v_add_f32 v208, v208, v226
    v_fma_f32 v209, v226, v226, v209
    v_mul_f32 v226, v226, v224
    s_waitcnt lgkmcnt(8)
    v_mfma_f32_16x16x32_bf16 v[80:83], v[44:47], v[132:135], v[80:83]
    v_add_f32 v208, v208, v227
    v_fma_f32 v209, v227, v227, v209
    v_mul_f32 v227, v227, v225
    v_mfma_f32_16x16x32_bf16 v[84:87], v[40:43], v[136:139], v[84:87]
    buffer_load_dwordx4 v7, s[8:11], s24 offen offset:3072 lds
    v_add_f32 v210, v210, v228
    v_fma_f32 v211, v228, v228, v211
    v_mfma_f32_16x16x32_bf16 v[84:87], v[44:47], v[140:143], v[84:87]
    s_add_u32 s24, s24, 128
    s_add_u32 s25, s25, s31
    v_mfma_f32_16x16x32_bf16 v[88:91], v[40:43], v[144:147], v[88:91]
    s_add_u32 s26, s26, 49152
    s_cmp_eq_u32 s26, 147456
    s_cselect_b32 s26, 0, s26
    s_cmp_eq_u32 s26, 98304
    s_cselect_b32 s27, s32, s33
    v_mfma_f32_16x16x32_bf16 v[88:91], v[44:47], v[148:151], v[88:91]
    v_add_u32 v10, s27, v10
    v_add_u32 v11, s27, v11
    v_add_u32 v12, s27, v12
    v_mfma_f32_16x16x32_bf16 v[92:95], v[40:43], v[152:155], v[92:95]
    v_add_u32 v13, s27, v13
    v_add_u32 v14, s27, v14
    v_add_u32 v15, s27, v15
    v_mfma_f32_16x16x32_bf16 v[92:95], v[44:47], v[156:159], v[92:95]
    s_waitcnt vmcnt(6) lgkmcnt(0)
    s_barrier
    s_add_u32 m0, s26, s30
    v_mfma_f32_16x16x32_bf16 v[96:99], v[48:51], v[128:131], v[96:99]
    ds_read_b128 v[160:163], v10 offset:0
    buffer_load_dwordx4 v8, s[12:15], s25 offen offset:0 lds
    v_mul_f32 v228, v228, v224
    v_add_f32 v210, v210, v229
    v_fma_f32 v211, v229, v229, v211
    v_mfma_f32_16x16x32_bf16 v[96:99], v[52:55], v[132:135], v[96:99]
    ds_read_b64_tr_b16 v[32:33], v12 offset:0
    v_mul_f32 v229, v229, v225
    v_cvt_pk_bf16_f32 v226, v226, v227
    v_cvt_pk_bf16_f32 v228, v228, v229
    v_mfma_f32_16x16x32_bf16 v[100:103], v[48:51], v[136:139], v[100:103]
    ds_read_b64_tr_b16 v[34:35], v12 offset:1024
    v_lshlrev_b32 v227, 16, v226
    v_and_b32 v226, 0xffff0000, v226
    v_add_f32 v212, v212, v227
    v_mfma_f32_16x16x32_bf16 v[100:103], v[52:55], v[140:143], v[100:103]
    ds_read_b128 v[164:167], v11 offset:0
    v_add_f32 v212, v212, v226
    v_lshlrev_b32 v229, 16, v228
    v_and_b32 v228, 0xffff0000, v228
    v_mfma_f32_16x16x32_bf16 v[104:107], v[48:51], v[144:147], v[104:107]
    ds_read_b64_tr_b16 v[36:37], v12 offset:8192
    buffer_load_dwordx4 v9, s[12:15], s25 offen offset:1024 lds
    v_add_f32 v213, v213, v229
    v_add_f32 v213, v213, v228
    v_lshlrev_b32 v224, 16, v219
    v_mfma_f32_16x16x32_bf16 v[104:107], v[52:55], v[148:151], v[104:107]
    ds_read_b64_tr_b16 v[38:39], v12 offset:9216
    v_and_b32 v225, 0xffff0000, v219
    v_lshlrev_b32 v226, 16, v195
    v_and_b32 v227, 0xffff0000, v195
    v_mfma_f32_16x16x32_bf16 v[108:111], v[48:51], v[152:155], v[108:111]
    ds_read_b128 v[168:171], v10 offset:2048
    v_lshlrev_b32 v228, 16, v203
    v_and_b32 v229, 0xffff0000, v203
    v_mfma_f32_16x16x32_bf16 v[108:111], v[52:55], v[156:159], v[108:111]
    ds_read_b128 v[172:175], v11 offset:2048
    v_add_f32 v208, v208, v226
    v_fma_f32 v209, v226, v226, v209
    v_mul_f32 v226, v226, v224
    v_mfma_f32_16x16x32_bf16 v[112:115], v[56:59], v[128:131], v[112:115]
    ds_read_b128 v[176:179], v10 offset:4096
    s_add_u32 m0, s26, s29
    v_add_f32 v208, v208, v227
    v_fma_f32 v209, v227, v227, v209
    v_mul_f32 v227, v227, v225
    v_mfma_f32_16x16x32_bf16 v[112:115], v[60:63], v[132:135], v[112:115]
    ds_read_b128 v[180:183], v11 offset:4096
    buffer_load_dwordx4 v4, s[8:11], s24 offen offset:0 lds
    v_add_f32 v210, v210, v228
    v_fma_f32 v211, v228, v228, v211
    v_mul_f32 v228, v228, v224
    v_mfma_f32_16x16x32_bf16 v[116:119], v[56:59], v[136:139], v[116:119]
    ds_read_b128 v[184:187], v10 offset:6144
    v_add_f32 v210, v210, v229
    v_fma_f32 v211, v229, v229, v211
    v_mul_f32 v229, v229, v225
    v_mfma_f32_16x16x32_bf16 v[116:119], v[60:63], v[140:143], v[116:119]
    ds_read_b128 v[188:191], v11 offset:6144
    v_cvt_pk_bf16_f32 v226, v226, v227
    v_cvt_pk_bf16_f32 v228, v228, v229
    v_lshlrev_b32 v227, 16, v226
    v_mfma_f32_16x16x32_bf16 v[120:123], v[56:59], v[144:147], v[120:123]
    ds_read_b64_tr_b16 v[40:41], v13 offset:0
    v_and_b32 v226, 0xffff0000, v226
    v_add_f32 v212, v212, v227
    v_add_f32 v212, v212, v226
    v_mfma_f32_16x16x32_bf16 v[120:123], v[60:63], v[148:151], v[120:123]
    ds_read_b64_tr_b16 v[42:43], v13 offset:1024
    v_lshlrev_b32 v229, 16, v228
    v_and_b32 v228, 0xffff0000, v228
    v_mfma_f32_16x16x32_bf16 v[124:127], v[56:59], v[152:155], v[124:127]
    ds_read_b64_tr_b16 v[44:45], v13 offset:8192
    buffer_load_dwordx4 v5, s[8:11], s24 offen offset:1024 lds
    v_add_f32 v213, v213, v229
    v_add_f32 v213, v213, v228
    v_lshlrev_b32 v224, 16, v220
    v_mfma_f32_16x16x32_bf16 v[124:127], v[60:63], v[156:159], v[124:127]
    ds_read_b64_tr_b16 v[46:47], v13 offset:9216
    v_and_b32 v225, 0xffff0000, v220
    v_lshlrev_b32 v226, 16, v196
    v_and_b32 v227, 0xffff0000, v196
    s_waitcnt lgkmcnt(13)
    v_mfma_f32_16x16x32_bf16 v[64:67], v[32:35], v[160:163], v[64:67]
    ds_read_b64_tr_b16 v[48:49], v14 offset:0
    v_lshlrev_b32 v228, 16, v204
    v_and_b32 v229, 0xffff0000, v204
    v_add_f32 v208, v208, v226
    s_waitcnt lgkmcnt(11)
    v_mfma_f32_16x16x32_bf16 v[64:67], v[36:39], v[164:167], v[64:67]
    ds_read_b64_tr_b16 v[50:51], v14 offset:1024
    v_fma_f32 v209, v226, v226, v209
    v_mul_f32 v226, v226, v224
    v_add_f32 v208, v208, v227
    s_waitcnt lgkmcnt(11)
    v_mfma_f32_16x16x32_bf16 v[68:71], v[32:35], v[168:171], v[68:71]
    ds_read_b64_tr_b16 v[52:53], v14 offset:8192
    v_fma_f32 v209, v227, v227, v209
    v_mul_f32 v227, v227, v225
    v_add_f32 v210, v210, v228
    s_waitcnt lgkmcnt(11)
    v_mfma_f32_16x16x32_bf16 v[68:71], v[36:39], v[172:175], v[68:71]
    ds_read_b64_tr_b16 v[54:55], v14 offset:9216
    v_fma_f32 v211, v228, v228, v211
    v_mul_f32 v228, v228, v224
    v_add_f32 v210, v210, v229
    s_waitcnt lgkmcnt(11)
    v_mfma_f32_16x16x32_bf16 v[72:75], v[32:35], v[176:179], v[72:75]
    ds_read_b64_tr_b16 v[56:57], v15 offset:0
    buffer_load_dwordx4 v6, s[8:11], s24 offen offset:2048 lds
    v_fma_f32 v211, v229, v229, v211
    v_mul_f32 v229, v229, v225
    s_waitcnt lgkmcnt(11)
    v_mfma_f32_16x16x32_bf16 v[72:75], v[36:39], v[180:183], v[72:75]
    ds_read_b64_tr_b16 v[58:59], v15 offset:1024
    v_cvt_pk_bf16_f32 v226, v226, v227
    v_cvt_pk_bf16_f32 v228, v228, v229
    v_lshlrev_b32 v227, 16, v226
    s_waitcnt lgkmcnt(11)
    v_mfma_f32_16x16x32_bf16 v[76:79], v[32:35], v[184:187], v[76:79]
    ds_read_b64_tr_b16 v[60:61], v15 offset:8192
    v_and_b32 v226, 0xffff0000, v226
    v_add_f32 v212, v212, v227
    v_add_f32 v212, v212, v226
    s_waitcnt lgkmcnt(11)
    v_mfma_f32_16x16x32_bf16 v[76:79], v[36:39], v[188:191], v[76:79]
    ds_read_b64_tr_b16 v[62:63], v15 offset:9216
    v_lshlrev_b32 v229, 16, v228
    v_and_b32 v228, 0xffff0000, v228
    v_add_f32 v213, v213, v229
    s_waitcnt lgkmcnt(10)
    v_mfma_f32_16x16x32_bf16 v[80:83], v[40:43], v[160:163], v[80:83]
    v_add_f32 v213, v213, v228
    v_lshlrev_b32 v224, 16, v221
    v_and_b32 v225, 0xffff0000, v221
    s_waitcnt lgkmcnt(8)
    v_mfma_f32_16x16x32_bf16 v[80:83], v[44:47], v[164:167], v[80:83]
    v_lshlrev_b32 v226, 16, v197
    v_and_b32 v227, 0xffff0000, v197
    v_lshlrev_b32 v228, 16, v205
    v_mfma_f32_16x16x32_bf16 v[84:87], v[40:43], v[168:171], v[84:87]
    buffer_load_dwordx4 v7, s[8:11], s24 offen offset:3072 lds
    v_and_b32 v229, 0xffff0000, v205
    v_add_f32 v208, v208, v226
    v_mfma_f32_16x16x32_bf16 v[84:87], v[44:47], v[172:175], v[84:87]
    s_add_u32 s24, s24, 128
    s_add_u32 s25, s25, s31
    v_mfma_f32_16x16x32_bf16 v[88:91], v[40:43], v[176:179], v[88:91]
    s_add_u32 s26, s26, 49152
    s_cmp_eq_u32 s26, 147456
    s_cselect_b32 s26, 0, s26
    s_cmp_eq_u32 s26, 98304
    s_cselect_b32 s27, s32, s33
    v_mfma_f32_16x16x32_bf16 v[88:91], v[44:47], v[180:183], v[88:91]
    v_add_u32 v10, s27, v10
    v_add_u32 v11, s27, v11
    v_add_u32 v12, s27, v12
    v_mfma_f32_16x16x32_bf16 v[92:95], v[40:43], v[184:187], v[92:95]
    v_add_u32 v13, s27, v13
    v_add_u32 v14, s27, v14
    v_add_u32 v15, s27, v15
    v_mfma_f32_16x16x32_bf16 v[92:95], v[44:47], v[188:191], v[92:95]
    s_waitcnt vmcnt(6) lgkmcnt(0)
    s_barrier
    s_add_u32 m0, s26, s30
    v_mfma_f32_16x16x32_bf16 v[96:99], v[48:51], v[160:163], v[96:99]
    ds_read_b128 v[128:131], v10 offset:0
    buffer_load_dwordx4 v8, s[12:15], s25 offen offset:0 lds
    v_fma_f32 v209, v226, v226, v209
    v_mul_f32 v226, v226, v224
    v_add_f32 v208, v208, v227
    v_mfma_f32_16x16x32_bf16 v[96:99], v[52:55], v[164:167], v[96:99]
    ds_read_b64_tr_b16 v[32:33], v12 offset:0
    v_fma_f32 v209, v227, v227, v209
    v_mul_f32 v227, v227, v225
    v_add_f32 v210, v210, v228
    v_mfma_f32_16x16x32_bf16 v[100:103], v[48:51], v[168:171], v[100:103]
    ds_read_b64_tr_b16 v[34:35], v12 offset:1024
    v_fma_f32 v211, v228, v228, v211
    v_mul_f32 v228, v228, v224
    v_add_f32 v210, v210, v229
    v_mfma_f32_16x16x32_bf16 v[100:103], v[52:55], v[172:175], v[100:103]
    ds_read_b128 v[132:135], v11 offset:0
    v_fma_f32 v211, v229, v229, v211
    v_mul_f32 v229, v229, v225
    v_cvt_pk_bf16_f32 v226, v226, v227
    v_mfma_f32_16x16x32_bf16 v[104:107], v[48:51], v[176:179], v[104:107]
    ds_read_b64_tr_b16 v[36:37], v12 offset:8192
    buffer_load_dwordx4 v9, s[12:15], s25 offen offset:1024 lds
    v_cvt_pk_bf16_f32 v228, v228, v229
    v_lshlrev_b32 v227, 16, v226
    v_and_b32 v226, 0xffff0000, v226
    v_mfma_f32_16x16x32_bf16 v[104:107], v[52:55], v[180:183], v[104:107]
    ds_read_b64_tr_b16 v[38:39], v12 offset:9216
    v_add_f32 v212, v212, v227
    v_add_f32 v212, v212, v226
    v_lshlrev_b32 v229, 16, v228
    v_mfma_f32_16x16x32_bf16 v[108:111], v[48:51], v[184:187], v[108:111]
    ds_read_b128 v[136:139], v10 offset:2048
    v_and_b32 v228, 0xffff0000, v228
    v_add_f32 v213, v213, v229
    v_mfma_f32_16x16x32_bf16 v[108:111], v[52:55], v[188:191], v[108:111]
    ds_read_b128 v[140:143], v11 offset:2048
    v_add_f32 v213, v213, v228
    v_lshlrev_b32 v224, 16, v222
    v_and_b32 v225, 0xffff0000, v222
    v_mfma_f32_16x16x32_bf16 v[112:115], v[56:59], v[160:163], v[112:115]
    ds_read_b128 v[144:147], v10 offset:4096
    s_add_u32 m0, s26, s29
    v_lshlrev_b32 v226, 16, v198
    v_and_b32 v227, 0xffff0000, v198
    v_lshlrev_b32 v228, 16, v206
    v_mfma_f32_16x16x32_bf16 v[112:115], v[60:63], v[164:167], v[112:115]
    ds_read_b128 v[148:151], v11 offset:4096
    buffer_load_dwordx4 v4, s[8:11], s24 offen offset:0 lds
    v_and_b32 v229, 0xffff0000, v206
    v_add_f32 v208, v208, v226
    v_fma_f32 v209, v226, v226, v209
    v_mfma_f32_16x16x32_bf16 v[116:119], v[56:59], v[168:171], v[116:119]
    ds_read_b128 v[152:155], v10 offset:6144
    v_mul_f32 v226, v226, v224
    v_add_f32 v208, v208, v227
    v_fma_f32 v209, v227, v227, v209
    v_mfma_f32_16x16x32_bf16 v[116:119], v[60:63], v[172:175], v[116:119]
    ds_read_b128 v[156:159], v11 offset:6144
    v_mul_f32 v227, v227, v225
    v_add_f32 v210, v210, v228
    v_fma_f32 v211, v228, v228, v211
    v_mfma_f32_16x16x32_bf16 v[120:123], v[56:59], v[176:179], v[120:123]
    ds_read_b64_tr_b16 v[40:41], v13 offset:0
    v_mul_f32 v228, v228, v224
    v_add_f32 v210, v210, v229
    v_fma_f32 v211, v229, v229, v211
    v_mfma_f32_16x16x32_bf16 v[120:123], v[60:63], v[180:183], v[120:123]
    ds_read_b64_tr_b16 v[42:43], v13 offset:1024
    v_mul_f32 v229, v229, v225
    v_cvt_pk_bf16_f32 v226, v226, v227
    v_mfma_f32_16x16x32_bf16 v[124:127], v[56:59], v[184:187], v[124:127]
    ds_read_b64_tr_b16 v[44:45], v13 offset:8192
    buffer_load_dwordx4 v5, s[8:11], s24 offen offset:1024 lds
    v_cvt_pk_bf16_f32 v228, v228, v229
    v_lshlrev_b32 v227, 16, v226
    v_and_b32 v226, 0xffff0000, v226
    v_mfma_f32_16x16x32_bf16 v[124:127], v[60:63], v[188:191], v[124:127]
    ds_read_b64_tr_b16 v[46:47], v13 offset:9216
    v_add_f32 v212, v212, v227
    v_add_f32 v212, v212, v226
    v_lshlrev_b32 v229, 16, v228
    s_waitcnt lgkmcnt(13)
    v_mfma_f32_16x16x32_bf16 v[64:67], v[32:35], v[128:131], v[64:67]
    ds_read_b64_tr_b16 v[48:49], v14 offset:0
    v_and_b32 v228, 0xffff0000, v228
    v_add_f32 v213, v213, v229
    v_add_f32 v213, v213, v228
    s_waitcnt lgkmcnt(11)
    v_mfma_f32_16x16x32_bf16 v[64:67], v[36:39], v[132:135], v[64:67]
    ds_read_b64_tr_b16 v[50:51], v14 offset:1024
    v_lshlrev_b32 v224, 16, v223
    v_and_b32 v225, 0xffff0000, v223
    v_lshlrev_b32 v226, 16, v199
    s_waitcnt lgkmcnt(11)
    v_mfma_f32_16x16x32_bf16 v[68:71], v[32:35], v[136:139], v[68:71]
    ds_read_b64_tr_b16 v[52:53], v14 offset:8192
    v_and_b32 v227, 0xffff0000, v199
    v_lshlrev_b32 v228, 16, v207
    v_and_b32 v229, 0xffff0000, v207
    s_waitcnt lgkmcnt(11)
    v_mfma_f32_16x16x32_bf16 v[68:71], v[36:39], v[140:143], v[68:71]
    ds_read_b64_tr_b16 v[54:55], v14 offset:9216
    v_add_f32 v208, v208, v226
    v_fma_f32 v209, v226, v226, v209
    v_mul_f32 v226, v226, v224
    s_waitcnt lgkmcnt(11)
    v_mfma_f32_16x16x32_bf16 v[72:75], v[32:35], v[144:147], v[72:75]
    ds_read_b64_tr_b16 v[56:57], v15 offset:0
    buffer_load_dwordx4 v6, s[8:11], s24 offen offset:2048 lds
    v_add_f32 v208, v208, v227
    v_fma_f32 v209, v227, v227, v209
    s_waitcnt lgkmcnt(11)
    v_mfma_f32_16x16x32_bf16 v[72:75], v[36:39], v[148:151], v[72:75]
    ds_read_b64_tr_b16 v[58:59], v15 offset:1024
    v_mul_f32 v227, v227, v225
    v_add_f32 v210, v210, v228
    v_fma_f32 v211, v228, v228, v211
    s_waitcnt lgkmcnt(11)
    v_mfma_f32_16x16x32_bf16 v[76:79], v[32:35], v[152:155], v[76:79]
    ds_read_b64_tr_b16 v[60:61], v15 offset:8192
    v_mul_f32 v228, v228, v224
    v_add_f32 v210, v210, v229
    v_fma_f32 v211, v229, v229, v211
    s_waitcnt lgkmcnt(11)
    v_mfma_f32_16x16x32_bf16 v[76:79], v[36:39], v[156:159], v[76:79]
    ds_read_b64_tr_b16 v[62:63], v15 offset:9216
    v_mul_f32 v229, v229, v225
    v_cvt_pk_bf16_f32 v226, v226, v227
    v_cvt_pk_bf16_f32 v228, v228, v229
    s_waitcnt lgkmcnt(10)
    v_mfma_f32_16x16x32_bf16 v[80:83], v[40:43], v[128:131], v[80:83]
    v_lshlrev_b32 v227, 16, v226
    v_and_b32 v226, 0xffff0000, v226
    v_add_f32 v212, v212, v227
    s_waitcnt lgkmcnt(8)
    v_mfma_f32_16x16x32_bf16 v[80:83], v[44:47], v[132:135], v[80:83]
    v_add_f32 v212, v212, v226
    v_lshlrev_b32 v229, 16, v228
    v_and_b32 v228, 0xffff0000, v228
    v_mfma_f32_16x16x32_bf16 v[84:87], v[40:43], v[136:139], v[84:87]
    buffer_load_dwordx4 v7, s[8:11], s24 offen offset:3072 lds
    v_add_f32 v213, v213, v229
    v_add_f32 v213, v213, v228
    v_mfma_f32_16x16x32_bf16 v[84:87], v[44:47], v[140:143], v[84:87]
    s_add_u32 s24, s24, 128
    s_add_u32 s25, s25, s31
    v_mfma_f32_16x16x32_bf16 v[88:91], v[40:43], v[144:147], v[88:91]
    s_add_u32 s26, s26, 49152
    s_cmp_eq_u32 s26, 147456
    s_cselect_b32 s26, 0, s26
    s_cmp_eq_u32 s26, 98304
    s_cselect_b32 s27, s32, s33
    v_mfma_f32_16x16x32_bf16 v[88:91], v[44:47], v[148:151], v[88:91]
    v_add_u32 v10, s27, v10
    v_add_u32 v11, s27, v11
    v_add_u32 v12, s27, v12
    v_mfma_f32_16x16x32_bf16 v[92:95], v[40:43], v[152:155], v[92:95]
    v_add_u32 v13, s27, v13
    v_add_u32 v14, s27, v14
    v_add_u32 v15, s27, v15
    v_mfma_f32_16x16x32_bf16 v[92:95], v[44:47], v[156:159], v[92:95]
    s_waitcnt vmcnt(6) lgkmcnt(0)
    s_barrier
    s_add_u32 m0, s26, s30
    v_mfma_f32_16x16x32_bf16 v[96:99], v[48:51], v[128:131], v[96:99]
    ds_read_b128 v[160:163], v10 offset:0
    buffer_load_dwordx4 v8, s[12:15], s25 offen offset:0 lds
    s_nop 1
    v_add_f32_dpp v208, v208, v208 row_shr:1 row_mask:0xf bank_mask:0xf bound_ctrl:0
    v_add_f32_dpp v209, v209, v209 row_shr:1 row_mask:0xf bank_mask:0xf bound_ctrl:0
    v_mfma_f32_16x16x32_bf16 v[96:99], v[52:55], v[132:135], v[96:99]
    ds_read_b64_tr_b16 v[32:33], v12 offset:0
    v_add_f32_dpp v210, v210, v210 row_shr:1 row_mask:0xf bank_mask:0xf bound_ctrl:0
    v_add_f32_dpp v211, v211, v211 row_shr:1 row_mask:0xf bank_mask:0xf bound_ctrl:0
    v_add_f32_dpp v212, v212, v212 row_shr:1 row_mask:0xf bank_mask:0xf bound_ctrl:0
    v_mfma_f32_16x16x32_bf16 v[100:103], v[48:51], v[136:139], v[100:103]
    ds_read_b64_tr_b16 v[34:35], v12 offset:1024
    v_add_f32_dpp v213, v213, v213 row_shr:1 row_mask:0xf bank_mask:0xf bound_ctrl:0
    v_add_f32_dpp v208, v208, v208 row_shr:2 row_mask:0xf bank_mask:0xf bound_ctrl:0
    v_add_f32_dpp v209, v209, v209 row_shr:2 row_mask:0xf bank_mask:0xf bound_ctrl:0
    v_mfma_f32_16x16x32_bf16 v[100:103], v[52:55], v[140:143], v[100:103]
    ds_read_b128 v[164:167], v11 offset:0
    v_add_f32_dpp v210, v210, v210 row_shr:2 row_mask:0xf bank_mask:0xf bound_ctrl:0
    v_add_f32_dpp v211, v211, v211 row_shr:2 row_mask:0xf bank_mask:0xf bound_ctrl:0
    v_add_f32_dpp v212, v212, v212 row_shr:2 row_mask:0xf bank_mask:0xf bound_ctrl:0
    v_mfma_f32_16x16x32_bf16 v[104:107], v[48:51], v[144:147], v[104:107]
    ds_read_b64_tr_b16 v[36:37], v12 offset:8192
    buffer_load_dwordx4 v9, s[12:15], s25 offen offset:1024 lds
    v_add_f32_dpp v213, v213, v213 row_shr:2 row_mask:0xf bank_mask:0xf bound_ctrl:0
    v_add_f32_dpp v208, v208, v208 row_shr:4 row_mask:0xf bank_mask:0xf bound_ctrl:0
    v_add_f32_dpp v209, v209, v209 row_shr:4 row_mask:0xf bank_mask:0xf bound_ctrl:0
    v_mfma_f32_16x16x32_bf16 v[104:107], v[52:55], v[148:151], v[104:107]
    ds_read_b64_tr_b16 v[38:39], v12 offset:9216
    v_add_f32_dpp v210, v210, v210 row_shr:4 row_mask:0xf bank_mask:0xf bound_ctrl:0
    v_add_f32_dpp v211, v211, v211 row_shr:4 row_mask:0xf bank_mask:0xf bound_ctrl:0
    v_add_f32_dpp v212, v212, v212 row_shr:4 row_mask:0xf bank_mask:0xf bound_ctrl:0
    v_mfma_f32_16x16x32_bf16 v[108:111], v[48:51], v[152:155], v[108:111]
    ds_read_b128 v[168:171], v10 offset:2048
    v_add_f32_dpp v213, v213, v213 row_shr:4 row_mask:0xf bank_mask:0xf bound_ctrl:0
    v_add_f32_dpp v208, v208, v208 row_shr:8 row_mask:0xf bank_mask:0xf bound_ctrl:0
    v_mfma_f32_16x16x32_bf16 v[108:111], v[52:55], v[156:159], v[108:111]
    ds_read_b128 v[172:175], v11 offset:2048
    v_add_f32_dpp v209, v209, v209 row_shr:8 row_mask:0xf bank_mask:0xf bound_ctrl:0
    v_add_f32_dpp v210, v210, v210 row_shr:8 row_mask:0xf bank_mask:0xf bound_ctrl:0
    v_add_f32_dpp v211, v211, v211 row_shr:8 row_mask:0xf bank_mask:0xf bound_ctrl:0
    v_mfma_f32_16x16x32_bf16 v[112:115], v[56:59], v[128:131], v[112:115]
    ds_read_b128 v[176:179], v10 offset:4096
    s_add_u32 m0, s26, s29
    v_add_f32_dpp v212, v212, v212 row_shr:8 row_mask:0xf bank_mask:0xf bound_ctrl:0
    v_add_f32_dpp v213, v213, v213 row_shr:8 row_mask:0xf bank_mask:0xf bound_ctrl:0
    v_add_f32_dpp v208, v208, v208 row_bcast:15 row_mask:0xa bank_mask:0xf
    v_mfma_f32_16x16x32_bf16 v[112:115], v[60:63], v[132:135], v[112:115]
    ds_read_b128 v[180:183], v11 offset:4096
    buffer_load_dwordx4 v4, s[8:11], s24 offen offset:0 lds
    v_add_f32_dpp v209, v209, v209 row_bcast:15 row_mask:0xa bank_mask:0xf
    v_add_f32_dpp v210, v210, v210 row_bcast:15 row_mask:0xa bank_mask:0xf
    v_add_f32_dpp v211, v211, v211 row_bcast:15 row_mask:0xa bank_mask:0xf
    v_mfma_f32_16x16x32_bf16 v[116:119], v[56:59], v[136:139], v[116:119]
    ds_read_b128 v[184:187], v10 offset:6144
    v_add_f32_dpp v212, v212, v212 row_bcast:15 row_mask:0xa bank_mask:0xf
    v_add_f32_dpp v213, v213, v213 row_bcast:15 row_mask:0xa bank_mask:0xf
    v_add_f32_dpp v208, v208, v208 row_bcast:31 row_mask:0xc bank_mask:0xf
    v_mfma_f32_16x16x32_bf16 v[116:119], v[60:63], v[140:143], v[116:119]
    ds_read_b128 v[188:191], v11 offset:6144
    v_add_f32_dpp v209, v209, v209 row_bcast:31 row_mask:0xc bank_mask:0xf
    v_add_f32_dpp v210, v210, v210 row_bcast:31 row_mask:0xc bank_mask:0xf
    v_add_f32_dpp v211, v211, v211 row_bcast:31 row_mask:0xc bank_mask:0xf
    v_mfma_f32_16x16x32_bf16 v[120:123], v[56:59], v[144:147], v[120:123]
    ds_read_b64_tr_b16 v[40:41], v13 offset:0
    v_add_f32_dpp v212, v212, v212 row_bcast:31 row_mask:0xc bank_mask:0xf
    v_add_f32_dpp v213, v213, v213 row_bcast:31 row_mask:0xc bank_mask:0xf
    v_mul_f32 v208, 981467136, v208
    v_mfma_f32_16x16x32_bf16 v[120:123], v[60:63], v[148:151], v[120:123]
    ds_read_b64_tr_b16 v[42:43], v13 offset:1024
    v_mul_f32 v209, 981467136, v209
    v_fma_f32 v209, -v208, v208, v209
    v_mfma_f32_16x16x32_bf16 v[124:127], v[56:59], v[152:155], v[124:127]
    ds_read_b64_tr_b16 v[44:45], v13 offset:8192
    buffer_load_dwordx4 v5, s[8:11], s24 offen offset:1024 lds
    v_max_f32 v209, 0, v209
    v_add_f32 v209, 925353388, v209
    v_rsq_f32 v209, v209
    v_mfma_f32_16x16x32_bf16 v[124:127], v[60:63], v[156:159], v[124:127]
    ds_read_b64_tr_b16 v[46:47], v13 offset:9216
    v_mul_f32 v210, 981467136, v210
    v_mul_f32 v211, 981467136, v211
    v_fma_f32 v211, -v210, v210, v211
    s_waitcnt lgkmcnt(13)
    v_mfma_f32_16x16x32_bf16 v[64:67], v[32:35], v[160:163], v[64:67]
    ds_read_b64_tr_b16 v[48:49], v14 offset:0
    v_max_f32 v211, 0, v211
    v_add_f32 v211, 925353388, v211
    v_rsq_f32 v211, v211
    s_waitcnt lgkmcnt(11)
    v_mfma_f32_16x16x32_bf16 v[64:67], v[36:39], v[164:167], v[64:67]
    ds_read_b64_tr_b16 v[50:51], v14 offset:1024
    v_cvt_pk_bf16_f32 v212, v212, v213
    v_and_b32 v213, 0xffff0000, v212
    v_lshlrev_b32 v212, 16, v212
    s_waitcnt lgkmcnt(11)
    v_mfma_f32_16x16x32_bf16 v[68:71], v[32:35], v[168:171], v[68:71]
    ds_read_b64_tr_b16 v[52:53], v14 offset:8192
    v_mul_f32 v212, 3216550459, v212
    v_mul_f32 v213, 3216550459, v213
    v_exp_f32 v212, v212
    s_waitcnt lgkmcnt(11)
    v_mfma_f32_16x16x32_bf16 v[68:71], v[36:39], v[172:175], v[68:71]
    ds_read_b64_tr_b16 v[54:55], v14 offset:9216
    v_exp_f32 v213, v213
    s_nop 0
    v_add_f32 v212, 1.0, v212
    s_waitcnt lgkmcnt(11)
    v_mfma_f32_16x16x32_bf16 v[72:75], v[32:35], v[176:179], v[72:75]
    ds_read_b64_tr_b16 v[56:57], v15 offset:0
    buffer_load_dwordx4 v6, s[8:11], s24 offen offset:2048 lds
    v_add_f32 v213, 1.0, v213
    v_rcp_f32 v212, v212
    s_waitcnt lgkmcnt(11)
    v_mfma_f32_16x16x32_bf16 v[72:75], v[36:39], v[180:183], v[72:75]
    ds_read_b64_tr_b16 v[58:59], v15 offset:1024
    v_rcp_f32 v213, v213
    s_nop 0
    v_cvt_pk_bf16_f32 v212, v212, v213
    s_waitcnt lgkmcnt(11)
    v_mfma_f32_16x16x32_bf16 v[76:79], v[32:35], v[184:187], v[76:79]
    ds_read_b64_tr_b16 v[60:61], v15 offset:8192
    v_lshlrev_b32 v216, 16, v212
    v_and_b32 v218, 0xffff0000, v212
    v_sub_f32 v217, 1.0, v216
    s_waitcnt lgkmcnt(11)
    v_mfma_f32_16x16x32_bf16 v[76:79], v[36:39], v[188:191], v[76:79]
    ds_read_b64_tr_b16 v[62:63], v15 offset:9216
    v_sub_f32 v219, 1.0, v218
    v_cvt_pk_bf16_f32 v212, v217, v219
    v_lshlrev_b32 v217, 16, v212
    s_waitcnt lgkmcnt(10)
    v_mfma_f32_16x16x32_bf16 v[80:83], v[40:43], v[160:163], v[80:83]
    v_and_b32 v219, 0xffff0000, v212
    s_lshl_b32 s49, s59, 3
    s_add_u32 s54, s49, 42336256
    s_waitcnt lgkmcnt(8)
    v_mfma_f32_16x16x32_bf16 v[80:83], v[44:47], v[164:167], v[80:83]
    s_add_u32 s49, s49, 41943040
    v_mov_b32 v16, 0
    s_mov_b32 s52, 0
    v_mfma_f32_16x16x32_bf16 v[84:87], v[40:43], v[168:171], v[84:87]
    buffer_load_dwordx4 v7, s[8:11], s24 offen offset:3072 lds
    s_mov_b32 s53, 0x80000000
    s_mov_b64 exec, s[52:53]
    buffer_store_dwordx4 v[208:211], v16, s[16:19], s49 offen sc1
    buffer_store_dwordx4 v[216:219], v16, s[16:19], s54 offen sc1
    s_mov_b64 exec, -1
    v_mfma_f32_16x16x32_bf16 v[84:87], v[44:47], v[172:175], v[84:87]
    s_add_u32 s24, s24, 128
    s_add_u32 s25, s25, s31
    v_mfma_f32_16x16x32_bf16 v[88:91], v[40:43], v[176:179], v[88:91]
    s_add_u32 s26, s26, 49152
    s_cmp_eq_u32 s26, 147456
    s_cselect_b32 s26, 0, s26
    s_cmp_eq_u32 s26, 98304
    s_cselect_b32 s27, s32, s33
    v_mfma_f32_16x16x32_bf16 v[88:91], v[44:47], v[180:183], v[88:91]
    v_add_u32 v10, s27, v10
    v_add_u32 v11, s27, v11
    v_add_u32 v12, s27, v12
    v_mfma_f32_16x16x32_bf16 v[92:95], v[40:43], v[184:187], v[92:95]
    v_add_u32 v13, s27, v13
    v_add_u32 v14, s27, v14
    v_add_u32 v15, s27, v15
    v_mfma_f32_16x16x32_bf16 v[92:95], v[44:47], v[188:191], v[92:95]
    s_waitcnt vmcnt(8) lgkmcnt(0)
    s_barrier
    s_add_u32 m0, s26, s30
    v_mfma_f32_16x16x32_bf16 v[96:99], v[48:51], v[160:163], v[96:99]
    ds_read_b128 v[128:131], v10 offset:0
    buffer_load_dwordx4 v8, s[12:15], s25 offen offset:0 lds
    v_mfma_f32_16x16x32_bf16 v[96:99], v[52:55], v[164:167], v[96:99]
    ds_read_b64_tr_b16 v[32:33], v12 offset:0
    v_mfma_f32_16x16x32_bf16 v[100:103], v[48:51], v[168:171], v[100:103]
    ds_read_b64_tr_b16 v[34:35], v12 offset:1024
    v_mfma_f32_16x16x32_bf16 v[100:103], v[52:55], v[172:175], v[100:103]
    ds_read_b128 v[132:135], v11 offset:0
    v_mfma_f32_16x16x32_bf16 v[104:107], v[48:51], v[176:179], v[104:107]
    ds_read_b64_tr_b16 v[36:37], v12 offset:8192
    buffer_load_dwordx4 v9, s[12:15], s25 offen offset:1024 lds
    v_mfma_f32_16x16x32_bf16 v[104:107], v[52:55], v[180:183], v[104:107]
    ds_read_b64_tr_b16 v[38:39], v12 offset:9216
    v_mfma_f32_16x16x32_bf16 v[108:111], v[48:51], v[184:187], v[108:111]
    ds_read_b128 v[136:139], v10 offset:2048
    v_mfma_f32_16x16x32_bf16 v[108:111], v[52:55], v[188:191], v[108:111]
    ds_read_b128 v[140:143], v11 offset:2048
    v_mfma_f32_16x16x32_bf16 v[112:115], v[56:59], v[160:163], v[112:115]
    ds_read_b128 v[144:147], v10 offset:4096
    s_add_u32 m0, s26, s29
    v_mfma_f32_16x16x32_bf16 v[112:115], v[60:63], v[164:167], v[112:115]
    ds_read_b128 v[148:151], v11 offset:4096
    buffer_load_dwordx4 v4, s[8:11], s24 offen offset:0 lds
    v_mfma_f32_16x16x32_bf16 v[116:119], v[56:59], v[168:171], v[116:119]
    ds_read_b128 v[152:155], v10 offset:6144
    v_mfma_f32_16x16x32_bf16 v[116:119], v[60:63], v[172:175], v[116:119]
    ds_read_b128 v[156:159], v11 offset:6144
    v_mfma_f32_16x16x32_bf16 v[120:123], v[56:59], v[176:179], v[120:123]
    ds_read_b64_tr_b16 v[40:41], v13 offset:0
    v_mfma_f32_16x16x32_bf16 v[120:123], v[60:63], v[180:183], v[120:123]
    ds_read_b64_tr_b16 v[42:43], v13 offset:1024
    v_mfma_f32_16x16x32_bf16 v[124:127], v[56:59], v[184:187], v[124:127]
    ds_read_b64_tr_b16 v[44:45], v13 offset:8192
    buffer_load_dwordx4 v5, s[8:11], s24 offen offset:1024 lds
    v_mfma_f32_16x16x32_bf16 v[124:127], v[60:63], v[188:191], v[124:127]
    ds_read_b64_tr_b16 v[46:47], v13 offset:9216
    s_waitcnt lgkmcnt(13)
    v_mfma_f32_16x16x32_bf16 v[64:67], v[32:35], v[128:131], v[64:67]
    ds_read_b64_tr_b16 v[48:49], v14 offset:0
    s_waitcnt lgkmcnt(11)
    v_mfma_f32_16x16x32_bf16 v[64:67], v[36:39], v[132:135], v[64:67]
    ds_read_b64_tr_b16 v[50:51], v14 offset:1024
    s_waitcnt lgkmcnt(11)
    v_mfma_f32_16x16x32_bf16 v[68:71], v[32:35], v[136:139], v[68:71]
    ds_read_b64_tr_b16 v[52:53], v14 offset:8192
    s_waitcnt lgkmcnt(11)
    v_mfma_f32_16x16x32_bf16 v[68:71], v[36:39], v[140:143], v[68:71]
    ds_read_b64_tr_b16 v[54:55], v14 offset:9216
    s_waitcnt lgkmcnt(11)
    v_mfma_f32_16x16x32_bf16 v[72:75], v[32:35], v[144:147], v[72:75]
    ds_read_b64_tr_b16 v[56:57], v15 offset:0
    buffer_load_dwordx4 v6, s[8:11], s24 offen offset:2048 lds
    s_waitcnt lgkmcnt(11)
    v_mfma_f32_16x16x32_bf16 v[72:75], v[36:39], v[148:151], v[72:75]
    ds_read_b64_tr_b16 v[58:59], v15 offset:1024
    s_waitcnt lgkmcnt(11)
    v_mfma_f32_16x16x32_bf16 v[76:79], v[32:35], v[152:155], v[76:79]
    ds_read_b64_tr_b16 v[60:61], v15 offset:8192
    s_waitcnt lgkmcnt(11)
    v_mfma_f32_16x16x32_bf16 v[76:79], v[36:39], v[156:159], v[76:79]
    ds_read_b64_tr_b16 v[62:63], v15 offset:9216
    s_waitcnt lgkmcnt(10)
    v_mfma_f32_16x16x32_bf16 v[80:83], v[40:43], v[128:131], v[80:83]
    s_waitcnt lgkmcnt(8)
    v_mfma_f32_16x16x32_bf16 v[80:83], v[44:47], v[132:135], v[80:83]
    v_mfma_f32_16x16x32_bf16 v[84:87], v[40:43], v[136:139], v[84:87]
    buffer_load_dwordx4 v7, s[8:11], s24 offen offset:3072 lds
    v_mfma_f32_16x16x32_bf16 v[84:87], v[44:47], v[140:143], v[84:87]
    s_add_u32 s24, s24, 128
    s_add_u32 s25, s25, s31
    v_mfma_f32_16x16x32_bf16 v[88:91], v[40:43], v[144:147], v[88:91]
    s_add_u32 s26, s26, 49152
    s_cmp_eq_u32 s26, 147456
    s_cselect_b32 s26, 0, s26
    s_cmp_eq_u32 s26, 98304
    s_cselect_b32 s27, s32, s33
    v_mfma_f32_16x16x32_bf16 v[88:91], v[44:47], v[148:151], v[88:91]
    v_add_u32 v10, s27, v10
    v_add_u32 v11, s27, v11
    v_add_u32 v12, s27, v12
    v_mfma_f32_16x16x32_bf16 v[92:95], v[40:43], v[152:155], v[92:95]
    v_add_u32 v13, s27, v13
    v_add_u32 v14, s27, v14
    v_add_u32 v15, s27, v15
    v_mfma_f32_16x16x32_bf16 v[92:95], v[44:47], v[156:159], v[92:95]
    s_waitcnt vmcnt(8) lgkmcnt(0)
    s_barrier
    s_add_u32 m0, s26, s30
    v_mfma_f32_16x16x32_bf16 v[96:99], v[48:51], v[128:131], v[96:99]
    ds_read_b128 v[160:163], v10 offset:0
    buffer_load_dwordx4 v8, s[12:15], s25 offen offset:0 lds
    v_mfma_f32_16x16x32_bf16 v[96:99], v[52:55], v[132:135], v[96:99]
    ds_read_b64_tr_b16 v[32:33], v12 offset:0
    buffer_load_dwordx4 v9, s[12:15], s25 offen offset:1024 lds
    v_mfma_f32_16x16x32_bf16 v[100:103], v[48:51], v[136:139], v[100:103]
    ds_read_b64_tr_b16 v[34:35], v12 offset:1024
    v_mfma_f32_16x16x32_bf16 v[100:103], v[52:55], v[140:143], v[100:103]
    ds_read_b128 v[164:167], v11 offset:0
    s_add_u32 m0, s26, s29
    v_mfma_f32_16x16x32_bf16 v[104:107], v[48:51], v[144:147], v[104:107]
    ds_read_b64_tr_b16 v[36:37], v12 offset:8192
    buffer_load_dwordx4 v4, s[8:11], s24 offen offset:0 lds
    v_mfma_f32_16x16x32_bf16 v[104:107], v[52:55], v[148:151], v[104:107]
    ds_read_b64_tr_b16 v[38:39], v12 offset:9216
    buffer_load_dwordx4 v5, s[8:11], s24 offen offset:1024 lds
    v_mfma_f32_16x16x32_bf16 v[108:111], v[48:51], v[152:155], v[108:111]
    ds_read_b128 v[168:171], v10 offset:2048
    buffer_load_dwordx4 v6, s[8:11], s24 offen offset:2048 lds
    v_mfma_f32_16x16x32_bf16 v[108:111], v[52:55], v[156:159], v[108:111]
    ds_read_b128 v[172:175], v11 offset:2048
    v_mfma_f32_16x16x32_bf16 v[112:115], v[56:59], v[128:131], v[112:115]
    ds_read_b128 v[176:179], v10 offset:4096
    buffer_load_dwordx4 v7, s[8:11], s24 offen offset:3072 lds
    v_mfma_f32_16x16x32_bf16 v[112:115], v[60:63], v[132:135], v[112:115]
    ds_read_b128 v[180:183], v11 offset:4096
    s_add_u32 s24, s24, 128
    s_add_u32 s25, s25, s31
    v_mfma_f32_16x16x32_bf16 v[116:119], v[56:59], v[136:139], v[116:119]
    ds_read_b128 v[184:187], v10 offset:6144
    v_mfma_f32_16x16x32_bf16 v[116:119], v[60:63], v[140:143], v[116:119]
    ds_read_b128 v[188:191], v11 offset:6144
    v_mfma_f32_16x16x32_bf16 v[120:123], v[56:59], v[144:147], v[120:123]
    ds_read_b64_tr_b16 v[40:41], v13 offset:0
    v_mfma_f32_16x16x32_bf16 v[120:123], v[60:63], v[148:151], v[120:123]
    ds_read_b64_tr_b16 v[42:43], v13 offset:1024
    v_mfma_f32_16x16x32_bf16 v[124:127], v[56:59], v[152:155], v[124:127]
    ds_read_b64_tr_b16 v[44:45], v13 offset:8192
    v_mfma_f32_16x16x32_bf16 v[124:127], v[60:63], v[156:159], v[124:127]
    ds_read_b64_tr_b16 v[46:47], v13 offset:9216
    s_waitcnt lgkmcnt(13)
    v_mfma_f32_16x16x32_bf16 v[64:67], v[32:35], v[160:163], v[64:67]
    ds_read_b64_tr_b16 v[48:49], v14 offset:0
    s_waitcnt lgkmcnt(11)
    v_mfma_f32_16x16x32_bf16 v[64:67], v[36:39], v[164:167], v[64:67]
    ds_read_b64_tr_b16 v[50:51], v14 offset:1024
    s_waitcnt lgkmcnt(11)
    v_mfma_f32_16x16x32_bf16 v[68:71], v[32:35], v[168:171], v[68:71]
    ds_read_b64_tr_b16 v[52:53], v14 offset:8192
    s_waitcnt lgkmcnt(11)
    v_mfma_f32_16x16x32_bf16 v[68:71], v[36:39], v[172:175], v[68:71]
    ds_read_b64_tr_b16 v[54:55], v14 offset:9216
    s_waitcnt lgkmcnt(11)
    v_mfma_f32_16x16x32_bf16 v[72:75], v[32:35], v[176:179], v[72:75]
    ds_read_b64_tr_b16 v[56:57], v15 offset:0
    s_waitcnt lgkmcnt(11)
    v_mfma_f32_16x16x32_bf16 v[72:75], v[36:39], v[180:183], v[72:75]
    ds_read_b64_tr_b16 v[58:59], v15 offset:1024
    s_waitcnt lgkmcnt(11)
    v_mfma_f32_16x16x32_bf16 v[76:79], v[32:35], v[184:187], v[76:79]
    ds_read_b64_tr_b16 v[60:61], v15 offset:8192
    s_waitcnt lgkmcnt(11)
    v_mfma_f32_16x16x32_bf16 v[76:79], v[36:39], v[188:191], v[76:79]
    ds_read_b64_tr_b16 v[62:63], v15 offset:9216
    s_waitcnt lgkmcnt(10)
    v_mfma_f32_16x16x32_bf16 v[80:83], v[40:43], v[160:163], v[80:83]
    s_waitcnt lgkmcnt(8)
    v_mfma_f32_16x16x32_bf16 v[80:83], v[44:47], v[164:167], v[80:83]
    v_mfma_f32_16x16x32_bf16 v[84:87], v[40:43], v[168:171], v[84:87]
    v_mfma_f32_16x16x32_bf16 v[84:87], v[44:47], v[172:175], v[84:87]
    v_mfma_f32_16x16x32_bf16 v[88:91], v[40:43], v[176:179], v[88:91]
    s_add_u32 s26, s26, 49152
    s_cmp_eq_u32 s26, 147456
    s_cselect_b32 s26, 0, s26
    s_cmp_eq_u32 s26, 98304
    s_cselect_b32 s27, s32, s33
    v_mfma_f32_16x16x32_bf16 v[88:91], v[44:47], v[180:183], v[88:91]
    v_add_u32 v10, s27, v10
    v_add_u32 v11, s27, v11
    v_add_u32 v12, s27, v12
    v_mfma_f32_16x16x32_bf16 v[92:95], v[40:43], v[184:187], v[92:95]
    v_add_u32 v13, s27, v13
    v_add_u32 v14, s27, v14
    v_add_u32 v15, s27, v15
    v_mfma_f32_16x16x32_bf16 v[92:95], v[44:47], v[188:191], v[92:95]
    s_waitcnt vmcnt(0) lgkmcnt(0)
    s_barrier
    s_cmp_lg_u32 s20, 0
    s_cbranch_scc1 L_nosig_6006
    v_mov_b32 v16, 0
    v_mov_b32 v17, 1
    s_mov_b64 s[50:51], exec
    s_mov_b64 exec, 1
    buffer_atomic_add v17, v16, s[64:67], 0 offen
    s_mov_b64 exec, s[50:51]
L_nosig_6006:
    s_mov_b32 s28, 2
.p2align 6
L_loopk11S_6007:
    s_add_u32 m0, s26, s30
    v_mfma_f32_16x16x32_bf16 v[96:99], v[48:51], v[160:163], v[96:99]
    ds_read_b128 v[128:131], v10 offset:0
    buffer_load_dwordx4 v8, s[12:15], s25 offen offset:0 lds
    v_mfma_f32_16x16x32_bf16 v[96:99], v[52:55], v[164:167], v[96:99]
    ds_read_b64_tr_b16 v[32:33], v12 offset:0
    v_mfma_f32_16x16x32_bf16 v[100:103], v[48:51], v[168:171], v[100:103]
    ds_read_b64_tr_b16 v[34:35], v12 offset:1024
    v_mfma_f32_16x16x32_bf16 v[100:103], v[52:55], v[172:175], v[100:103]
    ds_read_b128 v[132:135], v11 offset:0
    v_mfma_f32_16x16x32_bf16 v[104:107], v[48:51], v[176:179], v[104:107]
    ds_read_b64_tr_b16 v[36:37], v12 offset:8192
    buffer_load_dwordx4 v9, s[12:15], s25 offen offset:1024 lds
    v_mfma_f32_16x16x32_bf16 v[104:107], v[52:55], v[180:183], v[104:107]
    ds_read_b64_tr_b16 v[38:39], v12 offset:9216
    v_mfma_f32_16x16x32_bf16 v[108:111], v[48:51], v[184:187], v[108:111]
    ds_read_b128 v[136:139], v10 offset:2048
    v_mfma_f32_16x16x32_bf16 v[108:111], v[52:55], v[188:191], v[108:111]
    ds_read_b128 v[140:143], v11 offset:2048
    v_mfma_f32_16x16x32_bf16 v[112:115], v[56:59], v[160:163], v[112:115]
    ds_read_b128 v[144:147], v10 offset:4096
    s_add_u32 m0, s26, s29
    v_mfma_f32_16x16x32_bf16 v[112:115], v[60:63], v[164:167], v[112:115]
    ds_read_b128 v[148:151], v11 offset:4096
    buffer_load_dwordx4 v4, s[8:11], s24 offen offset:0 lds
    v_mfma_f32_16x16x32_bf16 v[116:119], v[56:59], v[168:171], v[116:119]
    ds_read_b128 v[152:155], v10 offset:6144
    v_mfma_f32_16x16x32_bf16 v[116:119], v[60:63], v[172:175], v[116:119]
    ds_read_b128 v[156:159], v11 offset:6144
    v_mfma_f32_16x16x32_bf16 v[120:123], v[56:59], v[176:179], v[120:123]
    ds_read_b64_tr_b16 v[40:41], v13 offset:0
    v_mfma_f32_16x16x32_bf16 v[120:123], v[60:63], v[180:183], v[120:123]
    ds_read_b64_tr_b16 v[42:43], v13 offset:1024
    v_mfma_f32_16x16x32_bf16 v[124:127], v[56:59], v[184:187], v[124:127]
    ds_read_b64_tr_b16 v[44:45], v13 offset:8192
    buffer_load_dwordx4 v5, s[8:11], s24 offen offset:1024 lds
    v_mfma_f32_16x16x32_bf16 v[124:127], v[60:63], v[188:191], v[124:127]
    ds_read_b64_tr_b16 v[46:47], v13 offset:9216
    s_waitcnt lgkmcnt(13)
    v_mfma_f32_16x16x32_bf16 v[64:67], v[32:35], v[128:131], v[64:67]
    ds_read_b64_tr_b16 v[48:49], v14 offset:0
    s_waitcnt lgkmcnt(11)
    v_mfma_f32_16x16x32_bf16 v[64:67], v[36:39], v[132:135], v[64:67]
    ds_read_b64_tr_b16 v[50:51], v14 offset:1024
    s_waitcnt lgkmcnt(11)
    v_mfma_f32_16x16x32_bf16 v[68:71], v[32:35], v[136:139], v[68:71]
    ds_read_b64_tr_b16 v[52:53], v14 offset:8192
    s_waitcnt lgkmcnt(11)
    v_mfma_f32_16x16x32_bf16 v[68:71], v[36:39], v[140:143], v[68:71]
    ds_read_b64_tr_b16 v[54:55], v14 offset:9216
    s_waitcnt lgkmcnt(11)
    v_mfma_f32_16x16x32_bf16 v[72:75], v[32:35], v[144:147], v[72:75]
    ds_read_b64_tr_b16 v[56:57], v15 offset:0
    buffer_load_dwordx4 v6, s[8:11], s24 offen offset:2048 lds
    s_waitcnt lgkmcnt(11)
    v_mfma_f32_16x16x32_bf16 v[72:75], v[36:39], v[148:151], v[72:75]
    ds_read_b64_tr_b16 v[58:59], v15 offset:1024
    s_waitcnt lgkmcnt(11)
    v_mfma_f32_16x16x32_bf16 v[76:79], v[32:35], v[152:155], v[76:79]
    ds_read_b64_tr_b16 v[60:61], v15 offset:8192
    s_waitcnt lgkmcnt(11)
    v_mfma_f32_16x16x32_bf16 v[76:79], v[36:39], v[156:159], v[76:79]
    ds_read_b64_tr_b16 v[62:63], v15 offset:9216
    s_waitcnt lgkmcnt(10)
    v_mfma_f32_16x16x32_bf16 v[80:83], v[40:43], v[128:131], v[80:83]
    s_waitcnt lgkmcnt(8)
    v_mfma_f32_16x16x32_bf16 v[80:83], v[44:47], v[132:135], v[80:83]
    v_mfma_f32_16x16x32_bf16 v[84:87], v[40:43], v[136:139], v[84:87]
    buffer_load_dwordx4 v7, s[8:11], s24 offen offset:3072 lds
    v_mfma_f32_16x16x32_bf16 v[84:87], v[44:47], v[140:143], v[84:87]
    s_add_u32 s24, s24, 128
    s_add_u32 s25, s25, s31
    v_mfma_f32_16x16x32_bf16 v[88:91], v[40:43], v[144:147], v[88:91]
    s_add_u32 s26, s26, 49152
    s_cmp_eq_u32 s26, 147456
    s_cselect_b32 s26, 0, s26
    s_cmp_eq_u32 s26, 98304
    s_cselect_b32 s27, s32, s33
    v_mfma_f32_16x16x32_bf16 v[88:91], v[44:47], v[148:151], v[88:91]
    v_add_u32 v10, s27, v10
    v_add_u32 v11, s27, v11
    v_add_u32 v12, s27, v12
    v_mfma_f32_16x16x32_bf16 v[92:95], v[40:43], v[152:155], v[92:95]
    v_add_u32 v13, s27, v13
    v_add_u32 v14, s27, v14
    v_add_u32 v15, s27, v15
    v_mfma_f32_16x16x32_bf16 v[92:95], v[44:47], v[156:159], v[92:95]
    s_waitcnt vmcnt(6) lgkmcnt(0)
    s_barrier
    s_add_u32 m0, s26, s30
    v_mfma_f32_16x16x32_bf16 v[96:99], v[48:51], v[128:131], v[96:99]
    ds_read_b128 v[160:163], v10 offset:0
    buffer_load_dwordx4 v8, s[12:15], s25 offen offset:0 lds
    v_mfma_f32_16x16x32_bf16 v[96:99], v[52:55], v[132:135], v[96:99]
    ds_read_b64_tr_b16 v[32:33], v12 offset:0
    v_mfma_f32_16x16x32_bf16 v[100:103], v[48:51], v[136:139], v[100:103]
    ds_read_b64_tr_b16 v[34:35], v12 offset:1024
    v_mfma_f32_16x16x32_bf16 v[100:103], v[52:55], v[140:143], v[100:103]
    ds_read_b128 v[164:167], v11 offset:0
    v_mfma_f32_16x16x32_bf16 v[104:107], v[48:51], v[144:147], v[104:107]
    ds_read_b64_tr_b16 v[36:37], v12 offset:8192
    buffer_load_dwordx4 v9, s[12:15], s25 offen offset:1024 lds
    v_mfma_f32_16x16x32_bf16 v[104:107], v[52:55], v[148:151], v[104:107]
    ds_read_b64_tr_b16 v[38:39], v12 offset:9216
    v_mfma_f32_16x16x32_bf16 v[108:111], v[48:51], v[152:155], v[108:111]
    ds_read_b128 v[168:171], v10 offset:2048
    v_mfma_f32_16x16x32_bf16 v[108:111], v[52:55], v[156:159], v[108:111]
    ds_read_b128 v[172:175], v11 offset:2048
    v_mfma_f32_16x16x32_bf16 v[112:115], v[56:59], v[128:131], v[112:115]
    ds_read_b128 v[176:179], v10 offset:4096
    s_add_u32 m0, s26, s29
    v_mfma_f32_16x16x32_bf16 v[112:115], v[60:63], v[132:135], v[112:115]
    ds_read_b128 v[180:183], v11 offset:4096
    buffer_load_dwordx4 v4, s[8:11], s24 offen offset:0 lds
    v_mfma_f32_16x16x32_bf16 v[116:119], v[56:59], v[136:139], v[116:119]
    ds_read_b128 v[184:187], v10 offset:6144
    v_mfma_f32_16x16x32_bf16 v[116:119], v[60:63], v[140:143], v[116:119]
    ds_read_b128 v[188:191], v11 offset:6144
    v_mfma_f32_16x16x32_bf16 v[120:123], v[56:59], v[144:147], v[120:123]
    ds_read_b64_tr_b16 v[40:41], v13 offset:0
    v_mfma_f32_16x16x32_bf16 v[120:123], v[60:63], v[148:151], v[120:123]
    ds_read_b64_tr_b16 v[42:43], v13 offset:1024
    v_mfma_f32_16x16x32_bf16 v[124:127], v[56:59], v[152:155], v[124:127]
    ds_read_b64_tr_b16 v[44:45], v13 offset:8192
    buffer_load_dwordx4 v5, s[8:11], s24 offen offset:1024 lds
    v_mfma_f32_16x16x32_bf16 v[124:127], v[60:63], v[156:159], v[124:127]
    ds_read_b64_tr_b16 v[46:47], v13 offset:9216
    s_waitcnt lgkmcnt(13)
    v_mfma_f32_16x16x32_bf16 v[64:67], v[32:35], v[160:163], v[64:67]
    ds_read_b64_tr_b16 v[48:49], v14 offset:0
    s_waitcnt lgkmcnt(11)
    v_mfma_f32_16x16x32_bf16 v[64:67], v[36:39], v[164:167], v[64:67]
    ds_read_b64_tr_b16 v[50:51], v14 offset:1024
    s_waitcnt lgkmcnt(11)
    v_mfma_f32_16x16x32_bf16 v[68:71], v[32:35], v[168:171], v[68:71]
    ds_read_b64_tr_b16 v[52:53], v14 offset:8192
    s_waitcnt lgkmcnt(11)
    v_mfma_f32_16x16x32_bf16 v[68:71], v[36:39], v[172:175], v[68:71]
    ds_read_b64_tr_b16 v[54:55], v14 offset:9216
    s_waitcnt lgkmcnt(11)
    v_mfma_f32_16x16x32_bf16 v[72:75], v[32:35], v[176:179], v[72:75]
    ds_read_b64_tr_b16 v[56:57], v15 offset:0
    buffer_load_dwordx4 v6, s[8:11], s24 offen offset:2048 lds
    s_waitcnt lgkmcnt(11)
    v_mfma_f32_16x16x32_bf16 v[72:75], v[36:39], v[180:183], v[72:75]
    ds_read_b64_tr_b16 v[58:59], v15 offset:1024
    s_waitcnt lgkmcnt(11)
    v_mfma_f32_16x16x32_bf16 v[76:79], v[32:35], v[184:187], v[76:79]
    ds_read_b64_tr_b16 v[60:61], v15 offset:8192
    s_waitcnt lgkmcnt(11)
    v_mfma_f32_16x16x32_bf16 v[76:79], v[36:39], v[188:191], v[76:79]
    ds_read_b64_tr_b16 v[62:63], v15 offset:9216
    s_waitcnt lgkmcnt(10)
    v_mfma_f32_16x16x32_bf16 v[80:83], v[40:43], v[160:163], v[80:83]
    s_waitcnt lgkmcnt(8)
    v_mfma_f32_16x16x32_bf16 v[80:83], v[44:47], v[164:167], v[80:83]
    v_mfma_f32_16x16x32_bf16 v[84:87], v[40:43], v[168:171], v[84:87]
    buffer_load_dwordx4 v7, s[8:11], s24 offen offset:3072 lds
    v_mfma_f32_16x16x32_bf16 v[84:87], v[44:47], v[172:175], v[84:87]
    s_add_u32 s24, s24, 128
    s_add_u32 s25, s25, s31
    v_mfma_f32_16x16x32_bf16 v[88:91], v[40:43], v[176:179], v[88:91]
    s_add_u32 s26, s26, 49152
    s_cmp_eq_u32 s26, 147456
    s_cselect_b32 s26, 0, s26
    s_cmp_eq_u32 s26, 98304
    s_cselect_b32 s27, s32, s33
    v_mfma_f32_16x16x32_bf16 v[88:91], v[44:47], v[180:183], v[88:91]
    v_add_u32 v10, s27, v10
    v_add_u32 v11, s27, v11
    v_add_u32 v12, s27, v12
    v_mfma_f32_16x16x32_bf16 v[92:95], v[40:43], v[184:187], v[92:95]
    v_add_u32 v13, s27, v13
    v_add_u32 v14, s27, v14
    v_add_u32 v15, s27, v15
    s_sub_u32 s28, s28, 1
    s_cmp_lg_u32 s28, 0
    v_mfma_f32_16x16x32_bf16 v[92:95], v[44:47], v[188:191], v[92:95]
    s_waitcnt vmcnt(6) lgkmcnt(0)
    s_barrier
    s_cbranch_scc1 L_loopk11S_6007
    s_add_u32 m0, s26, s30
    v_mfma_f32_16x16x32_bf16 v[96:99], v[48:51], v[160:163], v[96:99]
    ds_read_b128 v[128:131], v10 offset:0
    buffer_load_dwordx4 v8, s[12:15], s25 offen offset:0 lds
    v_mfma_f32_16x16x32_bf16 v[96:99], v[52:55], v[164:167], v[96:99]
    ds_read_b64_tr_b16 v[32:33], v12 offset:0
    v_mfma_f32_16x16x32_bf16 v[100:103], v[48:51], v[168:171], v[100:103]
    ds_read_b64_tr_b16 v[34:35], v12 offset:1024
    v_mfma_f32_16x16x32_bf16 v[100:103], v[52:55], v[172:175], v[100:103]
    ds_read_b128 v[132:135], v11 offset:0
    v_mfma_f32_16x16x32_bf16 v[104:107], v[48:51], v[176:179], v[104:107]
    ds_read_b64_tr_b16 v[36:37], v12 offset:8192
    buffer_load_dwordx4 v9, s[12:15], s25 offen offset:1024 lds
    v_mfma_f32_16x16x32_bf16 v[104:107], v[52:55], v[180:183], v[104:107]
    ds_read_b64_tr_b16 v[38:39], v12 offset:9216
    v_mfma_f32_16x16x32_bf16 v[108:111], v[48:51], v[184:187], v[108:111]
    ds_read_b128 v[136:139], v10 offset:2048
    v_mfma_f32_16x16x32_bf16 v[108:111], v[52:55], v[188:191], v[108:111]
    ds_read_b128 v[140:143], v11 offset:2048
    v_mfma_f32_16x16x32_bf16 v[112:115], v[56:59], v[160:163], v[112:115]
    ds_read_b128 v[144:147], v10 offset:4096
    s_add_u32 m0, s26, s29
    v_mfma_f32_16x16x32_bf16 v[112:115], v[60:63], v[164:167], v[112:115]
    ds_read_b128 v[148:151], v11 offset:4096
    buffer_load_dwordx4 v4, s[8:11], s24 offen offset:0 lds
    v_mfma_f32_16x16x32_bf16 v[116:119], v[56:59], v[168:171], v[116:119]
    ds_read_b128 v[152:155], v10 offset:6144
    v_mfma_f32_16x16x32_bf16 v[116:119], v[60:63], v[172:175], v[116:119]
    ds_read_b128 v[156:159], v11 offset:6144
    v_mfma_f32_16x16x32_bf16 v[120:123], v[56:59], v[176:179], v[120:123]
    ds_read_b64_tr_b16 v[40:41], v13 offset:0
    v_mfma_f32_16x16x32_bf16 v[120:123], v[60:63], v[180:183], v[120:123]
    ds_read_b64_tr_b16 v[42:43], v13 offset:1024
    v_mfma_f32_16x16x32_bf16 v[124:127], v[56:59], v[184:187], v[124:127]
    ds_read_b64_tr_b16 v[44:45], v13 offset:8192
    buffer_load_dwordx4 v5, s[8:11], s24 offen offset:1024 lds
    v_mfma_f32_16x16x32_bf16 v[124:127], v[60:63], v[188:191], v[124:127]
    ds_read_b64_tr_b16 v[46:47], v13 offset:9216
    s_waitcnt lgkmcnt(13)
    v_mfma_f32_16x16x32_bf16 v[64:67], v[32:35], v[128:131], v[64:67]
    ds_read_b64_tr_b16 v[48:49], v14 offset:0
    s_waitcnt lgkmcnt(11)
    v_mfma_f32_16x16x32_bf16 v[64:67], v[36:39], v[132:135], v[64:67]
    ds_read_b64_tr_b16 v[50:51], v14 offset:1024
    s_waitcnt lgkmcnt(11)
    v_mfma_f32_16x16x32_bf16 v[68:71], v[32:35], v[136:139], v[68:71]
    ds_read_b64_tr_b16 v[52:53], v14 offset:8192
    s_waitcnt lgkmcnt(11)
    v_mfma_f32_16x16x32_bf16 v[68:71], v[36:39], v[140:143], v[68:71]
    ds_read_b64_tr_b16 v[54:55], v14 offset:9216
    s_waitcnt lgkmcnt(11)
    v_mfma_f32_16x16x32_bf16 v[72:75], v[32:35], v[144:147], v[72:75]
    ds_read_b64_tr_b16 v[56:57], v15 offset:0
    buffer_load_dwordx4 v6, s[8:11], s24 offen offset:2048 lds
    s_waitcnt lgkmcnt(11)
    v_mfma_f32_16x16x32_bf16 v[72:75], v[36:39], v[148:151], v[72:75]
    ds_read_b64_tr_b16 v[58:59], v15 offset:1024
    s_waitcnt lgkmcnt(11)
    v_mfma_f32_16x16x32_bf16 v[76:79], v[32:35], v[152:155], v[76:79]
    ds_read_b64_tr_b16 v[60:61], v15 offset:8192
    s_waitcnt lgkmcnt(11)
    v_mfma_f32_16x16x32_bf16 v[76:79], v[36:39], v[156:159], v[76:79]
    ds_read_b64_tr_b16 v[62:63], v15 offset:9216
    s_waitcnt lgkmcnt(10)
    v_mfma_f32_16x16x32_bf16 v[80:83], v[40:43], v[128:131], v[80:83]
    s_waitcnt lgkmcnt(8)
    v_mfma_f32_16x16x32_bf16 v[80:83], v[44:47], v[132:135], v[80:83]
    v_mfma_f32_16x16x32_bf16 v[84:87], v[40:43], v[136:139], v[84:87]
    buffer_load_dwordx4 v7, s[8:11], s24 offen offset:3072 lds
    v_mfma_f32_16x16x32_bf16 v[84:87], v[44:47], v[140:143], v[84:87]
    s_add_u32 s24, s24, 128
    s_add_u32 s25, s25, s31
    v_mfma_f32_16x16x32_bf16 v[88:91], v[40:43], v[144:147], v[88:91]
    s_add_u32 s26, s26, 49152
    s_cmp_eq_u32 s26, 147456
    s_cselect_b32 s26, 0, s26
    s_cmp_eq_u32 s26, 98304
    s_cselect_b32 s27, s32, s33
    v_mfma_f32_16x16x32_bf16 v[88:91], v[44:47], v[148:151], v[88:91]
    v_add_u32 v10, s27, v10
    v_add_u32 v11, s27, v11
    v_add_u32 v12, s27, v12
    v_mfma_f32_16x16x32_bf16 v[92:95], v[40:43], v[152:155], v[92:95]
    v_add_u32 v13, s27, v13
    v_add_u32 v14, s27, v14
    v_add_u32 v15, s27, v15
    v_mfma_f32_16x16x32_bf16 v[92:95], v[44:47], v[156:159], v[92:95]
    v_mov_b32 v16, 0
    s_cmp_lg_u32 s20, 0
    s_cbranch_scc1 L_np1_6008
    buffer_load_dword v27, v16, s[64:67], 0 offen sc1
L_np1_6008:
    s_waitcnt vmcnt(6) lgkmcnt(0)
    s_barrier
    s_add_u32 m0, s26, s30
    v_mfma_f32_16x16x32_bf16 v[96:99], v[48:51], v[128:131], v[96:99]
    ds_read_b128 v[160:163], v10 offset:0
    buffer_load_dwordx4 v8, s[12:15], s25 offen offset:0 lds
    v_mfma_f32_16x16x32_bf16 v[96:99], v[52:55], v[132:135], v[96:99]
    ds_read_b64_tr_b16 v[32:33], v12 offset:0
    v_mfma_f32_16x16x32_bf16 v[100:103], v[48:51], v[136:139], v[100:103]
    ds_read_b64_tr_b16 v[34:35], v12 offset:1024
    v_mfma_f32_16x16x32_bf16 v[100:103], v[52:55], v[140:143], v[100:103]
    ds_read_b128 v[164:167], v11 offset:0
    v_mfma_f32_16x16x32_bf16 v[104:107], v[48:51], v[144:147], v[104:107]
    ds_read_b64_tr_b16 v[36:37], v12 offset:8192
    buffer_load_dwordx4 v9, s[12:15], s25 offen offset:1024 lds
    v_mfma_f32_16x16x32_bf16 v[104:107], v[52:55], v[148:151], v[104:107]
    ds_read_b64_tr_b16 v[38:39], v12 offset:9216
    v_mfma_f32_16x16x32_bf16 v[108:111], v[48:51], v[152:155], v[108:111]
    ds_read_b128 v[168:171], v10 offset:2048
    v_mfma_f32_16x16x32_bf16 v[108:111], v[52:55], v[156:159], v[108:111]
    ds_read_b128 v[172:175], v11 offset:2048
    v_mfma_f32_16x16x32_bf16 v[112:115], v[56:59], v[128:131], v[112:115]
    ds_read_b128 v[176:179], v10 offset:4096
    s_add_u32 m0, s26, s29
    v_mfma_f32_16x16x32_bf16 v[112:115], v[60:63], v[132:135], v[112:115]
    ds_read_b128 v[180:183], v11 offset:4096
    buffer_load_dwordx4 v4, s[8:11], s24 offen offset:0 lds
    v_mfma_f32_16x16x32_bf16 v[116:119], v[56:59], v[136:139], v[116:119]
    ds_read_b128 v[184:187], v10 offset:6144
    v_mfma_f32_16x16x32_bf16 v[116:119], v[60:63], v[140:143], v[116:119]
    ds_read_b128 v[188:191], v11 offset:6144
    v_mfma_f32_16x16x32_bf16 v[120:123], v[56:59], v[144:147], v[120:123]
    ds_read_b64_tr_b16 v[40:41], v13 offset:0
    v_mfma_f32_16x16x32_bf16 v[120:123], v[60:63], v[148:151], v[120:123]
    ds_read_b64_tr_b16 v[42:43], v13 offset:1024
    v_mfma_f32_16x16x32_bf16 v[124:127], v[56:59], v[152:155], v[124:127]
    ds_read_b64_tr_b16 v[44:45], v13 offset:8192
    buffer_load_dwordx4 v5, s[8:11], s24 offen offset:1024 lds
    v_mfma_f32_16x16x32_bf16 v[124:127], v[60:63], v[156:159], v[124:127]
    ds_read_b64_tr_b16 v[46:47], v13 offset:9216
    s_waitcnt lgkmcnt(13)
    v_mfma_f32_16x16x32_bf16 v[64:67], v[32:35], v[160:163], v[64:67]
    ds_read_b64_tr_b16 v[48:49], v14 offset:0
    s_waitcnt lgkmcnt(11)
    v_mfma_f32_16x16x32_bf16 v[64:67], v[36:39], v[164:167], v[64:67]
    ds_read_b64_tr_b16 v[50:51], v14 offset:1024
    s_waitcnt lgkmcnt(11)
    v_mfma_f32_16x16x32_bf16 v[68:71], v[32:35], v[168:171], v[68:71]
    ds_read_b64_tr_b16 v[52:53], v14 offset:8192
    s_waitcnt lgkmcnt(11)
    v_mfma_f32_16x16x32_bf16 v[68:71], v[36:39], v[172:175], v[68:71]
    ds_read_b64_tr_b16 v[54:55], v14 offset:9216
    s_waitcnt lgkmcnt(11)
    v_mfma_f32_16x16x32_bf16 v[72:75], v[32:35], v[176:179], v[72:75]
    ds_read_b64_tr_b16 v[56:57], v15 offset:0
    buffer_load_dwordx4 v6, s[8:11], s24 offen offset:2048 lds
    s_waitcnt lgkmcnt(11)
    v_mfma_f32_16x16x32_bf16 v[72:75], v[36:39], v[180:183], v[72:75]
    ds_read_b64_tr_b16 v[58:59], v15 offset:1024
    s_waitcnt lgkmcnt(11)
    v_mfma_f32_16x16x32_bf16 v[76:79], v[32:35], v[184:187], v[76:79]
    ds_read_b64_tr_b16 v[60:61], v15 offset:8192
    s_waitcnt lgkmcnt(11)
    v_mfma_f32_16x16x32_bf16 v[76:79], v[36:39], v[188:191], v[76:79]
    ds_read_b64_tr_b16 v[62:63], v15 offset:9216
    s_waitcnt lgkmcnt(10)
    v_mfma_f32_16x16x32_bf16 v[80:83], v[40:43], v[160:163], v[80:83]
    s_waitcnt lgkmcnt(8)
    v_mfma_f32_16x16x32_bf16 v[80:83], v[44:47], v[164:167], v[80:83]
    v_mfma_f32_16x16x32_bf16 v[84:87], v[40:43], v[168:171], v[84:87]
    buffer_load_dwordx4 v7, s[8:11], s24 offen offset:3072 lds
    v_mfma_f32_16x16x32_bf16 v[84:87], v[44:47], v[172:175], v[84:87]
    s_add_u32 s24, s24, 128
    s_add_u32 s25, s25, s31
    v_mfma_f32_16x16x32_bf16 v[88:91], v[40:43], v[176:179], v[88:91]
    s_add_u32 s26, s26, 49152
    s_cmp_eq_u32 s26, 147456
    s_cselect_b32 s26, 0, s26
    s_cmp_eq_u32 s26, 98304
    s_cselect_b32 s27, s32, s33
    v_mfma_f32_16x16x32_bf16 v[88:91], v[44:47], v[180:183], v[88:91]
    v_add_u32 v10, s27, v10
    v_add_u32 v11, s27, v11
    v_add_u32 v12, s27, v12
    v_mfma_f32_16x16x32_bf16 v[92:95], v[40:43], v[184:187], v[92:95]
    v_add_u32 v13, s27, v13
    v_add_u32 v14, s27, v14
    v_add_u32 v15, s27, v15
    v_mfma_f32_16x16x32_bf16 v[92:95], v[44:47], v[188:191], v[92:95]
    s_cmp_lg_u32 s20, 0
    s_cbranch_scc1 L_pollok_6010
    s_waitcnt vmcnt(6)
    s_mov_b32 s49, 0
L_poll_6009:
    v_readfirstlane_b32 s48, v27
    s_cmp_ge_u32 s48, 256
    s_cbranch_scc1 L_pollok_6010
    s_add_u32 s49, s49, 1
    s_cmp_ge_u32 s49, 4194304
    s_cbranch_scc1 L_pollok_6010
    s_sleep 4
    buffer_load_dword v27, v16, s[64:67], 0 offen sc1
    s_waitcnt vmcnt(0)
    s_branch L_poll_6009
L_pollok_6010:
    s_waitcnt vmcnt(6) lgkmcnt(0)
    s_barrier
    v_mfma_f32_16x16x32_bf16 v[96:99], v[48:51], v[160:163], v[96:99]
    ds_read_b128 v[128:131], v10 offset:0
    v_mfma_f32_16x16x32_bf16 v[96:99], v[52:55], v[164:167], v[96:99]
    ds_read_b64_tr_b16 v[32:33], v12 offset:0
    v_mfma_f32_16x16x32_bf16 v[100:103], v[48:51], v[168:171], v[100:103]
    ds_read_b64_tr_b16 v[34:35], v12 offset:1024
    v_mfma_f32_16x16x32_bf16 v[100:103], v[52:55], v[172:175], v[100:103]
    ds_read_b128 v[132:135], v11 offset:0
    v_mfma_f32_16x16x32_bf16 v[104:107], v[48:51], v[176:179], v[104:107]
    ds_read_b64_tr_b16 v[36:37], v12 offset:8192
    v_mfma_f32_16x16x32_bf16 v[104:107], v[52:55], v[180:183], v[104:107]
    ds_read_b64_tr_b16 v[38:39], v12 offset:9216
    v_mfma_f32_16x16x32_bf16 v[108:111], v[48:51], v[184:187], v[108:111]
    ds_read_b128 v[136:139], v10 offset:2048
    v_mfma_f32_16x16x32_bf16 v[108:111], v[52:55], v[188:191], v[108:111]
    ds_read_b128 v[140:143], v11 offset:2048
    v_mfma_f32_16x16x32_bf16 v[112:115], v[56:59], v[160:163], v[112:115]
    ds_read_b128 v[144:147], v10 offset:4096
    v_mfma_f32_16x16x32_bf16 v[112:115], v[60:63], v[164:167], v[112:115]
    ds_read_b128 v[148:151], v11 offset:4096
    v_mfma_f32_16x16x32_bf16 v[116:119], v[56:59], v[168:171], v[116:119]
    ds_read_b128 v[152:155], v10 offset:6144
    v_mfma_f32_16x16x32_bf16 v[116:119], v[60:63], v[172:175], v[116:119]
    ds_read_b128 v[156:159], v11 offset:6144
    v_mfma_f32_16x16x32_bf16 v[120:123], v[56:59], v[176:179], v[120:123]
    ds_read_b64_tr_b16 v[40:41], v13 offset:0
    v_mfma_f32_16x16x32_bf16 v[120:123], v[60:63], v[180:183], v[120:123]
    ds_read_b64_tr_b16 v[42:43], v13 offset:1024
    v_mfma_f32_16x16x32_bf16 v[124:127], v[56:59], v[184:187], v[124:127]
    ds_read_b64_tr_b16 v[44:45], v13 offset:8192
    v_mfma_f32_16x16x32_bf16 v[124:127], v[60:63], v[188:191], v[124:127]
    ds_read_b64_tr_b16 v[46:47], v13 offset:9216
    s_waitcnt lgkmcnt(13)
    v_mfma_f32_16x16x32_bf16 v[64:67], v[32:35], v[128:131], v[64:67]
    ds_read_b64_tr_b16 v[48:49], v14 offset:0
    s_waitcnt lgkmcnt(11)
    v_mfma_f32_16x16x32_bf16 v[64:67], v[36:39], v[132:135], v[64:67]
    ds_read_b64_tr_b16 v[50:51], v14 offset:1024
    s_waitcnt lgkmcnt(11)
    v_mfma_f32_16x16x32_bf16 v[68:71], v[32:35], v[136:139], v[68:71]
    ds_read_b64_tr_b16 v[52:53], v14 offset:8192
    s_waitcnt lgkmcnt(11)
    v_mfma_f32_16x16x32_bf16 v[68:71], v[36:39], v[140:143], v[68:71]
    ds_read_b64_tr_b16 v[54:55], v14 offset:9216
    s_waitcnt lgkmcnt(11)
    v_mfma_f32_16x16x32_bf16 v[72:75], v[32:35], v[144:147], v[72:75]
    ds_read_b64_tr_b16 v[56:57], v15 offset:0
    s_waitcnt lgkmcnt(11)
    v_mfma_f32_16x16x32_bf16 v[72:75], v[36:39], v[148:151], v[72:75]
    ds_read_b64_tr_b16 v[58:59], v15 offset:1024
    s_waitcnt lgkmcnt(11)
    v_mfma_f32_16x16x32_bf16 v[76:79], v[32:35], v[152:155], v[76:79]
    ds_read_b64_tr_b16 v[60:61], v15 offset:8192
    s_waitcnt lgkmcnt(11)
    v_mfma_f32_16x16x32_bf16 v[76:79], v[36:39], v[156:159], v[76:79]
    ds_read_b64_tr_b16 v[62:63], v15 offset:9216
    s_waitcnt lgkmcnt(10)
    v_mfma_f32_16x16x32_bf16 v[80:83], v[40:43], v[128:131], v[80:83]
    s_waitcnt lgkmcnt(8)
    v_mfma_f32_16x16x32_bf16 v[80:83], v[44:47], v[132:135], v[80:83]
    v_mfma_f32_16x16x32_bf16 v[84:87], v[40:43], v[136:139], v[84:87]
    v_mfma_f32_16x16x32_bf16 v[84:87], v[44:47], v[140:143], v[84:87]
    v_mfma_f32_16x16x32_bf16 v[88:91], v[40:43], v[144:147], v[88:91]
    s_add_u32 s26, s26, 49152
    s_cmp_eq_u32 s26, 147456
    s_cselect_b32 s26, 0, s26
    s_cmp_eq_u32 s26, 98304
    s_cselect_b32 s27, s32, s33
    v_mfma_f32_16x16x32_bf16 v[88:91], v[44:47], v[148:151], v[88:91]
    v_add_u32 v10, s27, v10
    v_add_u32 v11, s27, v11
    v_add_u32 v12, s27, v12
    v_mfma_f32_16x16x32_bf16 v[92:95], v[40:43], v[152:155], v[92:95]
    v_add_u32 v13, s27, v13
    v_add_u32 v14, s27, v14
    v_add_u32 v15, s27, v15
    v_mfma_f32_16x16x32_bf16 v[92:95], v[44:47], v[156:159], v[92:95]
    s_waitcnt vmcnt(0) lgkmcnt(0)
    s_barrier
    v_mfma_f32_16x16x32_bf16 v[96:99], v[48:51], v[128:131], v[96:99]
    ds_read_b128 v[160:163], v10 offset:0
    v_mfma_f32_16x16x32_bf16 v[96:99], v[52:55], v[132:135], v[96:99]
    ds_read_b64_tr_b16 v[32:33], v12 offset:0
    v_mfma_f32_16x16x32_bf16 v[100:103], v[48:51], v[136:139], v[100:103]
    ds_read_b64_tr_b16 v[34:35], v12 offset:1024
    v_mfma_f32_16x16x32_bf16 v[100:103], v[52:55], v[140:143], v[100:103]
    ds_read_b128 v[164:167], v11 offset:0
    v_mfma_f32_16x16x32_bf16 v[104:107], v[48:51], v[144:147], v[104:107]
    ds_read_b64_tr_b16 v[36:37], v12 offset:8192
    v_mfma_f32_16x16x32_bf16 v[104:107], v[52:55], v[148:151], v[104:107]
    ds_read_b64_tr_b16 v[38:39], v12 offset:9216
    v_mfma_f32_16x16x32_bf16 v[108:111], v[48:51], v[152:155], v[108:111]
    ds_read_b128 v[168:171], v10 offset:2048
    v_mfma_f32_16x16x32_bf16 v[108:111], v[52:55], v[156:159], v[108:111]
    ds_read_b128 v[172:175], v11 offset:2048
    v_mfma_f32_16x16x32_bf16 v[112:115], v[56:59], v[128:131], v[112:115]
    ds_read_b128 v[176:179], v10 offset:4096
    v_mfma_f32_16x16x32_bf16 v[112:115], v[60:63], v[132:135], v[112:115]
    ds_read_b128 v[180:183], v11 offset:4096
    v_mfma_f32_16x16x32_bf16 v[116:119], v[56:59], v[136:139], v[116:119]
    ds_read_b128 v[184:187], v10 offset:6144
    v_mfma_f32_16x16x32_bf16 v[116:119], v[60:63], v[140:143], v[116:119]
    ds_read_b128 v[188:191], v11 offset:6144
    v_mfma_f32_16x16x32_bf16 v[120:123], v[56:59], v[144:147], v[120:123]
    ds_read_b64_tr_b16 v[40:41], v13 offset:0
    v_mfma_f32_16x16x32_bf16 v[120:123], v[60:63], v[148:151], v[120:123]
    ds_read_b64_tr_b16 v[42:43], v13 offset:1024
    v_mfma_f32_16x16x32_bf16 v[124:127], v[56:59], v[152:155], v[124:127]
    ds_read_b64_tr_b16 v[44:45], v13 offset:8192
    v_mfma_f32_16x16x32_bf16 v[124:127], v[60:63], v[156:159], v[124:127]
    ds_read_b64_tr_b16 v[46:47], v13 offset:9216
    s_waitcnt lgkmcnt(13)
    v_mfma_f32_16x16x32_bf16 v[64:67], v[32:35], v[160:163], v[64:67]
    ds_read_b64_tr_b16 v[48:49], v14 offset:0
    s_waitcnt lgkmcnt(11)
    v_mfma_f32_16x16x32_bf16 v[64:67], v[36:39], v[164:167], v[64:67]
    ds_read_b64_tr_b16 v[50:51], v14 offset:1024
    s_waitcnt lgkmcnt(11)
    v_mfma_f32_16x16x32_bf16 v[68:71], v[32:35], v[168:171], v[68:71]
    ds_read_b64_tr_b16 v[52:53], v14 offset:8192
    s_waitcnt lgkmcnt(11)
    v_mfma_f32_16x16x32_bf16 v[68:71], v[36:39], v[172:175], v[68:71]
    ds_read_b64_tr_b16 v[54:55], v14 offset:9216
    s_waitcnt lgkmcnt(11)
    v_mfma_f32_16x16x32_bf16 v[72:75], v[32:35], v[176:179], v[72:75]
    ds_read_b64_tr_b16 v[56:57], v15 offset:0
    s_waitcnt lgkmcnt(11)
    v_mfma_f32_16x16x32_bf16 v[72:75], v[36:39], v[180:183], v[72:75]
    ds_read_b64_tr_b16 v[58:59], v15 offset:1024
    s_waitcnt lgkmcnt(11)
    v_mfma_f32_16x16x32_bf16 v[76:79], v[32:35], v[184:187], v[76:79]
    ds_read_b64_tr_b16 v[60:61], v15 offset:8192
    s_waitcnt lgkmcnt(11)
    v_mfma_f32_16x16x32_bf16 v[76:79], v[36:39], v[188:191], v[76:79]
    ds_read_b64_tr_b16 v[62:63], v15 offset:9216
    s_waitcnt lgkmcnt(10)
    v_mfma_f32_16x16x32_bf16 v[80:83], v[40:43], v[160:163], v[80:83]
    s_waitcnt lgkmcnt(8)
    v_mfma_f32_16x16x32_bf16 v[80:83], v[44:47], v[164:167], v[80:83]
    v_mfma_f32_16x16x32_bf16 v[84:87], v[40:43], v[168:171], v[84:87]
    v_mfma_f32_16x16x32_bf16 v[84:87], v[44:47], v[172:175], v[84:87]
    v_mfma_f32_16x16x32_bf16 v[88:91], v[40:43], v[176:179], v[88:91]
    v_mfma_f32_16x16x32_bf16 v[88:91], v[44:47], v[180:183], v[88:91]
    v_mfma_f32_16x16x32_bf16 v[92:95], v[40:43], v[184:187], v[92:95]
    v_mfma_f32_16x16x32_bf16 v[92:95], v[44:47], v[188:191], v[92:95]
    s_waitcnt lgkmcnt(6)
    v_mfma_f32_16x16x32_bf16 v[96:99], v[48:51], v[160:163], v[96:99]
    s_waitcnt lgkmcnt(4)
    v_mfma_f32_16x16x32_bf16 v[96:99], v[52:55], v[164:167], v[96:99]
    v_mfma_f32_16x16x32_bf16 v[100:103], v[48:51], v[168:171], v[100:103]
    v_mfma_f32_16x16x32_bf16 v[100:103], v[52:55], v[172:175], v[100:103]
    v_mfma_f32_16x16x32_bf16 v[104:107], v[48:51], v[176:179], v[104:107]
    v_mfma_f32_16x16x32_bf16 v[104:107], v[52:55], v[180:183], v[104:107]
    v_mfma_f32_16x16x32_bf16 v[108:111], v[48:51], v[184:187], v[108:111]
    v_mfma_f32_16x16x32_bf16 v[108:111], v[52:55], v[188:191], v[108:111]
    s_waitcnt lgkmcnt(2)
    v_mfma_f32_16x16x32_bf16 v[112:115], v[56:59], v[160:163], v[112:115]
    s_waitcnt lgkmcnt(0)
    v_mfma_f32_16x16x32_bf16 v[112:115], v[60:63], v[164:167], v[112:115]
    v_mfma_f32_16x16x32_bf16 v[116:119], v[56:59], v[168:171], v[116:119]
    v_mfma_f32_16x16x32_bf16 v[116:119], v[60:63], v[172:175], v[116:119]
    v_mfma_f32_16x16x32_bf16 v[120:123], v[56:59], v[176:179], v[120:123]
    v_mfma_f32_16x16x32_bf16 v[120:123], v[60:63], v[180:183], v[120:123]
    v_mfma_f32_16x16x32_bf16 v[124:127], v[56:59], v[184:187], v[124:127]
    v_mfma_f32_16x16x32_bf16 v[124:127], v[60:63], v[188:191], v[124:127]
    s_branch L_k1_ep1
L_k1_p2S:
    s_add_u32 s48, s47, 64
    s_lshl_b32 s48, s48, 4
    s_lshl_b32 s49, s20, 1
    s_add_u32 s59, s48, s49
    s_lshl_b32 s49, s59, 11
    s_add_u32 s49, s49, 4096
    v_lshlrev_b32 v16, 5, v1
    buffer_load_dwordx4 v[192:195], v16, s[8:11], s49 offen offset:0
    buffer_load_dwordx4 v[196:199], v16, s[8:11], s49 offen offset:16
    buffer_load_dwordx4 v[200:203], v16, s[8:11], s49 offen offset:2048
    buffer_load_dwordx4 v[204:207], v16, s[8:11], s49 offen offset:2064
    s_mov_b32 s68, s72
    s_mov_b32 s69, s73
    s_mov_b32 s70, 2048
    s_mov_b32 s71, 0x00020000
    buffer_load_dwordx4 v[216:219], v16, s[68:71], 0 offen offset:0
    buffer_load_dwordx4 v[220:223], v16, s[68:71], 0 offen offset:16
    s_mov_b32 s32, 4294868992
    s_mov_b32 s33, 49152
    s_waitcnt vmcnt(12)
    s_barrier
    ds_read_b128 v[128:131], v10 offset:0
    ds_read_b64_tr_b16 v[32:33], v12 offset:0
    ds_read_b64_tr_b16 v[34:35], v12 offset:1024
    ds_read_b128 v[132:135], v11 offset:0
    ds_read_b64_tr_b16 v[36:37], v12 offset:8192
    ds_read_b64_tr_b16 v[38:39], v12 offset:9216
    ds_read_b128 v[136:139], v10 offset:2048
    ds_read_b128 v[140:143], v11 offset:2048
    ds_read_b128 v[144:147], v10 offset:4096
    ds_read_b128 v[148:151], v11 offset:4096
    ds_read_b128 v[152:155], v10 offset:6144
    ds_read_b128 v[156:159], v11 offset:6144
    s_add_u32 m0, s26, s30
    s_nop 0
    buffer_load_dwordx4 v8, s[12:15], s25 offen offset:0 lds
    buffer_load_dwordx4 v9, s[12:15], s25 offen offset:1024 lds
    s_add_u32 m0, s26, s29
    s_nop 0
    buffer_load_dwordx4 v4, s[8:11], s24 offen offset:0 lds
    buffer_load_dwordx4 v5, s[8:11], s24 offen offset:1024 lds
    buffer_load_dwordx4 v6, s[8:11], s24 offen offset:2048 lds
    buffer_load_dwordx4 v7, s[8:11], s24 offen offset:3072 lds
    s_add_u32 s24, s24, 128
    s_add_u32 s25, s25, s31
    s_waitcnt lgkmcnt(9)
    v_mfma_f32_16x16x32_bf16 v[64:67], v[128:131], v[32:35], 0
    ds_read_b64_tr_b16 v[40:41], v13 offset:0
    s_waitcnt lgkmcnt(7)
    v_mfma_f32_16x16x32_bf16 v[64:67], v[132:135], v[36:39], v[64:67]
    ds_read_b64_tr_b16 v[42:43], v13 offset:1024
    s_waitcnt lgkmcnt(7)
    v_mfma_f32_16x16x32_bf16 v[68:71], v[136:139], v[32:35], 0
    ds_read_b64_tr_b16 v[44:45], v13 offset:8192
    s_waitcnt lgkmcnt(7)
    v_mfma_f32_16x16x32_bf16 v[68:71], v[140:143], v[36:39], v[68:71]
    ds_read_b64_tr_b16 v[46:47], v13 offset:9216
    s_waitcnt lgkmcnt(7)
    v_mfma_f32_16x16x32_bf16 v[72:75], v[144:147], v[32:35], 0
    ds_read_b64_tr_b16 v[48:49], v14 offset:0
    s_waitcnt lgkmcnt(7)
    v_mfma_f32_16x16x32_bf16 v[72:75], v[148:151], v[36:39], v[72:75]
    ds_read_b64_tr_b16 v[50:51], v14 offset:1024
    s_waitcnt lgkmcnt(7)
    v_mfma_f32_16x16x32_bf16 v[76:79], v[152:155], v[32:35], 0
    ds_read_b64_tr_b16 v[52:53], v14 offset:8192
    s_waitcnt lgkmcnt(7)
    v_mfma_f32_16x16x32_bf16 v[76:79], v[156:159], v[36:39], v[76:79]
    ds_read_b64_tr_b16 v[54:55], v14 offset:9216
    s_waitcnt lgkmcnt(6)
    v_mfma_f32_16x16x32_bf16 v[80:83], v[128:131], v[40:43], 0
    ds_read_b64_tr_b16 v[56:57], v15 offset:0
    s_waitcnt lgkmcnt(5)
    v_mfma_f32_16x16x32_bf16 v[80:83], v[132:135], v[44:47], v[80:83]
    ds_read_b64_tr_b16 v[58:59], v15 offset:1024
    v_mfma_f32_16x16x32_bf16 v[84:87], v[136:139], v[40:43], 0
    ds_read_b64_tr_b16 v[60:61], v15 offset:8192
    v_mfma_f32_16x16x32_bf16 v[84:87], v[140:143], v[44:47], v[84:87]
    ds_read_b64_tr_b16 v[62:63], v15 offset:9216
    v_mfma_f32_16x16x32_bf16 v[88:91], v[144:147], v[40:43], 0
    s_add_u32 s26, s26, 49152
    s_cmp_eq_u32 s26, 147456
    s_cselect_b32 s26, 0, s26
    s_cmp_eq_u32 s26, 98304
    s_cselect_b32 s27, s32, s33
    v_mfma_f32_16x16x32_bf16 v[88:91], v[148:151], v[44:47], v[88:91]
    v_add_u32 v10, s27, v10
    v_add_u32 v11, s27, v11
    v_add_u32 v12, s27, v12
    v_mfma_f32_16x16x32_bf16 v[92:95], v[152:155], v[40:43], 0
    v_add_u32 v13, s27, v13
    v_add_u32 v14, s27, v14
    v_add_u32 v15, s27, v15
    v_mfma_f32_16x16x32_bf16 v[92:95], v[156:159], v[44:47], v[92:95]
    s_waitcnt vmcnt(12) lgkmcnt(0)
    s_barrier
    s_add_u32 m0, s26, s30
    v_mfma_f32_16x16x32_bf16 v[96:99], v[128:131], v[48:51], 0
    ds_read_b128 v[160:163], v10 offset:0
    buffer_load_dwordx4 v8, s[12:15], s25 offen offset:0 lds
    v_mfma_f32_16x16x32_bf16 v[96:99], v[132:135], v[52:55], v[96:99]
    ds_read_b64_tr_b16 v[32:33], v12 offset:0
    v_mfma_f32_16x16x32_bf16 v[100:103], v[136:139], v[48:51], 0
    ds_read_b64_tr_b16 v[34:35], v12 offset:1024
    v_mfma_f32_16x16x32_bf16 v[100:103], v[140:143], v[52:55], v[100:103]
    ds_read_b128 v[164:167], v11 offset:0
    v_mfma_f32_16x16x32_bf16 v[104:107], v[144:147], v[48:51], 0
    ds_read_b64_tr_b16 v[36:37], v12 offset:8192
    buffer_load_dwordx4 v9, s[12:15], s25 offen offset:1024 lds
    v_mfma_f32_16x16x32_bf16 v[104:107], v[148:151], v[52:55], v[104:107]
    ds_read_b64_tr_b16 v[38:39], v12 offset:9216
    v_mfma_f32_16x16x32_bf16 v[108:111], v[152:155], v[48:51], 0
    ds_read_b128 v[168:171], v10 offset:2048
    v_mfma_f32_16x16x32_bf16 v[108:111], v[156:159], v[52:55], v[108:111]
    ds_read_b128 v[172:175], v11 offset:2048
    v_mfma_f32_16x16x32_bf16 v[112:115], v[128:131], v[56:59], 0
    ds_read_b128 v[176:179], v10 offset:4096
    s_add_u32 m0, s26, s29
    v_mfma_f32_16x16x32_bf16 v[112:115], v[132:135], v[60:63], v[112:115]
    ds_read_b128 v[180:183], v11 offset:4096
    buffer_load_dwordx4 v4, s[8:11], s24 offen offset:0 lds
    v_mfma_f32_16x16x32_bf16 v[116:119], v[136:139], v[56:59], 0
    ds_read_b128 v[184:187], v10 offset:6144
    v_mfma_f32_16x16x32_bf16 v[116:119], v[140:143], v[60:63], v[116:119]
    ds_read_b128 v[188:191], v11 offset:6144
    v_mfma_f32_16x16x32_bf16 v[120:123], v[144:147], v[56:59], 0
    ds_read_b64_tr_b16 v[40:41], v13 offset:0
    v_mfma_f32_16x16x32_bf16 v[120:123], v[148:151], v[60:63], v[120:123]
    ds_read_b64_tr_b16 v[42:43], v13 offset:1024
    v_mfma_f32_16x16x32_bf16 v[124:127], v[152:155], v[56:59], 0
    ds_read_b64_tr_b16 v[44:45], v13 offset:8192
    buffer_load_dwordx4 v5, s[8:11], s24 offen offset:1024 lds
    v_mfma_f32_16x16x32_bf16 v[124:127], v[156:159], v[60:63], v[124:127]
    ds_read_b64_tr_b16 v[46:47], v13 offset:9216
    s_waitcnt lgkmcnt(13)
    v_mfma_f32_16x16x32_bf16 v[64:67], v[160:163], v[32:35], v[64:67]
    ds_read_b64_tr_b16 v[48:49], v14 offset:0
    s_waitcnt lgkmcnt(11)
    v_mfma_f32_16x16x32_bf16 v[64:67], v[164:167], v[36:39], v[64:67]
    ds_read_b64_tr_b16 v[50:51], v14 offset:1024
    s_waitcnt lgkmcnt(11)
    v_mfma_f32_16x16x32_bf16 v[68:71], v[168:171], v[32:35], v[68:71]
    ds_read_b64_tr_b16 v[52:53], v14 offset:8192
    s_waitcnt lgkmcnt(11)
    v_mfma_f32_16x16x32_bf16 v[68:71], v[172:175], v[36:39], v[68:71]
    ds_read_b64_tr_b16 v[54:55], v14 offset:9216
    s_waitcnt lgkmcnt(11)
    v_mfma_f32_16x16x32_bf16 v[72:75], v[176:179], v[32:35], v[72:75]
    ds_read_b64_tr_b16 v[56:57], v15 offset:0
    buffer_load_dwordx4 v6, s[8:11], s24 offen offset:2048 lds
    s_waitcnt lgkmcnt(11)
    v_mfma_f32_16x16x32_bf16 v[72:75], v[180:183], v[36:39], v[72:75]
    ds_read_b64_tr_b16 v[58:59], v15 offset:1024
    s_waitcnt lgkmcnt(11)
    v_mfma_f32_16x16x32_bf16 v[76:79], v[184:187], v[32:35], v[76:79]
    ds_read_b64_tr_b16 v[60:61], v15 offset:8192
    s_waitcnt lgkmcnt(11)
    v_mfma_f32_16x16x32_bf16 v[76:79], v[188:191], v[36:39], v[76:79]
    ds_read_b64_tr_b16 v[62:63], v15 offset:9216
    s_waitcnt lgkmcnt(10)
    v_mfma_f32_16x16x32_bf16 v[80:83], v[160:163], v[40:43], v[80:83]
    s_waitcnt lgkmcnt(8)
    v_mfma_f32_16x16x32_bf16 v[80:83], v[164:167], v[44:47], v[80:83]
    v_mfma_f32_16x16x32_bf16 v[84:87], v[168:171], v[40:43], v[84:87]
    buffer_load_dwordx4 v7, s[8:11], s24 offen offset:3072 lds
    v_mfma_f32_16x16x32_bf16 v[84:87], v[172:175], v[44:47], v[84:87]
    s_add_u32 s24, s24, 128
    s_add_u32 s25, s25, s31
    v_mfma_f32_16x16x32_bf16 v[88:91], v[176:179], v[40:43], v[88:91]
    s_add_u32 s26, s26, 49152
    s_cmp_eq_u32 s26, 147456
    s_cselect_b32 s26, 0, s26
    s_cmp_eq_u32 s26, 98304
    s_cselect_b32 s27, s32, s33
    v_mfma_f32_16x16x32_bf16 v[88:91], v[180:183], v[44:47], v[88:91]
    v_add_u32 v10, s27, v10
    v_add_u32 v11, s27, v11
    v_add_u32 v12, s27, v12
    v_mfma_f32_16x16x32_bf16 v[92:95], v[184:187], v[40:43], v[92:95]
    v_add_u32 v13, s27, v13
    v_add_u32 v14, s27, v14
    v_add_u32 v15, s27, v15
    v_mfma_f32_16x16x32_bf16 v[92:95], v[188:191], v[44:47], v[92:95]
    s_waitcnt vmcnt(6) lgkmcnt(0)
    s_barrier
    s_add_u32 m0, s26, s30
    v_mfma_f32_16x16x32_bf16 v[96:99], v[160:163], v[48:51], v[96:99]
    ds_read_b128 v[128:131], v10 offset:0
    buffer_load_dwordx4 v8, s[12:15], s25 offen offset:0 lds
    v_mov_b32 v208, 0
    v_mov_b32 v209, 0
    v_mfma_f32_16x16x32_bf16 v[96:99], v[164:167], v[52:55], v[96:99]
    ds_read_b64_tr_b16 v[32:33], v12 offset:0
    v_mov_b32 v210, 0
    v_mov_b32 v211, 0
    v_mov_b32 v212, 0
    v_mfma_f32_16x16x32_bf16 v[100:103], v[168:171], v[48:51], v[100:103]
    ds_read_b64_tr_b16 v[34:35], v12 offset:1024
    v_mov_b32 v213, 0
    v_lshlrev_b32 v224, 16, v216
    v_and_b32 v225, 0xffff0000, v216
    v_mfma_f32_16x16x32_bf16 v[100:103], v[172:175], v[52:55], v[100:103]
    ds_read_b128 v[132:135], v11 offset:0
    v_lshlrev_b32 v226, 16, v192
    v_and_b32 v227, 0xffff0000, v192
    v_lshlrev_b32 v228, 16, v200
    v_mfma_f32_16x16x32_bf16 v[104:107], v[176:179], v[48:51], v[104:107]
    ds_read_b64_tr_b16 v[36:37], v12 offset:8192
    buffer_load_dwordx4 v9, s[12:15], s25 offen offset:1024 lds
    v_and_b32 v229, 0xffff0000, v200
    v_add_f32 v208, v208, v226
    v_fma_f32 v209, v226, v226, v209
    v_mfma_f32_16x16x32_bf16 v[104:107], v[180:183], v[52:55], v[104:107]
    ds_read_b64_tr_b16 v[38:39], v12 offset:9216
    v_mul_f32 v226, v226, v224
    v_add_f32 v208, v208, v227
    v_fma_f32 v209, v227, v227, v209
    v_mfma_f32_16x16x32_bf16 v[108:111], v[184:187], v[48:51], v[108:111]
    ds_read_b128 v[136:139], v10 offset:2048
    v_mul_f32 v227, v227, v225
    v_add_f32 v210, v210, v228
    v_mfma_f32_16x16x32_bf16 v[108:111], v[188:191], v[52:55], v[108:111]
    ds_read_b128 v[140:143], v11 offset:2048
    v_fma_f32 v211, v228, v228, v211
    v_mul_f32 v228, v228, v224
    v_add_f32 v210, v210, v229
    v_mfma_f32_16x16x32_bf16 v[112:115], v[160:163], v[56:59], v[112:115]
    ds_read_b128 v[144:147], v10 offset:4096
    s_add_u32 m0, s26, s29
    v_fma_f32 v211, v229, v229, v211
    v_mul_f32 v229, v229, v225
    v_cvt_pk_bf16_f32 v226, v226, v227
    v_mfma_f32_16x16x32_bf16 v[112:115], v[164:167], v[60:63], v[112:115]
    ds_read_b128 v[148:151], v11 offset:4096
    buffer_load_dwordx4 v4, s[8:11], s24 offen offset:0 lds
    v_cvt_pk_bf16_f32 v228, v228, v229
    v_lshlrev_b32 v227, 16, v226
    v_and_b32 v226, 0xffff0000, v226
    v_mfma_f32_16x16x32_bf16 v[116:119], v[168:171], v[56:59], v[116:119]
    ds_read_b128 v[152:155], v10 offset:6144
    v_add_f32 v212, v212, v227
    v_add_f32 v212, v212, v226
    v_lshlrev_b32 v229, 16, v228
    v_mfma_f32_16x16x32_bf16 v[116:119], v[172:175], v[60:63], v[116:119]
    ds_read_b128 v[156:159], v11 offset:6144
    v_and_b32 v228, 0xffff0000, v228
    v_add_f32 v213, v213, v229
    v_add_f32 v213, v213, v228
    v_mfma_f32_16x16x32_bf16 v[120:123], v[176:179], v[56:59], v[120:123]
    ds_read_b64_tr_b16 v[40:41], v13 offset:0
    v_lshlrev_b32 v224, 16, v217
    v_and_b32 v225, 0xffff0000, v217
    v_lshlrev_b32 v226, 16, v193
    v_mfma_f32_16x16x32_bf16 v[120:123], v[180:183], v[60:63], v[120:123]
    ds_read_b64_tr_b16 v[42:43], v13 offset:1024
    v_and_b32 v227, 0xffff0000, v193
    v_lshlrev_b32 v228, 16, v201
    v_mfma_f32_16x16x32_bf16 v[124:127], v[184:187], v[56:59], v[124:127]
    ds_read_b64_tr_b16 v[44:45], v13 offset:8192
    buffer_load_dwordx4 v5, s[8:11], s24 offen offset:1024 lds
    v_and_b32 v229, 0xffff0000, v201
    v_add_f32 v208, v208, v226
    v_fma_f32 v209, v226, v226, v209
    v_mfma_f32_16x16x32_bf16 v[124:127], v[188:191], v[60:63], v[124:127]
    ds_read_b64_tr_b16 v[46:47], v13 offset:9216
    v_mul_f32 v226, v226, v224
    v_add_f32 v208, v208, v227
    v_fma_f32 v209, v227, v227, v209
    s_waitcnt lgkmcnt(13)
    v_mfma_f32_16x16x32_bf16 v[64:67], v[128:131], v[32:35], v[64:67]
    ds_read_b64_tr_b16 v[48:49], v14 offset:0
    v_mul_f32 v227, v227, v225
    v_add_f32 v210, v210, v228
    v_fma_f32 v211, v228, v228, v211
    s_waitcnt lgkmcnt(11)
    v_mfma_f32_16x16x32_bf16 v[64:67], v[132:135], v[36:39], v[64:67]
    ds_read_b64_tr_b16 v[50:51], v14 offset:1024
    v_mul_f32 v228, v228, v224
    v_add_f32 v210, v210, v229
    v_fma_f32 v211, v229, v229, v211
    s_waitcnt lgkmcnt(11)
    v_mfma_f32_16x16x32_bf16 v[68:71], v[136:139], v[32:35], v[68:71]
    ds_read_b64_tr_b16 v[52:53], v14 offset:8192
    v_mul_f32 v229, v229, v225
    v_cvt_pk_bf16_f32 v226, v226, v227
    v_cvt_pk_bf16_f32 v228, v228, v229
    s_waitcnt lgkmcnt(11)
    v_mfma_f32_16x16x32_bf16 v[68:71], v[140:143], v[36:39], v[68:71]
    ds_read_b64_tr_b16 v[54:55], v14 offset:9216
    v_lshlrev_b32 v227, 16, v226
    v_and_b32 v226, 0xffff0000, v226
    v_add_f32 v212, v212, v227
    s_waitcnt lgkmcnt(11)
    v_mfma_f32_16x16x32_bf16 v[72:75], v[144:147], v[32:35], v[72:75]
    ds_read_b64_tr_b16 v[56:57], v15 offset:0
    buffer_load_dwordx4 v6, s[8:11], s24 offen offset:2048 lds
    v_add_f32 v212, v212, v226
    v_lshlrev_b32 v229, 16, v228
    s_waitcnt lgkmcnt(11)
    v_mfma_f32_16x16x32_bf16 v[72:75], v[148:151], v[36:39], v[72:75]
    ds_read_b64_tr_b16 v[58:59], v15 offset:1024
    v_and_b32 v228, 0xffff0000, v228
    v_add_f32 v213, v213, v229
    v_add_f32 v213, v213, v228
    s_waitcnt lgkmcnt(11)
    v_mfma_f32_16x16x32_bf16 v[76:79], v[152:155], v[32:35], v[76:79]
    ds_read_b64_tr_b16 v[60:61], v15 offset:8192
    v_lshlrev_b32 v224, 16, v218
    v_and_b32 v225, 0xffff0000, v218
    v_lshlrev_b32 v226, 16, v194
    s_waitcnt lgkmcnt(11)
    v_mfma_f32_16x16x32_bf16 v[76:79], v[156:159], v[36:39], v[76:79]
    ds_read_b64_tr_b16 v[62:63], v15 offset:9216
    v_and_b32 v227, 0xffff0000, v194
    v_lshlrev_b32 v228, 16, v202
    v_and_b32 v229, 0xffff0000, v202
    s_waitcnt lgkmcnt(10)
    v_mfma_f32_16x16x32_bf16 v[80:83], v[128:131], v[40:43], v[80:83]
    v_add_f32 v208, v208, v226
    v_fma_f32 v209, v226, v226, v209
    v_mul_f32 v226, v226, v224
    s_waitcnt lgkmcnt(8)
    v_mfma_f32_16x16x32_bf16 v[80:83], v[132:135], v[44:47], v[80:83]
    v_add_f32 v208, v208, v227
    v_fma_f32 v209, v227, v227, v209
    v_mul_f32 v227, v227, v225
    v_mfma_f32_16x16x32_bf16 v[84:87], v[136:139], v[40:43], v[84:87]
    buffer_load_dwordx4 v7, s[8:11], s24 offen offset:3072 lds
    v_add_f32 v210, v210, v228
    v_fma_f32 v211, v228, v228, v211
    v_mfma_f32_16x16x32_bf16 v[84:87], v[140:143], v[44:47], v[84:87]
    s_add_u32 s24, s24, 128
    s_add_u32 s25, s25, s31
    v_mfma_f32_16x16x32_bf16 v[88:91], v[144:147], v[40:43], v[88:91]
    s_add_u32 s26, s26, 49152
    s_cmp_eq_u32 s26, 147456
    s_cselect_b32 s26, 0, s26
    s_cmp_eq_u32 s26, 98304
    s_cselect_b32 s27, s32, s33
    v_mfma_f32_16x16x32_bf16 v[88:91], v[148:151], v[44:47], v[88:91]
    v_add_u32 v10, s27, v10
    v_add_u32 v11, s27, v11
    v_add_u32 v12, s27, v12
    v_mfma_f32_16x16x32_bf16 v[92:95], v[152:155], v[40:43], v[92:95]
    v_add_u32 v13, s27, v13
    v_add_u32 v14, s27, v14
    v_add_u32 v15, s27, v15
    v_mfma_f32_16x16x32_bf16 v[92:95], v[156:159], v[44:47], v[92:95]
    s_waitcnt vmcnt(6) lgkmcnt(0)
    s_barrier
    s_add_u32 m0, s26, s30
    v_mfma_f32_16x16x32_bf16 v[96:99], v[128:131], v[48:51], v[96:99]
    ds_read_b128 v[160:163], v10 offset:0
    buffer_load_dwordx4 v8, s[12:15], s25 offen offset:0 lds
    v_mul_f32 v228, v228, v224
    v_add_f32 v210, v210, v229
    v_fma_f32 v211, v229, v229, v211
    v_mfma_f32_16x16x32_bf16 v[96:99], v[132:135], v[52:55], v[96:99]
    ds_read_b64_tr_b16 v[32:33], v12 offset:0
    v_mul_f32 v229, v229, v225
    v_cvt_pk_bf16_f32 v226, v226, v227
    v_cvt_pk_bf16_f32 v228, v228, v229
    v_mfma_f32_16x16x32_bf16 v[100:103], v[136:139], v[48:51], v[100:103]
    ds_read_b64_tr_b16 v[34:35], v12 offset:1024
    v_lshlrev_b32 v227, 16, v226
    v_and_b32 v226, 0xffff0000, v226
    v_add_f32 v212, v212, v227
    v_mfma_f32_16x16x32_bf16 v[100:103], v[140:143], v[52:55], v[100:103]
    ds_read_b128 v[164:167], v11 offset:0
    v_add_f32 v212, v212, v226
    v_lshlrev_b32 v229, 16, v228
    v_and_b32 v228, 0xffff0000, v228
    v_mfma_f32_16x16x32_bf16 v[104:107], v[144:147], v[48:51], v[104:107]
    ds_read_b64_tr_b16 v[36:37], v12 offset:8192
    buffer_load_dwordx4 v9, s[12:15], s25 offen offset:1024 lds
    v_add_f32 v213, v213, v229
    v_add_f32 v213, v213, v228
    v_lshlrev_b32 v224, 16, v219
    v_mfma_f32_16x16x32_bf16 v[104:107], v[148:151], v[52:55], v[104:107]
    ds_read_b64_tr_b16 v[38:39], v12 offset:9216
    v_and_b32 v225, 0xffff0000, v219
    v_lshlrev_b32 v226, 16, v195
    v_and_b32 v227, 0xffff0000, v195
    v_mfma_f32_16x16x32_bf16 v[108:111], v[152:155], v[48:51], v[108:111]
    ds_read_b128 v[168:171], v10 offset:2048
    v_lshlrev_b32 v228, 16, v203
    v_and_b32 v229, 0xffff0000, v203
    v_mfma_f32_16x16x32_bf16 v[108:111], v[156:159], v[52:55], v[108:111]
    ds_read_b128 v[172:175], v11 offset:2048
    v_add_f32 v208, v208, v226
    v_fma_f32 v209, v226, v226, v209
    v_mul_f32 v226, v226, v224
    v_mfma_f32_16x16x32_bf16 v[112:115], v[128:131], v[56:59], v[112:115]
    ds_read_b128 v[176:179], v10 offset:4096
    s_add_u32 m0, s26, s29
    v_add_f32 v208, v208, v227
    v_fma_f32 v209, v227, v227, v209
    v_mul_f32 v227, v227, v225
    v_mfma_f32_16x16x32_bf16 v[112:115], v[132:135], v[60:63], v[112:115]
    ds_read_b128 v[180:183], v11 offset:4096
    buffer_load_dwordx4 v4, s[8:11], s24 offen offset:0 lds
    v_add_f32 v210, v210, v228
    v_fma_f32 v211, v228, v228, v211
    v_mul_f32 v228, v228, v224
    v_mfma_f32_16x16x32_bf16 v[116:119], v[136:139], v[56:59], v[116:119]
    ds_read_b128 v[184:187], v10 offset:6144
    v_add_f32 v210, v210, v229
    v_fma_f32 v211, v229, v229, v211
    v_mul_f32 v229, v229, v225
    v_mfma_f32_16x16x32_bf16 v[116:119], v[140:143], v[60:63], v[116:119]
    ds_read_b128 v[188:191], v11 offset:6144
    v_cvt_pk_bf16_f32 v226, v226, v227
    v_cvt_pk_bf16_f32 v228, v228, v229
    v_lshlrev_b32 v227, 16, v226
    v_mfma_f32_16x16x32_bf16 v[120:123], v[144:147], v[56:59], v[120:123]
    ds_read_b64_tr_b16 v[40:41], v13 offset:0
    v_and_b32 v226, 0xffff0000, v226
    v_add_f32 v212, v212, v227
    v_add_f32 v212, v212, v226
    v_mfma_f32_16x16x32_bf16 v[120:123], v[148:151], v[60:63], v[120:123]
    ds_read_b64_tr_b16 v[42:43], v13 offset:1024
    v_lshlrev_b32 v229, 16, v228
    v_and_b32 v228, 0xffff0000, v228
    v_mfma_f32_16x16x32_bf16 v[124:127], v[152:155], v[56:59], v[124:127]
    ds_read_b64_tr_b16 v[44:45], v13 offset:8192
    buffer_load_dwordx4 v5, s[8:11], s24 offen offset:1024 lds
    v_add_f32 v213, v213, v229
    v_add_f32 v213, v213, v228
    v_lshlrev_b32 v224, 16, v220
    v_mfma_f32_16x16x32_bf16 v[124:127], v[156:159], v[60:63], v[124:127]
    ds_read_b64_tr_b16 v[46:47], v13 offset:9216
    v_and_b32 v225, 0xffff0000, v220
    v_lshlrev_b32 v226, 16, v196
    v_and_b32 v227, 0xffff0000, v196
    s_waitcnt lgkmcnt(13)
    v_mfma_f32_16x16x32_bf16 v[64:67], v[160:163], v[32:35], v[64:67]
    ds_read_b64_tr_b16 v[48:49], v14 offset:0
    v_lshlrev_b32 v228, 16, v204
    v_and_b32 v229, 0xffff0000, v204
    v_add_f32 v208, v208, v226
    s_waitcnt lgkmcnt(11)
    v_mfma_f32_16x16x32_bf16 v[64:67], v[164:167], v[36:39], v[64:67]
    ds_read_b64_tr_b16 v[50:51], v14 offset:1024
    v_fma_f32 v209, v226, v226, v209
    v_mul_f32 v226, v226, v224
    v_add_f32 v208, v208, v227
    s_waitcnt lgkmcnt(11)
    v_mfma_f32_16x16x32_bf16 v[68:71], v[168:171], v[32:35], v[68:71]
    ds_read_b64_tr_b16 v[52:53], v14 offset:8192
    v_fma_f32 v209, v227, v227, v209
    v_mul_f32 v227, v227, v225
    v_add_f32 v210, v210, v228
    s_waitcnt lgkmcnt(11)
    v_mfma_f32_16x16x32_bf16 v[68:71], v[172:175], v[36:39], v[68:71]
    ds_read_b64_tr_b16 v[54:55], v14 offset:9216
    v_fma_f32 v211, v228, v228, v211
    v_mul_f32 v228, v228, v224
    v_add_f32 v210, v210, v229
    s_waitcnt lgkmcnt(11)
    v_mfma_f32_16x16x32_bf16 v[72:75], v[176:179], v[32:35], v[72:75]
    ds_read_b64_tr_b16 v[56:57], v15 offset:0
    buffer_load_dwordx4 v6, s[8:11], s24 offen offset:2048 lds
    v_fma_f32 v211, v229, v229, v211
    v_mul_f32 v229, v229, v225
    s_waitcnt lgkmcnt(11)
    v_mfma_f32_16x16x32_bf16 v[72:75], v[180:183], v[36:39], v[72:75]
    ds_read_b64_tr_b16 v[58:59], v15 offset:1024
    v_cvt_pk_bf16_f32 v226, v226, v227
    v_cvt_pk_bf16_f32 v228, v228, v229
    v_lshlrev_b32 v227, 16, v226
    s_waitcnt lgkmcnt(11)
    v_mfma_f32_16x16x32_bf16 v[76:79], v[184:187], v[32:35], v[76:79]
    ds_read_b64_tr_b16 v[60:61], v15 offset:8192
    v_and_b32 v226, 0xffff0000, v226
    v_add_f32 v212, v212, v227
    v_add_f32 v212, v212, v226
    s_waitcnt lgkmcnt(11)
    v_mfma_f32_16x16x32_bf16 v[76:79], v[188:191], v[36:39], v[76:79]
    ds_read_b64_tr_b16 v[62:63], v15 offset:9216
    v_lshlrev_b32 v229, 16, v228
    v_and_b32 v228, 0xffff0000, v228
    v_add_f32 v213, v213, v229
    s_waitcnt lgkmcnt(10)
    v_mfma_f32_16x16x32_bf16 v[80:83], v[160:163], v[40:43], v[80:83]
    v_add_f32 v213, v213, v228
    v_lshlrev_b32 v224, 16, v221
    v_and_b32 v225, 0xffff0000, v221
    s_waitcnt lgkmcnt(8)
    v_mfma_f32_16x16x32_bf16 v[80:83], v[164:167], v[44:47], v[80:83]
    v_lshlrev_b32 v226, 16, v197
    v_and_b32 v227, 0xffff0000, v197
    v_lshlrev_b32 v228, 16, v205
    v_mfma_f32_16x16x32_bf16 v[84:87], v[168:171], v[40:43], v[84:87]
    buffer_load_dwordx4 v7, s[8:11], s24 offen offset:3072 lds
    v_and_b32 v229, 0xffff0000, v205
    v_add_f32 v208, v208, v226
    v_mfma_f32_16x16x32_bf16 v[84:87], v[172:175], v[44:47], v[84:87]
    s_add_u32 s24, s24, 128
    s_add_u32 s25, s25, s31
    v_mfma_f32_16x16x32_bf16 v[88:91], v[176:179], v[40:43], v[88:91]
    s_add_u32 s26, s26, 49152
    s_cmp_eq_u32 s26, 147456
    s_cselect_b32 s26, 0, s26
    s_cmp_eq_u32 s26, 98304
    s_cselect_b32 s27, s32, s33
    v_mfma_f32_16x16x32_bf16 v[88:91], v[180:183], v[44:47], v[88:91]
    v_add_u32 v10, s27, v10
    v_add_u32 v11, s27, v11
    v_add_u32 v12, s27, v12
    v_mfma_f32_16x16x32_bf16 v[92:95], v[184:187], v[40:43], v[92:95]
    v_add_u32 v13, s27, v13
    v_add_u32 v14, s27, v14
    v_add_u32 v15, s27, v15
    v_mfma_f32_16x16x32_bf16 v[92:95], v[188:191], v[44:47], v[92:95]
    s_waitcnt vmcnt(6) lgkmcnt(0)
    s_barrier
    s_add_u32 m0, s26, s30
    v_mfma_f32_16x16x32_bf16 v[96:99], v[160:163], v[48:51], v[96:99]
    ds_read_b128 v[128:131], v10 offset:0
    buffer_load_dwordx4 v8, s[12:15], s25 offen offset:0 lds
    v_fma_f32 v209, v226, v226, v209
    v_mul_f32 v226, v226, v224
    v_add_f32 v208, v208, v227
    v_mfma_f32_16x16x32_bf16 v[96:99], v[164:167], v[52:55], v[96:99]
    ds_read_b64_tr_b16 v[32:33], v12 offset:0
    v_fma_f32 v209, v227, v227, v209
    v_mul_f32 v227, v227, v225
    v_add_f32 v210, v210, v228
    v_mfma_f32_16x16x32_bf16 v[100:103], v[168:171], v[48:51], v[100:103]
    ds_read_b64_tr_b16 v[34:35], v12 offset:1024
    v_fma_f32 v211, v228, v228, v211
    v_mul_f32 v228, v228, v224
    v_add_f32 v210, v210, v229
    v_mfma_f32_16x16x32_bf16 v[100:103], v[172:175], v[52:55], v[100:103]
    ds_read_b128 v[132:135], v11 offset:0
    v_fma_f32 v211, v229, v229, v211
    v_mul_f32 v229, v229, v225
    v_cvt_pk_bf16_f32 v226, v226, v227
    v_mfma_f32_16x16x32_bf16 v[104:107], v[176:179], v[48:51], v[104:107]
    ds_read_b64_tr_b16 v[36:37], v12 offset:8192
    buffer_load_dwordx4 v9, s[12:15], s25 offen offset:1024 lds
    v_cvt_pk_bf16_f32 v228, v228, v229
    v_lshlrev_b32 v227, 16, v226
    v_and_b32 v226, 0xffff0000, v226
    v_mfma_f32_16x16x32_bf16 v[104:107], v[180:183], v[52:55], v[104:107]
    ds_read_b64_tr_b16 v[38:39], v12 offset:9216
    v_add_f32 v212, v212, v227
    v_add_f32 v212, v212, v226
    v_lshlrev_b32 v229, 16, v228
    v_mfma_f32_16x16x32_bf16 v[108:111], v[184:187], v[48:51], v[108:111]
    ds_read_b128 v[136:139], v10 offset:2048
    v_and_b32 v228, 0xffff0000, v228
    v_add_f32 v213, v213, v229
    v_mfma_f32_16x16x32_bf16 v[108:111], v[188:191], v[52:55], v[108:111]
    ds_read_b128 v[140:143], v11 offset:2048
    v_add_f32 v213, v213, v228
    v_lshlrev_b32 v224, 16, v222
    v_and_b32 v225, 0xffff0000, v222
    v_mfma_f32_16x16x32_bf16 v[112:115], v[160:163], v[56:59], v[112:115]
    ds_read_b128 v[144:147], v10 offset:4096
    s_add_u32 m0, s26, s29
    v_lshlrev_b32 v226, 16, v198
    v_and_b32 v227, 0xffff0000, v198
    v_lshlrev_b32 v228, 16, v206
    v_mfma_f32_16x16x32_bf16 v[112:115], v[164:167], v[60:63], v[112:115]
    ds_read_b128 v[148:151], v11 offset:4096
    buffer_load_dwordx4 v4, s[8:11], s24 offen offset:0 lds
    v_and_b32 v229, 0xffff0000, v206
    v_add_f32 v208, v208, v226
    v_fma_f32 v209, v226, v226, v209
    v_mfma_f32_16x16x32_bf16 v[116:119], v[168:171], v[56:59], v[116:119]
    ds_read_b128 v[152:155], v10 offset:6144
    v_mul_f32 v226, v226, v224
    v_add_f32 v208, v208, v227
    v_fma_f32 v209, v227, v227, v209
    v_mfma_f32_16x16x32_bf16 v[116:119], v[172:175], v[60:63], v[116:119]
    ds_read_b128 v[156:159], v11 offset:6144
    v_mul_f32 v227, v227, v225
    v_add_f32 v210, v210, v228
    v_fma_f32 v211, v228, v228, v211
    v_mfma_f32_16x16x32_bf16 v[120:123], v[176:179], v[56:59], v[120:123]
    ds_read_b64_tr_b16 v[40:41], v13 offset:0
    v_mul_f32 v228, v228, v224
    v_add_f32 v210, v210, v229
    v_fma_f32 v211, v229, v229, v211
    v_mfma_f32_16x16x32_bf16 v[120:123], v[180:183], v[60:63], v[120:123]
    ds_read_b64_tr_b16 v[42:43], v13 offset:1024
    v_mul_f32 v229, v229, v225
    v_cvt_pk_bf16_f32 v226, v226, v227
    v_mfma_f32_16x16x32_bf16 v[124:127], v[184:187], v[56:59], v[124:127]
    ds_read_b64_tr_b16 v[44:45], v13 offset:8192
    buffer_load_dwordx4 v5, s[8:11], s24 offen offset:1024 lds
    v_cvt_pk_bf16_f32 v228, v228, v229
    v_lshlrev_b32 v227, 16, v226
    v_and_b32 v226, 0xffff0000, v226
    v_mfma_f32_16x16x32_bf16 v[124:127], v[188:191], v[60:63], v[124:127]
    ds_read_b64_tr_b16 v[46:47], v13 offset:9216
    v_add_f32 v212, v212, v227
    v_add_f32 v212, v212, v226
    v_lshlrev_b32 v229, 16, v228
    s_waitcnt lgkmcnt(13)
    v_mfma_f32_16x16x32_bf16 v[64:67], v[128:131], v[32:35], v[64:67]
    ds_read_b64_tr_b16 v[48:49], v14 offset:0
    v_and_b32 v228, 0xffff0000, v228
    v_add_f32 v213, v213, v229
    v_add_f32 v213, v213, v228
    s_waitcnt lgkmcnt(11)
    v_mfma_f32_16x16x32_bf16 v[64:67], v[132:135], v[36:39], v[64:67]
    ds_read_b64_tr_b16 v[50:51], v14 offset:1024
    v_lshlrev_b32 v224, 16, v223
    v_and_b32 v225, 0xffff0000, v223
    v_lshlrev_b32 v226, 16, v199
    s_waitcnt lgkmcnt(11)
    v_mfma_f32_16x16x32_bf16 v[68:71], v[136:139], v[32:35], v[68:71]
    ds_read_b64_tr_b16 v[52:53], v14 offset:8192
    v_and_b32 v227, 0xffff0000, v199
    v_lshlrev_b32 v228, 16, v207
    v_and_b32 v229, 0xffff0000, v207
    s_waitcnt lgkmcnt(11)
    v_mfma_f32_16x16x32_bf16 v[68:71], v[140:143], v[36:39], v[68:71]
    ds_read_b64_tr_b16 v[54:55], v14 offset:9216
    v_add_f32 v208, v208, v226
    v_fma_f32 v209, v226, v226, v209
    v_mul_f32 v226, v226, v224
    s_waitcnt lgkmcnt(11)
    v_mfma_f32_16x16x32_bf16 v[72:75], v[144:147], v[32:35], v[72:75]
    ds_read_b64_tr_b16 v[56:57], v15 offset:0
    buffer_load_dwordx4 v6, s[8:11], s24 offen offset:2048 lds
    v_add_f32 v208, v208, v227
    v_fma_f32 v209, v227, v227, v209
    s_waitcnt lgkmcnt(11)
    v_mfma_f32_16x16x32_bf16 v[72:75], v[148:151], v[36:39], v[72:75]
    ds_read_b64_tr_b16 v[58:59], v15 offset:1024
    v_mul_f32 v227, v227, v225
    v_add_f32 v210, v210, v228
    v_fma_f32 v211, v228, v228, v211
    s_waitcnt lgkmcnt(11)
    v_mfma_f32_16x16x32_bf16 v[76:79], v[152:155], v[32:35], v[76:79]
    ds_read_b64_tr_b16 v[60:61], v15 offset:8192
    v_mul_f32 v228, v228, v224
    v_add_f32 v210, v210, v229
    v_fma_f32 v211, v229, v229, v211
    s_waitcnt lgkmcnt(11)
    v_mfma_f32_16x16x32_bf16 v[76:79], v[156:159], v[36:39], v[76:79]
    ds_read_b64_tr_b16 v[62:63], v15 offset:9216
    v_mul_f32 v229, v229, v225
    v_cvt_pk_bf16_f32 v226, v226, v227
    v_cvt_pk_bf16_f32 v228, v228, v229
    s_waitcnt lgkmcnt(10)
    v_mfma_f32_16x16x32_bf16 v[80:83], v[128:131], v[40:43], v[80:83]
    v_lshlrev_b32 v227, 16, v226
    v_and_b32 v226, 0xffff0000, v226
    v_add_f32 v212, v212, v227
    s_waitcnt lgkmcnt(8)
    v_mfma_f32_16x16x32_bf16 v[80:83], v[132:135], v[44:47], v[80:83]
    v_add_f32 v212, v212, v226
    v_lshlrev_b32 v229, 16, v228
    v_and_b32 v228, 0xffff0000, v228
    v_mfma_f32_16x16x32_bf16 v[84:87], v[136:139], v[40:43], v[84:87]
    buffer_load_dwordx4 v7, s[8:11], s24 offen offset:3072 lds
    v_add_f32 v213, v213, v229
    v_add_f32 v213, v213, v228
    v_mfma_f32_16x16x32_bf16 v[84:87], v[140:143], v[44:47], v[84:87]
    s_add_u32 s24, s24, 128
    s_add_u32 s25, s25, s31
    v_mfma_f32_16x16x32_bf16 v[88:91], v[144:147], v[40:43], v[88:91]
    s_add_u32 s26, s26, 49152
    s_cmp_eq_u32 s26, 147456
    s_cselect_b32 s26, 0, s26
    s_cmp_eq_u32 s26, 98304
    s_cselect_b32 s27, s32, s33
    v_mfma_f32_16x16x32_bf16 v[88:91], v[148:151], v[44:47], v[88:91]
    v_add_u32 v10, s27, v10
    v_add_u32 v11, s27, v11
    v_add_u32 v12, s27, v12
    v_mfma_f32_16x16x32_bf16 v[92:95], v[152:155], v[40:43], v[92:95]
    v_add_u32 v13, s27, v13
    v_add_u32 v14, s27, v14
    v_add_u32 v15, s27, v15
    v_mfma_f32_16x16x32_bf16 v[92:95], v[156:159], v[44:47], v[92:95]
    s_waitcnt vmcnt(6) lgkmcnt(0)
    s_barrier
    s_add_u32 m0, s26, s30
    v_mfma_f32_16x16x32_bf16 v[96:99], v[128:131], v[48:51], v[96:99]
    ds_read_b128 v[160:163], v10 offset:0
    buffer_load_dwordx4 v8, s[12:15], s25 offen offset:0 lds
    s_nop 1
    v_add_f32_dpp v208, v208, v208 row_shr:1 row_mask:0xf bank_mask:0xf bound_ctrl:0
    v_add_f32_dpp v209, v209, v209 row_shr:1 row_mask:0xf bank_mask:0xf bound_ctrl:0
    v_mfma_f32_16x16x32_bf16 v[96:99], v[132:135], v[52:55], v[96:99]
    ds_read_b64_tr_b16 v[32:33], v12 offset:0
    v_add_f32_dpp v210, v210, v210 row_shr:1 row_mask:0xf bank_mask:0xf bound_ctrl:0
    v_add_f32_dpp v211, v211, v211 row_shr:1 row_mask:0xf bank_mask:0xf bound_ctrl:0
    v_add_f32_dpp v212, v212, v212 row_shr:1 row_mask:0xf bank_mask:0xf bound_ctrl:0
    v_mfma_f32_16x16x32_bf16 v[100:103], v[136:139], v[48:51], v[100:103]
    ds_read_b64_tr_b16 v[34:35], v12 offset:1024
    v_add_f32_dpp v213, v213, v213 row_shr:1 row_mask:0xf bank_mask:0xf bound_ctrl:0
    v_add_f32_dpp v208, v208, v208 row_shr:2 row_mask:0xf bank_mask:0xf bound_ctrl:0
    v_add_f32_dpp v209, v209, v209 row_shr:2 row_mask:0xf bank_mask:0xf bound_ctrl:0
    v_mfma_f32_16x16x32_bf16 v[100:103], v[140:143], v[52:55], v[100:103]
    ds_read_b128 v[164:167], v11 offset:0
    v_add_f32_dpp v210, v210, v210 row_shr:2 row_mask:0xf bank_mask:0xf bound_ctrl:0
    v_add_f32_dpp v211, v211, v211 row_shr:2 row_mask:0xf bank_mask:0xf bound_ctrl:0
    v_add_f32_dpp v212, v212, v212 row_shr:2 row_mask:0xf bank_mask:0xf bound_ctrl:0
    v_mfma_f32_16x16x32_bf16 v[104:107], v[144:147], v[48:51], v[104:107]
    ds_read_b64_tr_b16 v[36:37], v12 offset:8192
    buffer_load_dwordx4 v9, s[12:15], s25 offen offset:1024 lds
    v_add_f32_dpp v213, v213, v213 row_shr:2 row_mask:0xf bank_mask:0xf bound_ctrl:0
    v_add_f32_dpp v208, v208, v208 row_shr:4 row_mask:0xf bank_mask:0xf bound_ctrl:0
    v_add_f32_dpp v209, v209, v209 row_shr:4 row_mask:0xf bank_mask:0xf bound_ctrl:0
    v_mfma_f32_16x16x32_bf16 v[104:107], v[148:151], v[52:55], v[104:107]
    ds_read_b64_tr_b16 v[38:39], v12 offset:9216
    v_add_f32_dpp v210, v210, v210 row_shr:4 row_mask:0xf bank_mask:0xf bound_ctrl:0
    v_add_f32_dpp v211, v211, v211 row_shr:4 row_mask:0xf bank_mask:0xf bound_ctrl:0
    v_add_f32_dpp v212, v212, v212 row_shr:4 row_mask:0xf bank_mask:0xf bound_ctrl:0
    v_mfma_f32_16x16x32_bf16 v[108:111], v[152:155], v[48:51], v[108:111]
    ds_read_b128 v[168:171], v10 offset:2048
    v_add_f32_dpp v213, v213, v213 row_shr:4 row_mask:0xf bank_mask:0xf bound_ctrl:0
    v_add_f32_dpp v208, v208, v208 row_shr:8 row_mask:0xf bank_mask:0xf bound_ctrl:0
    v_mfma_f32_16x16x32_bf16 v[108:111], v[156:159], v[52:55], v[108:111]
    ds_read_b128 v[172:175], v11 offset:2048
    v_add_f32_dpp v209, v209, v209 row_shr:8 row_mask:0xf bank_mask:0xf bound_ctrl:0
    v_add_f32_dpp v210, v210, v210 row_shr:8 row_mask:0xf bank_mask:0xf bound_ctrl:0
    v_add_f32_dpp v211, v211, v211 row_shr:8 row_mask:0xf bank_mask:0xf bound_ctrl:0
    v_mfma_f32_16x16x32_bf16 v[112:115], v[128:131], v[56:59], v[112:115]
    ds_read_b128 v[176:179], v10 offset:4096
    s_add_u32 m0, s26, s29
    v_add_f32_dpp v212, v212, v212 row_shr:8 row_mask:0xf bank_mask:0xf bound_ctrl:0
    v_add_f32_dpp v213, v213, v213 row_shr:8 row_mask:0xf bank_mask:0xf bound_ctrl:0
    v_add_f32_dpp v208, v208, v208 row_bcast:15 row_mask:0xa bank_mask:0xf
    v_mfma_f32_16x16x32_bf16 v[112:115], v[132:135], v[60:63], v[112:115]
    ds_read_b128 v[180:183], v11 offset:4096
    buffer_load_dwordx4 v4, s[8:11], s24 offen offset:0 lds
    v_add_f32_dpp v209, v209, v209 row_bcast:15 row_mask:0xa bank_mask:0xf
    v_add_f32_dpp v210, v210, v210 row_bcast:15 row_mask:0xa bank_mask:0xf
    v_add_f32_dpp v211, v211, v211 row_bcast:15 row_mask:0xa bank_mask:0xf
    v_mfma_f32_16x16x32_bf16 v[116:119], v[136:139], v[56:59], v[116:119]
    ds_read_b128 v[184:187], v10 offset:6144
    v_add_f32_dpp v212, v212, v212 row_bcast:15 row_mask:0xa bank_mask:0xf
    v_add_f32_dpp v213, v213, v213 row_bcast:15 row_mask:0xa bank_mask:0xf
    v_add_f32_dpp v208, v208, v208 row_bcast:31 row_mask:0xc bank_mask:0xf
    v_mfma_f32_16x16x32_bf16 v[116:119], v[140:143], v[60:63], v[116:119]
    ds_read_b128 v[188:191], v11 offset:6144
    v_add_f32_dpp v209, v209, v209 row_bcast:31 row_mask:0xc bank_mask:0xf
    v_add_f32_dpp v210, v210, v210 row_bcast:31 row_mask:0xc bank_mask:0xf
    v_add_f32_dpp v211, v211, v211 row_bcast:31 row_mask:0xc bank_mask:0xf
    v_mfma_f32_16x16x32_bf16 v[120:123], v[144:147], v[56:59], v[120:123]
    ds_read_b64_tr_b16 v[40:41], v13 offset:0
    v_add_f32_dpp v212, v212, v212 row_bcast:31 row_mask:0xc bank_mask:0xf
    v_add_f32_dpp v213, v213, v213 row_bcast:31 row_mask:0xc bank_mask:0xf
    v_mul_f32 v208, 981467136, v208
    v_mfma_f32_16x16x32_bf16 v[120:123], v[148:151], v[60:63], v[120:123]
    ds_read_b64_tr_b16 v[42:43], v13 offset:1024
    v_mul_f32 v209, 981467136, v209
    v_fma_f32 v209, -v208, v208, v209
    v_mfma_f32_16x16x32_bf16 v[124:127], v[152:155], v[56:59], v[124:127]
    ds_read_b64_tr_b16 v[44:45], v13 offset:8192
    buffer_load_dwordx4 v5, s[8:11], s24 offen offset:1024 lds
    v_max_f32 v209, 0, v209
    v_add_f32 v209, 925353388, v209
    v_rsq_f32 v209, v209
    v_mfma_f32_16x16x32_bf16 v[124:127], v[156:159], v[60:63], v[124:127]
    ds_read_b64_tr_b16 v[46:47], v13 offset:9216
    v_mul_f32 v210, 981467136, v210
    v_mul_f32 v211, 981467136, v211
    v_fma_f32 v211, -v210, v210, v211
    s_waitcnt lgkmcnt(13)
    v_mfma_f32_16x16x32_bf16 v[64:67], v[160:163], v[32:35], v[64:67]
    ds_read_b64_tr_b16 v[48:49], v14 offset:0
    v_max_f32 v211, 0, v211
    v_add_f32 v211, 925353388, v211
    v_rsq_f32 v211, v211
    s_waitcnt lgkmcnt(11)
    v_mfma_f32_16x16x32_bf16 v[64:67], v[164:167], v[36:39], v[64:67]
    ds_read_b64_tr_b16 v[50:51], v14 offset:1024
    v_cvt_pk_bf16_f32 v212, v212, v213
    v_and_b32 v213, 0xffff0000, v212
    v_lshlrev_b32 v212, 16, v212
    s_waitcnt lgkmcnt(11)
    v_mfma_f32_16x16x32_bf16 v[68:71], v[168:171], v[32:35], v[68:71]
    ds_read_b64_tr_b16 v[52:53], v14 offset:8192
    v_mul_f32 v212, 3216550459, v212
    v_mul_f32 v213, 3216550459, v213
    v_exp_f32 v212, v212
    s_waitcnt lgkmcnt(11)
    v_mfma_f32_16x16x32_bf16 v[68:71], v[172:175], v[36:39], v[68:71]
    ds_read_b64_tr_b16 v[54:55], v14 offset:9216
    v_exp_f32 v213, v213
    s_nop 0
    v_add_f32 v212, 1.0, v212
    s_waitcnt lgkmcnt(11)
    v_mfma_f32_16x16x32_bf16 v[72:75], v[176:179], v[32:35], v[72:75]
    ds_read_b64_tr_b16 v[56:57], v15 offset:0
    buffer_load_dwordx4 v6, s[8:11], s24 offen offset:2048 lds
    v_add_f32 v213, 1.0, v213
    v_rcp_f32 v212, v212
    s_waitcnt lgkmcnt(11)
    v_mfma_f32_16x16x32_bf16 v[72:75], v[180:183], v[36:39], v[72:75]
    ds_read_b64_tr_b16 v[58:59], v15 offset:1024
    v_rcp_f32 v213, v213
    s_nop 0
    v_cvt_pk_bf16_f32 v212, v212, v213
    s_waitcnt lgkmcnt(11)
    v_mfma_f32_16x16x32_bf16 v[76:79], v[184:187], v[32:35], v[76:79]
    ds_read_b64_tr_b16 v[60:61], v15 offset:8192
    v_lshlrev_b32 v216, 16, v212
    v_and_b32 v218, 0xffff0000, v212
    v_sub_f32 v217, 1.0, v216
    s_waitcnt lgkmcnt(11)
    v_mfma_f32_16x16x32_bf16 v[76:79], v[188:191], v[36:39], v[76:79]
    ds_read_b64_tr_b16 v[62:63], v15 offset:9216
    v_sub_f32 v219, 1.0, v218
    v_cvt_pk_bf16_f32 v212, v217, v219
    v_lshlrev_b32 v217, 16, v212
    s_waitcnt lgkmcnt(10)
    v_mfma_f32_16x16x32_bf16 v[80:83], v[160:163], v[40:43], v[80:83]
    v_and_b32 v219, 0xffff0000, v212
    s_lshl_b32 s49, s59, 3
    s_add_u32 s54, s49, 42336256
    s_waitcnt lgkmcnt(8)
    v_mfma_f32_16x16x32_bf16 v[80:83], v[164:167], v[44:47], v[80:83]
    s_add_u32 s49, s49, 41943040
    v_mov_b32 v16, 0
    s_mov_b32 s52, 0
    v_mfma_f32_16x16x32_bf16 v[84:87], v[168:171], v[40:43], v[84:87]
    buffer_load_dwordx4 v7, s[8:11], s24 offen offset:3072 lds
    s_mov_b32 s53, 0x80000000
    s_mov_b64 exec, s[52:53]
    buffer_store_dwordx4 v[208:211], v16, s[16:19], s49 offen sc1
    buffer_store_dwordx4 v[216:219], v16, s[16:19], s54 offen sc1
    s_mov_b64 exec, -1
    v_mfma_f32_16x16x32_bf16 v[84:87], v[172:175], v[44:47], v[84:87]
    s_add_u32 s24, s24, 128
    s_add_u32 s25, s25, s31
    v_mfma_f32_16x16x32_bf16 v[88:91], v[176:179], v[40:43], v[88:91]
    s_add_u32 s26, s26, 49152
    s_cmp_eq_u32 s26, 147456
    s_cselect_b32 s26, 0, s26
    s_cmp_eq_u32 s26, 98304
    s_cselect_b32 s27, s32, s33
    v_mfma_f32_16x16x32_bf16 v[88:91], v[180:183], v[44:47], v[88:91]
    v_add_u32 v10, s27, v10
    v_add_u32 v11, s27, v11
    v_add_u32 v12, s27, v12
    v_mfma_f32_16x16x32_bf16 v[92:95], v[184:187], v[40:43], v[92:95]
    v_add_u32 v13, s27, v13
    v_add_u32 v14, s27, v14
    v_add_u32 v15, s27, v15
    v_mfma_f32_16x16x32_bf16 v[92:95], v[188:191], v[44:47], v[92:95]
    s_waitcnt vmcnt(8) lgkmcnt(0)
    s_barrier
    s_add_u32 m0, s26, s30
    v_mfma_f32_16x16x32_bf16 v[96:99], v[160:163], v[48:51], v[96:99]
    ds_read_b128 v[128:131], v10 offset:0
    buffer_load_dwordx4 v8, s[12:15], s25 offen offset:0 lds
    v_mfma_f32_16x16x32_bf16 v[96:99], v[164:167], v[52:55], v[96:99]
    ds_read_b64_tr_b16 v[32:33], v12 offset:0
    v_mfma_f32_16x16x32_bf16 v[100:103], v[168:171], v[48:51], v[100:103]
    ds_read_b64_tr_b16 v[34:35], v12 offset:1024
    v_mfma_f32_16x16x32_bf16 v[100:103], v[172:175], v[52:55], v[100:103]
    ds_read_b128 v[132:135], v11 offset:0
    v_mfma_f32_16x16x32_bf16 v[104:107], v[176:179], v[48:51], v[104:107]
    ds_read_b64_tr_b16 v[36:37], v12 offset:8192
    buffer_load_dwordx4 v9, s[12:15], s25 offen offset:1024 lds
    v_mfma_f32_16x16x32_bf16 v[104:107], v[180:183], v[52:55], v[104:107]
    ds_read_b64_tr_b16 v[38:39], v12 offset:9216
    v_mfma_f32_16x16x32_bf16 v[108:111], v[184:187], v[48:51], v[108:111]
    ds_read_b128 v[136:139], v10 offset:2048
    v_mfma_f32_16x16x32_bf16 v[108:111], v[188:191], v[52:55], v[108:111]
    ds_read_b128 v[140:143], v11 offset:2048
    v_mfma_f32_16x16x32_bf16 v[112:115], v[160:163], v[56:59], v[112:115]
    ds_read_b128 v[144:147], v10 offset:4096
    s_add_u32 m0, s26, s29
    v_mfma_f32_16x16x32_bf16 v[112:115], v[164:167], v[60:63], v[112:115]
    ds_read_b128 v[148:151], v11 offset:4096
    buffer_load_dwordx4 v4, s[8:11], s24 offen offset:0 lds
    v_mfma_f32_16x16x32_bf16 v[116:119], v[168:171], v[56:59], v[116:119]
    ds_read_b128 v[152:155], v10 offset:6144
    v_mfma_f32_16x16x32_bf16 v[116:119], v[172:175], v[60:63], v[116:119]
    ds_read_b128 v[156:159], v11 offset:6144
    v_mfma_f32_16x16x32_bf16 v[120:123], v[176:179], v[56:59], v[120:123]
    ds_read_b64_tr_b16 v[40:41], v13 offset:0
    v_mfma_f32_16x16x32_bf16 v[120:123], v[180:183], v[60:63], v[120:123]
    ds_read_b64_tr_b16 v[42:43], v13 offset:1024
    v_mfma_f32_16x16x32_bf16 v[124:127], v[184:187], v[56:59], v[124:127]
    ds_read_b64_tr_b16 v[44:45], v13 offset:8192
    buffer_load_dwordx4 v5, s[8:11], s24 offen offset:1024 lds
    v_mfma_f32_16x16x32_bf16 v[124:127], v[188:191], v[60:63], v[124:127]
    ds_read_b64_tr_b16 v[46:47], v13 offset:9216
    s_waitcnt lgkmcnt(13)
    v_mfma_f32_16x16x32_bf16 v[64:67], v[128:131], v[32:35], v[64:67]
    ds_read_b64_tr_b16 v[48:49], v14 offset:0
    s_waitcnt lgkmcnt(11)
    v_mfma_f32_16x16x32_bf16 v[64:67], v[132:135], v[36:39], v[64:67]
    ds_read_b64_tr_b16 v[50:51], v14 offset:1024
    s_waitcnt lgkmcnt(11)
    v_mfma_f32_16x16x32_bf16 v[68:71], v[136:139], v[32:35], v[68:71]
    ds_read_b64_tr_b16 v[52:53], v14 offset:8192
    s_waitcnt lgkmcnt(11)
    v_mfma_f32_16x16x32_bf16 v[68:71], v[140:143], v[36:39], v[68:71]
    ds_read_b64_tr_b16 v[54:55], v14 offset:9216
    s_waitcnt lgkmcnt(11)
    v_mfma_f32_16x16x32_bf16 v[72:75], v[144:147], v[32:35], v[72:75]
    ds_read_b64_tr_b16 v[56:57], v15 offset:0
    buffer_load_dwordx4 v6, s[8:11], s24 offen offset:2048 lds
    s_waitcnt lgkmcnt(11)
    v_mfma_f32_16x16x32_bf16 v[72:75], v[148:151], v[36:39], v[72:75]
    ds_read_b64_tr_b16 v[58:59], v15 offset:1024
    s_waitcnt lgkmcnt(11)
    v_mfma_f32_16x16x32_bf16 v[76:79], v[152:155], v[32:35], v[76:79]
    ds_read_b64_tr_b16 v[60:61], v15 offset:8192
    s_waitcnt lgkmcnt(11)
    v_mfma_f32_16x16x32_bf16 v[76:79], v[156:159], v[36:39], v[76:79]
    ds_read_b64_tr_b16 v[62:63], v15 offset:9216
    s_waitcnt lgkmcnt(10)
    v_mfma_f32_16x16x32_bf16 v[80:83], v[128:131], v[40:43], v[80:83]
    s_waitcnt lgkmcnt(8)
    v_mfma_f32_16x16x32_bf16 v[80:83], v[132:135], v[44:47], v[80:83]
    v_mfma_f32_16x16x32_bf16 v[84:87], v[136:139], v[40:43], v[84:87]
    buffer_load_dwordx4 v7, s[8:11], s24 offen offset:3072 lds
    v_mfma_f32_16x16x32_bf16 v[84:87], v[140:143], v[44:47], v[84:87]
    s_add_u32 s24, s24, 128
    s_add_u32 s25, s25, s31
    v_mfma_f32_16x16x32_bf16 v[88:91], v[144:147], v[40:43], v[88:91]
    s_add_u32 s26, s26, 49152
    s_cmp_eq_u32 s26, 147456
    s_cselect_b32 s26, 0, s26
    s_cmp_eq_u32 s26, 98304
    s_cselect_b32 s27, s32, s33
    v_mfma_f32_16x16x32_bf16 v[88:91], v[148:151], v[44:47], v[88:91]
    v_add_u32 v10, s27, v10
    v_add_u32 v11, s27, v11
    v_add_u32 v12, s27, v12
    v_mfma_f32_16x16x32_bf16 v[92:95], v[152:155], v[40:43], v[92:95]
    v_add_u32 v13, s27, v13
    v_add_u32 v14, s27, v14
    v_add_u32 v15, s27, v15
    v_mfma_f32_16x16x32_bf16 v[92:95], v[156:159], v[44:47], v[92:95]
    s_waitcnt vmcnt(8) lgkmcnt(0)
    s_barrier
    s_add_u32 m0, s26, s30
    v_mfma_f32_16x16x32_bf16 v[96:99], v[128:131], v[48:51], v[96:99]
    ds_read_b128 v[160:163], v10 offset:0
    buffer_load_dwordx4 v8, s[12:15], s25 offen offset:0 lds
    v_mfma_f32_16x16x32_bf16 v[96:99], v[132:135], v[52:55], v[96:99]
    ds_read_b64_tr_b16 v[32:33], v12 offset:0
    buffer_load_dwordx4 v9, s[12:15], s25 offen offset:1024 lds
    v_mfma_f32_16x16x32_bf16 v[100:103], v[136:139], v[48:51], v[100:103]
    ds_read_b64_tr_b16 v[34:35], v12 offset:1024
    v_mfma_f32_16x16x32_bf16 v[100:103], v[140:143], v[52:55], v[100:103]
    ds_read_b128 v[164:167], v11 offset:0
    s_add_u32 m0, s26, s29
    v_mfma_f32_16x16x32_bf16 v[104:107], v[144:147], v[48:51], v[104:107]
    ds_read_b64_tr_b16 v[36:37], v12 offset:8192
    buffer_load_dwordx4 v4, s[8:11], s24 offen offset:0 lds
    v_mfma_f32_16x16x32_bf16 v[104:107], v[148:151], v[52:55], v[104:107]
    ds_read_b64_tr_b16 v[38:39], v12 offset:9216
    buffer_load_dwordx4 v5, s[8:11], s24 offen offset:1024 lds
    v_mfma_f32_16x16x32_bf16 v[108:111], v[152:155], v[48:51], v[108:111]
    ds_read_b128 v[168:171], v10 offset:2048
    buffer_load_dwordx4 v6, s[8:11], s24 offen offset:2048 lds
    v_mfma_f32_16x16x32_bf16 v[108:111], v[156:159], v[52:55], v[108:111]
    ds_read_b128 v[172:175], v11 offset:2048
    v_mfma_f32_16x16x32_bf16 v[112:115], v[128:131], v[56:59], v[112:115]
    ds_read_b128 v[176:179], v10 offset:4096
    buffer_load_dwordx4 v7, s[8:11], s24 offen offset:3072 lds
    v_mfma_f32_16x16x32_bf16 v[112:115], v[132:135], v[60:63], v[112:115]
    ds_read_b128 v[180:183], v11 offset:4096
    s_add_u32 s24, s24, 128
    s_add_u32 s25, s25, s31
    v_mfma_f32_16x16x32_bf16 v[116:119], v[136:139], v[56:59], v[116:119]
    ds_read_b128 v[184:187], v10 offset:6144
    v_mfma_f32_16x16x32_bf16 v[116:119], v[140:143], v[60:63], v[116:119]
    ds_read_b128 v[188:191], v11 offset:6144
    v_mfma_f32_16x16x32_bf16 v[120:123], v[144:147], v[56:59], v[120:123]
    ds_read_b64_tr_b16 v[40:41], v13 offset:0
    v_mfma_f32_16x16x32_bf16 v[120:123], v[148:151], v[60:63], v[120:123]
    ds_read_b64_tr_b16 v[42:43], v13 offset:1024
    v_mfma_f32_16x16x32_bf16 v[124:127], v[152:155], v[56:59], v[124:127]
    ds_read_b64_tr_b16 v[44:45], v13 offset:8192
    v_mfma_f32_16x16x32_bf16 v[124:127], v[156:159], v[60:63], v[124:127]
    ds_read_b64_tr_b16 v[46:47], v13 offset:9216
    s_waitcnt lgkmcnt(13)
    v_mfma_f32_16x16x32_bf16 v[64:67], v[160:163], v[32:35], v[64:67]
    ds_read_b64_tr_b16 v[48:49], v14 offset:0
    s_waitcnt lgkmcnt(11)
    v_mfma_f32_16x16x32_bf16 v[64:67], v[164:167], v[36:39], v[64:67]
    ds_read_b64_tr_b16 v[50:51], v14 offset:1024
    s_waitcnt lgkmcnt(11)
    v_mfma_f32_16x16x32_bf16 v[68:71], v[168:171], v[32:35], v[68:71]
    ds_read_b64_tr_b16 v[52:53], v14 offset:8192
    s_waitcnt lgkmcnt(11)
    v_mfma_f32_16x16x32_bf16 v[68:71], v[172:175], v[36:39], v[68:71]
    ds_read_b64_tr_b16 v[54:55], v14 offset:9216
    s_waitcnt lgkmcnt(11)
    v_mfma_f32_16x16x32_bf16 v[72:75], v[176:179], v[32:35], v[72:75]
    ds_read_b64_tr_b16 v[56:57], v15 offset:0
    s_waitcnt lgkmcnt(11)
    v_mfma_f32_16x16x32_bf16 v[72:75], v[180:183], v[36:39], v[72:75]
    ds_read_b64_tr_b16 v[58:59], v15 offset:1024
    s_waitcnt lgkmcnt(11)
    v_mfma_f32_16x16x32_bf16 v[76:79], v[184:187], v[32:35], v[76:79]
    ds_read_b64_tr_b16 v[60:61], v15 offset:8192
    s_waitcnt lgkmcnt(11)
    v_mfma_f32_16x16x32_bf16 v[76:79], v[188:191], v[36:39], v[76:79]
    ds_read_b64_tr_b16 v[62:63], v15 offset:9216
    s_waitcnt lgkmcnt(10)
    v_mfma_f32_16x16x32_bf16 v[80:83], v[160:163], v[40:43], v[80:83]
    s_waitcnt lgkmcnt(8)
    v_mfma_f32_16x16x32_bf16 v[80:83], v[164:167], v[44:47], v[80:83]
    v_mfma_f32_16x16x32_bf16 v[84:87], v[168:171], v[40:43], v[84:87]
    v_mfma_f32_16x16x32_bf16 v[84:87], v[172:175], v[44:47], v[84:87]
    v_mfma_f32_16x16x32_bf16 v[88:91], v[176:179], v[40:43], v[88:91]
    s_add_u32 s26, s26, 49152
    s_cmp_eq_u32 s26, 147456
    s_cselect_b32 s26, 0, s26
    s_cmp_eq_u32 s26, 98304
    s_cselect_b32 s27, s32, s33
    v_mfma_f32_16x16x32_bf16 v[88:91], v[180:183], v[44:47], v[88:91]
    v_add_u32 v10, s27, v10
    v_add_u32 v11, s27, v11
    v_add_u32 v12, s27, v12
    v_mfma_f32_16x16x32_bf16 v[92:95], v[184:187], v[40:43], v[92:95]
    v_add_u32 v13, s27, v13
    v_add_u32 v14, s27, v14
    v_add_u32 v15, s27, v15
    v_mfma_f32_16x16x32_bf16 v[92:95], v[188:191], v[44:47], v[92:95]
    s_waitcnt vmcnt(0) lgkmcnt(0)
    s_barrier
    s_cmp_lg_u32 s20, 0
    s_cbranch_scc1 L_nosig_6011
    v_mov_b32 v16, 0
    v_mov_b32 v17, 1
    s_mov_b64 s[50:51], exec
    s_mov_b64 exec, 1
    buffer_atomic_add v17, v16, s[64:67], 0 offen
    s_mov_b64 exec, s[50:51]
L_nosig_6011:
    s_mov_b32 s28, 2
.p2align 6
L_loopk12S_6012:
    s_add_u32 m0, s26, s30
    v_mfma_f32_16x16x32_bf16 v[96:99], v[160:163], v[48:51], v[96:99]
    ds_read_b128 v[128:131], v10 offset:0
    buffer_load_dwordx4 v8, s[12:15], s25 offen offset:0 lds
    v_mfma_f32_16x16x32_bf16 v[96:99], v[164:167], v[52:55], v[96:99]
    ds_read_b64_tr_b16 v[32:33], v12 offset:0
    v_mfma_f32_16x16x32_bf16 v[100:103], v[168:171], v[48:51], v[100:103]
    ds_read_b64_tr_b16 v[34:35], v12 offset:1024
    v_mfma_f32_16x16x32_bf16 v[100:103], v[172:175], v[52:55], v[100:103]
    ds_read_b128 v[132:135], v11 offset:0
    v_mfma_f32_16x16x32_bf16 v[104:107], v[176:179], v[48:51], v[104:107]
    ds_read_b64_tr_b16 v[36:37], v12 offset:8192
    buffer_load_dwordx4 v9, s[12:15], s25 offen offset:1024 lds
    v_mfma_f32_16x16x32_bf16 v[104:107], v[180:183], v[52:55], v[104:107]
    ds_read_b64_tr_b16 v[38:39], v12 offset:9216
    v_mfma_f32_16x16x32_bf16 v[108:111], v[184:187], v[48:51], v[108:111]
    ds_read_b128 v[136:139], v10 offset:2048
    v_mfma_f32_16x16x32_bf16 v[108:111], v[188:191], v[52:55], v[108:111]
    ds_read_b128 v[140:143], v11 offset:2048
    v_mfma_f32_16x16x32_bf16 v[112:115], v[160:163], v[56:59], v[112:115]
    ds_read_b128 v[144:147], v10 offset:4096
    s_add_u32 m0, s26, s29
    v_mfma_f32_16x16x32_bf16 v[112:115], v[164:167], v[60:63], v[112:115]
    ds_read_b128 v[148:151], v11 offset:4096
    buffer_load_dwordx4 v4, s[8:11], s24 offen offset:0 lds
    v_mfma_f32_16x16x32_bf16 v[116:119], v[168:171], v[56:59], v[116:119]
    ds_read_b128 v[152:155], v10 offset:6144
    v_mfma_f32_16x16x32_bf16 v[116:119], v[172:175], v[60:63], v[116:119]
    ds_read_b128 v[156:159], v11 offset:6144
    v_mfma_f32_16x16x32_bf16 v[120:123], v[176:179], v[56:59], v[120:123]
    ds_read_b64_tr_b16 v[40:41], v13 offset:0
    v_mfma_f32_16x16x32_bf16 v[120:123], v[180:183], v[60:63], v[120:123]
    ds_read_b64_tr_b16 v[42:43], v13 offset:1024
    v_mfma_f32_16x16x32_bf16 v[124:127], v[184:187], v[56:59], v[124:127]
    ds_read_b64_tr_b16 v[44:45], v13 offset:8192
    buffer_load_dwordx4 v5, s[8:11], s24 offen offset:1024 lds
    v_mfma_f32_16x16x32_bf16 v[124:127], v[188:191], v[60:63], v[124:127]
    ds_read_b64_tr_b16 v[46:47], v13 offset:9216
    s_waitcnt lgkmcnt(13)
    v_mfma_f32_16x16x32_bf16 v[64:67], v[128:131], v[32:35], v[64:67]
    ds_read_b64_tr_b16 v[48:49], v14 offset:0
    s_waitcnt lgkmcnt(11)
    v_mfma_f32_16x16x32_bf16 v[64:67], v[132:135], v[36:39], v[64:67]
    ds_read_b64_tr_b16 v[50:51], v14 offset:1024
    s_waitcnt lgkmcnt(11)
    v_mfma_f32_16x16x32_bf16 v[68:71], v[136:139], v[32:35], v[68:71]
    ds_read_b64_tr_b16 v[52:53], v14 offset:8192
    s_waitcnt lgkmcnt(11)
    v_mfma_f32_16x16x32_bf16 v[68:71], v[140:143], v[36:39], v[68:71]
    ds_read_b64_tr_b16 v[54:55], v14 offset:9216
    s_waitcnt lgkmcnt(11)
    v_mfma_f32_16x16x32_bf16 v[72:75], v[144:147], v[32:35], v[72:75]
    ds_read_b64_tr_b16 v[56:57], v15 offset:0
    buffer_load_dwordx4 v6, s[8:11], s24 offen offset:2048 lds
    s_waitcnt lgkmcnt(11)
    v_mfma_f32_16x16x32_bf16 v[72:75], v[148:151], v[36:39], v[72:75]
    ds_read_b64_tr_b16 v[58:59], v15 offset:1024
    s_waitcnt lgkmcnt(11)
    v_mfma_f32_16x16x32_bf16 v[76:79], v[152:155], v[32:35], v[76:79]
    ds_read_b64_tr_b16 v[60:61], v15 offset:8192
    s_waitcnt lgkmcnt(11)
    v_mfma_f32_16x16x32_bf16 v[76:79], v[156:159], v[36:39], v[76:79]
    ds_read_b64_tr_b16 v[62:63], v15 offset:9216
    s_waitcnt lgkmcnt(10)
    v_mfma_f32_16x16x32_bf16 v[80:83], v[128:131], v[40:43], v[80:83]
    s_waitcnt lgkmcnt(8)
    v_mfma_f32_16x16x32_bf16 v[80:83], v[132:135], v[44:47], v[80:83]
    v_mfma_f32_16x16x32_bf16 v[84:87], v[136:139], v[40:43], v[84:87]
    buffer_load_dwordx4 v7, s[8:11], s24 offen offset:3072 lds
    v_mfma_f32_16x16x32_bf16 v[84:87], v[140:143], v[44:47], v[84:87]
    s_add_u32 s24, s24, 128
    s_add_u32 s25, s25, s31
    v_mfma_f32_16x16x32_bf16 v[88:91], v[144:147], v[40:43], v[88:91]
    s_add_u32 s26, s26, 49152
    s_cmp_eq_u32 s26, 147456
    s_cselect_b32 s26, 0, s26
    s_cmp_eq_u32 s26, 98304
    s_cselect_b32 s27, s32, s33
    v_mfma_f32_16x16x32_bf16 v[88:91], v[148:151], v[44:47], v[88:91]
    v_add_u32 v10, s27, v10
    v_add_u32 v11, s27, v11
    v_add_u32 v12, s27, v12
    v_mfma_f32_16x16x32_bf16 v[92:95], v[152:155], v[40:43], v[92:95]
    v_add_u32 v13, s27, v13
    v_add_u32 v14, s27, v14
    v_add_u32 v15, s27, v15
    v_mfma_f32_16x16x32_bf16 v[92:95], v[156:159], v[44:47], v[92:95]
    s_waitcnt vmcnt(6) lgkmcnt(0)
    s_barrier
    s_add_u32 m0, s26, s30
    v_mfma_f32_16x16x32_bf16 v[96:99], v[128:131], v[48:51], v[96:99]
    ds_read_b128 v[160:163], v10 offset:0
    buffer_load_dwordx4 v8, s[12:15], s25 offen offset:0 lds
    v_mfma_f32_16x16x32_bf16 v[96:99], v[132:135], v[52:55], v[96:99]
    ds_read_b64_tr_b16 v[32:33], v12 offset:0
    v_mfma_f32_16x16x32_bf16 v[100:103], v[136:139], v[48:51], v[100:103]
    ds_read_b64_tr_b16 v[34:35], v12 offset:1024
    v_mfma_f32_16x16x32_bf16 v[100:103], v[140:143], v[52:55], v[100:103]
    ds_read_b128 v[164:167], v11 offset:0
    v_mfma_f32_16x16x32_bf16 v[104:107], v[144:147], v[48:51], v[104:107]
    ds_read_b64_tr_b16 v[36:37], v12 offset:8192
    buffer_load_dwordx4 v9, s[12:15], s25 offen offset:1024 lds
    v_mfma_f32_16x16x32_bf16 v[104:107], v[148:151], v[52:55], v[104:107]
    ds_read_b64_tr_b16 v[38:39], v12 offset:9216
    v_mfma_f32_16x16x32_bf16 v[108:111], v[152:155], v[48:51], v[108:111]
    ds_read_b128 v[168:171], v10 offset:2048
    v_mfma_f32_16x16x32_bf16 v[108:111], v[156:159], v[52:55], v[108:111]
    ds_read_b128 v[172:175], v11 offset:2048
    v_mfma_f32_16x16x32_bf16 v[112:115], v[128:131], v[56:59], v[112:115]
    ds_read_b128 v[176:179], v10 offset:4096
    s_add_u32 m0, s26, s29
    v_mfma_f32_16x16x32_bf16 v[112:115], v[132:135], v[60:63], v[112:115]
    ds_read_b128 v[180:183], v11 offset:4096
    buffer_load_dwordx4 v4, s[8:11], s24 offen offset:0 lds
    v_mfma_f32_16x16x32_bf16 v[116:119], v[136:139], v[56:59], v[116:119]
    ds_read_b128 v[184:187], v10 offset:6144
    v_mfma_f32_16x16x32_bf16 v[116:119], v[140:143], v[60:63], v[116:119]
    ds_read_b128 v[188:191], v11 offset:6144
    v_mfma_f32_16x16x32_bf16 v[120:123], v[144:147], v[56:59], v[120:123]
    ds_read_b64_tr_b16 v[40:41], v13 offset:0
    v_mfma_f32_16x16x32_bf16 v[120:123], v[148:151], v[60:63], v[120:123]
    ds_read_b64_tr_b16 v[42:43], v13 offset:1024
    v_mfma_f32_16x16x32_bf16 v[124:127], v[152:155], v[56:59], v[124:127]
    ds_read_b64_tr_b16 v[44:45], v13 offset:8192
    buffer_load_dwordx4 v5, s[8:11], s24 offen offset:1024 lds
    v_mfma_f32_16x16x32_bf16 v[124:127], v[156:159], v[60:63], v[124:127]
    ds_read_b64_tr_b16 v[46:47], v13 offset:9216
    s_waitcnt lgkmcnt(13)
    v_mfma_f32_16x16x32_bf16 v[64:67], v[160:163], v[32:35], v[64:67]
    ds_read_b64_tr_b16 v[48:49], v14 offset:0
    s_waitcnt lgkmcnt(11)
    v_mfma_f32_16x16x32_bf16 v[64:67], v[164:167], v[36:39], v[64:67]
    ds_read_b64_tr_b16 v[50:51], v14 offset:1024
    s_waitcnt lgkmcnt(11)
    v_mfma_f32_16x16x32_bf16 v[68:71], v[168:171], v[32:35], v[68:71]
    ds_read_b64_tr_b16 v[52:53], v14 offset:8192
    s_waitcnt lgkmcnt(11)
    v_mfma_f32_16x16x32_bf16 v[68:71], v[172:175], v[36:39], v[68:71]
    ds_read_b64_tr_b16 v[54:55], v14 offset:9216
    s_waitcnt lgkmcnt(11)
    v_mfma_f32_16x16x32_bf16 v[72:75], v[176:179], v[32:35], v[72:75]
    ds_read_b64_tr_b16 v[56:57], v15 offset:0
    buffer_load_dwordx4 v6, s[8:11], s24 offen offset:2048 lds
    s_waitcnt lgkmcnt(11)
    v_mfma_f32_16x16x32_bf16 v[72:75], v[180:183], v[36:39], v[72:75]
    ds_read_b64_tr_b16 v[58:59], v15 offset:1024
    s_waitcnt lgkmcnt(11)
    v_mfma_f32_16x16x32_bf16 v[76:79], v[184:187], v[32:35], v[76:79]
    ds_read_b64_tr_b16 v[60:61], v15 offset:8192
    s_waitcnt lgkmcnt(11)
    v_mfma_f32_16x16x32_bf16 v[76:79], v[188:191], v[36:39], v[76:79]
    ds_read_b64_tr_b16 v[62:63], v15 offset:9216
    s_waitcnt lgkmcnt(10)
    v_mfma_f32_16x16x32_bf16 v[80:83], v[160:163], v[40:43], v[80:83]
    s_waitcnt lgkmcnt(8)
    v_mfma_f32_16x16x32_bf16 v[80:83], v[164:167], v[44:47], v[80:83]
    v_mfma_f32_16x16x32_bf16 v[84:87], v[168:171], v[40:43], v[84:87]
    buffer_load_dwordx4 v7, s[8:11], s24 offen offset:3072 lds
    v_mfma_f32_16x16x32_bf16 v[84:87], v[172:175], v[44:47], v[84:87]
    s_add_u32 s24, s24, 128
    s_add_u32 s25, s25, s31
    v_mfma_f32_16x16x32_bf16 v[88:91], v[176:179], v[40:43], v[88:91]
    s_add_u32 s26, s26, 49152
    s_cmp_eq_u32 s26, 147456
    s_cselect_b32 s26, 0, s26
    s_cmp_eq_u32 s26, 98304
    s_cselect_b32 s27, s32, s33
    v_mfma_f32_16x16x32_bf16 v[88:91], v[180:183], v[44:47], v[88:91]
    v_add_u32 v10, s27, v10
    v_add_u32 v11, s27, v11
    v_add_u32 v12, s27, v12
    v_mfma_f32_16x16x32_bf16 v[92:95], v[184:187], v[40:43], v[92:95]
    v_add_u32 v13, s27, v13
    v_add_u32 v14, s27, v14
    v_add_u32 v15, s27, v15
    s_sub_u32 s28, s28, 1
    s_cmp_lg_u32 s28, 0
    v_mfma_f32_16x16x32_bf16 v[92:95], v[188:191], v[44:47], v[92:95]
    s_waitcnt vmcnt(6) lgkmcnt(0)
    s_barrier
    s_cbranch_scc1 L_loopk12S_6012
    s_add_u32 m0, s26, s30
    v_mfma_f32_16x16x32_bf16 v[96:99], v[160:163], v[48:51], v[96:99]
    ds_read_b128 v[128:131], v10 offset:0
    buffer_load_dwordx4 v8, s[12:15], s25 offen offset:0 lds
    v_mfma_f32_16x16x32_bf16 v[96:99], v[164:167], v[52:55], v[96:99]
    ds_read_b64_tr_b16 v[32:33], v12 offset:0
    v_mfma_f32_16x16x32_bf16 v[100:103], v[168:171], v[48:51], v[100:103]
    ds_read_b64_tr_b16 v[34:35], v12 offset:1024
    v_mfma_f32_16x16x32_bf16 v[100:103], v[172:175], v[52:55], v[100:103]
    ds_read_b128 v[132:135], v11 offset:0
    v_mfma_f32_16x16x32_bf16 v[104:107], v[176:179], v[48:51], v[104:107]
    ds_read_b64_tr_b16 v[36:37], v12 offset:8192
    buffer_load_dwordx4 v9, s[12:15], s25 offen offset:1024 lds
    v_mfma_f32_16x16x32_bf16 v[104:107], v[180:183], v[52:55], v[104:107]
    ds_read_b64_tr_b16 v[38:39], v12 offset:9216
    v_mfma_f32_16x16x32_bf16 v[108:111], v[184:187], v[48:51], v[108:111]
    ds_read_b128 v[136:139], v10 offset:2048
    v_mfma_f32_16x16x32_bf16 v[108:111], v[188:191], v[52:55], v[108:111]
    ds_read_b128 v[140:143], v11 offset:2048
    v_mfma_f32_16x16x32_bf16 v[112:115], v[160:163], v[56:59], v[112:115]
    ds_read_b128 v[144:147], v10 offset:4096
    s_add_u32 m0, s26, s29
    v_mfma_f32_16x16x32_bf16 v[112:115], v[164:167], v[60:63], v[112:115]
    ds_read_b128 v[148:151], v11 offset:4096
    buffer_load_dwordx4 v4, s[8:11], s24 offen offset:0 lds
    v_mfma_f32_16x16x32_bf16 v[116:119], v[168:171], v[56:59], v[116:119]
    ds_read_b128 v[152:155], v10 offset:6144
    v_mfma_f32_16x16x32_bf16 v[116:119], v[172:175], v[60:63], v[116:119]
    ds_read_b128 v[156:159], v11 offset:6144
    v_mfma_f32_16x16x32_bf16 v[120:123], v[176:179], v[56:59], v[120:123]
    ds_read_b64_tr_b16 v[40:41], v13 offset:0
    v_mfma_f32_16x16x32_bf16 v[120:123], v[180:183], v[60:63], v[120:123]
    ds_read_b64_tr_b16 v[42:43], v13 offset:1024
    v_mfma_f32_16x16x32_bf16 v[124:127], v[184:187], v[56:59], v[124:127]
    ds_read_b64_tr_b16 v[44:45], v13 offset:8192
    buffer_load_dwordx4 v5, s[8:11], s24 offen offset:1024 lds
    v_mfma_f32_16x16x32_bf16 v[124:127], v[188:191], v[60:63], v[124:127]
    ds_read_b64_tr_b16 v[46:47], v13 offset:9216
    s_waitcnt lgkmcnt(13)
    v_mfma_f32_16x16x32_bf16 v[64:67], v[128:131], v[32:35], v[64:67]
    ds_read_b64_tr_b16 v[48:49], v14 offset:0
    s_waitcnt lgkmcnt(11)
    v_mfma_f32_16x16x32_bf16 v[64:67], v[132:135], v[36:39], v[64:67]
    ds_read_b64_tr_b16 v[50:51], v14 offset:1024
    s_waitcnt lgkmcnt(11)
    v_mfma_f32_16x16x32_bf16 v[68:71], v[136:139], v[32:35], v[68:71]
    ds_read_b64_tr_b16 v[52:53], v14 offset:8192
    s_waitcnt lgkmcnt(11)
    v_mfma_f32_16x16x32_bf16 v[68:71], v[140:143], v[36:39], v[68:71]
    ds_read_b64_tr_b16 v[54:55], v14 offset:9216
    s_waitcnt lgkmcnt(11)
    v_mfma_f32_16x16x32_bf16 v[72:75], v[144:147], v[32:35], v[72:75]
    ds_read_b64_tr_b16 v[56:57], v15 offset:0
    buffer_load_dwordx4 v6, s[8:11], s24 offen offset:2048 lds
    s_waitcnt lgkmcnt(11)
    v_mfma_f32_16x16x32_bf16 v[72:75], v[148:151], v[36:39], v[72:75]
    ds_read_b64_tr_b16 v[58:59], v15 offset:1024
    s_waitcnt lgkmcnt(11)
    v_mfma_f32_16x16x32_bf16 v[76:79], v[152:155], v[32:35], v[76:79]
    ds_read_b64_tr_b16 v[60:61], v15 offset:8192
    s_waitcnt lgkmcnt(11)
    v_mfma_f32_16x16x32_bf16 v[76:79], v[156:159], v[36:39], v[76:79]
    ds_read_b64_tr_b16 v[62:63], v15 offset:9216
    s_waitcnt lgkmcnt(10)
    v_mfma_f32_16x16x32_bf16 v[80:83], v[128:131], v[40:43], v[80:83]
    s_waitcnt lgkmcnt(8)
    v_mfma_f32_16x16x32_bf16 v[80:83], v[132:135], v[44:47], v[80:83]
    v_mfma_f32_16x16x32_bf16 v[84:87], v[136:139], v[40:43], v[84:87]
    buffer_load_dwordx4 v7, s[8:11], s24 offen offset:3072 lds
    v_mfma_f32_16x16x32_bf16 v[84:87], v[140:143], v[44:47], v[84:87]
    s_add_u32 s24, s24, 128
    s_add_u32 s25, s25, s31
    v_mfma_f32_16x16x32_bf16 v[88:91], v[144:147], v[40:43], v[88:91]
    s_add_u32 s26, s26, 49152
    s_cmp_eq_u32 s26, 147456
    s_cselect_b32 s26, 0, s26
    s_cmp_eq_u32 s26, 98304
    s_cselect_b32 s27, s32, s33
    v_mfma_f32_16x16x32_bf16 v[88:91], v[148:151], v[44:47], v[88:91]
    v_add_u32 v10, s27, v10
    v_add_u32 v11, s27, v11
    v_add_u32 v12, s27, v12
    v_mfma_f32_16x16x32_bf16 v[92:95], v[152:155], v[40:43], v[92:95]
    v_add_u32 v13, s27, v13
    v_add_u32 v14, s27, v14
    v_add_u32 v15, s27, v15
    v_mfma_f32_16x16x32_bf16 v[92:95], v[156:159], v[44:47], v[92:95]
    v_mov_b32 v16, 0
    s_cmp_lg_u32 s20, 0
    s_cbranch_scc1 L_np1_6013
    buffer_load_dword v27, v16, s[64:67], 0 offen sc1
L_np1_6013:
    s_waitcnt vmcnt(6) lgkmcnt(0)
    s_barrier
    s_add_u32 m0, s26, s30
    v_mfma_f32_16x16x32_bf16 v[96:99], v[128:131], v[48:51], v[96:99]
    ds_read_b128 v[160:163], v10 offset:0
    buffer_load_dwordx4 v8, s[12:15], s25 offen offset:0 lds
    v_mfma_f32_16x16x32_bf16 v[96:99], v[132:135], v[52:55], v[96:99]
    ds_read_b64_tr_b16 v[32:33], v12 offset:0
    v_mfma_f32_16x16x32_bf16 v[100:103], v[136:139], v[48:51], v[100:103]
    ds_read_b64_tr_b16 v[34:35], v12 offset:1024
    v_mfma_f32_16x16x32_bf16 v[100:103], v[140:143], v[52:55], v[100:103]
    ds_read_b128 v[164:167], v11 offset:0
    v_mfma_f32_16x16x32_bf16 v[104:107], v[144:147], v[48:51], v[104:107]
    ds_read_b64_tr_b16 v[36:37], v12 offset:8192
    buffer_load_dwordx4 v9, s[12:15], s25 offen offset:1024 lds
    v_mfma_f32_16x16x32_bf16 v[104:107], v[148:151], v[52:55], v[104:107]
    ds_read_b64_tr_b16 v[38:39], v12 offset:9216
    v_mfma_f32_16x16x32_bf16 v[108:111], v[152:155], v[48:51], v[108:111]
    ds_read_b128 v[168:171], v10 offset:2048
    v_mfma_f32_16x16x32_bf16 v[108:111], v[156:159], v[52:55], v[108:111]
    ds_read_b128 v[172:175], v11 offset:2048
    v_mfma_f32_16x16x32_bf16 v[112:115], v[128:131], v[56:59], v[112:115]
    ds_read_b128 v[176:179], v10 offset:4096
    s_add_u32 m0, s26, s29
    v_mfma_f32_16x16x32_bf16 v[112:115], v[132:135], v[60:63], v[112:115]
    ds_read_b128 v[180:183], v11 offset:4096
    buffer_load_dwordx4 v4, s[8:11], s24 offen offset:0 lds
    v_mfma_f32_16x16x32_bf16 v[116:119], v[136:139], v[56:59], v[116:119]
    ds_read_b128 v[184:187], v10 offset:6144
    v_mfma_f32_16x16x32_bf16 v[116:119], v[140:143], v[60:63], v[116:119]
    ds_read_b128 v[188:191], v11 offset:6144
    v_mfma_f32_16x16x32_bf16 v[120:123], v[144:147], v[56:59], v[120:123]
    ds_read_b64_tr_b16 v[40:41], v13 offset:0
    v_mfma_f32_16x16x32_bf16 v[120:123], v[148:151], v[60:63], v[120:123]
    ds_read_b64_tr_b16 v[42:43], v13 offset:1024
    v_mfma_f32_16x16x32_bf16 v[124:127], v[152:155], v[56:59], v[124:127]
    ds_read_b64_tr_b16 v[44:45], v13 offset:8192
    buffer_load_dwordx4 v5, s[8:11], s24 offen offset:1024 lds
    v_mfma_f32_16x16x32_bf16 v[124:127], v[156:159], v[60:63], v[124:127]
    ds_read_b64_tr_b16 v[46:47], v13 offset:9216
    s_waitcnt lgkmcnt(13)
    v_mfma_f32_16x16x32_bf16 v[64:67], v[160:163], v[32:35], v[64:67]
    ds_read_b64_tr_b16 v[48:49], v14 offset:0
    s_waitcnt lgkmcnt(11)
    v_mfma_f32_16x16x32_bf16 v[64:67], v[164:167], v[36:39], v[64:67]
    ds_read_b64_tr_b16 v[50:51], v14 offset:1024
    s_waitcnt lgkmcnt(11)
    v_mfma_f32_16x16x32_bf16 v[68:71], v[168:171], v[32:35], v[68:71]
    ds_read_b64_tr_b16 v[52:53], v14 offset:8192
    s_waitcnt lgkmcnt(11)
    v_mfma_f32_16x16x32_bf16 v[68:71], v[172:175], v[36:39], v[68:71]
    ds_read_b64_tr_b16 v[54:55], v14 offset:9216
    s_waitcnt lgkmcnt(11)
    v_mfma_f32_16x16x32_bf16 v[72:75], v[176:179], v[32:35], v[72:75]
    ds_read_b64_tr_b16 v[56:57], v15 offset:0
    buffer_load_dwordx4 v6, s[8:11], s24 offen offset:2048 lds
    s_waitcnt lgkmcnt(11)
    v_mfma_f32_16x16x32_bf16 v[72:75], v[180:183], v[36:39], v[72:75]
    ds_read_b64_tr_b16 v[58:59], v15 offset:1024
    s_waitcnt lgkmcnt(11)
    v_mfma_f32_16x16x32_bf16 v[76:79], v[184:187], v[32:35], v[76:79]
    ds_read_b64_tr_b16 v[60:61], v15 offset:8192
    s_waitcnt lgkmcnt(11)
    v_mfma_f32_16x16x32_bf16 v[76:79], v[188:191], v[36:39], v[76:79]
    ds_read_b64_tr_b16 v[62:63], v15 offset:9216
    s_waitcnt lgkmcnt(10)
    v_mfma_f32_16x16x32_bf16 v[80:83], v[160:163], v[40:43], v[80:83]
    s_waitcnt lgkmcnt(8)
    v_mfma_f32_16x16x32_bf16 v[80:83], v[164:167], v[44:47], v[80:83]
    v_mfma_f32_16x16x32_bf16 v[84:87], v[168:171], v[40:43], v[84:87]
    buffer_load_dwordx4 v7, s[8:11], s24 offen offset:3072 lds
    v_mfma_f32_16x16x32_bf16 v[84:87], v[172:175], v[44:47], v[84:87]
    s_add_u32 s24, s24, 128
    s_add_u32 s25, s25, s31
    v_mfma_f32_16x16x32_bf16 v[88:91], v[176:179], v[40:43], v[88:91]
    s_add_u32 s26, s26, 49152
    s_cmp_eq_u32 s26, 147456
    s_cselect_b32 s26, 0, s26
    s_cmp_eq_u32 s26, 98304
    s_cselect_b32 s27, s32, s33
    v_mfma_f32_16x16x32_bf16 v[88:91], v[180:183], v[44:47], v[88:91]
    v_add_u32 v10, s27, v10
    v_add_u32 v11, s27, v11
    v_add_u32 v12, s27, v12
    v_mfma_f32_16x16x32_bf16 v[92:95], v[184:187], v[40:43], v[92:95]
    v_add_u32 v13, s27, v13
    v_add_u32 v14, s27, v14
    v_add_u32 v15, s27, v15
    v_mfma_f32_16x16x32_bf16 v[92:95], v[188:191], v[44:47], v[92:95]
    s_cmp_lg_u32 s20, 0
    s_cbranch_scc1 L_pollok_6015
    s_waitcnt vmcnt(6)
    s_mov_b32 s49, 0
L_poll_6014:
    v_readfirstlane_b32 s48, v27
    s_cmp_ge_u32 s48, 256
    s_cbranch_scc1 L_pollok_6015
    s_add_u32 s49, s49, 1
    s_cmp_ge_u32 s49, 4194304
    s_cbranch_scc1 L_pollok_6015
    s_sleep 4
    buffer_load_dword v27, v16, s[64:67], 0 offen sc1
    s_waitcnt vmcnt(0)
    s_branch L_poll_6014
L_pollok_6015:
    s_waitcnt vmcnt(6) lgkmcnt(0)
    s_barrier
    v_mfma_f32_16x16x32_bf16 v[96:99], v[160:163], v[48:51], v[96:99]
    ds_read_b128 v[128:131], v10 offset:0
    v_mfma_f32_16x16x32_bf16 v[96:99], v[164:167], v[52:55], v[96:99]
    ds_read_b64_tr_b16 v[32:33], v12 offset:0
    v_mfma_f32_16x16x32_bf16 v[100:103], v[168:171], v[48:51], v[100:103]
    ds_read_b64_tr_b16 v[34:35], v12 offset:1024
    v_mfma_f32_16x16x32_bf16 v[100:103], v[172:175], v[52:55], v[100:103]
    ds_read_b128 v[132:135], v11 offset:0
    v_mfma_f32_16x16x32_bf16 v[104:107], v[176:179], v[48:51], v[104:107]
    ds_read_b64_tr_b16 v[36:37], v12 offset:8192
    v_mfma_f32_16x16x32_bf16 v[104:107], v[180:183], v[52:55], v[104:107]
    ds_read_b64_tr_b16 v[38:39], v12 offset:9216
    v_mfma_f32_16x16x32_bf16 v[108:111], v[184:187], v[48:51], v[108:111]
    ds_read_b128 v[136:139], v10 offset:2048
    v_mfma_f32_16x16x32_bf16 v[108:111], v[188:191], v[52:55], v[108:111]
    ds_read_b128 v[140:143], v11 offset:2048
    v_mfma_f32_16x16x32_bf16 v[112:115], v[160:163], v[56:59], v[112:115]
    ds_read_b128 v[144:147], v10 offset:4096
    v_mfma_f32_16x16x32_bf16 v[112:115], v[164:167], v[60:63], v[112:115]
    ds_read_b128 v[148:151], v11 offset:4096
    v_mfma_f32_16x16x32_bf16 v[116:119], v[168:171], v[56:59], v[116:119]
    ds_read_b128 v[152:155], v10 offset:6144
    v_mfma_f32_16x16x32_bf16 v[116:119], v[172:175], v[60:63], v[116:119]
    ds_read_b128 v[156:159], v11 offset:6144
    v_mfma_f32_16x16x32_bf16 v[120:123], v[176:179], v[56:59], v[120:123]
    ds_read_b64_tr_b16 v[40:41], v13 offset:0
    v_mfma_f32_16x16x32_bf16 v[120:123], v[180:183], v[60:63], v[120:123]
    ds_read_b64_tr_b16 v[42:43], v13 offset:1024
    v_mfma_f32_16x16x32_bf16 v[124:127], v[184:187], v[56:59], v[124:127]
    ds_read_b64_tr_b16 v[44:45], v13 offset:8192
    v_mfma_f32_16x16x32_bf16 v[124:127], v[188:191], v[60:63], v[124:127]
    ds_read_b64_tr_b16 v[46:47], v13 offset:9216
    s_waitcnt lgkmcnt(13)
    v_mfma_f32_16x16x32_bf16 v[64:67], v[128:131], v[32:35], v[64:67]
    ds_read_b64_tr_b16 v[48:49], v14 offset:0
    s_waitcnt lgkmcnt(11)
    v_mfma_f32_16x16x32_bf16 v[64:67], v[132:135], v[36:39], v[64:67]
    ds_read_b64_tr_b16 v[50:51], v14 offset:1024
    s_waitcnt lgkmcnt(11)
    v_mfma_f32_16x16x32_bf16 v[68:71], v[136:139], v[32:35], v[68:71]
    ds_read_b64_tr_b16 v[52:53], v14 offset:8192
    s_waitcnt lgkmcnt(11)
    v_mfma_f32_16x16x32_bf16 v[68:71], v[140:143], v[36:39], v[68:71]
    ds_read_b64_tr_b16 v[54:55], v14 offset:9216
    s_waitcnt lgkmcnt(11)
    v_mfma_f32_16x16x32_bf16 v[72:75], v[144:147], v[32:35], v[72:75]
    ds_read_b64_tr_b16 v[56:57], v15 offset:0
    s_waitcnt lgkmcnt(11)
    v_mfma_f32_16x16x32_bf16 v[72:75], v[148:151], v[36:39], v[72:75]
    ds_read_b64_tr_b16 v[58:59], v15 offset:1024
    s_waitcnt lgkmcnt(11)
    v_mfma_f32_16x16x32_bf16 v[76:79], v[152:155], v[32:35], v[76:79]
    ds_read_b64_tr_b16 v[60:61], v15 offset:8192
    s_waitcnt lgkmcnt(11)
    v_mfma_f32_16x16x32_bf16 v[76:79], v[156:159], v[36:39], v[76:79]
    ds_read_b64_tr_b16 v[62:63], v15 offset:9216
    s_waitcnt lgkmcnt(10)
    v_mfma_f32_16x16x32_bf16 v[80:83], v[128:131], v[40:43], v[80:83]
    s_waitcnt lgkmcnt(8)
    v_mfma_f32_16x16x32_bf16 v[80:83], v[132:135], v[44:47], v[80:83]
    v_mfma_f32_16x16x32_bf16 v[84:87], v[136:139], v[40:43], v[84:87]
    v_mfma_f32_16x16x32_bf16 v[84:87], v[140:143], v[44:47], v[84:87]
    v_mfma_f32_16x16x32_bf16 v[88:91], v[144:147], v[40:43], v[88:91]
    s_add_u32 s26, s26, 49152
    s_cmp_eq_u32 s26, 147456
    s_cselect_b32 s26, 0, s26
    s_cmp_eq_u32 s26, 98304
    s_cselect_b32 s27, s32, s33
    v_mfma_f32_16x16x32_bf16 v[88:91], v[148:151], v[44:47], v[88:91]
    v_add_u32 v10, s27, v10
    v_add_u32 v11, s27, v11
    v_add_u32 v12, s27, v12
    v_mfma_f32_16x16x32_bf16 v[92:95], v[152:155], v[40:43], v[92:95]
    v_add_u32 v13, s27, v13
    v_add_u32 v14, s27, v14
    v_add_u32 v15, s27, v15
    v_mfma_f32_16x16x32_bf16 v[92:95], v[156:159], v[44:47], v[92:95]
    s_waitcnt vmcnt(0) lgkmcnt(0)
    s_barrier
    v_mfma_f32_16x16x32_bf16 v[96:99], v[128:131], v[48:51], v[96:99]
    ds_read_b128 v[160:163], v10 offset:0
    v_mfma_f32_16x16x32_bf16 v[96:99], v[132:135], v[52:55], v[96:99]
    ds_read_b64_tr_b16 v[32:33], v12 offset:0
    v_mfma_f32_16x16x32_bf16 v[100:103], v[136:139], v[48:51], v[100:103]
    ds_read_b64_tr_b16 v[34:35], v12 offset:1024
    v_mfma_f32_16x16x32_bf16 v[100:103], v[140:143], v[52:55], v[100:103]
    ds_read_b128 v[164:167], v11 offset:0
    v_mfma_f32_16x16x32_bf16 v[104:107], v[144:147], v[48:51], v[104:107]
    ds_read_b64_tr_b16 v[36:37], v12 offset:8192
    v_mfma_f32_16x16x32_bf16 v[104:107], v[148:151], v[52:55], v[104:107]
    ds_read_b64_tr_b16 v[38:39], v12 offset:9216
    v_mfma_f32_16x16x32_bf16 v[108:111], v[152:155], v[48:51], v[108:111]
    ds_read_b128 v[168:171], v10 offset:2048
    v_mfma_f32_16x16x32_bf16 v[108:111], v[156:159], v[52:55], v[108:111]
    ds_read_b128 v[172:175], v11 offset:2048
    v_mfma_f32_16x16x32_bf16 v[112:115], v[128:131], v[56:59], v[112:115]
    ds_read_b128 v[176:179], v10 offset:4096
    v_mfma_f32_16x16x32_bf16 v[112:115], v[132:135], v[60:63], v[112:115]
    ds_read_b128 v[180:183], v11 offset:4096
    v_mfma_f32_16x16x32_bf16 v[116:119], v[136:139], v[56:59], v[116:119]
    ds_read_b128 v[184:187], v10 offset:6144
    v_mfma_f32_16x16x32_bf16 v[116:119], v[140:143], v[60:63], v[116:119]
    ds_read_b128 v[188:191], v11 offset:6144
    v_mfma_f32_16x16x32_bf16 v[120:123], v[144:147], v[56:59], v[120:123]
    ds_read_b64_tr_b16 v[40:41], v13 offset:0
    v_mfma_f32_16x16x32_bf16 v[120:123], v[148:151], v[60:63], v[120:123]
    ds_read_b64_tr_b16 v[42:43], v13 offset:1024
    v_mfma_f32_16x16x32_bf16 v[124:127], v[152:155], v[56:59], v[124:127]
    ds_read_b64_tr_b16 v[44:45], v13 offset:8192
    v_mfma_f32_16x16x32_bf16 v[124:127], v[156:159], v[60:63], v[124:127]
    ds_read_b64_tr_b16 v[46:47], v13 offset:9216
    s_waitcnt lgkmcnt(13)
    v_mfma_f32_16x16x32_bf16 v[64:67], v[160:163], v[32:35], v[64:67]
    ds_read_b64_tr_b16 v[48:49], v14 offset:0
    s_waitcnt lgkmcnt(11)
    v_mfma_f32_16x16x32_bf16 v[64:67], v[164:167], v[36:39], v[64:67]
    ds_read_b64_tr_b16 v[50:51], v14 offset:1024
    s_waitcnt lgkmcnt(11)
    v_mfma_f32_16x16x32_bf16 v[68:71], v[168:171], v[32:35], v[68:71]
    ds_read_b64_tr_b16 v[52:53], v14 offset:8192
    s_waitcnt lgkmcnt(11)
    v_mfma_f32_16x16x32_bf16 v[68:71], v[172:175], v[36:39], v[68:71]
    ds_read_b64_tr_b16 v[54:55], v14 offset:9216
    s_waitcnt lgkmcnt(11)
    v_mfma_f32_16x16x32_bf16 v[72:75], v[176:179], v[32:35], v[72:75]
    ds_read_b64_tr_b16 v[56:57], v15 offset:0
    s_waitcnt lgkmcnt(11)
    v_mfma_f32_16x16x32_bf16 v[72:75], v[180:183], v[36:39], v[72:75]
    ds_read_b64_tr_b16 v[58:59], v15 offset:1024
    s_waitcnt lgkmcnt(11)
    v_mfma_f32_16x16x32_bf16 v[76:79], v[184:187], v[32:35], v[76:79]
    ds_read_b64_tr_b16 v[60:61], v15 offset:8192
    s_waitcnt lgkmcnt(11)
    v_mfma_f32_16x16x32_bf16 v[76:79], v[188:191], v[36:39], v[76:79]
    ds_read_b64_tr_b16 v[62:63], v15 offset:9216
    s_waitcnt lgkmcnt(10)
    v_mfma_f32_16x16x32_bf16 v[80:83], v[160:163], v[40:43], v[80:83]
    s_waitcnt lgkmcnt(8)
    v_mfma_f32_16x16x32_bf16 v[80:83], v[164:167], v[44:47], v[80:83]
    v_mfma_f32_16x16x32_bf16 v[84:87], v[168:171], v[40:43], v[84:87]
    v_mfma_f32_16x16x32_bf16 v[84:87], v[172:175], v[44:47], v[84:87]
    v_mfma_f32_16x16x32_bf16 v[88:91], v[176:179], v[40:43], v[88:91]
    v_mfma_f32_16x16x32_bf16 v[88:91], v[180:183], v[44:47], v[88:91]
    v_mfma_f32_16x16x32_bf16 v[92:95], v[184:187], v[40:43], v[92:95]
    v_mfma_f32_16x16x32_bf16 v[92:95], v[188:191], v[44:47], v[92:95]
    s_waitcnt lgkmcnt(6)
    v_mfma_f32_16x16x32_bf16 v[96:99], v[160:163], v[48:51], v[96:99]
    s_waitcnt lgkmcnt(4)
    v_mfma_f32_16x16x32_bf16 v[96:99], v[164:167], v[52:55], v[96:99]
    v_mfma_f32_16x16x32_bf16 v[100:103], v[168:171], v[48:51], v[100:103]
    v_mfma_f32_16x16x32_bf16 v[100:103], v[172:175], v[52:55], v[100:103]
    v_mfma_f32_16x16x32_bf16 v[104:107], v[176:179], v[48:51], v[104:107]
    v_mfma_f32_16x16x32_bf16 v[104:107], v[180:183], v[52:55], v[104:107]
    v_mfma_f32_16x16x32_bf16 v[108:111], v[184:187], v[48:51], v[108:111]
    v_mfma_f32_16x16x32_bf16 v[108:111], v[188:191], v[52:55], v[108:111]
    s_waitcnt lgkmcnt(2)
    v_mfma_f32_16x16x32_bf16 v[112:115], v[160:163], v[56:59], v[112:115]
    s_waitcnt lgkmcnt(0)
    v_mfma_f32_16x16x32_bf16 v[112:115], v[164:167], v[60:63], v[112:115]
    v_mfma_f32_16x16x32_bf16 v[116:119], v[168:171], v[56:59], v[116:119]
    v_mfma_f32_16x16x32_bf16 v[116:119], v[172:175], v[60:63], v[116:119]
    v_mfma_f32_16x16x32_bf16 v[120:123], v[176:179], v[56:59], v[120:123]
    v_mfma_f32_16x16x32_bf16 v[120:123], v[180:183], v[60:63], v[120:123]
    v_mfma_f32_16x16x32_bf16 v[124:127], v[184:187], v[56:59], v[124:127]
    v_mfma_f32_16x16x32_bf16 v[124:127], v[188:191], v[60:63], v[124:127]
    s_branch L_k1_ep2
L_k1_p3S:
    s_mov_b32 s32, 4294868992
    s_mov_b32 s33, 49152
    s_waitcnt vmcnt(6)
    s_barrier
    ds_read_b128 v[128:131], v10 offset:0
    ds_read_b64_tr_b16 v[32:33], v12 offset:0
    ds_read_b64_tr_b16 v[34:35], v12 offset:1024
    ds_read_b128 v[132:135], v11 offset:0
    ds_read_b64_tr_b16 v[36:37], v12 offset:8192
    ds_read_b64_tr_b16 v[38:39], v12 offset:9216
    ds_read_b128 v[136:139], v10 offset:2048
    ds_read_b128 v[140:143], v11 offset:2048
    ds_read_b128 v[144:147], v10 offset:4096
    ds_read_b128 v[148:151], v11 offset:4096
    ds_read_b128 v[152:155], v10 offset:6144
    ds_read_b128 v[156:159], v11 offset:6144
    s_add_u32 m0, s26, s30
    s_nop 0
    buffer_load_dwordx4 v8, s[12:15], s25 offen offset:0 lds
    buffer_load_dwordx4 v9, s[12:15], s25 offen offset:1024 lds
    s_add_u32 m0, s26, s29
    s_nop 0
    buffer_load_dwordx4 v4, s[8:11], s24 offen offset:0 lds
    buffer_load_dwordx4 v5, s[8:11], s24 offen offset:1024 lds
    buffer_load_dwordx4 v6, s[8:11], s24 offen offset:2048 lds
    buffer_load_dwordx4 v7, s[8:11], s24 offen offset:3072 lds
    s_add_u32 s24, s24, 128
    s_add_u32 s25, s25, s31
    s_waitcnt lgkmcnt(9)
    v_mfma_f32_16x16x32_bf16 v[64:67], v[32:35], v[128:131], 0
    ds_read_b64_tr_b16 v[40:41], v13 offset:0
    s_waitcnt lgkmcnt(7)
    v_mfma_f32_16x16x32_bf16 v[64:67], v[36:39], v[132:135], v[64:67]
    ds_read_b64_tr_b16 v[42:43], v13 offset:1024
    s_waitcnt lgkmcnt(7)
    v_mfma_f32_16x16x32_bf16 v[68:71], v[32:35], v[136:139], 0
    ds_read_b64_tr_b16 v[44:45], v13 offset:8192
    s_waitcnt lgkmcnt(7)
    v_mfma_f32_16x16x32_bf16 v[68:71], v[36:39], v[140:143], v[68:71]
    ds_read_b64_tr_b16 v[46:47], v13 offset:9216
    s_waitcnt lgkmcnt(7)
    v_mfma_f32_16x16x32_bf16 v[72:75], v[32:35], v[144:147], 0
    ds_read_b64_tr_b16 v[48:49], v14 offset:0
    s_waitcnt lgkmcnt(7)
    v_mfma_f32_16x16x32_bf16 v[72:75], v[36:39], v[148:151], v[72:75]
    ds_read_b64_tr_b16 v[50:51], v14 offset:1024
    s_waitcnt lgkmcnt(7)
    v_mfma_f32_16x16x32_bf16 v[76:79], v[32:35], v[152:155], 0
    ds_read_b64_tr_b16 v[52:53], v14 offset:8192
    s_waitcnt lgkmcnt(7)
    v_mfma_f32_16x16x32_bf16 v[76:79], v[36:39], v[156:159], v[76:79]
    ds_read_b64_tr_b16 v[54:55], v14 offset:9216
    s_waitcnt lgkmcnt(6)
    v_mfma_f32_16x16x32_bf16 v[80:83], v[40:43], v[128:131], 0
    ds_read_b64_tr_b16 v[56:57], v15 offset:0
    s_waitcnt lgkmcnt(5)
    v_mfma_f32_16x16x32_bf16 v[80:83], v[44:47], v[132:135], v[80:83]
    ds_read_b64_tr_b16 v[58:59], v15 offset:1024
    v_mfma_f32_16x16x32_bf16 v[84:87], v[40:43], v[136:139], 0
    ds_read_b64_tr_b16 v[60:61], v15 offset:8192
    v_mfma_f32_16x16x32_bf16 v[84:87], v[44:47], v[140:143], v[84:87]
    ds_read_b64_tr_b16 v[62:63], v15 offset:9216
    v_mfma_f32_16x16x32_bf16 v[88:91], v[40:43], v[144:147], 0
    s_add_u32 s26, s26, 49152
    s_cmp_eq_u32 s26, 147456
    s_cselect_b32 s26, 0, s26
    s_cmp_eq_u32 s26, 98304
    s_cselect_b32 s27, s32, s33
    v_mfma_f32_16x16x32_bf16 v[88:91], v[44:47], v[148:151], v[88:91]
    v_add_u32 v10, s27, v10
    v_add_u32 v11, s27, v11
    v_add_u32 v12, s27, v12
    v_mfma_f32_16x16x32_bf16 v[92:95], v[40:43], v[152:155], 0
    v_add_u32 v13, s27, v13
    v_add_u32 v14, s27, v14
    v_add_u32 v15, s27, v15
    v_mfma_f32_16x16x32_bf16 v[92:95], v[44:47], v[156:159], v[92:95]
    s_waitcnt vmcnt(6) lgkmcnt(0)
    s_barrier
    s_add_u32 m0, s26, s30
    v_mfma_f32_16x16x32_bf16 v[96:99], v[48:51], v[128:131], 0
    ds_read_b128 v[160:163], v10 offset:0
    buffer_load_dwordx4 v8, s[12:15], s25 offen offset:0 lds
    v_mfma_f32_16x16x32_bf16 v[96:99], v[52:55], v[132:135], v[96:99]
    ds_read_b64_tr_b16 v[32:33], v12 offset:0
    v_mfma_f32_16x16x32_bf16 v[100:103], v[48:51], v[136:139], 0
    ds_read_b64_tr_b16 v[34:35], v12 offset:1024
    v_mfma_f32_16x16x32_bf16 v[100:103], v[52:55], v[140:143], v[100:103]
    ds_read_b128 v[164:167], v11 offset:0
    v_mfma_f32_16x16x32_bf16 v[104:107], v[48:51], v[144:147], 0
    ds_read_b64_tr_b16 v[36:37], v12 offset:8192
    buffer_load_dwordx4 v9, s[12:15], s25 offen offset:1024 lds
    v_mfma_f32_16x16x32_bf16 v[104:107], v[52:55], v[148:151], v[104:107]
    ds_read_b64_tr_b16 v[38:39], v12 offset:9216
    v_mfma_f32_16x16x32_bf16 v[108:111], v[48:51], v[152:155], 0
    ds_read_b128 v[168:171], v10 offset:2048
    v_mfma_f32_16x16x32_bf16 v[108:111], v[52:55], v[156:159], v[108:111]
    ds_read_b128 v[172:175], v11 offset:2048
    v_mfma_f32_16x16x32_bf16 v[112:115], v[56:59], v[128:131], 0
    ds_read_b128 v[176:179], v10 offset:4096
    s_add_u32 m0, s26, s29
    v_mfma_f32_16x16x32_bf16 v[112:115], v[60:63], v[132:135], v[112:115]
    ds_read_b128 v[180:183], v11 offset:4096
    buffer_load_dwordx4 v4, s[8:11], s24 offen offset:0 lds
    v_mfma_f32_16x16x32_bf16 v[116:119], v[56:59], v[136:139], 0
    ds_read_b128 v[184:187], v10 offset:6144
    v_mfma_f32_16x16x32_bf16 v[116:119], v[60:63], v[140:143], v[116:119]
    ds_read_b128 v[188:191], v11 offset:6144
    v_mfma_f32_16x16x32_bf16 v[120:123], v[56:59], v[144:147], 0
    ds_read_b64_tr_b16 v[40:41], v13 offset:0
    v_mfma_f32_16x16x32_bf16 v[120:123], v[60:63], v[148:151], v[120:123]
    ds_read_b64_tr_b16 v[42:43], v13 offset:1024
    v_mfma_f32_16x16x32_bf16 v[124:127], v[56:59], v[152:155], 0
    ds_read_b64_tr_b16 v[44:45], v13 offset:8192
    buffer_load_dwordx4 v5, s[8:11], s24 offen offset:1024 lds
    v_mfma_f32_16x16x32_bf16 v[124:127], v[60:63], v[156:159], v[124:127]
    ds_read_b64_tr_b16 v[46:47], v13 offset:9216
    s_waitcnt lgkmcnt(13)
    v_mfma_f32_16x16x32_bf16 v[64:67], v[32:35], v[160:163], v[64:67]
    ds_read_b64_tr_b16 v[48:49], v14 offset:0
    s_waitcnt lgkmcnt(11)
    v_mfma_f32_16x16x32_bf16 v[64:67], v[36:39], v[164:167], v[64:67]
    ds_read_b64_tr_b16 v[50:51], v14 offset:1024
    s_waitcnt lgkmcnt(11)
    v_mfma_f32_16x16x32_bf16 v[68:71], v[32:35], v[168:171], v[68:71]
    ds_read_b64_tr_b16 v[52:53], v14 offset:8192
    s_waitcnt lgkmcnt(11)
    v_mfma_f32_16x16x32_bf16 v[68:71], v[36:39], v[172:175], v[68:71]
    ds_read_b64_tr_b16 v[54:55], v14 offset:9216
    s_waitcnt lgkmcnt(11)
    v_mfma_f32_16x16x32_bf16 v[72:75], v[32:35], v[176:179], v[72:75]
    ds_read_b64_tr_b16 v[56:57], v15 offset:0
    buffer_load_dwordx4 v6, s[8:11], s24 offen offset:2048 lds
    s_waitcnt lgkmcnt(11)
    v_mfma_f32_16x16x32_bf16 v[72:75], v[36:39], v[180:183], v[72:75]
    ds_read_b64_tr_b16 v[58:59], v15 offset:1024
    s_waitcnt lgkmcnt(11)
    v_mfma_f32_16x16x32_bf16 v[76:79], v[32:35], v[184:187], v[76:79]
    ds_read_b64_tr_b16 v[60:61], v15 offset:8192
    s_waitcnt lgkmcnt(11)
    v_mfma_f32_16x16x32_bf16 v[76:79], v[36:39], v[188:191], v[76:79]
    ds_read_b64_tr_b16 v[62:63], v15 offset:9216
    s_waitcnt lgkmcnt(10)
    v_mfma_f32_16x16x32_bf16 v[80:83], v[40:43], v[160:163], v[80:83]
    s_waitcnt lgkmcnt(8)
    v_mfma_f32_16x16x32_bf16 v[80:83], v[44:47], v[164:167], v[80:83]
    v_mfma_f32_16x16x32_bf16 v[84:87], v[40:43], v[168:171], v[84:87]
    buffer_load_dwordx4 v7, s[8:11], s24 offen offset:3072 lds
    v_mfma_f32_16x16x32_bf16 v[84:87], v[44:47], v[172:175], v[84:87]
    s_add_u32 s24, s24, 128
    s_add_u32 s25, s25, s31
    v_mfma_f32_16x16x32_bf16 v[88:91], v[40:43], v[176:179], v[88:91]
    s_add_u32 s26, s26, 49152
    s_cmp_eq_u32 s26, 147456
    s_cselect_b32 s26, 0, s26
    s_cmp_eq_u32 s26, 98304
    s_cselect_b32 s27, s32, s33
    v_mfma_f32_16x16x32_bf16 v[88:91], v[44:47], v[180:183], v[88:91]
    v_add_u32 v10, s27, v10
    v_add_u32 v11, s27, v11
    v_add_u32 v12, s27, v12
    v_mfma_f32_16x16x32_bf16 v[92:95], v[40:43], v[184:187], v[92:95]
    v_add_u32 v13, s27, v13
    v_add_u32 v14, s27, v14
    v_add_u32 v15, s27, v15
    v_mfma_f32_16x16x32_bf16 v[92:95], v[44:47], v[188:191], v[92:95]
    s_waitcnt vmcnt(6) lgkmcnt(0)
    s_barrier
    s_mov_b32 s68, s38
    s_mov_b32 s69, s39
    s_mov_b32 s70, 2097152
    s_mov_b32 s71, 0x00020000
    s_lshl_b32 s48, s47, 3
    s_add_u32 s48, s48, s20
    s_lshl_b32 s48, s48, 12
    v_lshlrev_b32 v27, 6, v1
    buffer_load_dword v28, v27, s[68:71], s48 offen
    s_add_u32 m0, s26, s30
    v_mfma_f32_16x16x32_bf16 v[96:99], v[48:51], v[160:163], v[96:99]
    ds_read_b128 v[128:131], v10 offset:0
    buffer_load_dwordx4 v8, s[12:15], s25 offen offset:0 lds
    v_mfma_f32_16x16x32_bf16 v[96:99], v[52:55], v[164:167], v[96:99]
    ds_read_b64_tr_b16 v[32:33], v12 offset:0
    v_mfma_f32_16x16x32_bf16 v[100:103], v[48:51], v[168:171], v[100:103]
    ds_read_b64_tr_b16 v[34:35], v12 offset:1024
    v_mfma_f32_16x16x32_bf16 v[100:103], v[52:55], v[172:175], v[100:103]
    ds_read_b128 v[132:135], v11 offset:0
    v_mfma_f32_16x16x32_bf16 v[104:107], v[48:51], v[176:179], v[104:107]
    ds_read_b64_tr_b16 v[36:37], v12 offset:8192
    buffer_load_dwordx4 v9, s[12:15], s25 offen offset:1024 lds
    v_mfma_f32_16x16x32_bf16 v[104:107], v[52:55], v[180:183], v[104:107]
    ds_read_b64_tr_b16 v[38:39], v12 offset:9216
    v_mfma_f32_16x16x32_bf16 v[108:111], v[48:51], v[184:187], v[108:111]
    ds_read_b128 v[136:139], v10 offset:2048
    v_mfma_f32_16x16x32_bf16 v[108:111], v[52:55], v[188:191], v[108:111]
    ds_read_b128 v[140:143], v11 offset:2048
    v_mfma_f32_16x16x32_bf16 v[112:115], v[56:59], v[160:163], v[112:115]
    ds_read_b128 v[144:147], v10 offset:4096
    s_add_u32 m0, s26, s29
    v_mfma_f32_16x16x32_bf16 v[112:115], v[60:63], v[164:167], v[112:115]
    ds_read_b128 v[148:151], v11 offset:4096
    buffer_load_dwordx4 v4, s[8:11], s24 offen offset:0 lds
    v_mfma_f32_16x16x32_bf16 v[116:119], v[56:59], v[168:171], v[116:119]
    ds_read_b128 v[152:155], v10 offset:6144
    v_mfma_f32_16x16x32_bf16 v[116:119], v[60:63], v[172:175], v[116:119]
    ds_read_b128 v[156:159], v11 offset:6144
    v_mfma_f32_16x16x32_bf16 v[120:123], v[56:59], v[176:179], v[120:123]
    ds_read_b64_tr_b16 v[40:41], v13 offset:0
    v_mfma_f32_16x16x32_bf16 v[120:123], v[60:63], v[180:183], v[120:123]
    ds_read_b64_tr_b16 v[42:43], v13 offset:1024
    v_mfma_f32_16x16x32_bf16 v[124:127], v[56:59], v[184:187], v[124:127]
    ds_read_b64_tr_b16 v[44:45], v13 offset:8192
    buffer_load_dwordx4 v5, s[8:11], s24 offen offset:1024 lds
    v_mfma_f32_16x16x32_bf16 v[124:127], v[60:63], v[188:191], v[124:127]
    ds_read_b64_tr_b16 v[46:47], v13 offset:9216
    s_waitcnt lgkmcnt(13)
    v_mfma_f32_16x16x32_bf16 v[64:67], v[32:35], v[128:131], v[64:67]
    ds_read_b64_tr_b16 v[48:49], v14 offset:0
    s_waitcnt lgkmcnt(11)
    v_mfma_f32_16x16x32_bf16 v[64:67], v[36:39], v[132:135], v[64:67]
    ds_read_b64_tr_b16 v[50:51], v14 offset:1024
    s_waitcnt lgkmcnt(11)
    v_mfma_f32_16x16x32_bf16 v[68:71], v[32:35], v[136:139], v[68:71]
    ds_read_b64_tr_b16 v[52:53], v14 offset:8192
    s_waitcnt lgkmcnt(11)
    v_mfma_f32_16x16x32_bf16 v[68:71], v[36:39], v[140:143], v[68:71]
    ds_read_b64_tr_b16 v[54:55], v14 offset:9216
    s_waitcnt lgkmcnt(11)
    v_mfma_f32_16x16x32_bf16 v[72:75], v[32:35], v[144:147], v[72:75]
    ds_read_b64_tr_b16 v[56:57], v15 offset:0
    buffer_load_dwordx4 v6, s[8:11], s24 offen offset:2048 lds
    s_waitcnt lgkmcnt(11)
    v_mfma_f32_16x16x32_bf16 v[72:75], v[36:39], v[148:151], v[72:75]
    ds_read_b64_tr_b16 v[58:59], v15 offset:1024
    s_waitcnt lgkmcnt(11)
    v_mfma_f32_16x16x32_bf16 v[76:79], v[32:35], v[152:155], v[76:79]
    ds_read_b64_tr_b16 v[60:61], v15 offset:8192
    s_waitcnt lgkmcnt(11)
    v_mfma_f32_16x16x32_bf16 v[76:79], v[36:39], v[156:159], v[76:79]
    ds_read_b64_tr_b16 v[62:63], v15 offset:9216
    s_waitcnt lgkmcnt(10)
    v_mfma_f32_16x16x32_bf16 v[80:83], v[40:43], v[128:131], v[80:83]
    s_waitcnt lgkmcnt(8)
    v_mfma_f32_16x16x32_bf16 v[80:83], v[44:47], v[132:135], v[80:83]
    v_mfma_f32_16x16x32_bf16 v[84:87], v[40:43], v[136:139], v[84:87]
    buffer_load_dwordx4 v7, s[8:11], s24 offen offset:3072 lds
    v_mfma_f32_16x16x32_bf16 v[84:87], v[44:47], v[140:143], v[84:87]
    s_add_u32 s24, s24, 128
    s_add_u32 s25, s25, s31
    v_mfma_f32_16x16x32_bf16 v[88:91], v[40:43], v[144:147], v[88:91]
    s_add_u32 s26, s26, 49152
    s_cmp_eq_u32 s26, 147456
    s_cselect_b32 s26, 0, s26
    s_cmp_eq_u32 s26, 98304
    s_cselect_b32 s27, s32, s33
    v_mfma_f32_16x16x32_bf16 v[88:91], v[44:47], v[148:151], v[88:91]
    v_add_u32 v10, s27, v10
    v_add_u32 v11, s27, v11
    v_add_u32 v12, s27, v12
    v_mfma_f32_16x16x32_bf16 v[92:95], v[40:43], v[152:155], v[92:95]
    v_add_u32 v13, s27, v13
    v_add_u32 v14, s27, v14
    v_add_u32 v15, s27, v15
    v_mfma_f32_16x16x32_bf16 v[92:95], v[44:47], v[156:159], v[92:95]
    s_waitcnt vmcnt(6) lgkmcnt(0)
    s_barrier
    s_add_u32 m0, s26, s30
    v_mfma_f32_16x16x32_bf16 v[96:99], v[48:51], v[128:131], v[96:99]
    ds_read_b128 v[160:163], v10 offset:0
    buffer_load_dwordx4 v8, s[12:15], s25 offen offset:0 lds
    v_mfma_f32_16x16x32_bf16 v[96:99], v[52:55], v[132:135], v[96:99]
    ds_read_b64_tr_b16 v[32:33], v12 offset:0
    buffer_load_dwordx4 v9, s[12:15], s25 offen offset:1024 lds
    v_mfma_f32_16x16x32_bf16 v[100:103], v[48:51], v[136:139], v[100:103]
    ds_read_b64_tr_b16 v[34:35], v12 offset:1024
    v_mfma_f32_16x16x32_bf16 v[100:103], v[52:55], v[140:143], v[100:103]
    ds_read_b128 v[164:167], v11 offset:0
    s_add_u32 m0, s26, s29
    v_mfma_f32_16x16x32_bf16 v[104:107], v[48:51], v[144:147], v[104:107]
    ds_read_b64_tr_b16 v[36:37], v12 offset:8192
    buffer_load_dwordx4 v4, s[8:11], s24 offen offset:0 lds
    v_mfma_f32_16x16x32_bf16 v[104:107], v[52:55], v[148:151], v[104:107]
    ds_read_b64_tr_b16 v[38:39], v12 offset:9216
    buffer_load_dwordx4 v5, s[8:11], s24 offen offset:1024 lds
    v_mfma_f32_16x16x32_bf16 v[108:111], v[48:51], v[152:155], v[108:111]
    ds_read_b128 v[168:171], v10 offset:2048
    buffer_load_dwordx4 v6, s[8:11], s24 offen offset:2048 lds
    v_mfma_f32_16x16x32_bf16 v[108:111], v[52:55], v[156:159], v[108:111]
    ds_read_b128 v[172:175], v11 offset:2048
    v_mfma_f32_16x16x32_bf16 v[112:115], v[56:59], v[128:131], v[112:115]
    ds_read_b128 v[176:179], v10 offset:4096
    buffer_load_dwordx4 v7, s[8:11], s24 offen offset:3072 lds
    v_mfma_f32_16x16x32_bf16 v[112:115], v[60:63], v[132:135], v[112:115]
    ds_read_b128 v[180:183], v11 offset:4096
    s_add_u32 s24, s24, 128
    s_add_u32 s25, s25, s31
    v_mfma_f32_16x16x32_bf16 v[116:119], v[56:59], v[136:139], v[116:119]
    ds_read_b128 v[184:187], v10 offset:6144
    v_mfma_f32_16x16x32_bf16 v[116:119], v[60:63], v[140:143], v[116:119]
    ds_read_b128 v[188:191], v11 offset:6144
    v_mfma_f32_16x16x32_bf16 v[120:123], v[56:59], v[144:147], v[120:123]
    ds_read_b64_tr_b16 v[40:41], v13 offset:0
    v_mfma_f32_16x16x32_bf16 v[120:123], v[60:63], v[148:151], v[120:123]
    ds_read_b64_tr_b16 v[42:43], v13 offset:1024
    v_mfma_f32_16x16x32_bf16 v[124:127], v[56:59], v[152:155], v[124:127]
    ds_read_b64_tr_b16 v[44:45], v13 offset:8192
    v_mfma_f32_16x16x32_bf16 v[124:127], v[60:63], v[156:159], v[124:127]
    ds_read_b64_tr_b16 v[46:47], v13 offset:9216
    s_waitcnt lgkmcnt(13)
    v_mfma_f32_16x16x32_bf16 v[64:67], v[32:35], v[160:163], v[64:67]
    ds_read_b64_tr_b16 v[48:49], v14 offset:0
    s_waitcnt lgkmcnt(11)
    v_mfma_f32_16x16x32_bf16 v[64:67], v[36:39], v[164:167], v[64:67]
    ds_read_b64_tr_b16 v[50:51], v14 offset:1024
    s_waitcnt lgkmcnt(11)
    v_mfma_f32_16x16x32_bf16 v[68:71], v[32:35], v[168:171], v[68:71]
    ds_read_b64_tr_b16 v[52:53], v14 offset:8192
    s_waitcnt lgkmcnt(11)
    v_mfma_f32_16x16x32_bf16 v[68:71], v[36:39], v[172:175], v[68:71]
    ds_read_b64_tr_b16 v[54:55], v14 offset:9216
    s_waitcnt lgkmcnt(11)
    v_mfma_f32_16x16x32_bf16 v[72:75], v[32:35], v[176:179], v[72:75]
    ds_read_b64_tr_b16 v[56:57], v15 offset:0
    s_waitcnt lgkmcnt(11)
    v_mfma_f32_16x16x32_bf16 v[72:75], v[36:39], v[180:183], v[72:75]
    ds_read_b64_tr_b16 v[58:59], v15 offset:1024
    s_waitcnt lgkmcnt(11)
    v_mfma_f32_16x16x32_bf16 v[76:79], v[32:35], v[184:187], v[76:79]
    ds_read_b64_tr_b16 v[60:61], v15 offset:8192
    s_waitcnt lgkmcnt(11)
    v_mfma_f32_16x16x32_bf16 v[76:79], v[36:39], v[188:191], v[76:79]
    ds_read_b64_tr_b16 v[62:63], v15 offset:9216
    s_waitcnt lgkmcnt(10)
    v_mfma_f32_16x16x32_bf16 v[80:83], v[40:43], v[160:163], v[80:83]
    s_waitcnt lgkmcnt(8)
    v_mfma_f32_16x16x32_bf16 v[80:83], v[44:47], v[164:167], v[80:83]
    v_mfma_f32_16x16x32_bf16 v[84:87], v[40:43], v[168:171], v[84:87]
    v_mfma_f32_16x16x32_bf16 v[84:87], v[44:47], v[172:175], v[84:87]
    v_mfma_f32_16x16x32_bf16 v[88:91], v[40:43], v[176:179], v[88:91]
    s_add_u32 s26, s26, 49152
    s_cmp_eq_u32 s26, 147456
    s_cselect_b32 s26, 0, s26
    s_cmp_eq_u32 s26, 98304
    s_cselect_b32 s27, s32, s33
    v_mfma_f32_16x16x32_bf16 v[88:91], v[44:47], v[180:183], v[88:91]
    v_add_u32 v10, s27, v10
    v_add_u32 v11, s27, v11
    v_add_u32 v12, s27, v12
    v_mfma_f32_16x16x32_bf16 v[92:95], v[40:43], v[184:187], v[92:95]
    v_add_u32 v13, s27, v13
    v_add_u32 v14, s27, v14
    v_add_u32 v15, s27, v15
    v_mfma_f32_16x16x32_bf16 v[92:95], v[44:47], v[188:191], v[92:95]
    s_waitcnt vmcnt(0) lgkmcnt(0)
    s_barrier
    s_cmp_lg_u32 s20, 0
    s_cbranch_scc1 L_nosig_6016
    v_mov_b32 v16, 0
    v_mov_b32 v17, 1
    s_mov_b64 s[50:51], exec
    s_mov_b64 exec, 1
    buffer_atomic_add v17, v16, s[64:67], 0 offen
    s_mov_b64 exec, s[50:51]
L_nosig_6016:
    s_mov_b32 s28, 3
.p2align 6
L_loopk13S_6017:
    s_add_u32 m0, s26, s30
    v_mfma_f32_16x16x32_bf16 v[96:99], v[48:51], v[160:163], v[96:99]
    ds_read_b128 v[128:131], v10 offset:0
    buffer_load_dwordx4 v8, s[12:15], s25 offen offset:0 lds
    v_mfma_f32_16x16x32_bf16 v[96:99], v[52:55], v[164:167], v[96:99]
    ds_read_b64_tr_b16 v[32:33], v12 offset:0
    v_mfma_f32_16x16x32_bf16 v[100:103], v[48:51], v[168:171], v[100:103]
    ds_read_b64_tr_b16 v[34:35], v12 offset:1024
    v_mfma_f32_16x16x32_bf16 v[100:103], v[52:55], v[172:175], v[100:103]
    ds_read_b128 v[132:135], v11 offset:0
    v_mfma_f32_16x16x32_bf16 v[104:107], v[48:51], v[176:179], v[104:107]
    ds_read_b64_tr_b16 v[36:37], v12 offset:8192
    buffer_load_dwordx4 v9, s[12:15], s25 offen offset:1024 lds
    v_mfma_f32_16x16x32_bf16 v[104:107], v[52:55], v[180:183], v[104:107]
    ds_read_b64_tr_b16 v[38:39], v12 offset:9216
    v_mfma_f32_16x16x32_bf16 v[108:111], v[48:51], v[184:187], v[108:111]
    ds_read_b128 v[136:139], v10 offset:2048
    v_mfma_f32_16x16x32_bf16 v[108:111], v[52:55], v[188:191], v[108:111]
    ds_read_b128 v[140:143], v11 offset:2048
    v_mfma_f32_16x16x32_bf16 v[112:115], v[56:59], v[160:163], v[112:115]
    ds_read_b128 v[144:147], v10 offset:4096
    s_add_u32 m0, s26, s29
    v_mfma_f32_16x16x32_bf16 v[112:115], v[60:63], v[164:167], v[112:115]
    ds_read_b128 v[148:151], v11 offset:4096
    buffer_load_dwordx4 v4, s[8:11], s24 offen offset:0 lds
    v_mfma_f32_16x16x32_bf16 v[116:119], v[56:59], v[168:171], v[116:119]
    ds_read_b128 v[152:155], v10 offset:6144
    v_mfma_f32_16x16x32_bf16 v[116:119], v[60:63], v[172:175], v[116:119]
    ds_read_b128 v[156:159], v11 offset:6144
    v_mfma_f32_16x16x32_bf16 v[120:123], v[56:59], v[176:179], v[120:123]
    ds_read_b64_tr_b16 v[40:41], v13 offset:0
    v_mfma_f32_16x16x32_bf16 v[120:123], v[60:63], v[180:183], v[120:123]
    ds_read_b64_tr_b16 v[42:43], v13 offset:1024
    v_mfma_f32_16x16x32_bf16 v[124:127], v[56:59], v[184:187], v[124:127]
    ds_read_b64_tr_b16 v[44:45], v13 offset:8192
    buffer_load_dwordx4 v5, s[8:11], s24 offen offset:1024 lds
    v_mfma_f32_16x16x32_bf16 v[124:127], v[60:63], v[188:191], v[124:127]
    ds_read_b64_tr_b16 v[46:47], v13 offset:9216
    s_waitcnt lgkmcnt(13)
    v_mfma_f32_16x16x32_bf16 v[64:67], v[32:35], v[128:131], v[64:67]
    ds_read_b64_tr_b16 v[48:49], v14 offset:0
    s_waitcnt lgkmcnt(11)
    v_mfma_f32_16x16x32_bf16 v[64:67], v[36:39], v[132:135], v[64:67]
    ds_read_b64_tr_b16 v[50:51], v14 offset:1024
    s_waitcnt lgkmcnt(11)
    v_mfma_f32_16x16x32_bf16 v[68:71], v[32:35], v[136:139], v[68:71]
    ds_read_b64_tr_b16 v[52:53], v14 offset:8192
    s_waitcnt lgkmcnt(11)
    v_mfma_f32_16x16x32_bf16 v[68:71], v[36:39], v[140:143], v[68:71]
    ds_read_b64_tr_b16 v[54:55], v14 offset:9216
    s_waitcnt lgkmcnt(11)
    v_mfma_f32_16x16x32_bf16 v[72:75], v[32:35], v[144:147], v[72:75]
    ds_read_b64_tr_b16 v[56:57], v15 offset:0
    buffer_load_dwordx4 v6, s[8:11], s24 offen offset:2048 lds
    s_waitcnt lgkmcnt(11)
    v_mfma_f32_16x16x32_bf16 v[72:75], v[36:39], v[148:151], v[72:75]
    ds_read_b64_tr_b16 v[58:59], v15 offset:1024
    s_waitcnt lgkmcnt(11)
    v_mfma_f32_16x16x32_bf16 v[76:79], v[32:35], v[152:155], v[76:79]
    ds_read_b64_tr_b16 v[60:61], v15 offset:8192
    s_waitcnt lgkmcnt(11)
    v_mfma_f32_16x16x32_bf16 v[76:79], v[36:39], v[156:159], v[76:79]
    ds_read_b64_tr_b16 v[62:63], v15 offset:9216
    s_waitcnt lgkmcnt(10)
    v_mfma_f32_16x16x32_bf16 v[80:83], v[40:43], v[128:131], v[80:83]
    s_waitcnt lgkmcnt(8)
    v_mfma_f32_16x16x32_bf16 v[80:83], v[44:47], v[132:135], v[80:83]
    v_mfma_f32_16x16x32_bf16 v[84:87], v[40:43], v[136:139], v[84:87]
    buffer_load_dwordx4 v7, s[8:11], s24 offen offset:3072 lds
    v_mfma_f32_16x16x32_bf16 v[84:87], v[44:47], v[140:143], v[84:87]
    s_add_u32 s24, s24, 128
    s_add_u32 s25, s25, s31
    v_mfma_f32_16x16x32_bf16 v[88:91], v[40:43], v[144:147], v[88:91]
    s_add_u32 s26, s26, 49152
    s_cmp_eq_u32 s26, 147456
    s_cselect_b32 s26, 0, s26
    s_cmp_eq_u32 s26, 98304
    s_cselect_b32 s27, s32, s33
    v_mfma_f32_16x16x32_bf16 v[88:91], v[44:47], v[148:151], v[88:91]
    v_add_u32 v10, s27, v10
    v_add_u32 v11, s27, v11
    v_add_u32 v12, s27, v12
    v_mfma_f32_16x16x32_bf16 v[92:95], v[40:43], v[152:155], v[92:95]
    v_add_u32 v13, s27, v13
    v_add_u32 v14, s27, v14
    v_add_u32 v15, s27, v15
    v_mfma_f32_16x16x32_bf16 v[92:95], v[44:47], v[156:159], v[92:95]
    s_waitcnt vmcnt(6) lgkmcnt(0)
    s_barrier
    s_add_u32 m0, s26, s30
    v_mfma_f32_16x16x32_bf16 v[96:99], v[48:51], v[128:131], v[96:99]
    ds_read_b128 v[160:163], v10 offset:0
    buffer_load_dwordx4 v8, s[12:15], s25 offen offset:0 lds
    v_mfma_f32_16x16x32_bf16 v[96:99], v[52:55], v[132:135], v[96:99]
    ds_read_b64_tr_b16 v[32:33], v12 offset:0
    v_mfma_f32_16x16x32_bf16 v[100:103], v[48:51], v[136:139], v[100:103]
    ds_read_b64_tr_b16 v[34:35], v12 offset:1024
    v_mfma_f32_16x16x32_bf16 v[100:103], v[52:55], v[140:143], v[100:103]
    ds_read_b128 v[164:167], v11 offset:0
    v_mfma_f32_16x16x32_bf16 v[104:107], v[48:51], v[144:147], v[104:107]
    ds_read_b64_tr_b16 v[36:37], v12 offset:8192
    buffer_load_dwordx4 v9, s[12:15], s25 offen offset:1024 lds
    v_mfma_f32_16x16x32_bf16 v[104:107], v[52:55], v[148:151], v[104:107]
    ds_read_b64_tr_b16 v[38:39], v12 offset:9216
    v_mfma_f32_16x16x32_bf16 v[108:111], v[48:51], v[152:155], v[108:111]
    ds_read_b128 v[168:171], v10 offset:2048
    v_mfma_f32_16x16x32_bf16 v[108:111], v[52:55], v[156:159], v[108:111]
    ds_read_b128 v[172:175], v11 offset:2048
    v_mfma_f32_16x16x32_bf16 v[112:115], v[56:59], v[128:131], v[112:115]
    ds_read_b128 v[176:179], v10 offset:4096
    s_add_u32 m0, s26, s29
    v_mfma_f32_16x16x32_bf16 v[112:115], v[60:63], v[132:135], v[112:115]
    ds_read_b128 v[180:183], v11 offset:4096
    buffer_load_dwordx4 v4, s[8:11], s24 offen offset:0 lds
    v_mfma_f32_16x16x32_bf16 v[116:119], v[56:59], v[136:139], v[116:119]
    ds_read_b128 v[184:187], v10 offset:6144
    v_mfma_f32_16x16x32_bf16 v[116:119], v[60:63], v[140:143], v[116:119]
    ds_read_b128 v[188:191], v11 offset:6144
    v_mfma_f32_16x16x32_bf16 v[120:123], v[56:59], v[144:147], v[120:123]
    ds_read_b64_tr_b16 v[40:41], v13 offset:0
    v_mfma_f32_16x16x32_bf16 v[120:123], v[60:63], v[148:151], v[120:123]
    ds_read_b64_tr_b16 v[42:43], v13 offset:1024
    v_mfma_f32_16x16x32_bf16 v[124:127], v[56:59], v[152:155], v[124:127]
    ds_read_b64_tr_b16 v[44:45], v13 offset:8192
    buffer_load_dwordx4 v5, s[8:11], s24 offen offset:1024 lds
    v_mfma_f32_16x16x32_bf16 v[124:127], v[60:63], v[156:159], v[124:127]
    ds_read_b64_tr_b16 v[46:47], v13 offset:9216
    s_waitcnt lgkmcnt(13)
    v_mfma_f32_16x16x32_bf16 v[64:67], v[32:35], v[160:163], v[64:67]
    ds_read_b64_tr_b16 v[48:49], v14 offset:0
    s_waitcnt lgkmcnt(11)
    v_mfma_f32_16x16x32_bf16 v[64:67], v[36:39], v[164:167], v[64:67]
    ds_read_b64_tr_b16 v[50:51], v14 offset:1024
    s_waitcnt lgkmcnt(11)
    v_mfma_f32_16x16x32_bf16 v[68:71], v[32:35], v[168:171], v[68:71]
    ds_read_b64_tr_b16 v[52:53], v14 offset:8192
    s_waitcnt lgkmcnt(11)
    v_mfma_f32_16x16x32_bf16 v[68:71], v[36:39], v[172:175], v[68:71]
    ds_read_b64_tr_b16 v[54:55], v14 offset:9216
    s_waitcnt lgkmcnt(11)
    v_mfma_f32_16x16x32_bf16 v[72:75], v[32:35], v[176:179], v[72:75]
    ds_read_b64_tr_b16 v[56:57], v15 offset:0
    buffer_load_dwordx4 v6, s[8:11], s24 offen offset:2048 lds
    s_waitcnt lgkmcnt(11)
    v_mfma_f32_16x16x32_bf16 v[72:75], v[36:39], v[180:183], v[72:75]
    ds_read_b64_tr_b16 v[58:59], v15 offset:1024
    s_waitcnt lgkmcnt(11)
    v_mfma_f32_16x16x32_bf16 v[76:79], v[32:35], v[184:187], v[76:79]
    ds_read_b64_tr_b16 v[60:61], v15 offset:8192
    s_waitcnt lgkmcnt(11)
    v_mfma_f32_16x16x32_bf16 v[76:79], v[36:39], v[188:191], v[76:79]
    ds_read_b64_tr_b16 v[62:63], v15 offset:9216
    s_waitcnt lgkmcnt(10)
    v_mfma_f32_16x16x32_bf16 v[80:83], v[40:43], v[160:163], v[80:83]
    s_waitcnt lgkmcnt(8)
    v_mfma_f32_16x16x32_bf16 v[80:83], v[44:47], v[164:167], v[80:83]
    v_mfma_f32_16x16x32_bf16 v[84:87], v[40:43], v[168:171], v[84:87]
    buffer_load_dwordx4 v7, s[8:11], s24 offen offset:3072 lds
    v_mfma_f32_16x16x32_bf16 v[84:87], v[44:47], v[172:175], v[84:87]
    s_add_u32 s24, s24, 128
    s_add_u32 s25, s25, s31
    v_mfma_f32_16x16x32_bf16 v[88:91], v[40:43], v[176:179], v[88:91]
    s_add_u32 s26, s26, 49152
    s_cmp_eq_u32 s26, 147456
    s_cselect_b32 s26, 0, s26
    s_cmp_eq_u32 s26, 98304
    s_cselect_b32 s27, s32, s33
    v_mfma_f32_16x16x32_bf16 v[88:91], v[44:47], v[180:183], v[88:91]
    v_add_u32 v10, s27, v10
    v_add_u32 v11, s27, v11
    v_add_u32 v12, s27, v12
    v_mfma_f32_16x16x32_bf16 v[92:95], v[40:43], v[184:187], v[92:95]
    v_add_u32 v13, s27, v13
    v_add_u32 v14, s27, v14
    v_add_u32 v15, s27, v15
    s_sub_u32 s28, s28, 1
    s_cmp_lg_u32 s28, 0
    v_mfma_f32_16x16x32_bf16 v[92:95], v[44:47], v[188:191], v[92:95]
    s_waitcnt vmcnt(6) lgkmcnt(0)
    s_barrier
    s_cbranch_scc1 L_loopk13S_6017
    s_add_u32 m0, s26, s30
    v_mfma_f32_16x16x32_bf16 v[96:99], v[48:51], v[160:163], v[96:99]
    ds_read_b128 v[128:131], v10 offset:0
    buffer_load_dwordx4 v8, s[12:15], s25 offen offset:0 lds
    v_mfma_f32_16x16x32_bf16 v[96:99], v[52:55], v[164:167], v[96:99]
    ds_read_b64_tr_b16 v[32:33], v12 offset:0
    v_mfma_f32_16x16x32_bf16 v[100:103], v[48:51], v[168:171], v[100:103]
    ds_read_b64_tr_b16 v[34:35], v12 offset:1024
    v_mfma_f32_16x16x32_bf16 v[100:103], v[52:55], v[172:175], v[100:103]
    ds_read_b128 v[132:135], v11 offset:0
    v_mfma_f32_16x16x32_bf16 v[104:107], v[48:51], v[176:179], v[104:107]
    ds_read_b64_tr_b16 v[36:37], v12 offset:8192
    buffer_load_dwordx4 v9, s[12:15], s25 offen offset:1024 lds
    v_mfma_f32_16x16x32_bf16 v[104:107], v[52:55], v[180:183], v[104:107]
    ds_read_b64_tr_b16 v[38:39], v12 offset:9216
    v_mfma_f32_16x16x32_bf16 v[108:111], v[48:51], v[184:187], v[108:111]
    ds_read_b128 v[136:139], v10 offset:2048
    v_mfma_f32_16x16x32_bf16 v[108:111], v[52:55], v[188:191], v[108:111]
    ds_read_b128 v[140:143], v11 offset:2048
    v_mfma_f32_16x16x32_bf16 v[112:115], v[56:59], v[160:163], v[112:115]
    ds_read_b128 v[144:147], v10 offset:4096
    s_add_u32 m0, s26, s29
    v_mfma_f32_16x16x32_bf16 v[112:115], v[60:63], v[164:167], v[112:115]
    ds_read_b128 v[148:151], v11 offset:4096
    buffer_load_dwordx4 v4, s[8:11], s24 offen offset:0 lds
    v_mfma_f32_16x16x32_bf16 v[116:119], v[56:59], v[168:171], v[116:119]
    ds_read_b128 v[152:155], v10 offset:6144
    v_mfma_f32_16x16x32_bf16 v[116:119], v[60:63], v[172:175], v[116:119]
    ds_read_b128 v[156:159], v11 offset:6144
    v_mfma_f32_16x16x32_bf16 v[120:123], v[56:59], v[176:179], v[120:123]
    ds_read_b64_tr_b16 v[40:41], v13 offset:0
    v_mfma_f32_16x16x32_bf16 v[120:123], v[60:63], v[180:183], v[120:123]
    ds_read_b64_tr_b16 v[42:43], v13 offset:1024
    v_mfma_f32_16x16x32_bf16 v[124:127], v[56:59], v[184:187], v[124:127]
    ds_read_b64_tr_b16 v[44:45], v13 offset:8192
    buffer_load_dwordx4 v5, s[8:11], s24 offen offset:1024 lds
    v_mfma_f32_16x16x32_bf16 v[124:127], v[60:63], v[188:191], v[124:127]
    ds_read_b64_tr_b16 v[46:47], v13 offset:9216
    s_waitcnt lgkmcnt(13)
    v_mfma_f32_16x16x32_bf16 v[64:67], v[32:35], v[128:131], v[64:67]
    ds_read_b64_tr_b16 v[48:49], v14 offset:0
    s_waitcnt lgkmcnt(11)
    v_mfma_f32_16x16x32_bf16 v[64:67], v[36:39], v[132:135], v[64:67]
    ds_read_b64_tr_b16 v[50:51], v14 offset:1024
    s_waitcnt lgkmcnt(11)
    v_mfma_f32_16x16x32_bf16 v[68:71], v[32:35], v[136:139], v[68:71]
    ds_read_b64_tr_b16 v[52:53], v14 offset:8192
    s_waitcnt lgkmcnt(11)
    v_mfma_f32_16x16x32_bf16 v[68:71], v[36:39], v[140:143], v[68:71]
    ds_read_b64_tr_b16 v[54:55], v14 offset:9216
    s_waitcnt lgkmcnt(11)
    v_mfma_f32_16x16x32_bf16 v[72:75], v[32:35], v[144:147], v[72:75]
    ds_read_b64_tr_b16 v[56:57], v15 offset:0
    buffer_load_dwordx4 v6, s[8:11], s24 offen offset:2048 lds
    s_waitcnt lgkmcnt(11)
    v_mfma_f32_16x16x32_bf16 v[72:75], v[36:39], v[148:151], v[72:75]
    ds_read_b64_tr_b16 v[58:59], v15 offset:1024
    s_waitcnt lgkmcnt(11)
    v_mfma_f32_16x16x32_bf16 v[76:79], v[32:35], v[152:155], v[76:79]
    ds_read_b64_tr_b16 v[60:61], v15 offset:8192
    s_waitcnt lgkmcnt(11)
    v_mfma_f32_16x16x32_bf16 v[76:79], v[36:39], v[156:159], v[76:79]
    ds_read_b64_tr_b16 v[62:63], v15 offset:9216
    s_waitcnt lgkmcnt(10)
    v_mfma_f32_16x16x32_bf16 v[80:83], v[40:43], v[128:131], v[80:83]
    s_waitcnt lgkmcnt(8)
    v_mfma_f32_16x16x32_bf16 v[80:83], v[44:47], v[132:135], v[80:83]
    v_mfma_f32_16x16x32_bf16 v[84:87], v[40:43], v[136:139], v[84:87]
    buffer_load_dwordx4 v7, s[8:11], s24 offen offset:3072 lds
    v_mfma_f32_16x16x32_bf16 v[84:87], v[44:47], v[140:143], v[84:87]
    s_add_u32 s24, s24, 128
    s_add_u32 s25, s25, s31
    v_mfma_f32_16x16x32_bf16 v[88:91], v[40:43], v[144:147], v[88:91]
    s_add_u32 s26, s26, 49152
    s_cmp_eq_u32 s26, 147456
    s_cselect_b32 s26, 0, s26
    s_cmp_eq_u32 s26, 98304
    s_cselect_b32 s27, s32, s33
    v_mfma_f32_16x16x32_bf16 v[88:91], v[44:47], v[148:151], v[88:91]
    v_add_u32 v10, s27, v10
    v_add_u32 v11, s27, v11
    v_add_u32 v12, s27, v12
    v_mfma_f32_16x16x32_bf16 v[92:95], v[40:43], v[152:155], v[92:95]
    v_add_u32 v13, s27, v13
    v_add_u32 v14, s27, v14
    v_add_u32 v15, s27, v15
    v_mfma_f32_16x16x32_bf16 v[92:95], v[44:47], v[156:159], v[92:95]
    v_mov_b32 v16, 0
    s_cmp_lg_u32 s20, 0
    s_cbranch_scc1 L_np1_6018
    buffer_load_dword v27, v16, s[64:67], 0 offen sc1
L_np1_6018:
    s_waitcnt vmcnt(6) lgkmcnt(0)
    s_barrier
    s_add_u32 m0, s26, s30
    v_mfma_f32_16x16x32_bf16 v[96:99], v[48:51], v[128:131], v[96:99]
    ds_read_b128 v[160:163], v10 offset:0
    buffer_load_dwordx4 v8, s[12:15], s25 offen offset:0 lds
    v_mfma_f32_16x16x32_bf16 v[96:99], v[52:55], v[132:135], v[96:99]
    ds_read_b64_tr_b16 v[32:33], v12 offset:0
    v_mfma_f32_16x16x32_bf16 v[100:103], v[48:51], v[136:139], v[100:103]
    ds_read_b64_tr_b16 v[34:35], v12 offset:1024
    v_mfma_f32_16x16x32_bf16 v[100:103], v[52:55], v[140:143], v[100:103]
    ds_read_b128 v[164:167], v11 offset:0
    v_mfma_f32_16x16x32_bf16 v[104:107], v[48:51], v[144:147], v[104:107]
    ds_read_b64_tr_b16 v[36:37], v12 offset:8192
    buffer_load_dwordx4 v9, s[12:15], s25 offen offset:1024 lds
    v_mfma_f32_16x16x32_bf16 v[104:107], v[52:55], v[148:151], v[104:107]
    ds_read_b64_tr_b16 v[38:39], v12 offset:9216
    v_mfma_f32_16x16x32_bf16 v[108:111], v[48:51], v[152:155], v[108:111]
    ds_read_b128 v[168:171], v10 offset:2048
    v_mfma_f32_16x16x32_bf16 v[108:111], v[52:55], v[156:159], v[108:111]
    ds_read_b128 v[172:175], v11 offset:2048
    v_mfma_f32_16x16x32_bf16 v[112:115], v[56:59], v[128:131], v[112:115]
    ds_read_b128 v[176:179], v10 offset:4096
    s_add_u32 m0, s26, s29
    v_mfma_f32_16x16x32_bf16 v[112:115], v[60:63], v[132:135], v[112:115]
    ds_read_b128 v[180:183], v11 offset:4096
    buffer_load_dwordx4 v4, s[8:11], s24 offen offset:0 lds
    v_mfma_f32_16x16x32_bf16 v[116:119], v[56:59], v[136:139], v[116:119]
    ds_read_b128 v[184:187], v10 offset:6144
    v_mfma_f32_16x16x32_bf16 v[116:119], v[60:63], v[140:143], v[116:119]
    ds_read_b128 v[188:191], v11 offset:6144
    v_mfma_f32_16x16x32_bf16 v[120:123], v[56:59], v[144:147], v[120:123]
    ds_read_b64_tr_b16 v[40:41], v13 offset:0
    v_mfma_f32_16x16x32_bf16 v[120:123], v[60:63], v[148:151], v[120:123]
    ds_read_b64_tr_b16 v[42:43], v13 offset:1024
    v_mfma_f32_16x16x32_bf16 v[124:127], v[56:59], v[152:155], v[124:127]
    ds_read_b64_tr_b16 v[44:45], v13 offset:8192
    buffer_load_dwordx4 v5, s[8:11], s24 offen offset:1024 lds
    v_mfma_f32_16x16x32_bf16 v[124:127], v[60:63], v[156:159], v[124:127]
    ds_read_b64_tr_b16 v[46:47], v13 offset:9216
    s_waitcnt lgkmcnt(13)
    v_mfma_f32_16x16x32_bf16 v[64:67], v[32:35], v[160:163], v[64:67]
    ds_read_b64_tr_b16 v[48:49], v14 offset:0
    s_waitcnt lgkmcnt(11)
    v_mfma_f32_16x16x32_bf16 v[64:67], v[36:39], v[164:167], v[64:67]
    ds_read_b64_tr_b16 v[50:51], v14 offset:1024
    s_waitcnt lgkmcnt(11)
    v_mfma_f32_16x16x32_bf16 v[68:71], v[32:35], v[168:171], v[68:71]
    ds_read_b64_tr_b16 v[52:53], v14 offset:8192
    s_waitcnt lgkmcnt(11)
    v_mfma_f32_16x16x32_bf16 v[68:71], v[36:39], v[172:175], v[68:71]
    ds_read_b64_tr_b16 v[54:55], v14 offset:9216
    s_waitcnt lgkmcnt(11)
    v_mfma_f32_16x16x32_bf16 v[72:75], v[32:35], v[176:179], v[72:75]
    ds_read_b64_tr_b16 v[56:57], v15 offset:0
    buffer_load_dwordx4 v6, s[8:11], s24 offen offset:2048 lds
    s_waitcnt lgkmcnt(11)
    v_mfma_f32_16x16x32_bf16 v[72:75], v[36:39], v[180:183], v[72:75]
    ds_read_b64_tr_b16 v[58:59], v15 offset:1024
    s_waitcnt lgkmcnt(11)
    v_mfma_f32_16x16x32_bf16 v[76:79], v[32:35], v[184:187], v[76:79]
    ds_read_b64_tr_b16 v[60:61], v15 offset:8192
    s_waitcnt lgkmcnt(11)
    v_mfma_f32_16x16x32_bf16 v[76:79], v[36:39], v[188:191], v[76:79]
    ds_read_b64_tr_b16 v[62:63], v15 offset:9216
    s_waitcnt lgkmcnt(10)
    v_mfma_f32_16x16x32_bf16 v[80:83], v[40:43], v[160:163], v[80:83]
    s_waitcnt lgkmcnt(8)
    v_mfma_f32_16x16x32_bf16 v[80:83], v[44:47], v[164:167], v[80:83]
    v_mfma_f32_16x16x32_bf16 v[84:87], v[40:43], v[168:171], v[84:87]
    buffer_load_dwordx4 v7, s[8:11], s24 offen offset:3072 lds
    v_mfma_f32_16x16x32_bf16 v[84:87], v[44:47], v[172:175], v[84:87]
    s_add_u32 s24, s24, 128
    s_add_u32 s25, s25, s31
    v_mfma_f32_16x16x32_bf16 v[88:91], v[40:43], v[176:179], v[88:91]
    s_add_u32 s26, s26, 49152
    s_cmp_eq_u32 s26, 147456
    s_cselect_b32 s26, 0, s26
    s_cmp_eq_u32 s26, 98304
    s_cselect_b32 s27, s32, s33
    v_mfma_f32_16x16x32_bf16 v[88:91], v[44:47], v[180:183], v[88:91]
    v_add_u32 v10, s27, v10
    v_add_u32 v11, s27, v11
    v_add_u32 v12, s27, v12
    v_mfma_f32_16x16x32_bf16 v[92:95], v[40:43], v[184:187], v[92:95]
    v_add_u32 v13, s27, v13
    v_add_u32 v14, s27, v14
    v_add_u32 v15, s27, v15
    v_mfma_f32_16x16x32_bf16 v[92:95], v[44:47], v[188:191], v[92:95]
    s_cmp_lg_u32 s20, 0
    s_cbranch_scc1 L_pollok_6020
    s_waitcnt vmcnt(6)
    s_mov_b32 s49, 0
L_poll_6019:
    v_readfirstlane_b32 s48, v27
    s_cmp_ge_u32 s48, 256
    s_cbranch_scc1 L_pollok_6020
    s_add_u32 s49, s49, 1
    s_cmp_ge_u32 s49, 4194304
    s_cbranch_scc1 L_pollok_6020
    s_sleep 4
    buffer_load_dword v27, v16, s[64:67], 0 offen sc1
    s_waitcnt vmcnt(0)
    s_branch L_poll_6019
L_pollok_6020:
    s_waitcnt vmcnt(6) lgkmcnt(0)
    s_barrier
    s_add_u32 m0, s26, s30
    v_mfma_f32_16x16x32_bf16 v[96:99], v[48:51], v[160:163], v[96:99]
    ds_read_b128 v[128:131], v10 offset:0
    buffer_load_dwordx4 v8, s[12:15], s25 offen offset:0 lds
    s_lshl_b32 s48, s21, 6
    s_add_u32 s48, s48, s46
    s_lshl_b32 s48, s48, 3
    s_add_u32 s48, s48, 41943040
    v_mfma_f32_16x16x32_bf16 v[96:99], v[52:55], v[164:167], v[96:99]
    ds_read_b64_tr_b16 v[32:33], v12 offset:0
    v_lshlrev_b32 v16, 3, v2
    v_mfma_f32_16x16x32_bf16 v[100:103], v[48:51], v[168:171], v[100:103]
    ds_read_b64_tr_b16 v[34:35], v12 offset:1024
    buffer_load_dwordx2 v[208:209], v16, s[16:19], s48 offen offset:0 sc1
    v_mfma_f32_16x16x32_bf16 v[100:103], v[52:55], v[172:175], v[100:103]
    ds_read_b128 v[132:135], v11 offset:0
    v_mfma_f32_16x16x32_bf16 v[104:107], v[48:51], v[176:179], v[104:107]
    ds_read_b64_tr_b16 v[36:37], v12 offset:8192
    buffer_load_dwordx4 v9, s[12:15], s25 offen offset:1024 lds
    buffer_load_dwordx2 v[210:211], v16, s[16:19], s48 offen offset:128 sc1
    v_mfma_f32_16x16x32_bf16 v[104:107], v[52:55], v[180:183], v[104:107]
    ds_read_b64_tr_b16 v[38:39], v12 offset:9216
    buffer_load_dwordx2 v[212:213], v16, s[16:19], s48 offen offset:256 sc1
    v_mfma_f32_16x16x32_bf16 v[108:111], v[48:51], v[184:187], v[108:111]
    ds_read_b128 v[136:139], v10 offset:2048
    v_mfma_f32_16x16x32_bf16 v[108:111], v[52:55], v[188:191], v[108:111]
    ds_read_b128 v[140:143], v11 offset:2048
    buffer_load_dwordx2 v[214:215], v16, s[16:19], s48 offen offset:384 sc1
    v_mfma_f32_16x16x32_bf16 v[112:115], v[56:59], v[160:163], v[112:115]
    ds_read_b128 v[144:147], v10 offset:4096
    s_add_u32 m0, s26, s29
    v_and_b32 v17, 127, v0
    v_mfma_f32_16x16x32_bf16 v[112:115], v[60:63], v[164:167], v[112:115]
    ds_read_b128 v[148:151], v11 offset:4096
    buffer_load_dwordx4 v4, s[8:11], s24 offen offset:0 lds
    v_lshrrev_b32 v18, 7, v0
    v_mfma_f32_16x16x32_bf16 v[116:119], v[56:59], v[168:171], v[116:119]
    ds_read_b128 v[152:155], v10 offset:6144
    v_mfma_f32_16x16x32_bf16 v[116:119], v[60:63], v[172:175], v[116:119]
    ds_read_b128 v[156:159], v11 offset:6144
    v_lshlrev_b32 v19, 15, v18
    v_mfma_f32_16x16x32_bf16 v[120:123], v[56:59], v[176:179], v[120:123]
    ds_read_b64_tr_b16 v[40:41], v13 offset:0
    v_lshl_add_u32 v19, v17, 2, v19
    v_mfma_f32_16x16x32_bf16 v[120:123], v[60:63], v[180:183], v[120:123]
    ds_read_b64_tr_b16 v[42:43], v13 offset:1024
    v_mfma_f32_16x16x32_bf16 v[124:127], v[56:59], v[184:187], v[124:127]
    ds_read_b64_tr_b16 v[44:45], v13 offset:8192
    buffer_load_dwordx4 v5, s[8:11], s24 offen offset:1024 lds
    s_lshl_b32 s49, s44, 9
    s_add_u32 s49, s49, 42663936
    v_mfma_f32_16x16x32_bf16 v[124:127], v[60:63], v[188:191], v[124:127]
    ds_read_b64_tr_b16 v[46:47], v13 offset:9216
    buffer_load_dword v216, v19, s[16:19], s49 offen sc1
    s_add_u32 s49, s49, 4096
    s_waitcnt lgkmcnt(13)
    v_mfma_f32_16x16x32_bf16 v[64:67], v[32:35], v[128:131], v[64:67]
    ds_read_b64_tr_b16 v[48:49], v14 offset:0
    s_waitcnt lgkmcnt(11)
    v_mfma_f32_16x16x32_bf16 v[64:67], v[36:39], v[132:135], v[64:67]
    ds_read_b64_tr_b16 v[50:51], v14 offset:1024
    buffer_load_dword v217, v19, s[16:19], s49 offen sc1
    s_add_u32 s49, s49, 4096
    s_waitcnt lgkmcnt(11)
    v_mfma_f32_16x16x32_bf16 v[68:71], v[32:35], v[136:139], v[68:71]
    ds_read_b64_tr_b16 v[52:53], v14 offset:8192
    buffer_load_dword v218, v19, s[16:19], s49 offen sc1
    s_add_u32 s49, s49, 4096
    s_waitcnt lgkmcnt(11)
    v_mfma_f32_16x16x32_bf16 v[68:71], v[36:39], v[140:143], v[68:71]
    ds_read_b64_tr_b16 v[54:55], v14 offset:9216
    buffer_load_dword v219, v19, s[16:19], s49 offen sc1
    s_add_u32 s49, s49, 4096
    s_waitcnt lgkmcnt(11)
    v_mfma_f32_16x16x32_bf16 v[72:75], v[32:35], v[144:147], v[72:75]
    ds_read_b64_tr_b16 v[56:57], v15 offset:0
    buffer_load_dwordx4 v6, s[8:11], s24 offen offset:2048 lds
    s_waitcnt lgkmcnt(11)
    v_mfma_f32_16x16x32_bf16 v[72:75], v[36:39], v[148:151], v[72:75]
    ds_read_b64_tr_b16 v[58:59], v15 offset:1024
    buffer_load_dword v220, v19, s[16:19], s49 offen sc1
    s_add_u32 s49, s49, 4096
    s_waitcnt lgkmcnt(11)
    v_mfma_f32_16x16x32_bf16 v[76:79], v[32:35], v[152:155], v[76:79]
    ds_read_b64_tr_b16 v[60:61], v15 offset:8192
    buffer_load_dword v221, v19, s[16:19], s49 offen sc1
    s_add_u32 s49, s49, 4096
    s_waitcnt lgkmcnt(11)
    v_mfma_f32_16x16x32_bf16 v[76:79], v[36:39], v[156:159], v[76:79]
    ds_read_b64_tr_b16 v[62:63], v15 offset:9216
    s_waitcnt lgkmcnt(10)
    v_mfma_f32_16x16x32_bf16 v[80:83], v[40:43], v[128:131], v[80:83]
    buffer_load_dword v222, v19, s[16:19], s49 offen sc1
    s_add_u32 s49, s49, 4096
    s_waitcnt lgkmcnt(8)
    v_mfma_f32_16x16x32_bf16 v[80:83], v[44:47], v[132:135], v[80:83]
    buffer_load_dword v223, v19, s[16:19], s49 offen sc1
    s_add_u32 s49, s49, 4096
    v_mfma_f32_16x16x32_bf16 v[84:87], v[40:43], v[136:139], v[84:87]
    buffer_load_dwordx4 v7, s[8:11], s24 offen offset:3072 lds
    v_mfma_f32_16x16x32_bf16 v[84:87], v[44:47], v[140:143], v[84:87]
    s_add_u32 s24, s24, 128
    s_add_u32 s25, s25, s31
    v_mfma_f32_16x16x32_bf16 v[88:91], v[40:43], v[144:147], v[88:91]
    s_add_u32 s26, s26, 49152
    s_cmp_eq_u32 s26, 147456
    s_cselect_b32 s26, 0, s26
    s_cmp_eq_u32 s26, 98304
    s_cselect_b32 s27, s32, s33
    v_mfma_f32_16x16x32_bf16 v[88:91], v[44:47], v[148:151], v[88:91]
    v_add_u32 v10, s27, v10
    v_add_u32 v11, s27, v11
    v_add_u32 v12, s27, v12
    v_mfma_f32_16x16x32_bf16 v[92:95], v[40:43], v[152:155], v[92:95]
    v_add_u32 v13, s27, v13
    v_add_u32 v14, s27, v14
    v_add_u32 v15, s27, v15
    v_mfma_f32_16x16x32_bf16 v[92:95], v[44:47], v[156:159], v[92:95]
    s_waitcnt vmcnt(18) lgkmcnt(0)
    s_barrier
    s_add_u32 m0, s26, s30
    v_mfma_f32_16x16x32_bf16 v[96:99], v[48:51], v[128:131], v[96:99]
    ds_read_b128 v[160:163], v10 offset:0
    buffer_load_dwordx4 v8, s[12:15], s25 offen offset:0 lds
    v_mfma_f32_16x16x32_bf16 v[96:99], v[52:55], v[132:135], v[96:99]
    ds_read_b64_tr_b16 v[32:33], v12 offset:0
    v_mfma_f32_16x16x32_bf16 v[100:103], v[48:51], v[136:139], v[100:103]
    ds_read_b64_tr_b16 v[34:35], v12 offset:1024
    v_mfma_f32_16x16x32_bf16 v[100:103], v[52:55], v[140:143], v[100:103]
    ds_read_b128 v[164:167], v11 offset:0
    v_mfma_f32_16x16x32_bf16 v[104:107], v[48:51], v[144:147], v[104:107]
    ds_read_b64_tr_b16 v[36:37], v12 offset:8192
    buffer_load_dwordx4 v9, s[12:15], s25 offen offset:1024 lds
    v_mfma_f32_16x16x32_bf16 v[104:107], v[52:55], v[148:151], v[104:107]
    ds_read_b64_tr_b16 v[38:39], v12 offset:9216
    v_mfma_f32_16x16x32_bf16 v[108:111], v[48:51], v[152:155], v[108:111]
    ds_read_b128 v[168:171], v10 offset:2048
    v_mfma_f32_16x16x32_bf16 v[108:111], v[52:55], v[156:159], v[108:111]
    ds_read_b128 v[172:175], v11 offset:2048
    v_mfma_f32_16x16x32_bf16 v[112:115], v[56:59], v[128:131], v[112:115]
    ds_read_b128 v[176:179], v10 offset:4096
    s_add_u32 m0, s26, s29
    v_mfma_f32_16x16x32_bf16 v[112:115], v[60:63], v[132:135], v[112:115]
    ds_read_b128 v[180:183], v11 offset:4096
    buffer_load_dwordx4 v4, s[8:11], s24 offen offset:0 lds
    v_mfma_f32_16x16x32_bf16 v[116:119], v[56:59], v[136:139], v[116:119]
    ds_read_b128 v[184:187], v10 offset:6144
    v_mfma_f32_16x16x32_bf16 v[116:119], v[60:63], v[140:143], v[116:119]
    ds_read_b128 v[188:191], v11 offset:6144
    v_mfma_f32_16x16x32_bf16 v[120:123], v[56:59], v[144:147], v[120:123]
    ds_read_b64_tr_b16 v[40:41], v13 offset:0
    v_mfma_f32_16x16x32_bf16 v[120:123], v[60:63], v[148:151], v[120:123]
    ds_read_b64_tr_b16 v[42:43], v13 offset:1024
    v_mfma_f32_16x16x32_bf16 v[124:127], v[56:59], v[152:155], v[124:127]
    ds_read_b64_tr_b16 v[44:45], v13 offset:8192
    buffer_load_dwordx4 v5, s[8:11], s24 offen offset:1024 lds
    v_mfma_f32_16x16x32_bf16 v[124:127], v[60:63], v[156:159], v[124:127]
    ds_read_b64_tr_b16 v[46:47], v13 offset:9216
    s_waitcnt lgkmcnt(13)
    v_mfma_f32_16x16x32_bf16 v[64:67], v[32:35], v[160:163], v[64:67]
    ds_read_b64_tr_b16 v[48:49], v14 offset:0
    s_waitcnt lgkmcnt(11)
    v_mfma_f32_16x16x32_bf16 v[64:67], v[36:39], v[164:167], v[64:67]
    ds_read_b64_tr_b16 v[50:51], v14 offset:1024
    s_waitcnt lgkmcnt(11)
    v_mfma_f32_16x16x32_bf16 v[68:71], v[32:35], v[168:171], v[68:71]
    ds_read_b64_tr_b16 v[52:53], v14 offset:8192
    s_waitcnt lgkmcnt(11)
    v_mfma_f32_16x16x32_bf16 v[68:71], v[36:39], v[172:175], v[68:71]
    ds_read_b64_tr_b16 v[54:55], v14 offset:9216
    s_waitcnt lgkmcnt(11)
    v_mfma_f32_16x16x32_bf16 v[72:75], v[32:35], v[176:179], v[72:75]
    ds_read_b64_tr_b16 v[56:57], v15 offset:0
    buffer_load_dwordx4 v6, s[8:11], s24 offen offset:2048 lds
    s_waitcnt lgkmcnt(11)
    v_mfma_f32_16x16x32_bf16 v[72:75], v[36:39], v[180:183], v[72:75]
    ds_read_b64_tr_b16 v[58:59], v15 offset:1024
    s_waitcnt lgkmcnt(11)
    v_mfma_f32_16x16x32_bf16 v[76:79], v[32:35], v[184:187], v[76:79]
    ds_read_b64_tr_b16 v[60:61], v15 offset:8192
    s_waitcnt lgkmcnt(11)
    v_mfma_f32_16x16x32_bf16 v[76:79], v[36:39], v[188:191], v[76:79]
    ds_read_b64_tr_b16 v[62:63], v15 offset:9216
    s_waitcnt lgkmcnt(10)
    v_mfma_f32_16x16x32_bf16 v[80:83], v[40:43], v[160:163], v[80:83]
    s_waitcnt lgkmcnt(8)
    v_mfma_f32_16x16x32_bf16 v[80:83], v[44:47], v[164:167], v[80:83]
    v_mfma_f32_16x16x32_bf16 v[84:87], v[40:43], v[168:171], v[84:87]
    buffer_load_dwordx4 v7, s[8:11], s24 offen offset:3072 lds
    v_mfma_f32_16x16x32_bf16 v[84:87], v[44:47], v[172:175], v[84:87]
    s_add_u32 s24, s24, 128
    s_add_u32 s25, s25, s31
    v_mfma_f32_16x16x32_bf16 v[88:91], v[40:43], v[176:179], v[88:91]
    s_add_u32 s26, s26, 49152
    s_cmp_eq_u32 s26, 147456
    s_cselect_b32 s26, 0, s26
    s_cmp_eq_u32 s26, 98304
    s_cselect_b32 s27, s32, s33
    v_mfma_f32_16x16x32_bf16 v[88:91], v[44:47], v[180:183], v[88:91]
    v_add_u32 v10, s27, v10
    v_add_u32 v11, s27, v11
    v_add_u32 v12, s27, v12
    v_mfma_f32_16x16x32_bf16 v[92:95], v[40:43], v[184:187], v[92:95]
    v_add_u32 v13, s27, v13
    v_add_u32 v14, s27, v14
    v_add_u32 v15, s27, v15
    v_mfma_f32_16x16x32_bf16 v[92:95], v[44:47], v[188:191], v[92:95]
    s_waitcnt vmcnt(6) lgkmcnt(0)
    s_barrier
    v_mfma_f32_16x16x32_bf16 v[96:99], v[48:51], v[160:163], v[96:99]
    ds_read_b128 v[128:131], v10 offset:0
    s_lshr_b32 s48, s44, 1
    s_lshr_b32 s49, s48, 1
    s_add_u32 s49, s49, 1
    s_sub_u32 s50, 0, s49
    s_and_b32 s48, s48, 1
    s_cmp_eq_u32 s48, 0
    s_cselect_b32 s49, s49, s50
    s_lshl_b32 s48, s21, 6
    s_add_u32 s48, s48, s46
    s_add_u32 s48, s48, s49
    v_add_u32 v16, s48, v2
    v_mov_b32 v18, 2048
    v_mfma_f32_16x16x32_bf16 v[96:99], v[52:55], v[164:167], v[96:99]
    ds_read_b64_tr_b16 v[32:33], v12 offset:0
    v_cmp_lt_u32 s[50:51], v16, v18
    v_and_b32 v16, 2047, v16
    v_mfma_f32_16x16x32_bf16 v[100:103], v[48:51], v[168:171], v[100:103]
    ds_read_b64_tr_b16 v[34:35], v12 offset:1024
    v_lshrrev_b32 v17, 5, v16
    v_lshlrev_b32 v17, 16, v17
    v_mfma_f32_16x16x32_bf16 v[100:103], v[52:55], v[172:175], v[100:103]
    ds_read_b128 v[132:135], v11 offset:0
    v_bfe_u32 v18, v16, 4, 1
    v_lshl_add_u32 v17, v18, 11, v17
    v_mfma_f32_16x16x32_bf16 v[104:107], v[48:51], v[176:179], v[104:107]
    ds_read_b64_tr_b16 v[36:37], v12 offset:8192
    v_and_b32 v18, 15, v16
    v_lshl_add_u32 v17, v18, 4, v17
    v_mfma_f32_16x16x32_bf16 v[104:107], v[52:55], v[180:183], v[104:107]
    ds_read_b64_tr_b16 v[38:39], v12 offset:9216
    v_lshl_add_u32 v28, v3, 8, v17
    v_add_u32 v16, s48, v2
    v_add_u32 v16, 16, v16
    v_mfma_f32_16x16x32_bf16 v[108:111], v[48:51], v[184:187], v[108:111]
    ds_read_b128 v[136:139], v10 offset:2048
    v_mov_b32 v18, 2048
    v_cmp_lt_u32 s[52:53], v16, v18
    v_mfma_f32_16x16x32_bf16 v[108:111], v[52:55], v[188:191], v[108:111]
    ds_read_b128 v[140:143], v11 offset:2048
    v_and_b32 v16, 2047, v16
    v_lshrrev_b32 v17, 5, v16
    v_mfma_f32_16x16x32_bf16 v[112:115], v[56:59], v[160:163], v[112:115]
    ds_read_b128 v[144:147], v10 offset:4096
    v_lshlrev_b32 v17, 16, v17
    v_bfe_u32 v18, v16, 4, 1
    v_mfma_f32_16x16x32_bf16 v[112:115], v[60:63], v[164:167], v[112:115]
    ds_read_b128 v[148:151], v11 offset:4096
    v_lshl_add_u32 v17, v18, 11, v17
    v_and_b32 v18, 15, v16
    v_mfma_f32_16x16x32_bf16 v[116:119], v[56:59], v[168:171], v[116:119]
    ds_read_b128 v[152:155], v10 offset:6144
    v_lshl_add_u32 v17, v18, 4, v17
    v_lshl_add_u32 v29, v3, 8, v17
    v_add_u32 v16, s48, v2
    v_mfma_f32_16x16x32_bf16 v[116:119], v[60:63], v[172:175], v[116:119]
    ds_read_b128 v[156:159], v11 offset:6144
    v_add_u32 v16, 32, v16
    v_mov_b32 v18, 2048
    v_mfma_f32_16x16x32_bf16 v[120:123], v[56:59], v[176:179], v[120:123]
    ds_read_b64_tr_b16 v[40:41], v13 offset:0
    v_cmp_lt_u32 s[54:55], v16, v18
    v_and_b32 v16, 2047, v16
    v_mfma_f32_16x16x32_bf16 v[120:123], v[60:63], v[180:183], v[120:123]
    ds_read_b64_tr_b16 v[42:43], v13 offset:1024
    v_lshrrev_b32 v17, 5, v16
    v_lshlrev_b32 v17, 16, v17
    v_mfma_f32_16x16x32_bf16 v[124:127], v[56:59], v[184:187], v[124:127]
    ds_read_b64_tr_b16 v[44:45], v13 offset:8192
    v_bfe_u32 v18, v16, 4, 1
    v_lshl_add_u32 v17, v18, 11, v17
    v_mfma_f32_16x16x32_bf16 v[124:127], v[60:63], v[188:191], v[124:127]
    ds_read_b64_tr_b16 v[46:47], v13 offset:9216
    v_and_b32 v18, 15, v16
    v_lshl_add_u32 v17, v18, 4, v17
    s_waitcnt lgkmcnt(13)
    v_mfma_f32_16x16x32_bf16 v[64:67], v[32:35], v[128:131], v[64:67]
    ds_read_b64_tr_b16 v[48:49], v14 offset:0
    v_lshl_add_u32 v30, v3, 8, v17
    v_add_u32 v16, s48, v2
    v_add_u32 v16, 48, v16
    s_waitcnt lgkmcnt(11)
    v_mfma_f32_16x16x32_bf16 v[64:67], v[36:39], v[132:135], v[64:67]
    ds_read_b64_tr_b16 v[50:51], v14 offset:1024
    v_mov_b32 v18, 2048
    v_cmp_lt_u32 s[56:57], v16, v18
    s_waitcnt lgkmcnt(11)
    v_mfma_f32_16x16x32_bf16 v[68:71], v[32:35], v[136:139], v[68:71]
    ds_read_b64_tr_b16 v[52:53], v14 offset:8192
    v_and_b32 v16, 2047, v16
    v_lshrrev_b32 v17, 5, v16
    s_waitcnt lgkmcnt(11)
    v_mfma_f32_16x16x32_bf16 v[68:71], v[36:39], v[140:143], v[68:71]
    ds_read_b64_tr_b16 v[54:55], v14 offset:9216
    v_lshlrev_b32 v17, 16, v17
    v_bfe_u32 v18, v16, 4, 1
    s_waitcnt lgkmcnt(11)
    v_mfma_f32_16x16x32_bf16 v[72:75], v[32:35], v[144:147], v[72:75]
    ds_read_b64_tr_b16 v[56:57], v15 offset:0
    v_lshl_add_u32 v17, v18, 11, v17
    v_and_b32 v18, 15, v16
    s_waitcnt lgkmcnt(11)
    v_mfma_f32_16x16x32_bf16 v[72:75], v[36:39], v[148:151], v[72:75]
    ds_read_b64_tr_b16 v[58:59], v15 offset:1024
    v_lshl_add_u32 v17, v18, 4, v17
    v_lshl_add_u32 v31, v3, 8, v17
    s_waitcnt lgkmcnt(11)
    v_mfma_f32_16x16x32_bf16 v[76:79], v[32:35], v[152:155], v[76:79]
    ds_read_b64_tr_b16 v[60:61], v15 offset:8192
    v_add_f32 v216, v216, v217
    v_add_f32 v216, v216, v218
    s_waitcnt lgkmcnt(11)
    v_mfma_f32_16x16x32_bf16 v[76:79], v[36:39], v[156:159], v[76:79]
    ds_read_b64_tr_b16 v[62:63], v15 offset:9216
    v_add_f32 v216, v216, v219
    v_add_f32 v216, v216, v220
    s_waitcnt lgkmcnt(10)
    v_mfma_f32_16x16x32_bf16 v[80:83], v[40:43], v[128:131], v[80:83]
    v_add_f32 v216, v216, v221
    v_add_f32 v216, v216, v222
    s_waitcnt lgkmcnt(8)
    v_mfma_f32_16x16x32_bf16 v[80:83], v[44:47], v[132:135], v[80:83]
    v_add_f32 v216, v216, v223
    v_lshlrev_b32 v19, 2, v0
    v_mfma_f32_16x16x32_bf16 v[84:87], v[40:43], v[136:139], v[84:87]
    v_add_u32 v19, 148480, v19
    ds_write_b32 v19, v216
    v_mfma_f32_16x16x32_bf16 v[84:87], v[44:47], v[140:143], v[84:87]
    v_mfma_f32_16x16x32_bf16 v[88:91], v[40:43], v[144:147], v[88:91]
    s_add_u32 s26, s26, 49152
    s_cmp_eq_u32 s26, 147456
    s_cselect_b32 s26, 0, s26
    s_cmp_eq_u32 s26, 98304
    s_cselect_b32 s27, s32, s33
    v_mfma_f32_16x16x32_bf16 v[88:91], v[44:47], v[148:151], v[88:91]
    v_add_u32 v10, s27, v10
    v_add_u32 v11, s27, v11
    v_add_u32 v12, s27, v12
    v_mfma_f32_16x16x32_bf16 v[92:95], v[40:43], v[152:155], v[92:95]
    v_add_u32 v13, s27, v13
    v_add_u32 v14, s27, v14
    v_add_u32 v15, s27, v15
    v_mfma_f32_16x16x32_bf16 v[92:95], v[44:47], v[156:159], v[92:95]
    s_waitcnt vmcnt(0) lgkmcnt(0)
    s_barrier
    v_mfma_f32_16x16x32_bf16 v[96:99], v[48:51], v[128:131], v[96:99]
    ds_read_b128 v[160:163], v10 offset:0
    s_lshl_b32 s49, s22, 8
    s_add_u32 s49, s49, 148480
    v_lshl_add_u32 v19, v1, 2, s49
    v_mfma_f32_16x16x32_bf16 v[96:99], v[52:55], v[132:135], v[96:99]
    ds_read_b64_tr_b16 v[32:33], v12 offset:0
    ds_read_b32 v216, v19 offset:0
    v_mfma_f32_16x16x32_bf16 v[100:103], v[48:51], v[136:139], v[100:103]
    ds_read_b64_tr_b16 v[34:35], v12 offset:1024
    ds_read_b32 v217, v19 offset:512
    v_mfma_f32_16x16x32_bf16 v[100:103], v[52:55], v[140:143], v[100:103]
    ds_read_b128 v[164:167], v11 offset:0
    ds_read_b32 v218, v19 offset:1024
    v_mfma_f32_16x16x32_bf16 v[104:107], v[48:51], v[144:147], v[104:107]
    ds_read_b64_tr_b16 v[36:37], v12 offset:8192
    ds_read_b32 v219, v19 offset:1536
    v_mfma_f32_16x16x32_bf16 v[104:107], v[52:55], v[148:151], v[104:107]
    ds_read_b64_tr_b16 v[38:39], v12 offset:9216
    s_lshl_b32 s48, s44, 1
    s_add_u32 s48, s48, s22
    s_lshl_b32 s48, s48, 12
    s_add_u32 s48, s48, 12582912
    v_mfma_f32_16x16x32_bf16 v[108:111], v[48:51], v[152:155], v[108:111]
    ds_read_b128 v[168:171], v10 offset:2048
    s_nop 0
    v_mfma_f32_16x16x32_bf16 v[108:111], v[52:55], v[156:159], v[108:111]
    ds_read_b128 v[172:175], v11 offset:2048
    s_nop 0
    v_mfma_f32_16x16x32_bf16 v[112:115], v[56:59], v[128:131], v[112:115]
    ds_read_b128 v[176:179], v10 offset:4096
    s_nop 0
    v_mfma_f32_16x16x32_bf16 v[112:115], v[60:63], v[132:135], v[112:115]
    ds_read_b128 v[180:183], v11 offset:4096
    s_nop 0
    v_mfma_f32_16x16x32_bf16 v[116:119], v[56:59], v[136:139], v[116:119]
    ds_read_b128 v[184:187], v10 offset:6144
    s_waitcnt lgkmcnt(6)
    v_mfma_f32_16x16x32_bf16 v[116:119], v[60:63], v[140:143], v[116:119]
    ds_read_b128 v[188:191], v11 offset:6144
    v_add_f32 v216, v216, v217
    v_mfma_f32_16x16x32_bf16 v[120:123], v[56:59], v[144:147], v[120:123]
    ds_read_b64_tr_b16 v[40:41], v13 offset:0
    v_add_f32 v218, v218, v219
    v_mfma_f32_16x16x32_bf16 v[120:123], v[60:63], v[148:151], v[120:123]
    ds_read_b64_tr_b16 v[42:43], v13 offset:1024
    v_add_f32 v216, v216, v218
    v_mfma_f32_16x16x32_bf16 v[124:127], v[56:59], v[152:155], v[124:127]
    ds_read_b64_tr_b16 v[44:45], v13 offset:8192
    v_subrev_u32 v19, 1024, v19
    v_mfma_f32_16x16x32_bf16 v[124:127], v[60:63], v[156:159], v[124:127]
    ds_read_b64_tr_b16 v[46:47], v13 offset:9216
    ds_write_b32 v19, v216
    v_mfma_f32_16x16x32_bf16 v[64:67], v[32:35], v[160:163], v[64:67]
    ds_read_b64_tr_b16 v[48:49], v14 offset:0
    s_nop 0
    s_waitcnt lgkmcnt(12)
    v_mfma_f32_16x16x32_bf16 v[64:67], v[36:39], v[164:167], v[64:67]
    ds_read_b64_tr_b16 v[50:51], v14 offset:1024
    s_nop 0
    s_waitcnt lgkmcnt(12)
    v_mfma_f32_16x16x32_bf16 v[68:71], v[32:35], v[168:171], v[68:71]
    ds_read_b64_tr_b16 v[52:53], v14 offset:8192
    s_nop 0
    s_waitcnt lgkmcnt(12)
    v_mfma_f32_16x16x32_bf16 v[68:71], v[36:39], v[172:175], v[68:71]
    ds_read_b64_tr_b16 v[54:55], v14 offset:9216
    s_nop 0
    s_waitcnt lgkmcnt(12)
    v_mfma_f32_16x16x32_bf16 v[72:75], v[32:35], v[176:179], v[72:75]
    ds_read_b64_tr_b16 v[56:57], v15 offset:0
    s_waitcnt lgkmcnt(5)
    v_mfma_f32_16x16x32_bf16 v[72:75], v[36:39], v[180:183], v[72:75]
    ds_read_b64_tr_b16 v[58:59], v15 offset:1024
    s_lshl_b32 s49, s22, 8
    s_add_u32 s49, s49, 147456
    v_mfma_f32_16x16x32_bf16 v[76:79], v[32:35], v[184:187], v[76:79]
    ds_read_b64_tr_b16 v[60:61], v15 offset:8192
    v_lshl_add_u32 v16, v3, 4, s49
    v_mfma_f32_16x16x32_bf16 v[76:79], v[36:39], v[188:191], v[76:79]
    ds_read_b64_tr_b16 v[62:63], v15 offset:9216
    ds_read_b128 v[192:195], v16 offset:0
    v_mfma_f32_16x16x32_bf16 v[80:83], v[40:43], v[160:163], v[80:83]
    ds_read_b128 v[196:199], v16 offset:64
    v_mfma_f32_16x16x32_bf16 v[80:83], v[44:47], v[164:167], v[80:83]
    ds_read_b128 v[200:203], v16 offset:128
    v_mfma_f32_16x16x32_bf16 v[84:87], v[40:43], v[168:171], v[84:87]
    ds_read_b128 v[204:207], v16 offset:192
    v_mfma_f32_16x16x32_bf16 v[84:87], v[44:47], v[172:175], v[84:87]
    v_mfma_f32_16x16x32_bf16 v[88:91], v[40:43], v[176:179], v[88:91]
    v_mfma_f32_16x16x32_bf16 v[88:91], v[44:47], v[180:183], v[88:91]
    v_mfma_f32_16x16x32_bf16 v[92:95], v[40:43], v[184:187], v[92:95]
    v_mfma_f32_16x16x32_bf16 v[92:95], v[44:47], v[188:191], v[92:95]
    s_waitcnt lgkmcnt(10)
    v_mfma_f32_16x16x32_bf16 v[96:99], v[48:51], v[160:163], v[96:99]
    s_waitcnt lgkmcnt(8)
    v_mfma_f32_16x16x32_bf16 v[96:99], v[52:55], v[164:167], v[96:99]
    v_mfma_f32_16x16x32_bf16 v[100:103], v[48:51], v[168:171], v[100:103]
    v_mfma_f32_16x16x32_bf16 v[100:103], v[52:55], v[172:175], v[100:103]
    v_mfma_f32_16x16x32_bf16 v[104:107], v[48:51], v[176:179], v[104:107]
    v_mfma_f32_16x16x32_bf16 v[104:107], v[52:55], v[180:183], v[104:107]
    v_mfma_f32_16x16x32_bf16 v[108:111], v[48:51], v[184:187], v[108:111]
    v_mfma_f32_16x16x32_bf16 v[108:111], v[52:55], v[188:191], v[108:111]
    s_waitcnt lgkmcnt(6)
    v_mfma_f32_16x16x32_bf16 v[112:115], v[56:59], v[160:163], v[112:115]
    s_waitcnt lgkmcnt(4)
    v_mfma_f32_16x16x32_bf16 v[112:115], v[60:63], v[164:167], v[112:115]
    v_mfma_f32_16x16x32_bf16 v[116:119], v[56:59], v[168:171], v[116:119]
    v_mfma_f32_16x16x32_bf16 v[116:119], v[60:63], v[172:175], v[116:119]
    v_mfma_f32_16x16x32_bf16 v[120:123], v[56:59], v[176:179], v[120:123]
    v_mfma_f32_16x16x32_bf16 v[120:123], v[60:63], v[180:183], v[120:123]
    v_mfma_f32_16x16x32_bf16 v[124:127], v[56:59], v[184:187], v[124:127]
    v_mfma_f32_16x16x32_bf16 v[124:127], v[60:63], v[188:191], v[124:127]
    s_branch L_k1_ep3
L_k1_ep0:
    s_lshl_b32 s48, s44, 2
    s_lshl_b32 s49, s22, 1
    s_add_u32 s48, s48, s49
    s_lshl_b32 s48, s48, 17
    s_lshl_b32 s49, s42, 3
    s_lshl_b32 s50, s21, 1
    s_add_u32 s49, s49, s50
    s_lshl_b32 s49, s49, 11
    s_add_u32 s48, s48, s49
    s_add_u32 s48, s48, 0
    v_lshrrev_b32 v16, 3, v2
    v_lshlrev_b32 v16, 7, v16
    v_and_b32 v17, 7, v2
    v_lshl_add_u32 v16, v17, 4, v16
    v_lshl_add_u32 v16, v3, 9, v16
    v_mov_b32 v18, 1048744942
    v_mov_b32 v19, 1048744942
    v_pk_mul_f32 v[64:65], v[64:65], v[18:19]
    v_pk_mul_f32 v[66:67], v[66:67], v[18:19]
    v_pk_mul_f32 v[80:81], v[80:81], v[18:19]
    v_pk_mul_f32 v[82:83], v[82:83], v[18:19]
    v_cvt_pk_bf16_f32 v128, v64, v65
    v_cvt_pk_bf16_f32 v129, v66, v67
    v_cvt_pk_bf16_f32 v130, v80, v81
    v_cvt_pk_bf16_f32 v131, v82, v83
    s_add_u32 s49, s48, 0
    buffer_store_dwordx4 v[128:131], v16, s[16:19], s49 offen offset:0 sc1
    v_pk_mul_f32 v[68:69], v[68:69], v[18:19]
    v_pk_mul_f32 v[70:71], v[70:71], v[18:19]
    v_pk_mul_f32 v[84:85], v[84:85], v[18:19]
    v_pk_mul_f32 v[86:87], v[86:87], v[18:19]
    v_cvt_pk_bf16_f32 v132, v68, v69
    v_cvt_pk_bf16_f32 v133, v70, v71
    v_cvt_pk_bf16_f32 v134, v84, v85
    v_cvt_pk_bf16_f32 v135, v86, v87
    s_add_u32 s49, s48, 0
    buffer_store_dwordx4 v[132:135], v16, s[16:19], s49 offen offset:256 sc1
    v_pk_mul_f32 v[72:73], v[72:73], v[18:19]
    v_pk_mul_f32 v[74:75], v[74:75], v[18:19]
    v_pk_mul_f32 v[88:89], v[88:89], v[18:19]
    v_pk_mul_f32 v[90:91], v[90:91], v[18:19]
    v_cvt_pk_bf16_f32 v136, v72, v73
    v_cvt_pk_bf16_f32 v137, v74, v75
    v_cvt_pk_bf16_f32 v138, v88, v89
    v_cvt_pk_bf16_f32 v139, v90, v91
    s_add_u32 s49, s48, 2048
    buffer_store_dwordx4 v[136:139], v16, s[16:19], s49 offen offset:0 sc1
    v_pk_mul_f32 v[76:77], v[76:77], v[18:19]
    v_pk_mul_f32 v[78:79], v[78:79], v[18:19]
    v_pk_mul_f32 v[92:93], v[92:93], v[18:19]
    v_pk_mul_f32 v[94:95], v[94:95], v[18:19]
    v_cvt_pk_bf16_f32 v140, v76, v77
    v_cvt_pk_bf16_f32 v141, v78, v79
    v_cvt_pk_bf16_f32 v142, v92, v93
    v_cvt_pk_bf16_f32 v143, v94, v95
    s_add_u32 s49, s48, 2048
    buffer_store_dwordx4 v[140:143], v16, s[16:19], s49 offen offset:256 sc1
    v_pk_mul_f32 v[96:97], v[96:97], v[18:19]
    v_pk_mul_f32 v[98:99], v[98:99], v[18:19]
    v_pk_mul_f32 v[112:113], v[112:113], v[18:19]
    v_pk_mul_f32 v[114:115], v[114:115], v[18:19]
    v_cvt_pk_bf16_f32 v144, v96, v97
    v_cvt_pk_bf16_f32 v145, v98, v99
    v_cvt_pk_bf16_f32 v146, v112, v113
    v_cvt_pk_bf16_f32 v147, v114, v115
    s_add_u32 s49, s48, 131072
    buffer_store_dwordx4 v[144:147], v16, s[16:19], s49 offen offset:0 sc1
    v_pk_mul_f32 v[100:101], v[100:101], v[18:19]
    v_pk_mul_f32 v[102:103], v[102:103], v[18:19]
    v_pk_mul_f32 v[116:117], v[116:117], v[18:19]
    v_pk_mul_f32 v[118:119], v[118:119], v[18:19]
    v_cvt_pk_bf16_f32 v148, v100, v101
    v_cvt_pk_bf16_f32 v149, v102, v103
    v_cvt_pk_bf16_f32 v150, v116, v117
    v_cvt_pk_bf16_f32 v151, v118, v119
    s_add_u32 s49, s48, 131072
    buffer_store_dwordx4 v[148:151], v16, s[16:19], s49 offen offset:256 sc1
    v_pk_mul_f32 v[104:105], v[104:105], v[18:19]
    v_pk_mul_f32 v[106:107], v[106:107], v[18:19]
    v_pk_mul_f32 v[120:121], v[120:121], v[18:19]
    v_pk_mul_f32 v[122:123], v[122:123], v[18:19]
    v_cvt_pk_bf16_f32 v152, v104, v105
    v_cvt_pk_bf16_f32 v153, v106, v107
    v_cvt_pk_bf16_f32 v154, v120, v121
    v_cvt_pk_bf16_f32 v155, v122, v123
    s_add_u32 s49, s48, 133120
    buffer_store_dwordx4 v[152:155], v16, s[16:19], s49 offen offset:0 sc1
    v_pk_mul_f32 v[108:109], v[108:109], v[18:19]
    v_pk_mul_f32 v[110:111], v[110:111], v[18:19]
    v_pk_mul_f32 v[124:125], v[124:125], v[18:19]
    v_pk_mul_f32 v[126:127], v[126:127], v[18:19]
    v_cvt_pk_bf16_f32 v156, v108, v109
    v_cvt_pk_bf16_f32 v157, v110, v111
    v_cvt_pk_bf16_f32 v158, v124, v125
    v_cvt_pk_bf16_f32 v159, v126, v127
    s_add_u32 s49, s48, 133120
    buffer_store_dwordx4 v[156:159], v16, s[16:19], s49 offen offset:256 sc1
    s_branch L_k1_fin
L_k1_ep1:
    s_lshl_b32 s48, s44, 2
    s_lshl_b32 s49, s22, 1
    s_add_u32 s48, s48, s49
    s_lshl_b32 s48, s48, 18
    s_lshl_b32 s49, s42, 3
    s_lshl_b32 s50, s21, 1
    s_add_u32 s49, s49, s50
    s_lshl_b32 s49, s49, 12
    s_add_u32 s48, s48, s49
    s_add_u32 s48, s48, 4194304
    v_lshrrev_b32 v16, 3, v2
    v_lshlrev_b32 v16, 8, v16
    v_and_b32 v17, 7, v2
    v_lshl_add_u32 v16, v17, 4, v16
    v_lshl_add_u32 v16, v3, 9, v16
    v_cvt_pk_bf16_f32 v128, v64, v65
    v_cvt_pk_bf16_f32 v129, v66, v67
    v_cvt_pk_bf16_f32 v130, v80, v81
    v_cvt_pk_bf16_f32 v131, v82, v83
    s_add_u32 s49, s48, 0
    buffer_store_dwordx4 v[128:131], v16, s[16:19], s49 offen offset:0 sc1
    v_cvt_pk_bf16_f32 v132, v68, v69
    v_cvt_pk_bf16_f32 v133, v70, v71
    v_cvt_pk_bf16_f32 v134, v84, v85
    v_cvt_pk_bf16_f32 v135, v86, v87
    s_add_u32 s49, s48, 0
    buffer_store_dwordx4 v[132:135], v16, s[16:19], s49 offen offset:128 sc1
    v_cvt_pk_bf16_f32 v136, v72, v73
    v_cvt_pk_bf16_f32 v137, v74, v75
    v_cvt_pk_bf16_f32 v138, v88, v89
    v_cvt_pk_bf16_f32 v139, v90, v91
    s_add_u32 s49, s48, 4096
    buffer_store_dwordx4 v[136:139], v16, s[16:19], s49 offen offset:0 sc1
    v_cvt_pk_bf16_f32 v140, v76, v77
    v_cvt_pk_bf16_f32 v141, v78, v79
    v_cvt_pk_bf16_f32 v142, v92, v93
    v_cvt_pk_bf16_f32 v143, v94, v95
    s_add_u32 s49, s48, 4096
    buffer_store_dwordx4 v[140:143], v16, s[16:19], s49 offen offset:128 sc1
    v_cvt_pk_bf16_f32 v144, v96, v97
    v_cvt_pk_bf16_f32 v145, v98, v99
    v_cvt_pk_bf16_f32 v146, v112, v113
    v_cvt_pk_bf16_f32 v147, v114, v115
    s_add_u32 s49, s48, 262144
    buffer_store_dwordx4 v[144:147], v16, s[16:19], s49 offen offset:0 sc1
    v_cvt_pk_bf16_f32 v148, v100, v101
    v_cvt_pk_bf16_f32 v149, v102, v103
    v_cvt_pk_bf16_f32 v150, v116, v117
    v_cvt_pk_bf16_f32 v151, v118, v119
    s_add_u32 s49, s48, 262144
    buffer_store_dwordx4 v[148:151], v16, s[16:19], s49 offen offset:128 sc1
    v_cvt_pk_bf16_f32 v152, v104, v105
    v_cvt_pk_bf16_f32 v153, v106, v107
    v_cvt_pk_bf16_f32 v154, v120, v121
    v_cvt_pk_bf16_f32 v155, v122, v123
    s_add_u32 s49, s48, 266240
    buffer_store_dwordx4 v[152:155], v16, s[16:19], s49 offen offset:0 sc1
    v_cvt_pk_bf16_f32 v156, v108, v109
    v_cvt_pk_bf16_f32 v157, v110, v111
    v_cvt_pk_bf16_f32 v158, v124, v125
    v_cvt_pk_bf16_f32 v159, v126, v127
    s_add_u32 s49, s48, 266240
    buffer_store_dwordx4 v[156:159], v16, s[16:19], s49 offen offset:128 sc1
    s_branch L_k1_fin
L_k1_ep2:
    s_lshl_b32 s48, s44, 2
    s_lshl_b32 s49, s22, 1
    s_add_u32 s48, s48, s49
    s_lshl_b32 s48, s48, 18
    s_lshl_b32 s49, s42, 3
    s_lshl_b32 s50, s21, 1
    s_add_u32 s49, s49, s50
    s_lshl_b32 s49, s49, 12
    s_add_u32 s48, s48, s49
    s_add_u32 s48, s48, 4196352
    v_lshrrev_b32 v16, 3, v2
    v_lshlrev_b32 v16, 8, v16
    v_and_b32 v17, 7, v2
    v_lshl_add_u32 v16, v17, 4, v16
    v_lshl_add_u32 v16, v3, 9, v16
    v_cvt_pk_bf16_f32 v128, v64, v65
    v_cvt_pk_bf16_f32 v129, v66, v67
    v_cvt_pk_bf16_f32 v130, v68, v69
    v_cvt_pk_bf16_f32 v131, v70, v71
    s_add_u32 s49, s48, 0
    buffer_store_dwordx4 v[128:131], v16, s[16:19], s49 offen offset:0 sc1
    v_cvt_pk_bf16_f32 v132, v72, v73
    v_cvt_pk_bf16_f32 v133, v74, v75
    v_cvt_pk_bf16_f32 v134, v76, v77
    v_cvt_pk_bf16_f32 v135, v78, v79
    s_add_u32 s49, s48, 4096
    buffer_store_dwordx4 v[132:135], v16, s[16:19], s49 offen offset:0 sc1
    v_cvt_pk_bf16_f32 v136, v80, v81
    v_cvt_pk_bf16_f32 v137, v82, v83
    v_cvt_pk_bf16_f32 v138, v84, v85
    v_cvt_pk_bf16_f32 v139, v86, v87
    s_add_u32 s49, s48, 0
    buffer_store_dwordx4 v[136:139], v16, s[16:19], s49 offen offset:128 sc1
    v_cvt_pk_bf16_f32 v140, v88, v89
    v_cvt_pk_bf16_f32 v141, v90, v91
    v_cvt_pk_bf16_f32 v142, v92, v93
    v_cvt_pk_bf16_f32 v143, v94, v95
    s_add_u32 s49, s48, 4096
    buffer_store_dwordx4 v[140:143], v16, s[16:19], s49 offen offset:128 sc1
    v_cvt_pk_bf16_f32 v144, v96, v97
    v_cvt_pk_bf16_f32 v145, v98, v99
    v_cvt_pk_bf16_f32 v146, v100, v101
    v_cvt_pk_bf16_f32 v147, v102, v103
    s_add_u32 s49, s48, 262144
    buffer_store_dwordx4 v[144:147], v16, s[16:19], s49 offen offset:0 sc1
    v_cvt_pk_bf16_f32 v148, v104, v105
    v_cvt_pk_bf16_f32 v149, v106, v107
    v_cvt_pk_bf16_f32 v150, v108, v109
    v_cvt_pk_bf16_f32 v151, v110, v111
    s_add_u32 s49, s48, 266240
    buffer_store_dwordx4 v[148:151], v16, s[16:19], s49 offen offset:0 sc1
    v_cvt_pk_bf16_f32 v152, v112, v113
    v_cvt_pk_bf16_f32 v153, v114, v115
    v_cvt_pk_bf16_f32 v154, v116, v117
    v_cvt_pk_bf16_f32 v155, v118, v119
    s_add_u32 s49, s48, 262144
    buffer_store_dwordx4 v[152:155], v16, s[16:19], s49 offen offset:128 sc1
    v_cvt_pk_bf16_f32 v156, v120, v121
    v_cvt_pk_bf16_f32 v157, v122, v123
    v_cvt_pk_bf16_f32 v158, v124, v125
    v_cvt_pk_bf16_f32 v159, v126, v127
    s_add_u32 s49, s48, 266240
    buffer_store_dwordx4 v[156:159], v16, s[16:19], s49 offen offset:128 sc1
    s_branch L_k1_fin
L_k1_ep3:
    s_waitcnt vmcnt(0) lgkmcnt(0)
    v_mul_f32 v224, 3222493025, v209
    v_mul_f32 v226, v209, v209
    v_rcp_f32 v228, v209
    v_mul_f32 v226, v226, v224
    v_mul_f32 v226, 1027024659, v226
    v_sub_f32 v230, 0, v208
    v_mov_b32 v225, v224
    v_mov_b32 v227, v226
    v_mov_b32 v229, v228
    v_mov_b32 v231, v230
    v_pk_fma_f32 v[64:65], v[230:231], v[192:193], v[64:65]
    v_pk_fma_f32 v[66:67], v[230:231], v[194:195], v[66:67]
    v_pk_fma_f32 v[80:81], v[230:231], v[196:197], v[80:81]
    v_pk_fma_f32 v[82:83], v[230:231], v[198:199], v[82:83]
    v_pk_fma_f32 v[96:97], v[230:231], v[200:201], v[96:97]
    v_pk_fma_f32 v[98:99], v[230:231], v[202:203], v[98:99]
    v_pk_fma_f32 v[112:113], v[230:231], v[204:205], v[112:113]
    v_pk_fma_f32 v[114:115], v[230:231], v[206:207], v[114:115]
    v_pk_mul_f32 v[32:33], v[64:65], v[64:65]
    v_pk_mul_f32 v[34:35], v[66:67], v[66:67]
    v_pk_mul_f32 v[36:37], v[80:81], v[80:81]
    v_pk_mul_f32 v[38:39], v[82:83], v[82:83]
    v_pk_mul_f32 v[40:41], v[96:97], v[96:97]
    v_pk_mul_f32 v[42:43], v[98:99], v[98:99]
    v_pk_mul_f32 v[44:45], v[112:113], v[112:113]
    v_pk_mul_f32 v[46:47], v[114:115], v[114:115]
    v_pk_fma_f32 v[32:33], v[32:33], v[226:227], v[224:225]
    v_pk_fma_f32 v[34:35], v[34:35], v[226:227], v[224:225]
    v_pk_fma_f32 v[36:37], v[36:37], v[226:227], v[224:225]
    v_pk_fma_f32 v[38:39], v[38:39], v[226:227], v[224:225]
    v_pk_fma_f32 v[40:41], v[40:41], v[226:227], v[224:225]
    v_pk_fma_f32 v[42:43], v[42:43], v[226:227], v[224:225]
    v_pk_fma_f32 v[44:45], v[44:45], v[226:227], v[224:225]
    v_pk_fma_f32 v[46:47], v[46:47], v[226:227], v[224:225]
    v_pk_mul_f32 v[32:33], v[32:33], v[64:65]
    v_pk_mul_f32 v[34:35], v[34:35], v[66:67]
    v_pk_mul_f32 v[36:37], v[36:37], v[80:81]
    v_pk_mul_f32 v[38:39], v[38:39], v[82:83]
    v_pk_mul_f32 v[40:41], v[40:41], v[96:97]
    v_pk_mul_f32 v[42:43], v[42:43], v[98:99]
    v_pk_mul_f32 v[44:45], v[44:45], v[112:113]
    v_pk_mul_f32 v[46:47], v[46:47], v[114:115]
    v_exp_f32 v32, v32
    v_exp_f32 v33, v33
    v_exp_f32 v34, v34
    v_exp_f32 v35, v35
    v_exp_f32 v36, v36
    v_exp_f32 v37, v37
    v_exp_f32 v38, v38
    v_exp_f32 v39, v39
    v_exp_f32 v40, v40
    v_exp_f32 v41, v41
    v_exp_f32 v42, v42
    v_exp_f32 v43, v43
    v_exp_f32 v44, v44
    v_exp_f32 v45, v45
    v_exp_f32 v46, v46
    v_exp_f32 v47, v47
    s_nop 0
    v_pk_fma_f32 v[32:33], v[32:33], v[228:229], v[228:229]
    v_pk_fma_f32 v[34:35], v[34:35], v[228:229], v[228:229]
    v_pk_fma_f32 v[36:37], v[36:37], v[228:229], v[228:229]
    v_pk_fma_f32 v[38:39], v[38:39], v[228:229], v[228:229]
    v_pk_fma_f32 v[40:41], v[40:41], v[228:229], v[228:229]
    v_pk_fma_f32 v[42:43], v[42:43], v[228:229], v[228:229]
    v_pk_fma_f32 v[44:45], v[44:45], v[228:229], v[228:229]
    v_pk_fma_f32 v[46:47], v[46:47], v[228:229], v[228:229]
    v_rcp_f32 v32, v32
    v_rcp_f32 v33, v33
    v_rcp_f32 v34, v34
    v_rcp_f32 v35, v35
    v_rcp_f32 v36, v36
    v_rcp_f32 v37, v37
    v_rcp_f32 v38, v38
    v_rcp_f32 v39, v39
    v_rcp_f32 v40, v40
    v_rcp_f32 v41, v41
    v_rcp_f32 v42, v42
    v_rcp_f32 v43, v43
    v_rcp_f32 v44, v44
    v_rcp_f32 v45, v45
    v_rcp_f32 v46, v46
    v_rcp_f32 v47, v47
    s_nop 0
    v_pk_mul_f32 v[64:65], v[64:65], v[32:33]
    v_pk_mul_f32 v[66:67], v[66:67], v[34:35]
    v_pk_mul_f32 v[80:81], v[80:81], v[36:37]
    v_pk_mul_f32 v[82:83], v[82:83], v[38:39]
    v_pk_mul_f32 v[96:97], v[96:97], v[40:41]
    v_pk_mul_f32 v[98:99], v[98:99], v[42:43]
    v_pk_mul_f32 v[112:113], v[112:113], v[44:45]
    v_pk_mul_f32 v[114:115], v[114:115], v[46:47]
    v_cvt_pk_bf16_f32 v48, v64, v65
    v_cvt_pk_bf16_f32 v49, v66, v67
    v_cvt_pk_bf16_f32 v50, v80, v81
    v_cvt_pk_bf16_f32 v51, v82, v83
    v_cvt_pk_bf16_f32 v52, v96, v97
    v_cvt_pk_bf16_f32 v53, v98, v99
    v_cvt_pk_bf16_f32 v54, v112, v113
    v_cvt_pk_bf16_f32 v55, v114, v115
    v_cndmask_b32 v48, 0, v48, s[50:51]
    v_cndmask_b32 v49, 0, v49, s[50:51]
    v_cndmask_b32 v50, 0, v50, s[50:51]
    v_cndmask_b32 v51, 0, v51, s[50:51]
    v_cndmask_b32 v52, 0, v52, s[50:51]
    v_cndmask_b32 v53, 0, v53, s[50:51]
    v_cndmask_b32 v54, 0, v54, s[50:51]
    v_cndmask_b32 v55, 0, v55, s[50:51]
    buffer_store_dwordx4 v[48:51], v28, s[16:19], s48 offen offset:0 sc1
    buffer_store_dwordx4 v[52:55], v28, s[16:19], s48 offen offset:1024 sc1
    v_mul_f32 v224, 3222493025, v211
    v_mul_f32 v226, v211, v211
    v_rcp_f32 v228, v211
    v_mul_f32 v226, v226, v224
    v_mul_f32 v226, 1027024659, v226
    v_sub_f32 v230, 0, v210
    v_mov_b32 v225, v224
    v_mov_b32 v227, v226
    v_mov_b32 v229, v228
    v_mov_b32 v231, v230
    v_pk_fma_f32 v[68:69], v[230:231], v[192:193], v[68:69]
    v_pk_fma_f32 v[70:71], v[230:231], v[194:195], v[70:71]
    v_pk_fma_f32 v[84:85], v[230:231], v[196:197], v[84:85]
    v_pk_fma_f32 v[86:87], v[230:231], v[198:199], v[86:87]
    v_pk_fma_f32 v[100:101], v[230:231], v[200:201], v[100:101]
    v_pk_fma_f32 v[102:103], v[230:231], v[202:203], v[102:103]
    v_pk_fma_f32 v[116:117], v[230:231], v[204:205], v[116:117]
    v_pk_fma_f32 v[118:119], v[230:231], v[206:207], v[118:119]
    v_pk_mul_f32 v[32:33], v[68:69], v[68:69]
    v_pk_mul_f32 v[34:35], v[70:71], v[70:71]
    v_pk_mul_f32 v[36:37], v[84:85], v[84:85]
    v_pk_mul_f32 v[38:39], v[86:87], v[86:87]
    v_pk_mul_f32 v[40:41], v[100:101], v[100:101]
    v_pk_mul_f32 v[42:43], v[102:103], v[102:103]
    v_pk_mul_f32 v[44:45], v[116:117], v[116:117]
    v_pk_mul_f32 v[46:47], v[118:119], v[118:119]
    v_pk_fma_f32 v[32:33], v[32:33], v[226:227], v[224:225]
    v_pk_fma_f32 v[34:35], v[34:35], v[226:227], v[224:225]
    v_pk_fma_f32 v[36:37], v[36:37], v[226:227], v[224:225]
    v_pk_fma_f32 v[38:39], v[38:39], v[226:227], v[224:225]
    v_pk_fma_f32 v[40:41], v[40:41], v[226:227], v[224:225]
    v_pk_fma_f32 v[42:43], v[42:43], v[226:227], v[224:225]
    v_pk_fma_f32 v[44:45], v[44:45], v[226:227], v[224:225]
    v_pk_fma_f32 v[46:47], v[46:47], v[226:227], v[224:225]
    v_pk_mul_f32 v[32:33], v[32:33], v[68:69]
    v_pk_mul_f32 v[34:35], v[34:35], v[70:71]
    v_pk_mul_f32 v[36:37], v[36:37], v[84:85]
    v_pk_mul_f32 v[38:39], v[38:39], v[86:87]
    v_pk_mul_f32 v[40:41], v[40:41], v[100:101]
    v_pk_mul_f32 v[42:43], v[42:43], v[102:103]
    v_pk_mul_f32 v[44:45], v[44:45], v[116:117]
    v_pk_mul_f32 v[46:47], v[46:47], v[118:119]
    v_exp_f32 v32, v32
    v_exp_f32 v33, v33
    v_exp_f32 v34, v34
    v_exp_f32 v35, v35
    v_exp_f32 v36, v36
    v_exp_f32 v37, v37
    v_exp_f32 v38, v38
    v_exp_f32 v39, v39
    v_exp_f32 v40, v40
    v_exp_f32 v41, v41
    v_exp_f32 v42, v42
    v_exp_f32 v43, v43
    v_exp_f32 v44, v44
    v_exp_f32 v45, v45
    v_exp_f32 v46, v46
    v_exp_f32 v47, v47
    s_nop 0
    v_pk_fma_f32 v[32:33], v[32:33], v[228:229], v[228:229]
    v_pk_fma_f32 v[34:35], v[34:35], v[228:229], v[228:229]
    v_pk_fma_f32 v[36:37], v[36:37], v[228:229], v[228:229]
    v_pk_fma_f32 v[38:39], v[38:39], v[228:229], v[228:229]
    v_pk_fma_f32 v[40:41], v[40:41], v[228:229], v[228:229]
    v_pk_fma_f32 v[42:43], v[42:43], v[228:229], v[228:229]
    v_pk_fma_f32 v[44:45], v[44:45], v[228:229], v[228:229]
    v_pk_fma_f32 v[46:47], v[46:47], v[228:229], v[228:229]
    v_rcp_f32 v32, v32
    v_rcp_f32 v33, v33
    v_rcp_f32 v34, v34
    v_rcp_f32 v35, v35
    v_rcp_f32 v36, v36
    v_rcp_f32 v37, v37
    v_rcp_f32 v38, v38
    v_rcp_f32 v39, v39
    v_rcp_f32 v40, v40
    v_rcp_f32 v41, v41
    v_rcp_f32 v42, v42
    v_rcp_f32 v43, v43
    v_rcp_f32 v44, v44
    v_rcp_f32 v45, v45
    v_rcp_f32 v46, v46
    v_rcp_f32 v47, v47
    s_nop 0
    v_pk_mul_f32 v[68:69], v[68:69], v[32:33]
    v_pk_mul_f32 v[70:71], v[70:71], v[34:35]
    v_pk_mul_f32 v[84:85], v[84:85], v[36:37]
    v_pk_mul_f32 v[86:87], v[86:87], v[38:39]
    v_pk_mul_f32 v[100:101], v[100:101], v[40:41]
    v_pk_mul_f32 v[102:103], v[102:103], v[42:43]
    v_pk_mul_f32 v[116:117], v[116:117], v[44:45]
    v_pk_mul_f32 v[118:119], v[118:119], v[46:47]
    v_cvt_pk_bf16_f32 v56, v68, v69
    v_cvt_pk_bf16_f32 v57, v70, v71
    v_cvt_pk_bf16_f32 v58, v84, v85
    v_cvt_pk_bf16_f32 v59, v86, v87
    v_cvt_pk_bf16_f32 v60, v100, v101
    v_cvt_pk_bf16_f32 v61, v102, v103
    v_cvt_pk_bf16_f32 v62, v116, v117
    v_cvt_pk_bf16_f32 v63, v118, v119
    v_cndmask_b32 v56, 0, v56, s[52:53]
    v_cndmask_b32 v57, 0, v57, s[52:53]
    v_cndmask_b32 v58, 0, v58, s[52:53]
    v_cndmask_b32 v59, 0, v59, s[52:53]
    v_cndmask_b32 v60, 0, v60, s[52:53]
    v_cndmask_b32 v61, 0, v61, s[52:53]
    v_cndmask_b32 v62, 0, v62, s[52:53]
    v_cndmask_b32 v63, 0, v63, s[52:53]
    buffer_store_dwordx4 v[56:59], v29, s[16:19], s48 offen offset:0 sc1
    buffer_store_dwordx4 v[60:63], v29, s[16:19], s48 offen offset:1024 sc1
    v_mul_f32 v224, 3222493025, v213
    v_mul_f32 v226, v213, v213
    v_rcp_f32 v228, v213
    v_mul_f32 v226, v226, v224
    v_mul_f32 v226, 1027024659, v226
    v_sub_f32 v230, 0, v212
    v_mov_b32 v225, v224
    v_mov_b32 v227, v226
    v_mov_b32 v229, v228
    v_mov_b32 v231, v230
    v_pk_fma_f32 v[72:73], v[230:231], v[192:193], v[72:73]
    v_pk_fma_f32 v[74:75], v[230:231], v[194:195], v[74:75]
    v_pk_fma_f32 v[88:89], v[230:231], v[196:197], v[88:89]
    v_pk_fma_f32 v[90:91], v[230:231], v[198:199], v[90:91]
    v_pk_fma_f32 v[104:105], v[230:231], v[200:201], v[104:105]
    v_pk_fma_f32 v[106:107], v[230:231], v[202:203], v[106:107]
    v_pk_fma_f32 v[120:121], v[230:231], v[204:205], v[120:121]
    v_pk_fma_f32 v[122:123], v[230:231], v[206:207], v[122:123]
    v_pk_mul_f32 v[32:33], v[72:73], v[72:73]
    v_pk_mul_f32 v[34:35], v[74:75], v[74:75]
    v_pk_mul_f32 v[36:37], v[88:89], v[88:89]
    v_pk_mul_f32 v[38:39], v[90:91], v[90:91]
    v_pk_mul_f32 v[40:41], v[104:105], v[104:105]
    v_pk_mul_f32 v[42:43], v[106:107], v[106:107]
    v_pk_mul_f32 v[44:45], v[120:121], v[120:121]
    v_pk_mul_f32 v[46:47], v[122:123], v[122:123]
    v_pk_fma_f32 v[32:33], v[32:33], v[226:227], v[224:225]
    v_pk_fma_f32 v[34:35], v[34:35], v[226:227], v[224:225]
    v_pk_fma_f32 v[36:37], v[36:37], v[226:227], v[224:225]
    v_pk_fma_f32 v[38:39], v[38:39], v[226:227], v[224:225]
    v_pk_fma_f32 v[40:41], v[40:41], v[226:227], v[224:225]
    v_pk_fma_f32 v[42:43], v[42:43], v[226:227], v[224:225]
    v_pk_fma_f32 v[44:45], v[44:45], v[226:227], v[224:225]
    v_pk_fma_f32 v[46:47], v[46:47], v[226:227], v[224:225]
    v_pk_mul_f32 v[32:33], v[32:33], v[72:73]
    v_pk_mul_f32 v[34:35], v[34:35], v[74:75]
    v_pk_mul_f32 v[36:37], v[36:37], v[88:89]
    v_pk_mul_f32 v[38:39], v[38:39], v[90:91]
    v_pk_mul_f32 v[40:41], v[40:41], v[104:105]
    v_pk_mul_f32 v[42:43], v[42:43], v[106:107]
    v_pk_mul_f32 v[44:45], v[44:45], v[120:121]
    v_pk_mul_f32 v[46:47], v[46:47], v[122:123]
    v_exp_f32 v32, v32
    v_exp_f32 v33, v33
    v_exp_f32 v34, v34
    v_exp_f32 v35, v35
    v_exp_f32 v36, v36
    v_exp_f32 v37, v37
    v_exp_f32 v38, v38
    v_exp_f32 v39, v39
    v_exp_f32 v40, v40
    v_exp_f32 v41, v41
    v_exp_f32 v42, v42
    v_exp_f32 v43, v43
    v_exp_f32 v44, v44
    v_exp_f32 v45, v45
    v_exp_f32 v46, v46
    v_exp_f32 v47, v47
    s_nop 0
    v_pk_fma_f32 v[32:33], v[32:33], v[228:229], v[228:229]
    v_pk_fma_f32 v[34:35], v[34:35], v[228:229], v[228:229]
    v_pk_fma_f32 v[36:37], v[36:37], v[228:229], v[228:229]
    v_pk_fma_f32 v[38:39], v[38:39], v[228:229], v[228:229]
    v_pk_fma_f32 v[40:41], v[40:41], v[228:229], v[228:229]
    v_pk_fma_f32 v[42:43], v[42:43], v[228:229], v[228:229]
    v_pk_fma_f32 v[44:45], v[44:45], v[228:229], v[228:229]
    v_pk_fma_f32 v[46:47], v[46:47], v[228:229], v[228:229]
    v_rcp_f32 v32, v32
    v_rcp_f32 v33, v33
    v_rcp_f32 v34, v34
    v_rcp_f32 v35, v35
    v_rcp_f32 v36, v36
    v_rcp_f32 v37, v37
    v_rcp_f32 v38, v38
    v_rcp_f32 v39, v39
    v_rcp_f32 v40, v40
    v_rcp_f32 v41, v41
    v_rcp_f32 v42, v42
    v_rcp_f32 v43, v43
    v_rcp_f32 v44, v44
    v_rcp_f32 v45, v45
    v_rcp_f32 v46, v46
    v_rcp_f32 v47, v47
    s_nop 0
    v_pk_mul_f32 v[72:73], v[72:73], v[32:33]
    v_pk_mul_f32 v[74:75], v[74:75], v[34:35]
    v_pk_mul_f32 v[88:89], v[88:89], v[36:37]
    v_pk_mul_f32 v[90:91], v[90:91], v[38:39]
    v_pk_mul_f32 v[104:105], v[104:105], v[40:41]
    v_pk_mul_f32 v[106:107], v[106:107], v[42:43]
    v_pk_mul_f32 v[120:121], v[120:121], v[44:45]
    v_pk_mul_f32 v[122:123], v[122:123], v[46:47]
    v_cvt_pk_bf16_f32 v48, v72, v73
    v_cvt_pk_bf16_f32 v49, v74, v75
    v_cvt_pk_bf16_f32 v50, v88, v89
    v_cvt_pk_bf16_f32 v51, v90, v91
    v_cvt_pk_bf16_f32 v52, v104, v105
    v_cvt_pk_bf16_f32 v53, v106, v107
    v_cvt_pk_bf16_f32 v54, v120, v121
    v_cvt_pk_bf16_f32 v55, v122, v123
    v_cndmask_b32 v48, 0, v48, s[54:55]
    v_cndmask_b32 v49, 0, v49, s[54:55]
    v_cndmask_b32 v50, 0, v50, s[54:55]
    v_cndmask_b32 v51, 0, v51, s[54:55]
    v_cndmask_b32 v52, 0, v52, s[54:55]
    v_cndmask_b32 v53, 0, v53, s[54:55]
    v_cndmask_b32 v54, 0, v54, s[54:55]
    v_cndmask_b32 v55, 0, v55, s[54:55]
    buffer_store_dwordx4 v[48:51], v30, s[16:19], s48 offen offset:0 sc1
    buffer_store_dwordx4 v[52:55], v30, s[16:19], s48 offen offset:1024 sc1
    v_mul_f32 v224, 3222493025, v215
    v_mul_f32 v226, v215, v215
    v_rcp_f32 v228, v215
    v_mul_f32 v226, v226, v224
    v_mul_f32 v226, 1027024659, v226
    v_sub_f32 v230, 0, v214
    v_mov_b32 v225, v224
    v_mov_b32 v227, v226
    v_mov_b32 v229, v228
    v_mov_b32 v231, v230
    v_pk_fma_f32 v[76:77], v[230:231], v[192:193], v[76:77]
    v_pk_fma_f32 v[78:79], v[230:231], v[194:195], v[78:79]
    v_pk_fma_f32 v[92:93], v[230:231], v[196:197], v[92:93]
    v_pk_fma_f32 v[94:95], v[230:231], v[198:199], v[94:95]
    v_pk_fma_f32 v[108:109], v[230:231], v[200:201], v[108:109]
    v_pk_fma_f32 v[110:111], v[230:231], v[202:203], v[110:111]
    v_pk_fma_f32 v[124:125], v[230:231], v[204:205], v[124:125]
    v_pk_fma_f32 v[126:127], v[230:231], v[206:207], v[126:127]
    v_pk_mul_f32 v[32:33], v[76:77], v[76:77]
    v_pk_mul_f32 v[34:35], v[78:79], v[78:79]
    v_pk_mul_f32 v[36:37], v[92:93], v[92:93]
    v_pk_mul_f32 v[38:39], v[94:95], v[94:95]
    v_pk_mul_f32 v[40:41], v[108:109], v[108:109]
    v_pk_mul_f32 v[42:43], v[110:111], v[110:111]
    v_pk_mul_f32 v[44:45], v[124:125], v[124:125]
    v_pk_mul_f32 v[46:47], v[126:127], v[126:127]
    v_pk_fma_f32 v[32:33], v[32:33], v[226:227], v[224:225]
    v_pk_fma_f32 v[34:35], v[34:35], v[226:227], v[224:225]
    v_pk_fma_f32 v[36:37], v[36:37], v[226:227], v[224:225]
    v_pk_fma_f32 v[38:39], v[38:39], v[226:227], v[224:225]
    v_pk_fma_f32 v[40:41], v[40:41], v[226:227], v[224:225]
    v_pk_fma_f32 v[42:43], v[42:43], v[226:227], v[224:225]
    v_pk_fma_f32 v[44:45], v[44:45], v[226:227], v[224:225]
    v_pk_fma_f32 v[46:47], v[46:47], v[226:227], v[224:225]
    v_pk_mul_f32 v[32:33], v[32:33], v[76:77]
    v_pk_mul_f32 v[34:35], v[34:35], v[78:79]
    v_pk_mul_f32 v[36:37], v[36:37], v[92:93]
    v_pk_mul_f32 v[38:39], v[38:39], v[94:95]
    v_pk_mul_f32 v[40:41], v[40:41], v[108:109]
    v_pk_mul_f32 v[42:43], v[42:43], v[110:111]
    v_pk_mul_f32 v[44:45], v[44:45], v[124:125]
    v_pk_mul_f32 v[46:47], v[46:47], v[126:127]
    v_exp_f32 v32, v32
    v_exp_f32 v33, v33
    v_exp_f32 v34, v34
    v_exp_f32 v35, v35
    v_exp_f32 v36, v36
    v_exp_f32 v37, v37
    v_exp_f32 v38, v38
    v_exp_f32 v39, v39
    v_exp_f32 v40, v40
    v_exp_f32 v41, v41
    v_exp_f32 v42, v42
    v_exp_f32 v43, v43
    v_exp_f32 v44, v44
    v_exp_f32 v45, v45
    v_exp_f32 v46, v46
    v_exp_f32 v47, v47
    s_nop 0
    v_pk_fma_f32 v[32:33], v[32:33], v[228:229], v[228:229]
    v_pk_fma_f32 v[34:35], v[34:35], v[228:229], v[228:229]
    v_pk_fma_f32 v[36:37], v[36:37], v[228:229], v[228:229]
    v_pk_fma_f32 v[38:39], v[38:39], v[228:229], v[228:229]
    v_pk_fma_f32 v[40:41], v[40:41], v[228:229], v[228:229]
    v_pk_fma_f32 v[42:43], v[42:43], v[228:229], v[228:229]
    v_pk_fma_f32 v[44:45], v[44:45], v[228:229], v[228:229]
    v_pk_fma_f32 v[46:47], v[46:47], v[228:229], v[228:229]
    v_rcp_f32 v32, v32
    v_rcp_f32 v33, v33
    v_rcp_f32 v34, v34
    v_rcp_f32 v35, v35
    v_rcp_f32 v36, v36
    v_rcp_f32 v37, v37
    v_rcp_f32 v38, v38
    v_rcp_f32 v39, v39
    v_rcp_f32 v40, v40
    v_rcp_f32 v41, v41
    v_rcp_f32 v42, v42
    v_rcp_f32 v43, v43
    v_rcp_f32 v44, v44
    v_rcp_f32 v45, v45
    v_rcp_f32 v46, v46
    v_rcp_f32 v47, v47
    s_nop 0
    v_pk_mul_f32 v[76:77], v[76:77], v[32:33]
    v_pk_mul_f32 v[78:79], v[78:79], v[34:35]
    v_pk_mul_f32 v[92:93], v[92:93], v[36:37]
    v_pk_mul_f32 v[94:95], v[94:95], v[38:39]
    v_pk_mul_f32 v[108:109], v[108:109], v[40:41]
    v_pk_mul_f32 v[110:111], v[110:111], v[42:43]
    v_pk_mul_f32 v[124:125], v[124:125], v[44:45]
    v_pk_mul_f32 v[126:127], v[126:127], v[46:47]
    v_cvt_pk_bf16_f32 v56, v76, v77
    v_cvt_pk_bf16_f32 v57, v78, v79
    v_cvt_pk_bf16_f32 v58, v92, v93
    v_cvt_pk_bf16_f32 v59, v94, v95
    v_cvt_pk_bf16_f32 v60, v108, v109
    v_cvt_pk_bf16_f32 v61, v110, v111
    v_cvt_pk_bf16_f32 v62, v124, v125
    v_cvt_pk_bf16_f32 v63, v126, v127
    v_cndmask_b32 v56, 0, v56, s[56:57]
    v_cndmask_b32 v57, 0, v57, s[56:57]
    v_cndmask_b32 v58, 0, v58, s[56:57]
    v_cndmask_b32 v59, 0, v59, s[56:57]
    v_cndmask_b32 v60, 0, v60, s[56:57]
    v_cndmask_b32 v61, 0, v61, s[56:57]
    v_cndmask_b32 v62, 0, v62, s[56:57]
    v_cndmask_b32 v63, 0, v63, s[56:57]
    buffer_store_dwordx4 v[56:59], v31, s[16:19], s48 offen offset:0 sc1
    buffer_store_dwordx4 v[60:63], v31, s[16:19], s48 offen offset:1024 sc1
L_k1_fin:
    s_cmp_eq_u32 s43, 3
    s_add_u32 s61, s44, 56
    s_cmp_eq_u32 s43, 3
    s_cselect_b32 s61, 64, s61
    s_lshl_b32 s61, s61, 8
    s_add_u32 s61, s61, 42860544
    s_load_dwordx2 s[6:7], s[0:1], 40
    s_load_dwordx2 s[68:69], s[0:1], 48
    s_load_dwordx2 s[70:71], s[0:1], 16
    s_load_dwordx2 s[72:73], s[0:1], 56
    s_load_dwordx2 s[58:59], s[0:1], 72
    s_waitcnt lgkmcnt(0)
    s_and_b32 s60, s40, 1
    s_lshl_b32 s60, s60, 5
    s_add_u32 s60, s60, s41
    v_and_b32 v2, 31, v1
    v_lshrrev_b32 v3, 5, v1
    s_lshr_b32 s21, s20, 1
    s_and_b32 s22, s20, 1
    s_lshl_b32 s42, s40, 2
    s_and_b32 s43, s41, 3
    s_add_u32 s42, s42, s43
    s_lshr_b32 s43, s41, 2
    s_and_b32 s44, s40, 3
    s_lshl_b32 s44, s44, 2
    s_and_b32 s45, s41, 3
    s_add_u32 s44, s44, s45
    s_lshr_b32 s45, s40, 2
    s_lshl_b32 s45, s45, 3
    s_add_u32 s45, s45, s43
    v_lshlrev_b32 v15, 4, v1
    s_lshl_b32 s46, s42, 18
    s_add_u32 s46, s46, 4194304
    s_lshl_b32 s47, s20, 10
    s_add_u32 s47, s47, s46
    v_add_u32 v4, s47, v15
    s_lshl_b32 s47, s20, 12
    s_add_u32 s47, s47, s46
    v_add_u32 v7, s47, v15
    s_lshl_b32 s46, s44, 2
    s_add_u32 s46, s46, s21
    s_lshl_b32 s46, s46, 16
    s_lshl_b32 s47, s22, 11
    s_add_u32 s46, s46, s47
    s_add_u32 s46, s46, 12582912
    v_add_u32 v5, s46, v15
    v_lshrrev_b32 v17, 3, v1
    s_lshl_b32 s46, s20, 3
    v_add_u32 v17, s46, v17
    v_lshlrev_b32 v17, 11, v17
    v_and_b32 v18, 7, v1
    v_bfe_u32 v19, v1, 4, 1
    v_lshlrev_b32 v19, 2, v19
    v_xor_b32 v18, v18, v19
    v_lshl_add_u32 v17, v18, 4, v17
    s_lshl_b32 s46, s45, 7
    v_add_u32 v6, s46, v17
    s_lshl_b32 s30, s20, 10
    s_lshl_b32 s31, s20, 11
    s_add_u32 s31, s31, 8192
    s_add_u32 s34, s30, 24576
    s_lshl_b32 s27, s20, 12
    s_lshl_b32 s46, s22, 12
    v_add_u32 v8, s46, v15
    v_add_u32 v9, 65536, v8
    v_lshrrev_b32 v17, 4, v2
    v_lshlrev_b32 v17, 11, v17
    v_lshl_add_u32 v17, v3, 8, v17
    v_and_b32 v18, 15, v2
    v_lshl_add_u32 v14, v18, 4, v17
    s_lshl_b32 s46, s21, 12
    s_add_u32 s46, s46, 8192
    v_add_u32 v10, s46, v14
    v_add_u32 v11, 65536, v10
    v_bfe_u32 v17, v1, 2, 2
    v_lshl_add_u32 v18, v3, 2, v17
    v_bfe_u32 v19, v1, 1, 1
    v_bfe_u32 v20, v1, 4, 1
    v_lshl_add_u32 v19, v19, 1, v20
    s_lshl_b32 s46, s22, 2
    v_add_u32 v19, s46, v19
    v_lshrrev_b32 v17, 1, v17
    v_lshlrev_b32 v17, 2, v17
    v_xor_b32 v19, v19, v17
    v_lshlrev_b32 v18, 7, v18
    v_lshl_add_u32 v18, v19, 4, v18
    v_and_b32 v20, 1, v1
    v_lshl_add_u32 v18, v20, 3, v18
    v_add_u32 v12, 24576, v18
    v_add_u32 v13, 65536, v12
    v_bfe_u32 v17, v1, 2, 1
    v_bfe_u32 v18, v1, 4, 1
    v_cmp_eq_u32 vcc, v17, v18
    v_mov_b32 v19, 0x3f803f80
    s_nop 0
    v_cndmask_b32 v144, 0, v19, vcc
    v_cndmask_b32 v145, 0, v19, vcc
    v_cndmask_b32 v146, 0, v19, vcc
    v_cndmask_b32 v147, 0, v19, vcc
    s_mov_b32 s24, 0
    s_mov_b32 s25, 0
    s_mov_b32 s26, 0
    s_lshl_b32 s46, s42, 17
    s_lshl_b32 s47, s43, 3
    s_add_u32 s47, s47, s20
    s_andn2_b32 s48, s47, 1
    s_lshl_b32 s48, s48, 11
    s_add_u32 s46, s46, s48
    s_add_u32 s46, s46, 0
    s_lshl_b32 s48, s22, 14
    v_add_u32 v28, s48, v15
    v_add_u32 v29, 65536, v28
    s_mov_b32 s12, s6
    s_mov_b32 s13, s7
    s_mov_b32 s14, 2097152
    s_mov_b32 s15, 0x00020000
    s_mov_b32 s8, s4
    s_mov_b32 s9, s5
    s_mov_b32 s10, 4194304
    s_mov_b32 s11, 0x00020000
    v_mov_b32 v104, 0
    v_mov_b32 v105, 0
    v_mov_b32 v106, 0
    v_mov_b32 v107, 0
    v_mov_b32 v108, 0
    v_mov_b32 v109, 0
    v_mov_b32 v110, 0
    v_mov_b32 v111, 0
    v_mov_b32 v112, 0
    v_mov_b32 v113, 0
    v_mov_b32 v114, 0
    v_mov_b32 v115, 0
    v_mov_b32 v116, 0
    v_mov_b32 v117, 0
    v_mov_b32 v118, 0
    v_mov_b32 v119, 0
    v_mov_b32 v120, 0
    v_mov_b32 v121, 0
    v_mov_b32 v122, 0
    v_mov_b32 v123, 0
    v_mov_b32 v124, 0
    v_mov_b32 v125, 0
    v_mov_b32 v126, 0
    v_mov_b32 v127, 0
    v_mov_b32 v128, 0
    v_mov_b32 v129, 0
    v_mov_b32 v130, 0
    v_mov_b32 v131, 0
    v_mov_b32 v132, 0
    v_mov_b32 v133, 0
    v_mov_b32 v134, 0
    v_mov_b32 v135, 0
    v_mov_b32 v136, 0
    v_mov_b32 v137, 0
    v_mov_b32 v138, 0
    v_mov_b32 v139, 0
    v_mov_b32 v140, 0
    v_mov_b32 v141, 0
    v_mov_b32 v142, 0
    v_mov_b32 v143, 0
    v_mov_b32 v96, 0
    v_mov_b32 v97, 0
    v_mov_b32 v98, 0
    v_mov_b32 v99, 0
    v_mov_b32 v100, 0
    v_mov_b32 v101, 0
    v_mov_b32 v102, 0
    v_mov_b32 v103, 0
    v_mov_b32 v164, 0
    v_mov_b32 v165, 0
    v_mov_b32 v166, 0
    v_mov_b32 v167, 0
    v_mov_b32 v168, 0
    v_mov_b32 v169, 0
    v_mov_b32 v170, 0
    v_mov_b32 v171, 0
    v_mov_b32 v172, 0
    v_mov_b32 v173, 0
    v_mov_b32 v174, 0
    v_mov_b32 v175, 0
    v_mov_b32 v176, 0
    v_mov_b32 v177, 0
    v_mov_b32 v178, 0
    v_mov_b32 v179, 0
    v_mov_b32 v180, 0
    v_mov_b32 v181, 0
    v_mov_b32 v182, 0
    v_mov_b32 v183, 0
    v_mov_b32 v184, 0
    v_mov_b32 v185, 0
    v_mov_b32 v186, 0
    v_mov_b32 v187, 0
    v_mov_b32 v188, 0
    v_mov_b32 v189, 0
    v_mov_b32 v190, 0
    v_mov_b32 v191, 0
    v_mov_b32 v192, 0
    v_mov_b32 v193, 0
    v_mov_b32 v194, 0
    v_mov_b32 v195, 0
    s_waitcnt vmcnt(0) lgkmcnt(0)
    s_barrier
    s_cmp_lg_u32 s20, 0
    s_cbranch_scc1 L_nfp1_6021
    s_mov_b32 s48, s61
    v_mov_b32 v30, 0
    v_mov_b32 v31, 1
    s_mov_b64 exec, 1
    buffer_atomic_add v31, v30, s[16:19], s48 offen
    s_mov_b64 exec, -1
L_nfp1_6021:
    s_add_u32 s38, s40, 56
    s_lshl_b32 s38, s38, 8
    s_add_u32 s38, s38, 42860544
    s_cmp_lg_u32 s20, 0
    s_cbranch_scc1 L_ka_qw
    v_mov_b32 v30, 0
    v_mov_b32 v31, 0
    s_nop 0
    s_mov_b32 s91, 0
L_spqkv_6022:
    v_readfirstlane_b32 s90, v31
    s_cmp_ge_u32 s90, 24
    s_cbranch_scc1 L_spokqkv_6023
    s_add_u32 s91, s91, 1
    s_cmp_ge_u32 s91, 4194304
    s_cbranch_scc1 L_spokqkv_6023
    s_sleep 4
    buffer_load_dword v31, v30, s[16:19], s38 offen sc1
    s_waitcnt vmcnt(0)
    s_branch L_spqkv_6022
L_spokqkv_6023:
L_ka_qw:
    s_barrier
    buffer_load_dwordx4 v[32:35], v15, s[16:19], s46 offen offset:0 sc1
    buffer_load_dwordx4 v[36:39], v15, s[16:19], s46 offen offset:1024 sc1
    buffer_load_dwordx4 v[40:43], v15, s[16:19], s46 offen offset:2048 sc1
    buffer_load_dwordx4 v[44:47], v15, s[16:19], s46 offen offset:3072 sc1
    s_add_u32 m0, s27, 0
    s_nop 0
    buffer_load_dwordx4 v7, s[16:19], s24 offen offset:0 sc1 lds
    buffer_load_dwordx4 v7, s[16:19], s24 offen offset:1024 sc1 lds
    buffer_load_dwordx4 v7, s[16:19], s24 offen offset:2048 sc1 lds
    buffer_load_dwordx4 v7, s[16:19], s24 offen offset:3072 sc1 lds
    s_add_u32 s24, s24, 32768
    s_mov_b32 s38, 42876928
    v_mov_b32 v30, 0
    v_mov_b32 v31, 0
    s_waitcnt vmcnt(0)
    s_barrier
    ds_read_b128 v[156:159], v15
    ds_read_b128 v[160:163], v15 offset:1024
    ds_read_b128 v[148:151], v28 offset:0
    ds_read_b128 v[152:155], v28 offset:1024
    s_waitcnt lgkmcnt(2)
    v_mfma_f32_32x32x16_bf16 v[64:79], v[156:159], v[32:35], 0
    v_mfma_f32_32x32x16_bf16 v[64:79], v[160:163], v[36:39], v[64:79]
    v_mfma_f32_32x32x16_bf16 v[80:95], v[156:159], v[40:43], 0
    v_mfma_f32_32x32x16_bf16 v[80:95], v[160:163], v[44:47], v[80:95]
    ds_read_b128 v[164:167], v28 offset:2048
    ds_read_b128 v[168:171], v28 offset:3072
    s_nop 7
    s_nop 7
    v_max3_f32 v17, v64, v65, v66
    v_max3_f32 v18, v67, v68, v69
    v_max3_f32 v17, v17, v70, v71
    v_max3_f32 v18, v18, v72, v73
    v_max3_f32 v17, v17, v74, v75
    v_max3_f32 v18, v18, v76, v77
    v_max3_f32 v17, v17, v78, v79
    v_max3_f32 v18, v18, v80, v81
    v_max3_f32 v17, v17, v82, v83
    v_max3_f32 v18, v18, v84, v85
    v_max3_f32 v17, v17, v86, v87
    v_max3_f32 v18, v18, v88, v89
    v_max3_f32 v17, v17, v90, v91
    v_max3_f32 v18, v18, v92, v93
    v_max3_f32 v17, v17, v94, v95
    v_max_f32 v17, v17, v18
    v_mov_b32 v18, v17
    s_nop 1
    v_permlane32_swap_b32 v17, v18
    s_nop 1
    v_max_f32 v17, v17, v18
    v_sub_f32 v48, 0, v17
    v_sub_f32 v49, 0, v17
    v_sub_f32 v50, 0, v17
    v_sub_f32 v51, 0, v17
    v_sub_f32 v52, 0, v17
    v_sub_f32 v53, 0, v17
    v_sub_f32 v54, 0, v17
    v_sub_f32 v55, 0, v17
    v_sub_f32 v56, 0, v17
    v_sub_f32 v57, 0, v17
    v_sub_f32 v58, 0, v17
    v_sub_f32 v59, 0, v17
    v_sub_f32 v60, 0, v17
    v_sub_f32 v61, 0, v17
    v_sub_f32 v62, 0, v17
    v_sub_f32 v63, 0, v17
    s_nop 1
    s_waitcnt lgkmcnt(3)
    v_mfma_f32_32x32x16_bf16 v[64:79], v[148:151], v[32:35], v[48:63]
    s_waitcnt lgkmcnt(2)
    v_mfma_f32_32x32x16_bf16 v[64:79], v[152:155], v[36:39], v[64:79]
    s_nop 7
    s_nop 3
    v_mfma_f32_32x32x16_bf16 v[80:95], v[148:151], v[40:43], v[48:63]
    v_exp_f32 v64, v64
    v_exp_f32 v65, v65
    v_exp_f32 v66, v66
    v_mfma_f32_32x32x16_bf16 v[120:135], v[176:179], v[100:103], v[120:135]
    v_cvt_pk_bf16_f32 v96, v64, v65
    v_exp_f32 v67, v67
    v_exp_f32 v68, v68
    ds_read_b128 v[156:159], v28 offset:4096
    v_cvt_pk_bf16_f32 v97, v66, v67
    v_mfma_f32_32x32x16_bf16 v[80:95], v[152:155], v[44:47], v[80:95]
    v_exp_f32 v69, v69
    v_exp_f32 v70, v70
    v_cvt_pk_bf16_f32 v98, v68, v69
    v_mfma_f32_16x16x32_bf16 v[140:143], v[144:147], v[100:103], v[140:143]
    v_exp_f32 v71, v71
    v_exp_f32 v72, v72
    ds_read_b128 v[160:163], v28 offset:5120
    v_cvt_pk_bf16_f32 v99, v70, v71
    v_exp_f32 v73, v73
    v_exp_f32 v74, v74
    v_cvt_pk_bf16_f32 v100, v72, v73
    s_waitcnt lgkmcnt(3)
    v_mfma_f32_32x32x16_bf16 v[104:119], v[164:167], v[96:99], v[104:119]
    v_exp_f32 v75, v75
    v_exp_f32 v76, v76
    v_cvt_pk_bf16_f32 v101, v74, v75
    s_cmp_lg_u32 s20, 0
    s_cbranch_scc1 L_nhp_6024
    buffer_load_dword v31, v30, s[16:19], s38 offen sc1
L_nhp_6024:
    v_mfma_f32_16x16x32_bf16 v[136:139], v[144:147], v[96:99], v[136:139]
    v_exp_f32 v77, v77
    v_exp_f32 v78, v78
    v_exp_f32 v79, v79
    v_cvt_pk_bf16_f32 v102, v76, v77
    v_cvt_pk_bf16_f32 v103, v78, v79
    s_waitcnt lgkmcnt(1)
    v_mfma_f32_32x32x16_bf16 v[64:79], v[156:159], v[32:35], v[48:63]
    v_exp_f32 v80, v80
    v_exp_f32 v81, v81
    v_exp_f32 v82, v82
    v_mfma_f32_32x32x16_bf16 v[104:119], v[168:171], v[100:103], v[104:119]
    v_cvt_pk_bf16_f32 v96, v80, v81
    v_exp_f32 v83, v83
    v_exp_f32 v84, v84
    v_cvt_pk_bf16_f32 v97, v82, v83
    s_waitcnt lgkmcnt(0)
    v_mfma_f32_32x32x16_bf16 v[64:79], v[160:163], v[36:39], v[64:79]
    v_exp_f32 v85, v85
    v_exp_f32 v86, v86
    ds_read_b128 v[172:175], v28 offset:6144
    v_cvt_pk_bf16_f32 v98, v84, v85
    v_mfma_f32_16x16x32_bf16 v[136:139], v[144:147], v[100:103], v[136:139]
    v_exp_f32 v87, v87
    v_exp_f32 v88, v88
    v_cvt_pk_bf16_f32 v99, v86, v87
    v_exp_f32 v89, v89
    v_exp_f32 v90, v90
    v_cvt_pk_bf16_f32 v100, v88, v89
    v_mfma_f32_32x32x16_bf16 v[120:135], v[164:167], v[96:99], v[120:135]
    v_exp_f32 v91, v91
    v_exp_f32 v92, v92
    v_cvt_pk_bf16_f32 v101, v90, v91
    ds_read_b128 v[176:179], v28 offset:7168
    v_mfma_f32_16x16x32_bf16 v[140:143], v[144:147], v[96:99], v[140:143]
    v_exp_f32 v93, v93
    v_exp_f32 v94, v94
    v_exp_f32 v95, v95
    v_cvt_pk_bf16_f32 v102, v92, v93
    v_cvt_pk_bf16_f32 v103, v94, v95
    s_cmp_lg_u32 s20, 0
    s_cbranch_scc1 L_nhc_6025
    s_waitcnt vmcnt(0)
    s_mov_b32 s91, 0
L_sphs_6026:
    v_readfirstlane_b32 s90, v31
    s_cmp_ge_u32 s90, 64
    s_cbranch_scc1 L_spokhs_6027
    s_add_u32 s91, s91, 1
    s_cmp_ge_u32 s91, 4194304
    s_cbranch_scc1 L_spokhs_6027
    s_sleep 4
    buffer_load_dword v31, v30, s[16:19], s38 offen sc1
    s_waitcnt vmcnt(0)
    s_branch L_sphs_6026
L_spokhs_6027:
L_nhc_6025:
    s_barrier
    v_mfma_f32_32x32x16_bf16 v[80:95], v[156:159], v[40:43], v[48:63]
    v_exp_f32 v64, v64
    ds_read_b128 v[148:151], v28 offset:8192
    v_exp_f32 v65, v65
    v_exp_f32 v66, v66
    ds_read_b128 v[152:155], v28 offset:9216
    v_mfma_f32_32x32x16_bf16 v[120:135], v[168:171], v[100:103], v[120:135]
    v_cvt_pk_bf16_f32 v96, v64, v65
    s_add_u32 m0, s30, 32768
    v_exp_f32 v67, v67
    v_exp_f32 v68, v68
    buffer_load_dwordx4 v4, s[16:19], s24 offen sc1 lds
    v_cvt_pk_bf16_f32 v97, v66, v67
    v_mfma_f32_32x32x16_bf16 v[80:95], v[160:163], v[44:47], v[80:95]
    s_add_u32 m0, s31, 32768
    v_exp_f32 v69, v69
    v_exp_f32 v70, v70
    buffer_load_dwordx4 v5, s[16:19], s25 offen sc1 lds
    v_cvt_pk_bf16_f32 v98, v68, v69
    v_mfma_f32_16x16x32_bf16 v[140:143], v[144:147], v[100:103], v[140:143]
    buffer_load_dwordx4 v5, s[16:19], s25 offen offset:1024 sc1 lds
    v_exp_f32 v71, v71
    v_exp_f32 v72, v72
    s_add_u32 m0, s34, 32768
    v_cvt_pk_bf16_f32 v99, v70, v71
    v_exp_f32 v73, v73
    buffer_load_dwordx4 v6, s[12:15], s26 offen lds
    v_exp_f32 v74, v74
    v_cvt_pk_bf16_f32 v100, v72, v73
    s_add_u32 s24, s24, 8192
    s_waitcnt lgkmcnt(3)
    v_mfma_f32_32x32x16_bf16 v[104:119], v[172:175], v[96:99], v[104:119]
    v_exp_f32 v75, v75
    s_add_u32 s25, s25, 4096
    v_exp_f32 v76, v76
    v_cvt_pk_bf16_f32 v101, v74, v75
    s_add_u32 s26, s26, 131072
    v_mfma_f32_16x16x32_bf16 v[136:139], v[144:147], v[96:99], v[136:139]
    v_exp_f32 v77, v77
    v_exp_f32 v78, v78
    v_exp_f32 v79, v79
    v_cvt_pk_bf16_f32 v102, v76, v77
    v_cvt_pk_bf16_f32 v103, v78, v79
    s_waitcnt lgkmcnt(1)
    v_mfma_f32_32x32x16_bf16 v[64:79], v[148:151], v[32:35], v[48:63]
    v_exp_f32 v80, v80
    ds_read_b128 v[164:167], v28 offset:10240
    v_exp_f32 v81, v81
    v_exp_f32 v82, v82
    ds_read_b128 v[168:171], v28 offset:11264
    v_mfma_f32_32x32x16_bf16 v[104:119], v[176:179], v[100:103], v[104:119]
    v_cvt_pk_bf16_f32 v96, v80, v81
    s_add_u32 m0, s30, 65536
    v_exp_f32 v83, v83
    v_exp_f32 v84, v84
    buffer_load_dwordx4 v4, s[16:19], s24 offen sc1 lds
    v_cvt_pk_bf16_f32 v97, v82, v83
    s_waitcnt lgkmcnt(2)
    v_mfma_f32_32x32x16_bf16 v[64:79], v[152:155], v[36:39], v[64:79]
    s_add_u32 m0, s31, 65536
    v_exp_f32 v85, v85
    v_exp_f32 v86, v86
    buffer_load_dwordx4 v5, s[16:19], s25 offen sc1 lds
    v_cvt_pk_bf16_f32 v98, v84, v85
    v_mfma_f32_16x16x32_bf16 v[136:139], v[144:147], v[100:103], v[136:139]
    buffer_load_dwordx4 v5, s[16:19], s25 offen offset:1024 sc1 lds
    v_exp_f32 v87, v87
    v_exp_f32 v88, v88
    s_add_u32 m0, s34, 65536
    v_cvt_pk_bf16_f32 v99, v86, v87
    v_exp_f32 v89, v89
    buffer_load_dwordx4 v6, s[12:15], s26 offen lds
    v_exp_f32 v90, v90
    v_cvt_pk_bf16_f32 v100, v88, v89
    s_add_u32 s24, s24, 8192
    v_mfma_f32_32x32x16_bf16 v[120:135], v[172:175], v[96:99], v[120:135]
    v_exp_f32 v91, v91
    s_add_u32 s25, s25, 4096
    v_exp_f32 v92, v92
    v_cvt_pk_bf16_f32 v101, v90, v91
    s_add_u32 s26, s26, 131072
    v_mfma_f32_16x16x32_bf16 v[140:143], v[144:147], v[96:99], v[140:143]
    v_exp_f32 v93, v93
    v_exp_f32 v94, v94
    v_exp_f32 v95, v95
    v_cvt_pk_bf16_f32 v102, v92, v93
    v_cvt_pk_bf16_f32 v103, v94, v95
    v_mfma_f32_32x32x16_bf16 v[80:95], v[148:151], v[40:43], v[48:63]
    v_exp_f32 v64, v64
    v_exp_f32 v65, v65
    v_exp_f32 v66, v66
    v_mfma_f32_32x32x16_bf16 v[120:135], v[176:179], v[100:103], v[120:135]
    v_cvt_pk_bf16_f32 v96, v64, v65
    v_exp_f32 v67, v67
    v_exp_f32 v68, v68
    v_cvt_pk_bf16_f32 v97, v66, v67
    v_mfma_f32_32x32x16_bf16 v[80:95], v[152:155], v[44:47], v[80:95]
    v_exp_f32 v69, v69
    v_exp_f32 v70, v70
    ds_read_b128 v[156:159], v28 offset:12288
    v_cvt_pk_bf16_f32 v98, v68, v69
    v_mfma_f32_16x16x32_bf16 v[140:143], v[144:147], v[100:103], v[140:143]
    v_exp_f32 v71, v71
    v_exp_f32 v72, v72
    v_cvt_pk_bf16_f32 v99, v70, v71
    v_exp_f32 v73, v73
    v_exp_f32 v74, v74
    v_cvt_pk_bf16_f32 v100, v72, v73
    s_waitcnt lgkmcnt(2)
    v_mfma_f32_32x32x16_bf16 v[104:119], v[164:167], v[96:99], v[104:119]
    v_exp_f32 v75, v75
    v_exp_f32 v76, v76
    v_cvt_pk_bf16_f32 v101, v74, v75
    ds_read_b128 v[160:163], v28 offset:13312
    v_mfma_f32_16x16x32_bf16 v[136:139], v[144:147], v[96:99], v[136:139]
    v_exp_f32 v77, v77
    v_exp_f32 v78, v78
    v_exp_f32 v79, v79
    v_cvt_pk_bf16_f32 v102, v76, v77
    v_cvt_pk_bf16_f32 v103, v78, v79
    s_waitcnt lgkmcnt(1)
    v_mfma_f32_32x32x16_bf16 v[64:79], v[156:159], v[32:35], v[48:63]
    v_exp_f32 v80, v80
    v_exp_f32 v81, v81
    v_exp_f32 v82, v82
    v_mfma_f32_32x32x16_bf16 v[104:119], v[168:171], v[100:103], v[104:119]
    v_cvt_pk_bf16_f32 v96, v80, v81
    v_exp_f32 v83, v83
    v_exp_f32 v84, v84
    v_cvt_pk_bf16_f32 v97, v82, v83
    s_waitcnt lgkmcnt(0)
    v_mfma_f32_32x32x16_bf16 v[64:79], v[160:163], v[36:39], v[64:79]
    v_exp_f32 v85, v85
    v_exp_f32 v86, v86
    ds_read_b128 v[172:175], v28 offset:14336
    v_cvt_pk_bf16_f32 v98, v84, v85
    v_mfma_f32_16x16x32_bf16 v[136:139], v[144:147], v[100:103], v[136:139]
    v_exp_f32 v87, v87
    v_exp_f32 v88, v88
    v_cvt_pk_bf16_f32 v99, v86, v87
    v_exp_f32 v89, v89
    v_exp_f32 v90, v90
    v_cvt_pk_bf16_f32 v100, v88, v89
    v_mfma_f32_32x32x16_bf16 v[120:135], v[164:167], v[96:99], v[120:135]
    v_exp_f32 v91, v91
    v_exp_f32 v92, v92
    v_cvt_pk_bf16_f32 v101, v90, v91
    ds_read_b128 v[176:179], v28 offset:15360
    v_mfma_f32_16x16x32_bf16 v[140:143], v[144:147], v[96:99], v[140:143]
    v_exp_f32 v93, v93
    v_exp_f32 v94, v94
    v_exp_f32 v95, v95
    v_cvt_pk_bf16_f32 v102, v92, v93
    v_cvt_pk_bf16_f32 v103, v94, v95
    s_waitcnt vmcnt(0) lgkmcnt(0)
    s_barrier
    s_setprio 3
    v_mfma_f32_32x32x16_bf16 v[80:95], v[156:159], v[40:43], v[48:63]
    v_exp_f32 v64, v64
    ds_read_b128 v[196:199], v10 offset:32768
    v_exp_f32 v65, v65
    ds_read_b64_tr_b16 v[200:201], v12 offset:32768
    v_exp_f32 v66, v66
    ds_read_b64_tr_b16 v[202:203], v12 offset:34816
    v_mfma_f32_32x32x16_bf16 v[120:135], v[168:171], v[100:103], v[120:135]
    v_cvt_pk_bf16_f32 v96, v64, v65
    ds_read_b128 v[148:151], v8 offset:32768
    v_exp_f32 v67, v67
    ds_read_b128 v[152:155], v8 offset:33792
    v_exp_f32 v68, v68
    ds_read_b128 v[204:207], v10 offset:33280
    v_cvt_pk_bf16_f32 v97, v66, v67
    v_mfma_f32_32x32x16_bf16 v[80:95], v[160:163], v[44:47], v[80:95]
    ds_read_b64_tr_b16 v[208:209], v12 offset:33792
    v_exp_f32 v69, v69
    ds_read_b64_tr_b16 v[210:211], v12 offset:35840
    v_exp_f32 v70, v70
    s_add_u32 m0, s30, 98304
    v_cvt_pk_bf16_f32 v98, v68, v69
    v_mfma_f32_16x16x32_bf16 v[140:143], v[144:147], v[100:103], v[140:143]
    buffer_load_dwordx4 v4, s[16:19], s24 offen sc1 lds
    v_exp_f32 v71, v71
    s_add_u32 m0, s31, 98304
    v_exp_f32 v72, v72
    buffer_load_dwordx4 v5, s[16:19], s25 offen sc1 lds
    v_cvt_pk_bf16_f32 v99, v70, v71
    v_exp_f32 v73, v73
    buffer_load_dwordx4 v5, s[16:19], s25 offen offset:1024 sc1 lds
    v_exp_f32 v74, v74
    s_add_u32 m0, s34, 98304
    v_cvt_pk_bf16_f32 v100, v72, v73
    buffer_load_dwordx4 v6, s[12:15], s26 offen lds
    v_mfma_f32_32x32x16_bf16 v[104:119], v[172:175], v[96:99], v[104:119]
    v_exp_f32 v75, v75
    s_add_u32 s24, s24, 8192
    v_exp_f32 v76, v76
    s_add_u32 s25, s25, 4096
    v_cvt_pk_bf16_f32 v101, v74, v75
    s_add_u32 s26, s26, 131072
    v_mfma_f32_16x16x32_bf16 v[136:139], v[144:147], v[96:99], v[136:139]
    v_exp_f32 v77, v77
    v_exp_f32 v78, v78
    v_exp_f32 v79, v79
    v_cvt_pk_bf16_f32 v102, v76, v77
    v_cvt_pk_bf16_f32 v103, v78, v79
    s_setprio 2
    s_waitcnt lgkmcnt(4)
    v_mfma_f32_32x32x16_bf16 v[64:79], v[148:151], v[32:35], v[48:63]
    v_exp_f32 v80, v80
    ds_read_b128 v[212:215], v10 offset:33792
    v_exp_f32 v81, v81
    ds_read_b64_tr_b16 v[216:217], v12 offset:36864
    v_exp_f32 v82, v82
    v_mfma_f32_32x32x16_bf16 v[104:119], v[176:179], v[100:103], v[104:119]
    ds_read_b64_tr_b16 v[218:219], v12 offset:38912
    v_cvt_pk_bf16_f32 v96, v80, v81
    ds_read_b128 v[164:167], v8 offset:34816
    v_exp_f32 v83, v83
    v_exp_f32 v84, v84
    ds_read_b128 v[168:171], v8 offset:35840
    v_cvt_pk_bf16_f32 v97, v82, v83
    ds_read_b128 v[220:223], v10 offset:34304
    s_waitcnt lgkmcnt(9)
    v_mfma_f32_32x32x16_bf16 v[64:79], v[152:155], v[36:39], v[64:79]
    v_exp_f32 v85, v85
    ds_read_b64_tr_b16 v[224:225], v12 offset:37888
    v_exp_f32 v86, v86
    ds_read_b64_tr_b16 v[226:227], v12 offset:39936
    v_cvt_pk_bf16_f32 v98, v84, v85
    s_add_u32 m0, s30, 0
    v_mfma_f32_16x16x32_bf16 v[136:139], v[144:147], v[100:103], v[136:139]
    v_exp_f32 v87, v87
    buffer_load_dwordx4 v4, s[16:19], s24 offen sc1 lds
    v_exp_f32 v88, v88
    s_add_u32 m0, s31, 0
    v_mfma_f32_32x32x16_bf16 v[180:195], v[200:203], v[196:199], v[180:195]
    v_cvt_pk_bf16_f32 v99, v86, v87
    buffer_load_dwordx4 v5, s[16:19], s25 offen sc1 lds
    v_exp_f32 v89, v89
    buffer_load_dwordx4 v5, s[16:19], s25 offen offset:1024 sc1 lds
    v_exp_f32 v90, v90
    v_cvt_pk_bf16_f32 v100, v88, v89
    s_add_u32 m0, s34, 0
    v_mfma_f32_32x32x16_bf16 v[120:135], v[172:175], v[96:99], v[120:135]
    buffer_load_dwordx4 v6, s[12:15], s26 offen lds
    v_exp_f32 v91, v91
    v_exp_f32 v92, v92
    s_add_u32 s24, s24, 8192
    v_cvt_pk_bf16_f32 v101, v90, v91
    s_add_u32 s25, s25, 4096
    v_mfma_f32_16x16x32_bf16 v[140:143], v[144:147], v[96:99], v[140:143]
    s_add_u32 s26, s26, 131072
    v_exp_f32 v93, v93
    v_exp_f32 v94, v94
    s_waitcnt lgkmcnt(8)
    v_mfma_f32_32x32x16_bf16 v[180:195], v[208:211], v[204:207], v[180:195]
    v_exp_f32 v95, v95
    v_cvt_pk_bf16_f32 v102, v92, v93
    v_cvt_pk_bf16_f32 v103, v94, v95
    s_setprio 1
    v_mfma_f32_32x32x16_bf16 v[80:95], v[148:151], v[40:43], v[48:63]
    v_exp_f32 v64, v64
    v_exp_f32 v65, v65
    v_exp_f32 v66, v66
    ds_read_b128 v[196:199], v11 offset:0
    v_mfma_f32_32x32x16_bf16 v[120:135], v[176:179], v[100:103], v[120:135]
    v_cvt_pk_bf16_f32 v96, v64, v65
    v_exp_f32 v67, v67
    ds_read_b64_tr_b16 v[200:201], v13 offset:0
    v_exp_f32 v68, v68
    v_cvt_pk_bf16_f32 v97, v66, v67
    v_mfma_f32_32x32x16_bf16 v[80:95], v[152:155], v[44:47], v[80:95]
    ds_read_b64_tr_b16 v[202:203], v13 offset:2048
    v_exp_f32 v69, v69
    v_exp_f32 v70, v70
    v_cvt_pk_bf16_f32 v98, v68, v69
    ds_read_b128 v[156:159], v9 offset:0
    v_mfma_f32_16x16x32_bf16 v[140:143], v[144:147], v[100:103], v[140:143]
    v_exp_f32 v71, v71
    v_exp_f32 v72, v72
    s_waitcnt lgkmcnt(9)
    v_mfma_f32_32x32x16_bf16 v[180:195], v[216:219], v[212:215], v[180:195]
    ds_read_b128 v[160:163], v9 offset:1024
    v_cvt_pk_bf16_f32 v99, v70, v71
    v_exp_f32 v73, v73
    v_exp_f32 v74, v74
    ds_read_b128 v[204:207], v11 offset:512
    v_cvt_pk_bf16_f32 v100, v72, v73
    s_waitcnt lgkmcnt(10)
    v_mfma_f32_32x32x16_bf16 v[104:119], v[164:167], v[96:99], v[104:119]
    v_exp_f32 v75, v75
    ds_read_b64_tr_b16 v[208:209], v13 offset:1024
    v_exp_f32 v76, v76
    v_cvt_pk_bf16_f32 v101, v74, v75
    v_mfma_f32_16x16x32_bf16 v[136:139], v[144:147], v[96:99], v[136:139]
    ds_read_b64_tr_b16 v[210:211], v13 offset:3072
    v_exp_f32 v77, v77
    v_exp_f32 v78, v78
    s_waitcnt lgkmcnt(8)
    v_mfma_f32_32x32x16_bf16 v[180:195], v[224:227], v[220:223], v[180:195]
    v_exp_f32 v79, v79
    v_cvt_pk_bf16_f32 v102, v76, v77
    v_cvt_pk_bf16_f32 v103, v78, v79
    s_setprio 0
    s_waitcnt lgkmcnt(4)
    v_mfma_f32_32x32x16_bf16 v[64:79], v[156:159], v[32:35], v[48:63]
    v_exp_f32 v80, v80
    v_exp_f32 v81, v81
    v_exp_f32 v82, v82
    ds_read_b128 v[212:215], v11 offset:1024
    v_mfma_f32_32x32x16_bf16 v[104:119], v[168:171], v[100:103], v[104:119]
    v_cvt_pk_bf16_f32 v96, v80, v81
    v_exp_f32 v83, v83
    ds_read_b64_tr_b16 v[216:217], v13 offset:4096
    v_exp_f32 v84, v84
    v_cvt_pk_bf16_f32 v97, v82, v83
    s_waitcnt lgkmcnt(5)
    v_mfma_f32_32x32x16_bf16 v[64:79], v[160:163], v[36:39], v[64:79]
    ds_read_b64_tr_b16 v[218:219], v13 offset:6144
    v_exp_f32 v85, v85
    v_exp_f32 v86, v86
    v_cvt_pk_bf16_f32 v98, v84, v85
    ds_read_b128 v[172:175], v9 offset:2048
    v_mfma_f32_16x16x32_bf16 v[136:139], v[144:147], v[100:103], v[136:139]
    v_exp_f32 v87, v87
    v_exp_f32 v88, v88
    v_mfma_f32_32x32x16_bf16 v[180:195], v[200:203], v[196:199], v[180:195]
    ds_read_b128 v[176:179], v9 offset:3072
    v_cvt_pk_bf16_f32 v99, v86, v87
    v_exp_f32 v89, v89
    v_exp_f32 v90, v90
    ds_read_b128 v[220:223], v11 offset:1536
    v_cvt_pk_bf16_f32 v100, v88, v89
    v_mfma_f32_32x32x16_bf16 v[120:135], v[164:167], v[96:99], v[120:135]
    v_exp_f32 v91, v91
    ds_read_b64_tr_b16 v[224:225], v13 offset:5120
    v_exp_f32 v92, v92
    v_cvt_pk_bf16_f32 v101, v90, v91
    v_mfma_f32_16x16x32_bf16 v[140:143], v[144:147], v[96:99], v[140:143]
    ds_read_b64_tr_b16 v[226:227], v13 offset:7168
    v_exp_f32 v93, v93
    v_exp_f32 v94, v94
    s_waitcnt lgkmcnt(8)
    v_mfma_f32_32x32x16_bf16 v[180:195], v[208:211], v[204:207], v[180:195]
    v_exp_f32 v95, v95
    v_cvt_pk_bf16_f32 v102, v92, v93
    v_cvt_pk_bf16_f32 v103, v94, v95
    s_waitcnt vmcnt(0) lgkmcnt(0)
    s_barrier
    s_mov_b32 s29, 3
.p2align 6
L_pa_loop1:
    s_setprio 3
    v_mfma_f32_32x32x16_bf16 v[80:95], v[156:159], v[40:43], v[48:63]
    v_exp_f32 v64, v64
    ds_read_b128 v[196:199], v11 offset:32768
    v_exp_f32 v65, v65
    ds_read_b64_tr_b16 v[200:201], v13 offset:32768
    v_exp_f32 v66, v66
    v_mfma_f32_32x32x16_bf16 v[120:135], v[168:171], v[100:103], v[120:135]
    ds_read_b64_tr_b16 v[202:203], v13 offset:34816
    v_cvt_pk_bf16_f32 v96, v64, v65
    ds_read_b128 v[148:151], v9 offset:32768
    v_exp_f32 v67, v67
    v_exp_f32 v68, v68
    ds_read_b128 v[152:155], v9 offset:33792
    v_cvt_pk_bf16_f32 v97, v66, v67
    ds_read_b128 v[204:207], v11 offset:33280
    v_mfma_f32_32x32x16_bf16 v[80:95], v[160:163], v[44:47], v[80:95]
    v_exp_f32 v69, v69
    ds_read_b64_tr_b16 v[208:209], v13 offset:33792
    v_exp_f32 v70, v70
    ds_read_b64_tr_b16 v[210:211], v13 offset:35840
    v_cvt_pk_bf16_f32 v98, v68, v69
    s_add_u32 m0, s30, 32768
    v_mfma_f32_16x16x32_bf16 v[140:143], v[144:147], v[100:103], v[140:143]
    v_exp_f32 v71, v71
    buffer_load_dwordx4 v4, s[16:19], s24 offen sc1 lds
    v_exp_f32 v72, v72
    s_add_u32 m0, s31, 32768
    v_mfma_f32_32x32x16_bf16 v[180:195], v[216:219], v[212:215], v[180:195]
    v_cvt_pk_bf16_f32 v99, v70, v71
    buffer_load_dwordx4 v5, s[16:19], s25 offen sc1 lds
    v_exp_f32 v73, v73
    buffer_load_dwordx4 v5, s[16:19], s25 offen offset:1024 sc1 lds
    v_exp_f32 v74, v74
    v_cvt_pk_bf16_f32 v100, v72, v73
    s_add_u32 m0, s34, 32768
    v_mfma_f32_32x32x16_bf16 v[104:119], v[172:175], v[96:99], v[104:119]
    buffer_load_dwordx4 v6, s[12:15], s26 offen lds
    v_exp_f32 v75, v75
    v_exp_f32 v76, v76
    s_add_u32 s24, s24, 8192
    v_cvt_pk_bf16_f32 v101, v74, v75
    s_add_u32 s25, s25, 4096
    v_mfma_f32_16x16x32_bf16 v[136:139], v[144:147], v[96:99], v[136:139]
    s_add_u32 s26, s26, 131072
    v_exp_f32 v77, v77
    v_exp_f32 v78, v78
    v_mfma_f32_32x32x16_bf16 v[180:195], v[224:227], v[220:223], v[180:195]
    v_exp_f32 v79, v79
    v_cvt_pk_bf16_f32 v102, v76, v77
    v_cvt_pk_bf16_f32 v103, v78, v79
    s_setprio 2
    s_waitcnt lgkmcnt(4)
    v_mfma_f32_32x32x16_bf16 v[64:79], v[148:151], v[32:35], v[48:63]
    v_exp_f32 v80, v80
    ds_read_b128 v[212:215], v11 offset:33792
    v_exp_f32 v81, v81
    ds_read_b64_tr_b16 v[216:217], v13 offset:36864
    v_exp_f32 v82, v82
    v_mfma_f32_32x32x16_bf16 v[104:119], v[176:179], v[100:103], v[104:119]
    ds_read_b64_tr_b16 v[218:219], v13 offset:38912
    v_cvt_pk_bf16_f32 v96, v80, v81
    ds_read_b128 v[164:167], v9 offset:34816
    v_exp_f32 v83, v83
    v_exp_f32 v84, v84
    ds_read_b128 v[168:171], v9 offset:35840
    v_cvt_pk_bf16_f32 v97, v82, v83
    ds_read_b128 v[220:223], v11 offset:34304
    s_waitcnt lgkmcnt(9)
    v_mfma_f32_32x32x16_bf16 v[64:79], v[152:155], v[36:39], v[64:79]
    v_exp_f32 v85, v85
    ds_read_b64_tr_b16 v[224:225], v13 offset:37888
    v_exp_f32 v86, v86
    ds_read_b64_tr_b16 v[226:227], v13 offset:39936
    v_cvt_pk_bf16_f32 v98, v84, v85
    s_add_u32 m0, s30, 65536
    v_mfma_f32_16x16x32_bf16 v[136:139], v[144:147], v[100:103], v[136:139]
    v_exp_f32 v87, v87
    buffer_load_dwordx4 v4, s[16:19], s24 offen sc1 lds
    v_exp_f32 v88, v88
    s_add_u32 m0, s31, 65536
    v_mfma_f32_32x32x16_bf16 v[180:195], v[200:203], v[196:199], v[180:195]
    v_cvt_pk_bf16_f32 v99, v86, v87
    buffer_load_dwordx4 v5, s[16:19], s25 offen sc1 lds
    v_exp_f32 v89, v89
    buffer_load_dwordx4 v5, s[16:19], s25 offen offset:1024 sc1 lds
    v_exp_f32 v90, v90
    v_cvt_pk_bf16_f32 v100, v88, v89
    s_add_u32 m0, s34, 65536
    v_mfma_f32_32x32x16_bf16 v[120:135], v[172:175], v[96:99], v[120:135]
    buffer_load_dwordx4 v6, s[12:15], s26 offen lds
    v_exp_f32 v91, v91
    v_exp_f32 v92, v92
    s_add_u32 s24, s24, 8192
    v_cvt_pk_bf16_f32 v101, v90, v91
    s_add_u32 s25, s25, 4096
    v_mfma_f32_16x16x32_bf16 v[140:143], v[144:147], v[96:99], v[140:143]
    s_add_u32 s26, s26, 131072
    v_exp_f32 v93, v93
    v_exp_f32 v94, v94
    s_waitcnt lgkmcnt(8)
    v_mfma_f32_32x32x16_bf16 v[180:195], v[208:211], v[204:207], v[180:195]
    v_exp_f32 v95, v95
    v_cvt_pk_bf16_f32 v102, v92, v93
    v_cvt_pk_bf16_f32 v103, v94, v95
    s_setprio 1
    v_mfma_f32_32x32x16_bf16 v[80:95], v[148:151], v[40:43], v[48:63]
    v_exp_f32 v64, v64
    v_exp_f32 v65, v65
    v_exp_f32 v66, v66
    ds_read_b128 v[196:199], v10 offset:0
    v_mfma_f32_32x32x16_bf16 v[120:135], v[176:179], v[100:103], v[120:135]
    v_cvt_pk_bf16_f32 v96, v64, v65
    v_exp_f32 v67, v67
    ds_read_b64_tr_b16 v[200:201], v12 offset:0
    v_exp_f32 v68, v68
    v_cvt_pk_bf16_f32 v97, v66, v67
    v_mfma_f32_32x32x16_bf16 v[80:95], v[152:155], v[44:47], v[80:95]
    ds_read_b64_tr_b16 v[202:203], v12 offset:2048
    v_exp_f32 v69, v69
    v_exp_f32 v70, v70
    v_cvt_pk_bf16_f32 v98, v68, v69
    ds_read_b128 v[156:159], v8 offset:0
    v_mfma_f32_16x16x32_bf16 v[140:143], v[144:147], v[100:103], v[140:143]
    v_exp_f32 v71, v71
    v_exp_f32 v72, v72
    s_waitcnt lgkmcnt(9)
    v_mfma_f32_32x32x16_bf16 v[180:195], v[216:219], v[212:215], v[180:195]
    ds_read_b128 v[160:163], v8 offset:1024
    v_cvt_pk_bf16_f32 v99, v70, v71
    v_exp_f32 v73, v73
    v_exp_f32 v74, v74
    ds_read_b128 v[204:207], v10 offset:512
    v_cvt_pk_bf16_f32 v100, v72, v73
    s_waitcnt lgkmcnt(10)
    v_mfma_f32_32x32x16_bf16 v[104:119], v[164:167], v[96:99], v[104:119]
    v_exp_f32 v75, v75
    ds_read_b64_tr_b16 v[208:209], v12 offset:1024
    v_exp_f32 v76, v76
    v_cvt_pk_bf16_f32 v101, v74, v75
    v_mfma_f32_16x16x32_bf16 v[136:139], v[144:147], v[96:99], v[136:139]
    ds_read_b64_tr_b16 v[210:211], v12 offset:3072
    v_exp_f32 v77, v77
    v_exp_f32 v78, v78
    s_waitcnt lgkmcnt(8)
    v_mfma_f32_32x32x16_bf16 v[180:195], v[224:227], v[220:223], v[180:195]
    v_exp_f32 v79, v79
    v_cvt_pk_bf16_f32 v102, v76, v77
    v_cvt_pk_bf16_f32 v103, v78, v79
    s_setprio 0
    s_waitcnt lgkmcnt(4)
    v_mfma_f32_32x32x16_bf16 v[64:79], v[156:159], v[32:35], v[48:63]
    v_exp_f32 v80, v80
    v_exp_f32 v81, v81
    v_exp_f32 v82, v82
    ds_read_b128 v[212:215], v10 offset:1024
    v_mfma_f32_32x32x16_bf16 v[104:119], v[168:171], v[100:103], v[104:119]
    v_cvt_pk_bf16_f32 v96, v80, v81
    v_exp_f32 v83, v83
    ds_read_b64_tr_b16 v[216:217], v12 offset:4096
    v_exp_f32 v84, v84
    v_cvt_pk_bf16_f32 v97, v82, v83
    s_waitcnt lgkmcnt(5)
    v_mfma_f32_32x32x16_bf16 v[64:79], v[160:163], v[36:39], v[64:79]
    ds_read_b64_tr_b16 v[218:219], v12 offset:6144
    v_exp_f32 v85, v85
    v_exp_f32 v86, v86
    v_cvt_pk_bf16_f32 v98, v84, v85
    ds_read_b128 v[172:175], v8 offset:2048
    v_mfma_f32_16x16x32_bf16 v[136:139], v[144:147], v[100:103], v[136:139]
    v_exp_f32 v87, v87
    v_exp_f32 v88, v88
    v_mfma_f32_32x32x16_bf16 v[180:195], v[200:203], v[196:199], v[180:195]
    ds_read_b128 v[176:179], v8 offset:3072
    v_cvt_pk_bf16_f32 v99, v86, v87
    v_exp_f32 v89, v89
    v_exp_f32 v90, v90
    ds_read_b128 v[220:223], v10 offset:1536
    v_cvt_pk_bf16_f32 v100, v88, v89
    v_mfma_f32_32x32x16_bf16 v[120:135], v[164:167], v[96:99], v[120:135]
    v_exp_f32 v91, v91
    ds_read_b64_tr_b16 v[224:225], v12 offset:5120
    v_exp_f32 v92, v92
    v_cvt_pk_bf16_f32 v101, v90, v91
    v_mfma_f32_16x16x32_bf16 v[140:143], v[144:147], v[96:99], v[140:143]
    ds_read_b64_tr_b16 v[226:227], v12 offset:7168
    v_exp_f32 v93, v93
    v_exp_f32 v94, v94
    s_waitcnt lgkmcnt(8)
    v_mfma_f32_32x32x16_bf16 v[180:195], v[208:211], v[204:207], v[180:195]
    v_exp_f32 v95, v95
    v_cvt_pk_bf16_f32 v102, v92, v93
    v_cvt_pk_bf16_f32 v103, v94, v95
    s_waitcnt vmcnt(0) lgkmcnt(0)
    s_barrier
    s_setprio 3
    v_mfma_f32_32x32x16_bf16 v[80:95], v[156:159], v[40:43], v[48:63]
    v_exp_f32 v64, v64
    ds_read_b128 v[196:199], v10 offset:32768
    v_exp_f32 v65, v65
    ds_read_b64_tr_b16 v[200:201], v12 offset:32768
    v_exp_f32 v66, v66
    v_mfma_f32_32x32x16_bf16 v[120:135], v[168:171], v[100:103], v[120:135]
    ds_read_b64_tr_b16 v[202:203], v12 offset:34816
    v_cvt_pk_bf16_f32 v96, v64, v65
    ds_read_b128 v[148:151], v8 offset:32768
    v_exp_f32 v67, v67
    v_exp_f32 v68, v68
    ds_read_b128 v[152:155], v8 offset:33792
    v_cvt_pk_bf16_f32 v97, v66, v67
    ds_read_b128 v[204:207], v10 offset:33280
    v_mfma_f32_32x32x16_bf16 v[80:95], v[160:163], v[44:47], v[80:95]
    v_exp_f32 v69, v69
    ds_read_b64_tr_b16 v[208:209], v12 offset:33792
    v_exp_f32 v70, v70
    ds_read_b64_tr_b16 v[210:211], v12 offset:35840
    v_cvt_pk_bf16_f32 v98, v68, v69
    s_add_u32 m0, s30, 98304
    v_mfma_f32_16x16x32_bf16 v[140:143], v[144:147], v[100:103], v[140:143]
    v_exp_f32 v71, v71
    buffer_load_dwordx4 v4, s[16:19], s24 offen sc1 lds
    v_exp_f32 v72, v72
    s_add_u32 m0, s31, 98304
    v_mfma_f32_32x32x16_bf16 v[180:195], v[216:219], v[212:215], v[180:195]
    v_cvt_pk_bf16_f32 v99, v70, v71
    buffer_load_dwordx4 v5, s[16:19], s25 offen sc1 lds
    v_exp_f32 v73, v73
    buffer_load_dwordx4 v5, s[16:19], s25 offen offset:1024 sc1 lds
    v_exp_f32 v74, v74
    v_cvt_pk_bf16_f32 v100, v72, v73
    s_add_u32 m0, s34, 98304
    v_mfma_f32_32x32x16_bf16 v[104:119], v[172:175], v[96:99], v[104:119]
    buffer_load_dwordx4 v6, s[12:15], s26 offen lds
    v_exp_f32 v75, v75
    v_exp_f32 v76, v76
    s_add_u32 s24, s24, 8192
    v_cvt_pk_bf16_f32 v101, v74, v75
    s_add_u32 s25, s25, 4096
    v_mfma_f32_16x16x32_bf16 v[136:139], v[144:147], v[96:99], v[136:139]
    s_add_u32 s26, s26, 131072
    v_exp_f32 v77, v77
    v_exp_f32 v78, v78
    v_mfma_f32_32x32x16_bf16 v[180:195], v[224:227], v[220:223], v[180:195]
    v_exp_f32 v79, v79
    v_cvt_pk_bf16_f32 v102, v76, v77
    v_cvt_pk_bf16_f32 v103, v78, v79
    s_setprio 2
    s_waitcnt lgkmcnt(4)
    v_mfma_f32_32x32x16_bf16 v[64:79], v[148:151], v[32:35], v[48:63]
    v_exp_f32 v80, v80
    ds_read_b128 v[212:215], v10 offset:33792
    v_exp_f32 v81, v81
    ds_read_b64_tr_b16 v[216:217], v12 offset:36864
    v_exp_f32 v82, v82
    v_mfma_f32_32x32x16_bf16 v[104:119], v[176:179], v[100:103], v[104:119]
    ds_read_b64_tr_b16 v[218:219], v12 offset:38912
    v_cvt_pk_bf16_f32 v96, v80, v81
    ds_read_b128 v[164:167], v8 offset:34816
    v_exp_f32 v83, v83
    v_exp_f32 v84, v84
    ds_read_b128 v[168:171], v8 offset:35840
    v_cvt_pk_bf16_f32 v97, v82, v83
    ds_read_b128 v[220:223], v10 offset:34304
    s_waitcnt lgkmcnt(9)
    v_mfma_f32_32x32x16_bf16 v[64:79], v[152:155], v[36:39], v[64:79]
    v_exp_f32 v85, v85
    ds_read_b64_tr_b16 v[224:225], v12 offset:37888
    v_exp_f32 v86, v86
    ds_read_b64_tr_b16 v[226:227], v12 offset:39936
    v_cvt_pk_bf16_f32 v98, v84, v85
    s_add_u32 m0, s30, 0
    v_mfma_f32_16x16x32_bf16 v[136:139], v[144:147], v[100:103], v[136:139]
    v_exp_f32 v87, v87
    buffer_load_dwordx4 v4, s[16:19], s24 offen sc1 lds
    v_exp_f32 v88, v88
    s_add_u32 m0, s31, 0
    v_mfma_f32_32x32x16_bf16 v[180:195], v[200:203], v[196:199], v[180:195]
    v_cvt_pk_bf16_f32 v99, v86, v87
    buffer_load_dwordx4 v5, s[16:19], s25 offen sc1 lds
    v_exp_f32 v89, v89
    buffer_load_dwordx4 v5, s[16:19], s25 offen offset:1024 sc1 lds
    v_exp_f32 v90, v90
    v_cvt_pk_bf16_f32 v100, v88, v89
    s_add_u32 m0, s34, 0
    v_mfma_f32_32x32x16_bf16 v[120:135], v[172:175], v[96:99], v[120:135]
    buffer_load_dwordx4 v6, s[12:15], s26 offen lds
    v_exp_f32 v91, v91
    v_exp_f32 v92, v92
    s_add_u32 s24, s24, 8192
    v_cvt_pk_bf16_f32 v101, v90, v91
    s_add_u32 s25, s25, 4096
    v_mfma_f32_16x16x32_bf16 v[140:143], v[144:147], v[96:99], v[140:143]
    s_add_u32 s26, s26, 131072
    v_exp_f32 v93, v93
    v_exp_f32 v94, v94
    s_waitcnt lgkmcnt(8)
    v_mfma_f32_32x32x16_bf16 v[180:195], v[208:211], v[204:207], v[180:195]
    v_exp_f32 v95, v95
    v_cvt_pk_bf16_f32 v102, v92, v93
    v_cvt_pk_bf16_f32 v103, v94, v95
    s_setprio 1
    v_mfma_f32_32x32x16_bf16 v[80:95], v[148:151], v[40:43], v[48:63]
    v_exp_f32 v64, v64
    v_exp_f32 v65, v65
    v_exp_f32 v66, v66
    ds_read_b128 v[196:199], v11 offset:0
    v_mfma_f32_32x32x16_bf16 v[120:135], v[176:179], v[100:103], v[120:135]
    v_cvt_pk_bf16_f32 v96, v64, v65
    v_exp_f32 v67, v67
    ds_read_b64_tr_b16 v[200:201], v13 offset:0
    v_exp_f32 v68, v68
    v_cvt_pk_bf16_f32 v97, v66, v67
    v_mfma_f32_32x32x16_bf16 v[80:95], v[152:155], v[44:47], v[80:95]
    ds_read_b64_tr_b16 v[202:203], v13 offset:2048
    v_exp_f32 v69, v69
    v_exp_f32 v70, v70
    v_cvt_pk_bf16_f32 v98, v68, v69
    ds_read_b128 v[156:159], v9 offset:0
    v_mfma_f32_16x16x32_bf16 v[140:143], v[144:147], v[100:103], v[140:143]
    v_exp_f32 v71, v71
    v_exp_f32 v72, v72
    s_waitcnt lgkmcnt(9)
    v_mfma_f32_32x32x16_bf16 v[180:195], v[216:219], v[212:215], v[180:195]
    ds_read_b128 v[160:163], v9 offset:1024
    v_cvt_pk_bf16_f32 v99, v70, v71
    v_exp_f32 v73, v73
    v_exp_f32 v74, v74
    ds_read_b128 v[204:207], v11 offset:512
    v_cvt_pk_bf16_f32 v100, v72, v73
    s_waitcnt lgkmcnt(10)
    v_mfma_f32_32x32x16_bf16 v[104:119], v[164:167], v[96:99], v[104:119]
    v_exp_f32 v75, v75
    ds_read_b64_tr_b16 v[208:209], v13 offset:1024
    v_exp_f32 v76, v76
    v_cvt_pk_bf16_f32 v101, v74, v75
    v_mfma_f32_16x16x32_bf16 v[136:139], v[144:147], v[96:99], v[136:139]
    ds_read_b64_tr_b16 v[210:211], v13 offset:3072
    v_exp_f32 v77, v77
    v_exp_f32 v78, v78
    s_waitcnt lgkmcnt(8)
    v_mfma_f32_32x32x16_bf16 v[180:195], v[224:227], v[220:223], v[180:195]
    v_exp_f32 v79, v79
    v_cvt_pk_bf16_f32 v102, v76, v77
    v_cvt_pk_bf16_f32 v103, v78, v79
    s_setprio 0
    s_waitcnt lgkmcnt(4)
    v_mfma_f32_32x32x16_bf16 v[64:79], v[156:159], v[32:35], v[48:63]
    v_exp_f32 v80, v80
    v_exp_f32 v81, v81
    ds_read_b128 v[212:215], v11 offset:1024
    v_exp_f32 v82, v82
    v_mfma_f32_32x32x16_bf16 v[104:119], v[168:171], v[100:103], v[104:119]
    v_cvt_pk_bf16_f32 v96, v80, v81
    ds_read_b64_tr_b16 v[216:217], v13 offset:4096
    v_exp_f32 v83, v83
    v_exp_f32 v84, v84
    ds_read_b64_tr_b16 v[218:219], v13 offset:6144
    v_cvt_pk_bf16_f32 v97, v82, v83
    s_waitcnt lgkmcnt(6)
    v_mfma_f32_32x32x16_bf16 v[64:79], v[160:163], v[36:39], v[64:79]
    v_exp_f32 v85, v85
    ds_read_b128 v[172:175], v9 offset:2048
    v_exp_f32 v86, v86
    v_cvt_pk_bf16_f32 v98, v84, v85
    ds_read_b128 v[176:179], v9 offset:3072
    v_mfma_f32_16x16x32_bf16 v[136:139], v[144:147], v[100:103], v[136:139]
    v_exp_f32 v87, v87
    v_exp_f32 v88, v88
    ds_read_b128 v[220:223], v11 offset:1536
    v_mfma_f32_32x32x16_bf16 v[180:195], v[200:203], v[196:199], v[180:195]
    v_cvt_pk_bf16_f32 v99, v86, v87
    v_exp_f32 v89, v89
    ds_read_b64_tr_b16 v[224:225], v13 offset:5120
    v_exp_f32 v90, v90
    v_cvt_pk_bf16_f32 v100, v88, v89
    ds_read_b64_tr_b16 v[226:227], v13 offset:7168
    v_mfma_f32_32x32x16_bf16 v[120:135], v[164:167], v[96:99], v[120:135]
    v_exp_f32 v91, v91
    v_exp_f32 v92, v92
    s_sub_u32 s29, s29, 1
    v_cvt_pk_bf16_f32 v101, v90, v91
    v_mfma_f32_16x16x32_bf16 v[140:143], v[144:147], v[96:99], v[140:143]
    s_cmp_lg_u32 s29, 0
    v_exp_f32 v93, v93
    v_exp_f32 v94, v94
    s_waitcnt lgkmcnt(8)
    v_mfma_f32_32x32x16_bf16 v[180:195], v[208:211], v[204:207], v[180:195]
    v_exp_f32 v95, v95
    v_cvt_pk_bf16_f32 v102, v92, v93
    v_cvt_pk_bf16_f32 v103, v94, v95
    s_waitcnt vmcnt(0) lgkmcnt(0)
    s_barrier
    s_cbranch_scc1 L_pa_loop1
    s_setprio 3
    v_mfma_f32_32x32x16_bf16 v[80:95], v[156:159], v[40:43], v[48:63]
    v_exp_f32 v64, v64
    ds_read_b128 v[196:199], v11 offset:32768
    v_exp_f32 v65, v65
    v_exp_f32 v66, v66
    ds_read_b64_tr_b16 v[200:201], v13 offset:32768
    v_mfma_f32_32x32x16_bf16 v[120:135], v[168:171], v[100:103], v[120:135]
    v_cvt_pk_bf16_f32 v96, v64, v65
    ds_read_b64_tr_b16 v[202:203], v13 offset:34816
    v_exp_f32 v67, v67
    v_exp_f32 v68, v68
    ds_read_b128 v[148:151], v9 offset:32768
    v_cvt_pk_bf16_f32 v97, v66, v67
    v_mfma_f32_32x32x16_bf16 v[80:95], v[160:163], v[44:47], v[80:95]
    ds_read_b128 v[152:155], v9 offset:33792
    v_exp_f32 v69, v69
    v_exp_f32 v70, v70
    ds_read_b128 v[204:207], v11 offset:33280
    v_cvt_pk_bf16_f32 v98, v68, v69
    ds_read_b64_tr_b16 v[208:209], v13 offset:33792
    v_mfma_f32_16x16x32_bf16 v[140:143], v[144:147], v[100:103], v[140:143]
    v_exp_f32 v71, v71
    ds_read_b64_tr_b16 v[210:211], v13 offset:35840
    v_exp_f32 v72, v72
    v_mfma_f32_32x32x16_bf16 v[180:195], v[216:219], v[212:215], v[180:195]
    s_add_u32 m0, s27, 32768
    v_cvt_pk_bf16_f32 v99, v70, v71
    v_exp_f32 v73, v73
    buffer_load_dwordx4 v7, s[16:19], s24 offen offset:0 sc1 lds
    v_exp_f32 v74, v74
    v_cvt_pk_bf16_f32 v100, v72, v73
    buffer_load_dwordx4 v7, s[16:19], s24 offen offset:1024 sc1 lds
    v_mfma_f32_32x32x16_bf16 v[104:119], v[172:175], v[96:99], v[104:119]
    v_exp_f32 v75, v75
    buffer_load_dwordx4 v7, s[16:19], s24 offen offset:2048 sc1 lds
    v_exp_f32 v76, v76
    v_cvt_pk_bf16_f32 v101, v74, v75
    buffer_load_dwordx4 v7, s[16:19], s24 offen offset:3072 sc1 lds
    v_mfma_f32_16x16x32_bf16 v[136:139], v[144:147], v[96:99], v[136:139]
    s_add_u32 s24, s24, 32768
    v_exp_f32 v77, v77
    v_exp_f32 v78, v78
    v_mfma_f32_32x32x16_bf16 v[180:195], v[224:227], v[220:223], v[180:195]
    v_exp_f32 v79, v79
    v_cvt_pk_bf16_f32 v102, v76, v77
    v_cvt_pk_bf16_f32 v103, v78, v79
    s_setprio 2
    s_waitcnt lgkmcnt(4)
    v_mfma_f32_32x32x16_bf16 v[64:79], v[148:151], v[32:35], v[48:63]
    v_exp_f32 v80, v80
    ds_read_b128 v[212:215], v11 offset:33792
    v_exp_f32 v81, v81
    v_exp_f32 v82, v82
    ds_read_b64_tr_b16 v[216:217], v13 offset:36864
    v_mfma_f32_32x32x16_bf16 v[104:119], v[176:179], v[100:103], v[104:119]
    v_cvt_pk_bf16_f32 v96, v80, v81
    ds_read_b64_tr_b16 v[218:219], v13 offset:38912
    v_exp_f32 v83, v83
    v_exp_f32 v84, v84
    ds_read_b128 v[164:167], v9 offset:34816
    v_cvt_pk_bf16_f32 v97, v82, v83
    s_waitcnt lgkmcnt(7)
    v_mfma_f32_32x32x16_bf16 v[64:79], v[152:155], v[36:39], v[64:79]
    ds_read_b128 v[168:171], v9 offset:35840
    v_exp_f32 v85, v85
    v_exp_f32 v86, v86
    ds_read_b128 v[220:223], v11 offset:34304
    v_cvt_pk_bf16_f32 v98, v84, v85
    ds_read_b64_tr_b16 v[224:225], v13 offset:37888
    v_mfma_f32_16x16x32_bf16 v[136:139], v[144:147], v[100:103], v[136:139]
    v_exp_f32 v87, v87
    ds_read_b64_tr_b16 v[226:227], v13 offset:39936
    v_exp_f32 v88, v88
    v_mfma_f32_32x32x16_bf16 v[180:195], v[200:203], v[196:199], v[180:195]
    s_add_u32 m0, s27, 65536
    v_cvt_pk_bf16_f32 v99, v86, v87
    v_exp_f32 v89, v89
    buffer_load_dwordx4 v7, s[16:19], s24 offen offset:0 sc1 lds
    v_exp_f32 v90, v90
    v_cvt_pk_bf16_f32 v100, v88, v89
    buffer_load_dwordx4 v7, s[16:19], s24 offen offset:1024 sc1 lds
    v_mfma_f32_32x32x16_bf16 v[120:135], v[172:175], v[96:99], v[120:135]
    v_exp_f32 v91, v91
    buffer_load_dwordx4 v7, s[16:19], s24 offen offset:2048 sc1 lds
    v_exp_f32 v92, v92
    v_cvt_pk_bf16_f32 v101, v90, v91
    buffer_load_dwordx4 v7, s[16:19], s24 offen offset:3072 sc1 lds
    v_mfma_f32_16x16x32_bf16 v[140:143], v[144:147], v[96:99], v[140:143]
    s_add_u32 s24, s24, 32768
    v_exp_f32 v93, v93
    v_exp_f32 v94, v94
    s_waitcnt lgkmcnt(8)
    v_mfma_f32_32x32x16_bf16 v[180:195], v[208:211], v[204:207], v[180:195]
    v_exp_f32 v95, v95
    v_cvt_pk_bf16_f32 v102, v92, v93
    v_cvt_pk_bf16_f32 v103, v94, v95
    s_setprio 1
    v_mfma_f32_32x32x16_bf16 v[80:95], v[148:151], v[40:43], v[48:63]
    v_exp_f32 v64, v64
    v_exp_f32 v65, v65
    ds_read_b128 v[196:199], v10 offset:0
    v_exp_f32 v66, v66
    v_mfma_f32_32x32x16_bf16 v[120:135], v[176:179], v[100:103], v[120:135]
    v_cvt_pk_bf16_f32 v96, v64, v65
    ds_read_b64_tr_b16 v[200:201], v12 offset:0
    v_exp_f32 v67, v67
    v_exp_f32 v68, v68
    v_cvt_pk_bf16_f32 v97, v66, v67
    ds_read_b64_tr_b16 v[202:203], v12 offset:2048
    v_mfma_f32_32x32x16_bf16 v[80:95], v[152:155], v[44:47], v[80:95]
    v_exp_f32 v69, v69
    v_exp_f32 v70, v70
    ds_read_b128 v[156:159], v8 offset:0
    v_cvt_pk_bf16_f32 v98, v68, v69
    v_mfma_f32_16x16x32_bf16 v[140:143], v[144:147], v[100:103], v[140:143]
    v_exp_f32 v71, v71
    ds_read_b128 v[160:163], v8 offset:1024
    v_exp_f32 v72, v72
    s_waitcnt lgkmcnt(10)
    v_mfma_f32_32x32x16_bf16 v[180:195], v[216:219], v[212:215], v[180:195]
    v_cvt_pk_bf16_f32 v99, v70, v71
    ds_read_b128 v[204:207], v10 offset:512
    v_exp_f32 v73, v73
    v_exp_f32 v74, v74
    v_cvt_pk_bf16_f32 v100, v72, v73
    ds_read_b64_tr_b16 v[208:209], v12 offset:1024
    s_waitcnt lgkmcnt(11)
    v_mfma_f32_32x32x16_bf16 v[104:119], v[164:167], v[96:99], v[104:119]
    v_exp_f32 v75, v75
    v_exp_f32 v76, v76
    ds_read_b64_tr_b16 v[210:211], v12 offset:3072
    v_cvt_pk_bf16_f32 v101, v74, v75
    v_mfma_f32_16x16x32_bf16 v[136:139], v[144:147], v[96:99], v[136:139]
    s_lshl_b32 s46, s44, 7
    s_lshl_b32 s48, s21, 5
    s_add_u32 s46, s46, s48
    s_lshl_b32 s48, s46, 11
    s_lshl_b32 s49, s45, 7
    s_add_u32 s48, s48, s49
    s_lshl_b32 s49, s22, 6
    s_add_u32 s48, s48, s49
    v_lshlrev_b32 v17, 11, v2
    v_lshl_add_u32 v17, v3, 3, v17
    buffer_load_dwordx2 v[228:229], v17, s[8:11], s48 offen offset:0
    buffer_load_dwordx2 v[230:231], v17, s[8:11], s48 offen offset:32
    buffer_load_dwordx2 v[232:233], v17, s[8:11], s48 offen offset:16
    buffer_load_dwordx2 v[234:235], v17, s[8:11], s48 offen offset:48
    s_lshl_b32 s48, s47, 8
    s_add_u32 s48, s48, 42336256
    v_lshlrev_b32 v17, 3, v2
    buffer_load_dword v25, v17, s[16:19], s48 offen sc1
    v_exp_f32 v77, v77
    v_exp_f32 v78, v78
    s_waitcnt lgkmcnt(8)
    v_mfma_f32_32x32x16_bf16 v[180:195], v[224:227], v[220:223], v[180:195]
    v_exp_f32 v79, v79
    v_cvt_pk_bf16_f32 v102, v76, v77
    v_cvt_pk_bf16_f32 v103, v78, v79
    s_setprio 0
    s_waitcnt lgkmcnt(4)
    v_mfma_f32_32x32x16_bf16 v[64:79], v[156:159], v[32:35], v[48:63]
    v_exp_f32 v80, v80
    v_exp_f32 v81, v81
    v_exp_f32 v82, v82
    ds_read_b128 v[212:215], v10 offset:1024
    v_mfma_f32_32x32x16_bf16 v[104:119], v[168:171], v[100:103], v[104:119]
    v_cvt_pk_bf16_f32 v96, v80, v81
    v_exp_f32 v83, v83
    ds_read_b64_tr_b16 v[216:217], v12 offset:4096
    v_exp_f32 v84, v84
    v_cvt_pk_bf16_f32 v97, v82, v83
    s_waitcnt lgkmcnt(5)
    v_mfma_f32_32x32x16_bf16 v[64:79], v[160:163], v[36:39], v[64:79]
    ds_read_b64_tr_b16 v[218:219], v12 offset:6144
    v_exp_f32 v85, v85
    v_exp_f32 v86, v86
    v_cvt_pk_bf16_f32 v98, v84, v85
    ds_read_b128 v[172:175], v8 offset:2048
    v_mfma_f32_16x16x32_bf16 v[136:139], v[144:147], v[100:103], v[136:139]
    v_exp_f32 v87, v87
    v_exp_f32 v88, v88
    v_mfma_f32_32x32x16_bf16 v[180:195], v[200:203], v[196:199], v[180:195]
    ds_read_b128 v[176:179], v8 offset:3072
    v_cvt_pk_bf16_f32 v99, v86, v87
    v_exp_f32 v89, v89
    v_exp_f32 v90, v90
    ds_read_b128 v[220:223], v10 offset:1536
    v_cvt_pk_bf16_f32 v100, v88, v89
    v_mfma_f32_32x32x16_bf16 v[120:135], v[164:167], v[96:99], v[120:135]
    v_exp_f32 v91, v91
    ds_read_b64_tr_b16 v[224:225], v12 offset:5120
    v_exp_f32 v92, v92
    v_cvt_pk_bf16_f32 v101, v90, v91
    v_mfma_f32_16x16x32_bf16 v[140:143], v[144:147], v[96:99], v[140:143]
    ds_read_b64_tr_b16 v[226:227], v12 offset:7168
    v_exp_f32 v93, v93
    v_exp_f32 v94, v94
    s_waitcnt lgkmcnt(8)
    v_mfma_f32_32x32x16_bf16 v[180:195], v[208:211], v[204:207], v[180:195]
    v_exp_f32 v95, v95
    v_cvt_pk_bf16_f32 v102, v92, v93
    v_cvt_pk_bf16_f32 v103, v94, v95
    s_waitcnt vmcnt(5) lgkmcnt(0)
    s_barrier
    s_setprio 3
    v_mfma_f32_32x32x16_bf16 v[80:95], v[156:159], v[40:43], v[48:63]
    v_exp_f32 v64, v64
    v_exp_f32 v65, v65
    v_exp_f32 v66, v66
    ds_read_b128 v[148:151], v28 offset:32768
    v_mfma_f32_32x32x16_bf16 v[120:135], v[168:171], v[100:103], v[120:135]
    v_cvt_pk_bf16_f32 v96, v64, v65
    v_exp_f32 v67, v67
    ds_read_b128 v[152:155], v28 offset:33792
    v_exp_f32 v68, v68
    v_cvt_pk_bf16_f32 v97, v66, v67
    v_mfma_f32_32x32x16_bf16 v[80:95], v[160:163], v[44:47], v[80:95]
    s_add_u32 m0, s27, 98304
    v_exp_f32 v69, v69
    v_exp_f32 v70, v70
    v_cvt_pk_bf16_f32 v98, v68, v69
    buffer_load_dwordx4 v7, s[16:19], s24 offen offset:0 sc1 lds
    v_mfma_f32_16x16x32_bf16 v[140:143], v[144:147], v[100:103], v[140:143]
    v_exp_f32 v71, v71
    v_exp_f32 v72, v72
    v_mfma_f32_32x32x16_bf16 v[180:195], v[216:219], v[212:215], v[180:195]
    buffer_load_dwordx4 v7, s[16:19], s24 offen offset:1024 sc1 lds
    v_cvt_pk_bf16_f32 v99, v70, v71
    v_exp_f32 v73, v73
    v_exp_f32 v74, v74
    buffer_load_dwordx4 v7, s[16:19], s24 offen offset:2048 sc1 lds
    v_cvt_pk_bf16_f32 v100, v72, v73
    v_mfma_f32_32x32x16_bf16 v[104:119], v[172:175], v[96:99], v[104:119]
    v_exp_f32 v75, v75
    buffer_load_dwordx4 v7, s[16:19], s24 offen offset:3072 sc1 lds
    v_exp_f32 v76, v76
    v_cvt_pk_bf16_f32 v101, v74, v75
    v_mfma_f32_16x16x32_bf16 v[136:139], v[144:147], v[96:99], v[136:139]
    s_add_u32 s24, s24, 32768
    v_exp_f32 v77, v77
    v_exp_f32 v78, v78
    v_mfma_f32_32x32x16_bf16 v[180:195], v[224:227], v[220:223], v[180:195]
    v_exp_f32 v79, v79
    v_cvt_pk_bf16_f32 v102, v76, v77
    v_cvt_pk_bf16_f32 v103, v78, v79
    s_waitcnt lgkmcnt(1)
    v_mfma_f32_32x32x16_bf16 v[64:79], v[148:151], v[32:35], v[48:63]
    v_exp_f32 v80, v80
    v_exp_f32 v81, v81
    v_exp_f32 v82, v82
    v_mfma_f32_32x32x16_bf16 v[104:119], v[176:179], v[100:103], v[104:119]
    v_cvt_pk_bf16_f32 v96, v80, v81
    v_exp_f32 v83, v83
    v_exp_f32 v84, v84
    v_cvt_pk_bf16_f32 v97, v82, v83
    s_waitcnt lgkmcnt(0)
    v_mfma_f32_32x32x16_bf16 v[64:79], v[152:155], v[36:39], v[64:79]
    v_exp_f32 v85, v85
    v_exp_f32 v86, v86
    ds_read_b128 v[164:167], v28 offset:34816
    v_cvt_pk_bf16_f32 v98, v84, v85
    v_mfma_f32_16x16x32_bf16 v[136:139], v[144:147], v[100:103], v[136:139]
    v_exp_f32 v87, v87
    v_exp_f32 v88, v88
    v_cvt_pk_bf16_f32 v99, v86, v87
    v_exp_f32 v89, v89
    v_exp_f32 v90, v90
    v_cvt_pk_bf16_f32 v100, v88, v89
    v_mfma_f32_32x32x16_bf16 v[120:135], v[172:175], v[96:99], v[120:135]
    v_exp_f32 v91, v91
    v_exp_f32 v92, v92
    v_cvt_pk_bf16_f32 v101, v90, v91
    ds_read_b128 v[168:171], v28 offset:35840
    v_mfma_f32_16x16x32_bf16 v[140:143], v[144:147], v[96:99], v[140:143]
    v_exp_f32 v93, v93
    v_exp_f32 v94, v94
    v_exp_f32 v95, v95
    v_cvt_pk_bf16_f32 v102, v92, v93
    v_cvt_pk_bf16_f32 v103, v94, v95
    s_setprio 2
    v_mfma_f32_32x32x16_bf16 v[80:95], v[148:151], v[40:43], v[48:63]
    ds_read_b128 v[156:159], v28 offset:36864
    v_exp_f32 v64, v64
    ds_read_b128 v[160:163], v28 offset:37888
    v_exp_f32 v65, v65
    s_waitcnt vmcnt(4)
    v_exp_f32 v66, v66
    v_lshlrev_b32 v17, 16, v228
    v_mfma_f32_32x32x16_bf16 v[120:135], v[176:179], v[100:103], v[120:135]
    v_and_b32 v18, 0xffff0000, v228
    v_cvt_pk_bf16_f32 v96, v64, v65
    v_add_f32 v180, v180, v17
    v_exp_f32 v67, v67
    v_add_f32 v181, v181, v18
    v_exp_f32 v68, v68
    v_lshlrev_b32 v17, 16, v229
    v_and_b32 v18, 0xffff0000, v229
    v_cvt_pk_bf16_f32 v97, v66, v67
    v_add_f32 v182, v182, v17
    v_mfma_f32_32x32x16_bf16 v[80:95], v[152:155], v[44:47], v[80:95]
    v_add_f32 v183, v183, v18
    v_exp_f32 v69, v69
    v_lshlrev_b32 v17, 16, v230
    v_exp_f32 v70, v70
    v_and_b32 v18, 0xffff0000, v230
    v_cvt_pk_bf16_f32 v98, v68, v69
    v_add_f32 v184, v184, v17
    v_mfma_f32_16x16x32_bf16 v[140:143], v[144:147], v[100:103], v[140:143]
    v_add_f32 v185, v185, v18
    v_exp_f32 v71, v71
    v_lshlrev_b32 v17, 16, v231
    v_exp_f32 v72, v72
    v_and_b32 v18, 0xffff0000, v231
    v_add_f32 v186, v186, v17
    v_cvt_pk_bf16_f32 v99, v70, v71
    v_add_f32 v187, v187, v18
    v_exp_f32 v73, v73
    v_lshlrev_b32 v17, 16, v232
    v_exp_f32 v74, v74
    v_and_b32 v18, 0xffff0000, v232
    v_cvt_pk_bf16_f32 v100, v72, v73
    v_add_f32 v188, v188, v17
    s_waitcnt lgkmcnt(3)
    v_mfma_f32_32x32x16_bf16 v[104:119], v[164:167], v[96:99], v[104:119]
    v_add_f32 v189, v189, v18
    v_exp_f32 v75, v75
    v_lshlrev_b32 v17, 16, v233
    v_exp_f32 v76, v76
    v_and_b32 v18, 0xffff0000, v233
    v_cvt_pk_bf16_f32 v101, v74, v75
    v_add_f32 v190, v190, v17
    v_add_f32 v191, v191, v18
    v_mfma_f32_16x16x32_bf16 v[136:139], v[144:147], v[96:99], v[136:139]
    v_exp_f32 v77, v77
    v_exp_f32 v78, v78
    v_exp_f32 v79, v79
    v_cvt_pk_bf16_f32 v102, v76, v77
    v_cvt_pk_bf16_f32 v103, v78, v79
    s_waitcnt lgkmcnt(1)
    v_mfma_f32_32x32x16_bf16 v[64:79], v[156:159], v[32:35], v[48:63]
    ds_read_b128 v[172:175], v28 offset:38912
    v_exp_f32 v80, v80
    ds_read_b128 v[176:179], v28 offset:39936
    v_exp_f32 v81, v81
    v_lshlrev_b32 v17, 16, v234
    v_exp_f32 v82, v82
    v_and_b32 v18, 0xffff0000, v234
    v_mfma_f32_32x32x16_bf16 v[104:119], v[168:171], v[100:103], v[104:119]
    v_add_f32 v192, v192, v17
    v_cvt_pk_bf16_f32 v96, v80, v81
    v_add_f32 v193, v193, v18
    v_exp_f32 v83, v83
    v_lshlrev_b32 v17, 16, v235
    v_exp_f32 v84, v84
    v_and_b32 v18, 0xffff0000, v235
    v_add_f32 v194, v194, v17
    v_cvt_pk_bf16_f32 v97, v82, v83
    v_add_f32 v195, v195, v18
    s_waitcnt lgkmcnt(2)
    v_mfma_f32_32x32x16_bf16 v[64:79], v[160:163], v[36:39], v[64:79]
    v_cvt_pk_bf16_f32 v212, v180, v181
    v_exp_f32 v85, v85
    v_cvt_pk_bf16_f32 v213, v182, v183
    v_exp_f32 v86, v86
    v_cvt_pk_bf16_f32 v214, v184, v185
    v_cvt_pk_bf16_f32 v98, v84, v85
    v_cvt_pk_bf16_f32 v215, v186, v187
    v_mfma_f32_16x16x32_bf16 v[136:139], v[144:147], v[100:103], v[136:139]
    v_cvt_pk_bf16_f32 v216, v188, v189
    v_exp_f32 v87, v87
    v_cvt_pk_bf16_f32 v217, v190, v191
    v_exp_f32 v88, v88
    v_cvt_pk_bf16_f32 v218, v192, v193
    v_cvt_pk_bf16_f32 v219, v194, v195
    v_cvt_pk_bf16_f32 v99, v86, v87
    s_lshl_b32 s48, s44, 2
    s_add_u32 s48, s48, s21
    s_lshl_b32 s48, s48, 16
    s_lshl_b32 s49, s45, 12
    s_add_u32 s48, s48, s49
    s_lshl_b32 s49, s22, 10
    s_add_u32 s48, s48, s49
    s_add_u32 s48, s48, 16777216
    v_exp_f32 v89, v89
    buffer_store_dwordx4 v[212:215], v14, s[16:19], s48 offen sc1
    v_exp_f32 v90, v90
    buffer_store_dwordx4 v[216:219], v14, s[16:19], s48 offen offset:512 sc1
    v_cvt_pk_bf16_f32 v100, v88, v89
    v_mov_b32 v20, 0
    v_mfma_f32_32x32x16_bf16 v[120:135], v[164:167], v[96:99], v[120:135]
    v_mov_b32 v21, 0
    v_exp_f32 v91, v91
    v_lshlrev_b32 v17, 16, v212
    v_exp_f32 v92, v92
    v_and_b32 v18, 0xffff0000, v212
    v_cvt_pk_bf16_f32 v101, v90, v91
    v_add_f32 v20, v20, v17
    v_fma_f32 v21, v17, v17, v21
    v_mfma_f32_16x16x32_bf16 v[140:143], v[144:147], v[96:99], v[140:143]
    v_exp_f32 v93, v93
    v_exp_f32 v94, v94
    v_exp_f32 v95, v95
    v_cvt_pk_bf16_f32 v102, v92, v93
    v_cvt_pk_bf16_f32 v103, v94, v95
    s_setprio 1
    v_mfma_f32_32x32x16_bf16 v[80:95], v[156:159], v[40:43], v[48:63]
    ds_read_b128 v[148:151], v28 offset:40960
    v_exp_f32 v64, v64
    ds_read_b128 v[152:155], v28 offset:41984
    v_exp_f32 v65, v65
    v_add_f32 v20, v20, v18
    v_exp_f32 v66, v66
    v_fma_f32 v21, v18, v18, v21
    v_mfma_f32_32x32x16_bf16 v[120:135], v[168:171], v[100:103], v[120:135]
    v_lshlrev_b32 v17, 16, v213
    v_cvt_pk_bf16_f32 v96, v64, v65
    v_and_b32 v18, 0xffff0000, v213
    v_exp_f32 v67, v67
    v_add_f32 v20, v20, v17
    v_exp_f32 v68, v68
    v_fma_f32 v21, v17, v17, v21
    v_add_f32 v20, v20, v18
    v_cvt_pk_bf16_f32 v97, v66, v67
    v_fma_f32 v21, v18, v18, v21
    v_mfma_f32_32x32x16_bf16 v[80:95], v[160:163], v[44:47], v[80:95]
    v_lshlrev_b32 v17, 16, v214
    v_exp_f32 v69, v69
    v_and_b32 v18, 0xffff0000, v214
    v_exp_f32 v70, v70
    v_add_f32 v20, v20, v17
    v_cvt_pk_bf16_f32 v98, v68, v69
    v_fma_f32 v21, v17, v17, v21
    v_mfma_f32_16x16x32_bf16 v[140:143], v[144:147], v[100:103], v[140:143]
    v_add_f32 v20, v20, v18
    v_exp_f32 v71, v71
    v_fma_f32 v21, v18, v18, v21
    v_exp_f32 v72, v72
    v_lshlrev_b32 v17, 16, v215
    v_and_b32 v18, 0xffff0000, v215
    v_cvt_pk_bf16_f32 v99, v70, v71
    v_add_f32 v20, v20, v17
    v_exp_f32 v73, v73
    v_fma_f32 v21, v17, v17, v21
    v_exp_f32 v74, v74
    v_add_f32 v20, v20, v18
    v_cvt_pk_bf16_f32 v100, v72, v73
    v_fma_f32 v21, v18, v18, v21
    s_waitcnt lgkmcnt(3)
    v_mfma_f32_32x32x16_bf16 v[104:119], v[172:175], v[96:99], v[104:119]
    v_lshlrev_b32 v17, 16, v216
    v_exp_f32 v75, v75
    v_and_b32 v18, 0xffff0000, v216
    v_exp_f32 v76, v76
    v_add_f32 v20, v20, v17
    v_cvt_pk_bf16_f32 v101, v74, v75
    v_fma_f32 v21, v17, v17, v21
    v_add_f32 v20, v20, v18
    v_mfma_f32_16x16x32_bf16 v[136:139], v[144:147], v[96:99], v[136:139]
    v_exp_f32 v77, v77
    v_exp_f32 v78, v78
    v_exp_f32 v79, v79
    v_cvt_pk_bf16_f32 v102, v76, v77
    v_cvt_pk_bf16_f32 v103, v78, v79
    s_waitcnt lgkmcnt(1)
    v_mfma_f32_32x32x16_bf16 v[64:79], v[148:151], v[32:35], v[48:63]
    ds_read_b128 v[164:167], v28 offset:43008
    v_exp_f32 v80, v80
    ds_read_b128 v[168:171], v28 offset:44032
    v_exp_f32 v81, v81
    v_fma_f32 v21, v18, v18, v21
    v_exp_f32 v82, v82
    v_lshlrev_b32 v17, 16, v217
    v_mfma_f32_32x32x16_bf16 v[104:119], v[176:179], v[100:103], v[104:119]
    v_and_b32 v18, 0xffff0000, v217
    v_cvt_pk_bf16_f32 v96, v80, v81
    v_add_f32 v20, v20, v17
    v_exp_f32 v83, v83
    v_fma_f32 v21, v17, v17, v21
    v_exp_f32 v84, v84
    v_add_f32 v20, v20, v18
    v_cvt_pk_bf16_f32 v97, v82, v83
    v_fma_f32 v21, v18, v18, v21
    s_waitcnt lgkmcnt(2)
    v_mfma_f32_32x32x16_bf16 v[64:79], v[152:155], v[36:39], v[64:79]
    v_lshlrev_b32 v17, 16, v218
    v_exp_f32 v85, v85
    v_and_b32 v18, 0xffff0000, v218
    v_exp_f32 v86, v86
    v_add_f32 v20, v20, v17
    v_cvt_pk_bf16_f32 v98, v84, v85
    v_fma_f32 v21, v17, v17, v21
    v_mfma_f32_16x16x32_bf16 v[136:139], v[144:147], v[100:103], v[136:139]
    v_add_f32 v20, v20, v18
    v_exp_f32 v87, v87
    v_fma_f32 v21, v18, v18, v21
    v_exp_f32 v88, v88
    v_lshlrev_b32 v17, 16, v219
    v_cvt_pk_bf16_f32 v99, v86, v87
    v_and_b32 v18, 0xffff0000, v219
    v_exp_f32 v89, v89
    v_add_f32 v20, v20, v17
    v_exp_f32 v90, v90
    v_fma_f32 v21, v17, v17, v21
    v_cvt_pk_bf16_f32 v100, v88, v89
    v_add_f32 v20, v20, v18
    v_mfma_f32_32x32x16_bf16 v[120:135], v[172:175], v[96:99], v[120:135]
    v_fma_f32 v21, v18, v18, v21
    v_exp_f32 v91, v91
    v_mov_b32 v22, v20
    v_mov_b32 v23, v21
    s_nop 1
    v_permlane32_swap_b32 v20, v22
    v_permlane32_swap_b32 v21, v23
    s_nop 1
    v_add_f32 v20, v20, v22
    v_add_f32 v21, v21, v23
    v_exp_f32 v92, v92
    v_lshlrev_b32 v24, 3, v2
    v_cvt_pk_bf16_f32 v101, v90, v91
    s_lshl_b32 s48, s46, 3
    s_lshl_b32 s49, s45, 1
    s_add_u32 s49, s49, s22
    s_lshl_b32 s49, s49, 14
    s_add_u32 s48, s48, s49
    s_add_u32 s48, s48, 44040192
    buffer_store_dwordx2 v[20:21], v24, s[16:19], s48 offen sc1
    v_mfma_f32_16x16x32_bf16 v[140:143], v[144:147], v[96:99], v[140:143]
    v_exp_f32 v93, v93
    v_exp_f32 v94, v94
    v_exp_f32 v95, v95
    v_cvt_pk_bf16_f32 v102, v92, v93
    v_cvt_pk_bf16_f32 v103, v94, v95
    s_setprio 0
    v_mfma_f32_32x32x16_bf16 v[80:95], v[148:151], v[40:43], v[48:63]
    v_exp_f32 v64, v64
    v_exp_f32 v65, v65
    v_exp_f32 v66, v66
    v_mfma_f32_32x32x16_bf16 v[120:135], v[176:179], v[100:103], v[120:135]
    v_cvt_pk_bf16_f32 v96, v64, v65
    v_exp_f32 v67, v67
    v_exp_f32 v68, v68
    v_cvt_pk_bf16_f32 v97, v66, v67
    v_mfma_f32_32x32x16_bf16 v[80:95], v[152:155], v[44:47], v[80:95]
    v_exp_f32 v69, v69
    v_exp_f32 v70, v70
    ds_read_b128 v[156:159], v28 offset:45056
    v_cvt_pk_bf16_f32 v98, v68, v69
    v_mfma_f32_16x16x32_bf16 v[140:143], v[144:147], v[100:103], v[140:143]
    v_exp_f32 v71, v71
    v_exp_f32 v72, v72
    v_cvt_pk_bf16_f32 v99, v70, v71
    v_exp_f32 v73, v73
    v_exp_f32 v74, v74
    v_cvt_pk_bf16_f32 v100, v72, v73
    s_waitcnt lgkmcnt(2)
    v_mfma_f32_32x32x16_bf16 v[104:119], v[164:167], v[96:99], v[104:119]
    v_exp_f32 v75, v75
    v_exp_f32 v76, v76
    v_cvt_pk_bf16_f32 v101, v74, v75
    ds_read_b128 v[160:163], v28 offset:46080
    v_mfma_f32_16x16x32_bf16 v[136:139], v[144:147], v[96:99], v[136:139]
    v_exp_f32 v77, v77
    v_exp_f32 v78, v78
    v_exp_f32 v79, v79
    v_cvt_pk_bf16_f32 v102, v76, v77
    v_cvt_pk_bf16_f32 v103, v78, v79
    s_waitcnt lgkmcnt(1)
    v_mfma_f32_32x32x16_bf16 v[64:79], v[156:159], v[32:35], v[48:63]
    v_exp_f32 v80, v80
    v_exp_f32 v81, v81
    v_exp_f32 v82, v82
    v_mfma_f32_32x32x16_bf16 v[104:119], v[168:171], v[100:103], v[104:119]
    v_cvt_pk_bf16_f32 v96, v80, v81
    v_exp_f32 v83, v83
    v_exp_f32 v84, v84
    v_cvt_pk_bf16_f32 v97, v82, v83
    s_waitcnt lgkmcnt(0)
    v_mfma_f32_32x32x16_bf16 v[64:79], v[160:163], v[36:39], v[64:79]
    v_exp_f32 v85, v85
    v_exp_f32 v86, v86
    ds_read_b128 v[172:175], v28 offset:47104
    v_cvt_pk_bf16_f32 v98, v84, v85
    v_mfma_f32_16x16x32_bf16 v[136:139], v[144:147], v[100:103], v[136:139]
    v_exp_f32 v87, v87
    v_exp_f32 v88, v88
    v_cvt_pk_bf16_f32 v99, v86, v87
    v_exp_f32 v89, v89
    v_exp_f32 v90, v90
    v_cvt_pk_bf16_f32 v100, v88, v89
    v_mfma_f32_32x32x16_bf16 v[120:135], v[164:167], v[96:99], v[120:135]
    v_exp_f32 v91, v91
    v_exp_f32 v92, v92
    v_cvt_pk_bf16_f32 v101, v90, v91
    ds_read_b128 v[176:179], v28 offset:48128
    v_mfma_f32_16x16x32_bf16 v[140:143], v[144:147], v[96:99], v[140:143]
    v_exp_f32 v93, v93
    v_exp_f32 v94, v94
    v_exp_f32 v95, v95
    v_cvt_pk_bf16_f32 v102, v92, v93
    v_cvt_pk_bf16_f32 v103, v94, v95
    s_waitcnt vmcnt(0) lgkmcnt(0)
    s_barrier
    s_cmp_lg_u32 s20, 0
    s_cbranch_scc1 L_nfx1_6028
    s_lshr_b32 s48, s44, 1
    s_add_u32 s48, s48, 16
    s_lshl_b32 s48, s48, 8
    s_add_u32 s48, s48, 42860544
    v_mov_b32 v30, 0
    v_mov_b32 v31, 1
    s_mov_b64 exec, 1
    buffer_atomic_add v31, v30, s[16:19], s48 offen
    s_mov_b64 exec, -1
L_nfx1_6028:
    s_setprio 3
    v_mfma_f32_32x32x16_bf16 v[80:95], v[156:159], v[40:43], v[48:63]
    v_exp_f32 v64, v64
    v_exp_f32 v65, v65
    v_exp_f32 v66, v66
    ds_read_b128 v[148:151], v29 offset:0
    v_mfma_f32_32x32x16_bf16 v[120:135], v[168:171], v[100:103], v[120:135]
    v_cvt_pk_bf16_f32 v96, v64, v65
    v_exp_f32 v67, v67
    v_exp_f32 v68, v68
    ds_read_b128 v[152:155], v29 offset:1024
    v_cvt_pk_bf16_f32 v97, v66, v67
    v_mfma_f32_32x32x16_bf16 v[80:95], v[160:163], v[44:47], v[80:95]
    v_exp_f32 v69, v69
    v_exp_f32 v70, v70
    s_mov_b32 s96, s68
    s_mov_b32 s97, s69
    s_mov_b32 s98, 7340032
    s_mov_b32 s99, 0x00020000
    v_cvt_pk_bf16_f32 v98, v68, v69
    v_mfma_f32_16x16x32_bf16 v[140:143], v[144:147], v[100:103], v[140:143]
    v_exp_f32 v71, v71
    v_exp_f32 v72, v72
    s_mul_i32 s48, s2, 7
    s_add_u32 s48, s48, s20
    s_sub_u32 s48, s48, 1
    s_lshl_b32 s48, s48, 12
    s_cmp_eq_u32 s20, 0
    s_cselect_b32 s48, 0x7f000000, s48
    v_cvt_pk_bf16_f32 v99, v70, v71
    v_exp_f32 v73, v73
    v_exp_f32 v74, v74
    v_cvt_pk_bf16_f32 v100, v72, v73
    v_lshlrev_b32 v26, 6, v1
    v_mfma_f32_32x32x16_bf16 v[104:119], v[172:175], v[96:99], v[104:119]
    v_exp_f32 v75, v75
    v_exp_f32 v76, v76
    v_cvt_pk_bf16_f32 v101, v74, v75
    buffer_load_dword v27, v26, s[96:99], s48 offen
    v_mfma_f32_16x16x32_bf16 v[136:139], v[144:147], v[96:99], v[136:139]
    v_exp_f32 v77, v77
    v_exp_f32 v78, v78
    v_exp_f32 v79, v79
    v_cvt_pk_bf16_f32 v102, v76, v77
    v_cvt_pk_bf16_f32 v103, v78, v79
    s_waitcnt lgkmcnt(1)
    v_mfma_f32_32x32x16_bf16 v[64:79], v[148:151], v[32:35], v[48:63]
    v_exp_f32 v80, v80
    v_exp_f32 v81, v81
    v_exp_f32 v82, v82
    v_mfma_f32_32x32x16_bf16 v[104:119], v[176:179], v[100:103], v[104:119]
    v_cvt_pk_bf16_f32 v96, v80, v81
    v_exp_f32 v83, v83
    v_exp_f32 v84, v84
    v_cvt_pk_bf16_f32 v97, v82, v83
    s_waitcnt lgkmcnt(0)
    v_mfma_f32_32x32x16_bf16 v[64:79], v[152:155], v[36:39], v[64:79]
    v_exp_f32 v85, v85
    v_exp_f32 v86, v86
    ds_read_b128 v[164:167], v29 offset:2048
    v_cvt_pk_bf16_f32 v98, v84, v85
    v_mfma_f32_16x16x32_bf16 v[136:139], v[144:147], v[100:103], v[136:139]
    v_exp_f32 v87, v87
    v_exp_f32 v88, v88
    v_cvt_pk_bf16_f32 v99, v86, v87
    v_exp_f32 v89, v89
    v_exp_f32 v90, v90
    v_cvt_pk_bf16_f32 v100, v88, v89
    v_mfma_f32_32x32x16_bf16 v[120:135], v[172:175], v[96:99], v[120:135]
    v_exp_f32 v91, v91
    v_exp_f32 v92, v92
    v_cvt_pk_bf16_f32 v101, v90, v91
    ds_read_b128 v[168:171], v29 offset:3072
    v_mfma_f32_16x16x32_bf16 v[140:143], v[144:147], v[96:99], v[140:143]
    v_exp_f32 v93, v93
    v_exp_f32 v94, v94
    v_exp_f32 v95, v95
    v_cvt_pk_bf16_f32 v102, v92, v93
    v_cvt_pk_bf16_f32 v103, v94, v95
    s_setprio 2
    v_mfma_f32_32x32x16_bf16 v[80:95], v[148:151], v[40:43], v[48:63]
    v_exp_f32 v64, v64
    v_exp_f32 v65, v65
    v_exp_f32 v66, v66
    v_mfma_f32_32x32x16_bf16 v[120:135], v[176:179], v[100:103], v[120:135]
    v_cvt_pk_bf16_f32 v96, v64, v65
    v_exp_f32 v67, v67
    v_exp_f32 v68, v68
    v_cvt_pk_bf16_f32 v97, v66, v67
    v_mfma_f32_32x32x16_bf16 v[80:95], v[152:155], v[44:47], v[80:95]
    v_exp_f32 v69, v69
    v_exp_f32 v70, v70
    ds_read_b128 v[156:159], v29 offset:4096
    v_cvt_pk_bf16_f32 v98, v68, v69
    v_mfma_f32_16x16x32_bf16 v[140:143], v[144:147], v[100:103], v[140:143]
    v_exp_f32 v71, v71
    v_exp_f32 v72, v72
    v_cvt_pk_bf16_f32 v99, v70, v71
    v_exp_f32 v73, v73
    v_exp_f32 v74, v74
    v_cvt_pk_bf16_f32 v100, v72, v73
    s_waitcnt lgkmcnt(2)
    v_mfma_f32_32x32x16_bf16 v[104:119], v[164:167], v[96:99], v[104:119]
    v_exp_f32 v75, v75
    v_exp_f32 v76, v76
    v_cvt_pk_bf16_f32 v101, v74, v75
    ds_read_b128 v[160:163], v29 offset:5120
    v_mfma_f32_16x16x32_bf16 v[136:139], v[144:147], v[96:99], v[136:139]
    v_exp_f32 v77, v77
    v_exp_f32 v78, v78
    v_exp_f32 v79, v79
    v_cvt_pk_bf16_f32 v102, v76, v77
    v_cvt_pk_bf16_f32 v103, v78, v79
    s_waitcnt lgkmcnt(1)
    v_mfma_f32_32x32x16_bf16 v[64:79], v[156:159], v[32:35], v[48:63]
    v_exp_f32 v80, v80
    v_exp_f32 v81, v81
    v_exp_f32 v82, v82
    v_mfma_f32_32x32x16_bf16 v[104:119], v[168:171], v[100:103], v[104:119]
    v_cvt_pk_bf16_f32 v96, v80, v81
    v_exp_f32 v83, v83
    v_exp_f32 v84, v84
    v_cvt_pk_bf16_f32 v97, v82, v83
    s_waitcnt lgkmcnt(0)
    v_mfma_f32_32x32x16_bf16 v[64:79], v[160:163], v[36:39], v[64:79]
    v_exp_f32 v85, v85
    v_exp_f32 v86, v86
    ds_read_b128 v[172:175], v29 offset:6144
    v_cvt_pk_bf16_f32 v98, v84, v85
    v_mfma_f32_16x16x32_bf16 v[136:139], v[144:147], v[100:103], v[136:139]
    v_exp_f32 v87, v87
    v_exp_f32 v88, v88
    v_cvt_pk_bf16_f32 v99, v86, v87
    v_exp_f32 v89, v89
    v_exp_f32 v90, v90
    v_cvt_pk_bf16_f32 v100, v88, v89
    v_mfma_f32_32x32x16_bf16 v[120:135], v[164:167], v[96:99], v[120:135]
    v_exp_f32 v91, v91
    v_exp_f32 v92, v92
    v_cvt_pk_bf16_f32 v101, v90, v91
    ds_read_b128 v[176:179], v29 offset:7168
    v_mfma_f32_16x16x32_bf16 v[140:143], v[144:147], v[96:99], v[140:143]
    v_exp_f32 v93, v93
    v_exp_f32 v94, v94
    v_exp_f32 v95, v95
    v_cvt_pk_bf16_f32 v102, v92, v93
    v_cvt_pk_bf16_f32 v103, v94, v95
    s_setprio 1
    v_mfma_f32_32x32x16_bf16 v[80:95], v[156:159], v[40:43], v[48:63]
    v_exp_f32 v64, v64
    v_exp_f32 v65, v65
    v_exp_f32 v66, v66
    v_mfma_f32_32x32x16_bf16 v[120:135], v[168:171], v[100:103], v[120:135]
    v_cvt_pk_bf16_f32 v96, v64, v65
    ds_read_b128 v[148:151], v29 offset:8192
    v_exp_f32 v67, v67
    v_exp_f32 v68, v68
    v_cvt_pk_bf16_f32 v97, v66, v67
    v_mfma_f32_32x32x16_bf16 v[80:95], v[160:163], v[44:47], v[80:95]
    v_exp_f32 v69, v69
    v_exp_f32 v70, v70
    ds_read_b128 v[152:155], v29 offset:9216
    v_cvt_pk_bf16_f32 v98, v68, v69
    v_mfma_f32_16x16x32_bf16 v[140:143], v[144:147], v[100:103], v[140:143]
    v_exp_f32 v71, v71
    v_exp_f32 v72, v72
    v_cvt_pk_bf16_f32 v99, v70, v71
    v_exp_f32 v73, v73
    s_mov_b32 s96, s70
    s_mov_b32 s97, s71
    s_mov_b32 s98, 2097152
    s_sub_u32 s49, s48, 5242880
    v_exp_f32 v74, v74
    v_cvt_pk_bf16_f32 v100, v72, v73
    s_waitcnt lgkmcnt(3)
    v_mfma_f32_32x32x16_bf16 v[104:119], v[172:175], v[96:99], v[104:119]
    v_exp_f32 v75, v75
    v_exp_f32 v76, v76
    v_cvt_pk_bf16_f32 v101, v74, v75
    buffer_load_dword v27, v26, s[96:99], s49 offen
    v_mfma_f32_16x16x32_bf16 v[136:139], v[144:147], v[96:99], v[136:139]
    v_exp_f32 v77, v77
    v_exp_f32 v78, v78
    v_exp_f32 v79, v79
    v_cvt_pk_bf16_f32 v102, v76, v77
    v_cvt_pk_bf16_f32 v103, v78, v79
    s_waitcnt lgkmcnt(1)
    v_mfma_f32_32x32x16_bf16 v[64:79], v[148:151], v[32:35], v[48:63]
    v_exp_f32 v80, v80
    v_exp_f32 v81, v81
    v_exp_f32 v82, v82
    v_mfma_f32_32x32x16_bf16 v[104:119], v[176:179], v[100:103], v[104:119]
    v_cvt_pk_bf16_f32 v96, v80, v81
    v_exp_f32 v83, v83
    v_exp_f32 v84, v84
    v_cvt_pk_bf16_f32 v97, v82, v83
    s_waitcnt lgkmcnt(0)
    v_mfma_f32_32x32x16_bf16 v[64:79], v[152:155], v[36:39], v[64:79]
    v_exp_f32 v85, v85
    v_exp_f32 v86, v86
    ds_read_b128 v[164:167], v29 offset:10240
    v_cvt_pk_bf16_f32 v98, v84, v85
    v_mfma_f32_16x16x32_bf16 v[136:139], v[144:147], v[100:103], v[136:139]
    v_exp_f32 v87, v87
    v_exp_f32 v88, v88
    v_cvt_pk_bf16_f32 v99, v86, v87
    v_exp_f32 v89, v89
    v_exp_f32 v90, v90
    v_cvt_pk_bf16_f32 v100, v88, v89
    v_mfma_f32_32x32x16_bf16 v[120:135], v[172:175], v[96:99], v[120:135]
    v_exp_f32 v91, v91
    v_exp_f32 v92, v92
    v_cvt_pk_bf16_f32 v101, v90, v91
    ds_read_b128 v[168:171], v29 offset:11264
    v_mfma_f32_16x16x32_bf16 v[140:143], v[144:147], v[96:99], v[140:143]
    v_exp_f32 v93, v93
    v_exp_f32 v94, v94
    v_exp_f32 v95, v95
    v_cvt_pk_bf16_f32 v102, v92, v93
    v_cvt_pk_bf16_f32 v103, v94, v95
    s_setprio 0
    v_mfma_f32_32x32x16_bf16 v[80:95], v[148:151], v[40:43], v[48:63]
    v_exp_f32 v64, v64
    v_exp_f32 v65, v65
    v_exp_f32 v66, v66
    v_mfma_f32_32x32x16_bf16 v[120:135], v[176:179], v[100:103], v[120:135]
    v_cvt_pk_bf16_f32 v96, v64, v65
    v_exp_f32 v67, v67
    v_exp_f32 v68, v68
    v_cvt_pk_bf16_f32 v97, v66, v67
    v_mfma_f32_32x32x16_bf16 v[80:95], v[152:155], v[44:47], v[80:95]
    v_exp_f32 v69, v69
    v_exp_f32 v70, v70
    ds_read_b128 v[156:159], v29 offset:12288
    v_cvt_pk_bf16_f32 v98, v68, v69
    v_mfma_f32_16x16x32_bf16 v[140:143], v[144:147], v[100:103], v[140:143]
    v_exp_f32 v71, v71
    v_exp_f32 v72, v72
    v_cvt_pk_bf16_f32 v99, v70, v71
    v_exp_f32 v73, v73
    v_exp_f32 v74, v74
    v_cvt_pk_bf16_f32 v100, v72, v73
    s_waitcnt lgkmcnt(2)
    v_mfma_f32_32x32x16_bf16 v[104:119], v[164:167], v[96:99], v[104:119]
    v_exp_f32 v75, v75
    v_exp_f32 v76, v76
    v_cvt_pk_bf16_f32 v101, v74, v75
    ds_read_b128 v[160:163], v29 offset:13312
    v_mfma_f32_16x16x32_bf16 v[136:139], v[144:147], v[96:99], v[136:139]
    v_exp_f32 v77, v77
    v_exp_f32 v78, v78
    v_exp_f32 v79, v79
    v_cvt_pk_bf16_f32 v102, v76, v77
    v_cvt_pk_bf16_f32 v103, v78, v79
    s_waitcnt lgkmcnt(1)
    v_mfma_f32_32x32x16_bf16 v[64:79], v[156:159], v[32:35], v[48:63]
    v_exp_f32 v80, v80
    v_exp_f32 v81, v81
    v_exp_f32 v82, v82
    v_mfma_f32_32x32x16_bf16 v[104:119], v[168:171], v[100:103], v[104:119]
    v_cvt_pk_bf16_f32 v96, v80, v81
    v_exp_f32 v83, v83
    v_exp_f32 v84, v84
    v_cvt_pk_bf16_f32 v97, v82, v83
    s_waitcnt lgkmcnt(0)
    v_mfma_f32_32x32x16_bf16 v[64:79], v[160:163], v[36:39], v[64:79]
    v_exp_f32 v85, v85
    v_exp_f32 v86, v86
    ds_read_b128 v[172:175], v29 offset:14336
    v_cvt_pk_bf16_f32 v98, v84, v85
    v_mfma_f32_16x16x32_bf16 v[136:139], v[144:147], v[100:103], v[136:139]
    v_exp_f32 v87, v87
    v_exp_f32 v88, v88
    v_cvt_pk_bf16_f32 v99, v86, v87
    v_exp_f32 v89, v89
    v_exp_f32 v90, v90
    v_cvt_pk_bf16_f32 v100, v88, v89
    v_mfma_f32_32x32x16_bf16 v[120:135], v[164:167], v[96:99], v[120:135]
    v_exp_f32 v91, v91
    v_exp_f32 v92, v92
    v_cvt_pk_bf16_f32 v101, v90, v91
    ds_read_b128 v[176:179], v29 offset:15360
    v_mfma_f32_16x16x32_bf16 v[140:143], v[144:147], v[96:99], v[140:143]
    v_exp_f32 v93, v93
    v_exp_f32 v94, v94
    v_exp_f32 v95, v95
    v_cvt_pk_bf16_f32 v102, v92, v93
    v_cvt_pk_bf16_f32 v103, v94, v95
    s_waitcnt lgkmcnt(0)
    s_barrier
    s_setprio 3
    v_mfma_f32_32x32x16_bf16 v[80:95], v[156:159], v[40:43], v[48:63]
    v_exp_f32 v64, v64
    v_exp_f32 v65, v65
    v_exp_f32 v66, v66
    v_mfma_f32_32x32x16_bf16 v[120:135], v[168:171], v[100:103], v[120:135]
    v_cvt_pk_bf16_f32 v96, v64, v65
    v_exp_f32 v67, v67
    v_exp_f32 v68, v68
    v_cvt_pk_bf16_f32 v97, v66, v67
    v_mfma_f32_32x32x16_bf16 v[80:95], v[160:163], v[44:47], v[80:95]
    v_exp_f32 v69, v69
    v_exp_f32 v70, v70
    ds_read_b128 v[148:151], v29 offset:32768
    v_cvt_pk_bf16_f32 v98, v68, v69
    v_mfma_f32_16x16x32_bf16 v[140:143], v[144:147], v[100:103], v[140:143]
    v_exp_f32 v71, v71
    v_exp_f32 v72, v72
    v_cvt_pk_bf16_f32 v99, v70, v71
    v_exp_f32 v73, v73
    v_exp_f32 v74, v74
    v_cvt_pk_bf16_f32 v100, v72, v73
    v_mfma_f32_32x32x16_bf16 v[104:119], v[172:175], v[96:99], v[104:119]
    v_exp_f32 v75, v75
    v_exp_f32 v76, v76
    v_cvt_pk_bf16_f32 v101, v74, v75
    ds_read_b128 v[152:155], v29 offset:33792
    v_mfma_f32_16x16x32_bf16 v[136:139], v[144:147], v[96:99], v[136:139]
    v_exp_f32 v77, v77
    v_exp_f32 v78, v78
    v_exp_f32 v79, v79
    v_cvt_pk_bf16_f32 v102, v76, v77
    v_cvt_pk_bf16_f32 v103, v78, v79
    s_waitcnt lgkmcnt(1)
    v_mfma_f32_32x32x16_bf16 v[64:79], v[148:151], v[32:35], v[48:63]
    v_exp_f32 v80, v80
    v_exp_f32 v81, v81
    v_exp_f32 v82, v82
    v_mfma_f32_32x32x16_bf16 v[104:119], v[176:179], v[100:103], v[104:119]
    v_cvt_pk_bf16_f32 v96, v80, v81
    v_exp_f32 v83, v83
    v_exp_f32 v84, v84
    v_cvt_pk_bf16_f32 v97, v82, v83
    s_waitcnt lgkmcnt(0)
    v_mfma_f32_32x32x16_bf16 v[64:79], v[152:155], v[36:39], v[64:79]
    v_exp_f32 v85, v85
    v_exp_f32 v86, v86
    ds_read_b128 v[164:167], v29 offset:34816
    v_cvt_pk_bf16_f32 v98, v84, v85
    v_mfma_f32_16x16x32_bf16 v[136:139], v[144:147], v[100:103], v[136:139]
    v_exp_f32 v87, v87
    v_exp_f32 v88, v88
    v_cvt_pk_bf16_f32 v99, v86, v87
    v_exp_f32 v89, v89
    v_exp_f32 v90, v90
    v_cvt_pk_bf16_f32 v100, v88, v89
    v_mfma_f32_32x32x16_bf16 v[120:135], v[172:175], v[96:99], v[120:135]
    v_exp_f32 v91, v91
    v_exp_f32 v92, v92
    v_cvt_pk_bf16_f32 v101, v90, v91
    ds_read_b128 v[168:171], v29 offset:35840
    v_mfma_f32_16x16x32_bf16 v[140:143], v[144:147], v[96:99], v[140:143]
    v_exp_f32 v93, v93
    v_exp_f32 v94, v94
    v_exp_f32 v95, v95
    v_cvt_pk_bf16_f32 v102, v92, v93
    v_cvt_pk_bf16_f32 v103, v94, v95
    s_setprio 2
    v_mfma_f32_32x32x16_bf16 v[80:95], v[148:151], v[40:43], v[48:63]
    v_exp_f32 v64, v64
    v_exp_f32 v65, v65
    v_exp_f32 v66, v66
    v_mfma_f32_32x32x16_bf16 v[120:135], v[176:179], v[100:103], v[120:135]
    v_cvt_pk_bf16_f32 v96, v64, v65
    v_exp_f32 v67, v67
    v_exp_f32 v68, v68
    v_cvt_pk_bf16_f32 v97, v66, v67
    v_mfma_f32_32x32x16_bf16 v[80:95], v[152:155], v[44:47], v[80:95]
    v_exp_f32 v69, v69
    v_exp_f32 v70, v70
    ds_read_b128 v[156:159], v29 offset:36864
    v_cvt_pk_bf16_f32 v98, v68, v69
    v_mfma_f32_16x16x32_bf16 v[140:143], v[144:147], v[100:103], v[140:143]
    v_exp_f32 v71, v71
    v_exp_f32 v72, v72
    v_cvt_pk_bf16_f32 v99, v70, v71
    v_exp_f32 v73, v73
    v_exp_f32 v74, v74
    v_cvt_pk_bf16_f32 v100, v72, v73
    s_waitcnt lgkmcnt(2)
    v_mfma_f32_32x32x16_bf16 v[104:119], v[164:167], v[96:99], v[104:119]
    v_exp_f32 v75, v75
    v_exp_f32 v76, v76
    v_cvt_pk_bf16_f32 v101, v74, v75
    ds_read_b128 v[160:163], v29 offset:37888
    v_mfma_f32_16x16x32_bf16 v[136:139], v[144:147], v[96:99], v[136:139]
    v_exp_f32 v77, v77
    v_exp_f32 v78, v78
    v_exp_f32 v79, v79
    v_cvt_pk_bf16_f32 v102, v76, v77
    v_cvt_pk_bf16_f32 v103, v78, v79
    s_waitcnt lgkmcnt(1)
    v_mfma_f32_32x32x16_bf16 v[64:79], v[156:159], v[32:35], v[48:63]
    v_exp_f32 v80, v80
    v_exp_f32 v81, v81
    v_exp_f32 v82, v82
    v_mfma_f32_32x32x16_bf16 v[104:119], v[168:171], v[100:103], v[104:119]
    v_cvt_pk_bf16_f32 v96, v80, v81
    v_exp_f32 v83, v83
    v_exp_f32 v84, v84
    ds_read_b128 v[172:175], v29 offset:38912
    v_cvt_pk_bf16_f32 v97, v82, v83
    s_waitcnt lgkmcnt(1)
    v_mfma_f32_32x32x16_bf16 v[64:79], v[160:163], v[36:39], v[64:79]
    v_exp_f32 v85, v85
    v_exp_f32 v86, v86
    v_cvt_pk_bf16_f32 v98, v84, v85
    v_mfma_f32_16x16x32_bf16 v[136:139], v[144:147], v[100:103], v[136:139]
    v_exp_f32 v87, v87
    v_exp_f32 v88, v88
    ds_read_b128 v[176:179], v29 offset:39936
    v_cvt_pk_bf16_f32 v99, v86, v87
    v_exp_f32 v89, v89
    v_exp_f32 v90, v90
    v_cvt_pk_bf16_f32 v100, v88, v89
    v_mfma_f32_32x32x16_bf16 v[120:135], v[164:167], v[96:99], v[120:135]
    v_exp_f32 v91, v91
    v_exp_f32 v92, v92
    v_cvt_pk_bf16_f32 v101, v90, v91
    s_and_b32 s38, s60, 7
    s_add_u32 s38, s38, 16
    s_lshl_b32 s38, s38, 8
    s_add_u32 s38, s38, 42860544
    v_mov_b32 v30, 0
    s_cmp_lg_u32 s20, 0
    s_cbranch_scc1 L_np_6029
    buffer_load_dword v31, v30, s[16:19], s38 offen sc1
L_np_6029:
    v_mfma_f32_16x16x32_bf16 v[140:143], v[144:147], v[96:99], v[140:143]
    v_exp_f32 v93, v93
    v_exp_f32 v94, v94
    v_exp_f32 v95, v95
    v_cvt_pk_bf16_f32 v102, v92, v93
    v_cvt_pk_bf16_f32 v103, v94, v95
    s_setprio 1
    v_mfma_f32_32x32x16_bf16 v[80:95], v[156:159], v[40:43], v[48:63]
    v_exp_f32 v64, v64
    v_exp_f32 v65, v65
    v_exp_f32 v66, v66
    v_mfma_f32_32x32x16_bf16 v[120:135], v[168:171], v[100:103], v[120:135]
    v_cvt_pk_bf16_f32 v96, v64, v65
    v_exp_f32 v67, v67
    v_exp_f32 v68, v68
    v_cvt_pk_bf16_f32 v97, v66, v67
    v_mfma_f32_32x32x16_bf16 v[80:95], v[160:163], v[44:47], v[80:95]
    v_exp_f32 v69, v69
    v_exp_f32 v70, v70
    ds_read_b128 v[148:151], v29 offset:40960
    v_cvt_pk_bf16_f32 v98, v68, v69
    v_mfma_f32_16x16x32_bf16 v[140:143], v[144:147], v[100:103], v[140:143]
    v_exp_f32 v71, v71
    v_exp_f32 v72, v72
    v_cvt_pk_bf16_f32 v99, v70, v71
    v_exp_f32 v73, v73
    v_exp_f32 v74, v74
    v_cvt_pk_bf16_f32 v100, v72, v73
    s_waitcnt lgkmcnt(2)
    v_mfma_f32_32x32x16_bf16 v[104:119], v[172:175], v[96:99], v[104:119]
    v_exp_f32 v75, v75
    v_exp_f32 v76, v76
    v_cvt_pk_bf16_f32 v101, v74, v75
    ds_read_b128 v[152:155], v29 offset:41984
    v_mfma_f32_16x16x32_bf16 v[136:139], v[144:147], v[96:99], v[136:139]
    v_exp_f32 v77, v77
    v_exp_f32 v78, v78
    v_exp_f32 v79, v79
    v_cvt_pk_bf16_f32 v102, v76, v77
    v_cvt_pk_bf16_f32 v103, v78, v79
    s_waitcnt lgkmcnt(1)
    v_mfma_f32_32x32x16_bf16 v[64:79], v[148:151], v[32:35], v[48:63]
    v_exp_f32 v80, v80
    v_exp_f32 v81, v81
    v_exp_f32 v82, v82
    v_mfma_f32_32x32x16_bf16 v[104:119], v[176:179], v[100:103], v[104:119]
    v_cvt_pk_bf16_f32 v96, v80, v81
    v_exp_f32 v83, v83
    v_exp_f32 v84, v84
    v_cvt_pk_bf16_f32 v97, v82, v83
    s_waitcnt lgkmcnt(0)
    v_mfma_f32_32x32x16_bf16 v[64:79], v[152:155], v[36:39], v[64:79]
    v_exp_f32 v85, v85
    v_exp_f32 v86, v86
    ds_read_b128 v[164:167], v29 offset:43008
    v_cvt_pk_bf16_f32 v98, v84, v85
    v_mfma_f32_16x16x32_bf16 v[136:139], v[144:147], v[100:103], v[136:139]
    v_exp_f32 v87, v87
    v_exp_f32 v88, v88
    v_cvt_pk_bf16_f32 v99, v86, v87
    v_exp_f32 v89, v89
    v_exp_f32 v90, v90
    v_cvt_pk_bf16_f32 v100, v88, v89
    v_mfma_f32_32x32x16_bf16 v[120:135], v[172:175], v[96:99], v[120:135]
    v_exp_f32 v91, v91
    v_exp_f32 v92, v92
    v_cvt_pk_bf16_f32 v101, v90, v91
    ds_read_b128 v[168:171], v29 offset:44032
    v_mfma_f32_16x16x32_bf16 v[140:143], v[144:147], v[96:99], v[140:143]
    v_exp_f32 v93, v93
    v_exp_f32 v94, v94
    v_exp_f32 v95, v95
    v_cvt_pk_bf16_f32 v102, v92, v93
    v_cvt_pk_bf16_f32 v103, v94, v95
    s_setprio 0
    v_mfma_f32_32x32x16_bf16 v[80:95], v[148:151], v[40:43], v[48:63]
    v_exp_f32 v64, v64
    v_exp_f32 v65, v65
    v_exp_f32 v66, v66
    v_mfma_f32_32x32x16_bf16 v[120:135], v[176:179], v[100:103], v[120:135]
    v_cvt_pk_bf16_f32 v96, v64, v65
    v_exp_f32 v67, v67
    v_exp_f32 v68, v68
    v_cvt_pk_bf16_f32 v97, v66, v67
    v_mfma_f32_32x32x16_bf16 v[80:95], v[152:155], v[44:47], v[80:95]
    v_exp_f32 v69, v69
    v_exp_f32 v70, v70
    ds_read_b128 v[156:159], v29 offset:45056
    v_cvt_pk_bf16_f32 v98, v68, v69
    v_mfma_f32_16x16x32_bf16 v[140:143], v[144:147], v[100:103], v[140:143]
    v_exp_f32 v71, v71
    v_exp_f32 v72, v72
    v_cvt_pk_bf16_f32 v99, v70, v71
    v_exp_f32 v73, v73
    v_exp_f32 v74, v74
    v_cvt_pk_bf16_f32 v100, v72, v73
    s_waitcnt lgkmcnt(2)
    v_mfma_f32_32x32x16_bf16 v[104:119], v[164:167], v[96:99], v[104:119]
    v_exp_f32 v75, v75
    v_exp_f32 v76, v76
    v_cvt_pk_bf16_f32 v101, v74, v75
    ds_read_b128 v[160:163], v29 offset:46080
    v_mfma_f32_16x16x32_bf16 v[136:139], v[144:147], v[96:99], v[136:139]
    v_exp_f32 v77, v77
    v_exp_f32 v78, v78
    v_exp_f32 v79, v79
    v_cvt_pk_bf16_f32 v102, v76, v77
    v_cvt_pk_bf16_f32 v103, v78, v79
    s_waitcnt lgkmcnt(1)
    v_mfma_f32_32x32x16_bf16 v[64:79], v[156:159], v[32:35], v[48:63]
    v_exp_f32 v80, v80
    v_exp_f32 v81, v81
    v_exp_f32 v82, v82
    v_mfma_f32_32x32x16_bf16 v[104:119], v[168:171], v[100:103], v[104:119]
    v_cvt_pk_bf16_f32 v96, v80, v81
    v_exp_f32 v83, v83
    v_exp_f32 v84, v84
    ds_read_b128 v[172:175], v29 offset:47104
    v_cvt_pk_bf16_f32 v97, v82, v83
    s_waitcnt lgkmcnt(1)
    v_mfma_f32_32x32x16_bf16 v[64:79], v[160:163], v[36:39], v[64:79]
    v_exp_f32 v85, v85
    v_exp_f32 v86, v86
    v_cvt_pk_bf16_f32 v98, v84, v85
    v_mfma_f32_16x16x32_bf16 v[136:139], v[144:147], v[100:103], v[136:139]
    v_exp_f32 v87, v87
    v_exp_f32 v88, v88
    ds_read_b128 v[176:179], v29 offset:48128
    v_cvt_pk_bf16_f32 v99, v86, v87
    v_exp_f32 v89, v89
    v_exp_f32 v90, v90
    v_cvt_pk_bf16_f32 v100, v88, v89
    v_mfma_f32_32x32x16_bf16 v[120:135], v[164:167], v[96:99], v[120:135]
    v_exp_f32 v91, v91
    v_exp_f32 v92, v92
    v_cvt_pk_bf16_f32 v101, v90, v91
    s_cmp_lg_u32 s20, 0
    s_cbranch_scc1 L_nc_6030
    s_waitcnt vmcnt(0)
    s_mov_b32 s91, 0
L_spx1_6031:
    v_readfirstlane_b32 s90, v31
    s_cmp_ge_u32 s90, 32
    s_cbranch_scc1 L_spokx1_6032
    s_add_u32 s91, s91, 1
    s_cmp_ge_u32 s91, 4194304
    s_cbranch_scc1 L_spokx1_6032
    s_sleep 4
    buffer_load_dword v31, v30, s[16:19], s38 offen sc1
    s_waitcnt vmcnt(0)
    s_branch L_spx1_6031
L_spokx1_6032:
L_nc_6030:
    v_mfma_f32_16x16x32_bf16 v[140:143], v[144:147], v[96:99], v[140:143]
    v_exp_f32 v93, v93
    v_exp_f32 v94, v94
    v_exp_f32 v95, v95
    v_cvt_pk_bf16_f32 v102, v92, v93
    v_cvt_pk_bf16_f32 v103, v94, v95
    s_waitcnt lgkmcnt(0)
    s_barrier
    s_mov_b32 s35, s47
    s_mov_b32 s36, s42
    s_mov_b32 s37, s43
    s_cmp_ge_u32 s60, 56
    s_cbranch_scc1 L_ka_noe
    s_and_b32 s42, s60, 7
    s_mov_b32 s39, s42
    s_lshr_b32 s43, s40, 1
    s_mul_i32 s43, s43, 7
    s_lshr_b32 s44, s60, 3
    s_add_u32 s44, s44, s43
    s_movk_i32 s23, 7168
    s_lshl_b32 s45, s44, 8
    s_lshl_b32 s46, s42, 3
    v_and_b32 v236, 15, v1
    v_lshrrev_b32 v237, 4, v1
    v_lshlrev_b32 v235, 1, v237
    v_xor_b32 v239, v236, v235
    v_xor_b32 v235, 8, v239
    s_lshl_b32 s33, s20, 3
    v_add_u32 v238, s33, v237
    v_mul_lo_u32 v238, v238, s23
    v_add_u32 v238, s45, v238
    v_lshl_add_u32 v8, v239, 4, v238
    s_lshl_b32 s33, s23, 2
    s_sub_u32 s33, s33, 1024
    v_lshl_add_u32 v235, v235, 4, v238
    v_add_u32 v9, s33, v235
    s_lshl_b32 s31, s23, 6
    s_lshl_b32 s29, s20, 12
    s_lshl_b32 s30, s20, 11
    s_add_u32 s30, s30, 32768
    s_mov_b32 s24, 0
    s_mov_b32 s25, 0
    s_add_u32 s33, s46, s20
    s_mul_i32 s33, s33, 65536
    v_lshlrev_b32 v238, 4, v1
    v_add_u32 v4, s33, v238
    s_add_u32 s8, s62, 16777216
    s_addc_u32 s9, s63, 0
    s_mov_b32 s10, 4194304
    s_mov_b32 s11, 0x00020000
    s_mov_b32 s12, s68
    s_mov_b32 s13, s69
    s_mov_b32 s14, 7340032
    s_mov_b32 s15, 0x00020000
    s_mov_b32 s26, 0
    s_add_u32 m0, s26, s30
    s_nop 0
    buffer_load_dwordx4 v8, s[12:15], s25 offen offset:0 lds
    buffer_load_dwordx4 v9, s[12:15], s25 offen offset:1024 lds
    s_add_u32 m0, s26, s29
    s_nop 0
    buffer_load_dwordx4 v4, s[8:11], s24 offen offset:0 sc1 lds
    buffer_load_dwordx4 v4, s[8:11], s24 offen offset:1024 sc1 lds
    buffer_load_dwordx4 v4, s[8:11], s24 offen offset:2048 sc1 lds
    buffer_load_dwordx4 v4, s[8:11], s24 offen offset:3072 sc1 lds
    s_add_u32 s24, s24, 4096
    s_add_u32 s25, s25, s31
    s_add_u32 s26, s26, 49152
    s_add_u32 m0, s26, s30
    s_nop 0
    buffer_load_dwordx4 v8, s[12:15], s25 offen offset:0 lds
    buffer_load_dwordx4 v9, s[12:15], s25 offen offset:1024 lds
    s_add_u32 m0, s26, s29
    s_nop 0
    buffer_load_dwordx4 v4, s[8:11], s24 offen offset:0 sc1 lds
    buffer_load_dwordx4 v4, s[8:11], s24 offen offset:1024 sc1 lds
    buffer_load_dwordx4 v4, s[8:11], s24 offen offset:2048 sc1 lds
    buffer_load_dwordx4 v4, s[8:11], s24 offen offset:3072 sc1 lds
    s_add_u32 s24, s24, 4096
    s_add_u32 s25, s25, s31
    s_add_u32 s26, s26, 49152
L_ka_noe:
    v_mfma_f32_32x32x16_bf16 v[80:95], v[156:159], v[40:43], v[48:63]
    v_exp_f32 v64, v64
    v_exp_f32 v65, v65
    v_exp_f32 v66, v66
    v_mfma_f32_32x32x16_bf16 v[120:135], v[168:171], v[100:103], v[120:135]
    v_cvt_pk_bf16_f32 v96, v64, v65
    v_exp_f32 v67, v67
    v_exp_f32 v68, v68
    v_cvt_pk_bf16_f32 v97, v66, v67
    v_mfma_f32_32x32x16_bf16 v[80:95], v[160:163], v[44:47], v[80:95]
    v_exp_f32 v69, v69
    v_exp_f32 v70, v70
    v_cvt_pk_bf16_f32 v98, v68, v69
    v_mfma_f32_16x16x32_bf16 v[140:143], v[144:147], v[100:103], v[140:143]
    v_exp_f32 v71, v71
    v_exp_f32 v72, v72
    v_cvt_pk_bf16_f32 v99, v70, v71
    v_exp_f32 v73, v73
    v_exp_f32 v74, v74
    v_cvt_pk_bf16_f32 v100, v72, v73
    v_mfma_f32_32x32x16_bf16 v[104:119], v[172:175], v[96:99], v[104:119]
    v_exp_f32 v75, v75
    v_exp_f32 v76, v76
    v_cvt_pk_bf16_f32 v101, v74, v75
    v_mfma_f32_16x16x32_bf16 v[136:139], v[144:147], v[96:99], v[136:139]
    v_exp_f32 v77, v77
    v_exp_f32 v78, v78
    v_exp_f32 v79, v79
    v_cvt_pk_bf16_f32 v102, v76, v77
    v_cvt_pk_bf16_f32 v103, v78, v79
    v_exp_f32 v80, v80
    v_exp_f32 v81, v81
    v_exp_f32 v82, v82
    v_mfma_f32_32x32x16_bf16 v[104:119], v[176:179], v[100:103], v[104:119]
    v_cvt_pk_bf16_f32 v96, v80, v81
    v_exp_f32 v83, v83
    v_exp_f32 v84, v84
    v_cvt_pk_bf16_f32 v97, v82, v83
    v_exp_f32 v85, v85
    v_exp_f32 v86, v86
    v_cvt_pk_bf16_f32 v98, v84, v85
    v_mfma_f32_16x16x32_bf16 v[136:139], v[144:147], v[100:103], v[136:139]
    v_exp_f32 v87, v87
    v_exp_f32 v88, v88
    v_cvt_pk_bf16_f32 v99, v86, v87
    v_exp_f32 v89, v89
    v_exp_f32 v90, v90
    v_cvt_pk_bf16_f32 v100, v88, v89
    v_mfma_f32_32x32x16_bf16 v[120:135], v[172:175], v[96:99], v[120:135]
    v_exp_f32 v91, v91
    v_exp_f32 v92, v92
    v_cvt_pk_bf16_f32 v101, v90, v91
    v_mfma_f32_16x16x32_bf16 v[140:143], v[144:147], v[96:99], v[140:143]
    v_exp_f32 v93, v93
    v_exp_f32 v94, v94
    v_exp_f32 v95, v95
    v_cvt_pk_bf16_f32 v102, v92, v93
    v_cvt_pk_bf16_f32 v103, v94, v95
    s_nop 1
    v_mfma_f32_32x32x16_bf16 v[120:135], v[176:179], v[100:103], v[120:135]
    v_mfma_f32_16x16x32_bf16 v[140:143], v[144:147], v[100:103], v[140:143]
    s_nop 3
    s_lshl_b32 s48, s20, 12
    s_add_u32 s48, s48, 98304
    v_add_u32 v22, s48, v15
    v_xor_b32 v23, 4096, v22
    s_lshl_b32 s48, s20, 8
    s_add_u32 s48, s48, 131072
    v_lshl_add_u32 v20, v1, 2, s48
    v_xor_b32 v21, 256, v20
    s_cmp_eq_u32 s22, 0
    s_cbranch_scc0 L_pa_x1
    ds_write_b128 v22, v[120:123] offset:0
    ds_write_b128 v22, v[124:127] offset:1024
    ds_write_b128 v22, v[128:131] offset:2048
    ds_write_b128 v22, v[132:135] offset:3072
    ds_write_b32 v20, v140
    s_branch L_pa_x2
L_pa_x1:
    ds_write_b128 v22, v[104:107] offset:0
    ds_write_b128 v22, v[108:111] offset:1024
    ds_write_b128 v22, v[112:115] offset:2048
    ds_write_b128 v22, v[116:119] offset:3072
    ds_write_b32 v20, v136
    s_waitcnt lgkmcnt(0)
    v_mov_b32 v104, v120
    v_mov_b32 v105, v121
    v_mov_b32 v106, v122
    v_mov_b32 v107, v123
    v_mov_b32 v108, v124
    v_mov_b32 v109, v125
    v_mov_b32 v110, v126
    v_mov_b32 v111, v127
    v_mov_b32 v112, v128
    v_mov_b32 v113, v129
    v_mov_b32 v114, v130
    v_mov_b32 v115, v131
    v_mov_b32 v116, v132
    v_mov_b32 v117, v133
    v_mov_b32 v118, v134
    v_mov_b32 v119, v135
    v_mov_b32 v136, v140
    v_mov_b32 v32, v40
    v_mov_b32 v33, v41
    v_mov_b32 v34, v42
    v_mov_b32 v35, v43
    v_mov_b32 v36, v44
    v_mov_b32 v37, v45
    v_mov_b32 v38, v46
    v_mov_b32 v39, v47
L_pa_x2:
    s_waitcnt lgkmcnt(0)
    s_barrier
    ds_read_b128 v[120:123], v23 offset:0
    ds_read_b128 v[124:127], v23 offset:1024
    ds_read_b128 v[128:131], v23 offset:2048
    ds_read_b128 v[132:135], v23 offset:3072
    ds_read_b32 v140, v21
    s_waitcnt lgkmcnt(0)
    v_add_f32 v104, v104, v120
    v_add_f32 v105, v105, v121
    v_add_f32 v106, v106, v122
    v_add_f32 v107, v107, v123
    v_add_f32 v108, v108, v124
    v_add_f32 v109, v109, v125
    v_add_f32 v110, v110, v126
    v_add_f32 v111, v111, v127
    v_add_f32 v112, v112, v128
    v_add_f32 v113, v113, v129
    v_add_f32 v114, v114, v130
    v_add_f32 v115, v115, v131
    v_add_f32 v116, v116, v132
    v_add_f32 v117, v117, v133
    v_add_f32 v118, v118, v134
    v_add_f32 v119, v119, v135
    v_add_f32 v136, v136, v140
    v_max3_f32 v18, abs(v104), abs(v105), abs(v106)
    v_max3_f32 v18, v18, abs(v107), abs(v108)
    v_max3_f32 v18, v18, abs(v109), abs(v110)
    v_max3_f32 v18, v18, abs(v111), abs(v112)
    v_max3_f32 v18, v18, abs(v113), abs(v114)
    v_max3_f32 v18, v18, abs(v115), abs(v116)
    v_max3_f32 v18, v18, abs(v117), abs(v118)
    v_max3_f32 v18, v18, abs(v119), abs(v119)
    v_mov_b32 v19, 1568669696
    v_cmp_nlt_f32 vcc, v136, v19
    v_mov_b32 v19, 2071986176
    v_cmp_nlt_f32 s[50:51], v18, v19
    v_mov_b32 v19, 562036736
    v_cmp_ngt_f32 s[52:53], v136, v19
    s_nop 1
    s_or_b64 vcc, vcc, s[50:51]
    s_or_b64 vcc, vcc, s[52:53]
    s_cbranch_vccnz L_pa_fallback
L_pa_fin:
    v_rcp_f32 v18, v136
    s_nop 0
    v_mul_f32 v18, v18, v25
    v_mul_f32 v104, v104, v18
    v_mul_f32 v105, v105, v18
    v_mul_f32 v106, v106, v18
    v_mul_f32 v107, v107, v18
    v_mul_f32 v108, v108, v18
    v_mul_f32 v109, v109, v18
    v_mul_f32 v110, v110, v18
    v_mul_f32 v111, v111, v18
    v_mul_f32 v112, v112, v18
    v_mul_f32 v113, v113, v18
    v_mul_f32 v114, v114, v18
    v_mul_f32 v115, v115, v18
    v_mul_f32 v116, v116, v18
    v_mul_f32 v117, v117, v18
    v_mul_f32 v118, v118, v18
    v_mul_f32 v119, v119, v18
    v_cvt_pk_bf16_f32 v228, v104, v105
    v_cvt_pk_bf16_f32 v229, v106, v107
    v_cvt_pk_bf16_f32 v230, v108, v109
    v_cvt_pk_bf16_f32 v231, v110, v111
    v_cvt_pk_bf16_f32 v232, v112, v113
    v_cvt_pk_bf16_f32 v233, v114, v115
    v_cvt_pk_bf16_f32 v234, v116, v117
    v_cvt_pk_bf16_f32 v235, v118, v119
    s_lshl_b32 s48, s35, 16
    s_lshr_b32 s49, s36, 1
    s_lshl_b32 s49, s49, 12
    s_add_u32 s48, s48, s49
    s_and_b32 s49, s36, 1
    s_lshl_b32 s49, s49, 10
    s_add_u32 s48, s48, s49
    s_add_u32 s48, s48, 20971520
    buffer_store_dwordx4 v[228:231], v14, s[16:19], s48 offen sc1
    buffer_store_dwordx4 v[232:235], v14, s[16:19], s48 offen offset:512 sc1
    s_setprio 0
    s_cmp_ge_u32 s60, 56
    s_cbranch_scc1 L_ka_skip3
    v_and_b32 v2, 15, v1
    v_lshrrev_b32 v3, 4, v1
    s_lshr_b32 s21, s20, 1
    s_mov_b32 s49, s26
    v_bfe_u32 v17, v1, 2, 2
    v_lshl_add_u32 v18, v3, 2, v17
    v_and_b32 v19, 7, v18
    s_lshl_b32 s33, s22, 2
    v_xor_b32 v19, s33, v19
    v_lshlrev_b32 v18, 8, v18
    v_lshl_add_u32 v18, v19, 5, v18
    v_and_b32 v20, 3, v1
    v_lshl_add_u32 v18, v20, 3, v18
    v_add_u32 v12, 32768, v18
    v_xor_b32 v13, 32, v12
    v_xor_b32 v14, 64, v12
    v_xor_b32 v15, 96, v12
    s_lshl_b32 s33, s21, 13
    v_lshlrev_b32 v16, 4, v1
    v_add_u32 v10, s33, v16
    s_mov_b32 s26, 0
    s_mov_b32 s26, s49
    s_mov_b32 s32, 4294868992
    s_mov_b32 s33, 49152
    s_waitcnt vmcnt(8)
    s_barrier
    ds_read_b128 v[128:131], v10 offset:0
    ds_read_b64_tr_b16 v[32:33], v12 offset:0
    ds_read_b64_tr_b16 v[34:35], v12 offset:4096
    ds_read_b128 v[132:135], v10 offset:1024
    ds_read_b64_tr_b16 v[36:37], v12 offset:8192
    ds_read_b64_tr_b16 v[38:39], v12 offset:12288
    ds_read_b128 v[136:139], v10 offset:2048
    ds_read_b128 v[140:143], v10 offset:3072
    ds_read_b128 v[144:147], v10 offset:4096
    ds_read_b128 v[148:151], v10 offset:5120
    ds_read_b128 v[152:155], v10 offset:6144
    ds_read_b128 v[156:159], v10 offset:7168
    s_add_u32 m0, s26, s30
    s_nop 0
    buffer_load_dwordx4 v8, s[12:15], s25 offen offset:0 lds
    buffer_load_dwordx4 v9, s[12:15], s25 offen offset:1024 lds
    s_add_u32 m0, s26, s29
    s_nop 0
    buffer_load_dwordx4 v4, s[8:11], s24 offen offset:0 sc1 lds
    buffer_load_dwordx4 v4, s[8:11], s24 offen offset:1024 sc1 lds
    buffer_load_dwordx4 v4, s[8:11], s24 offen offset:2048 sc1 lds
    buffer_load_dwordx4 v4, s[8:11], s24 offen offset:3072 sc1 lds
    s_add_u32 s24, s24, 4096
    s_add_u32 s25, s25, s31
    s_waitcnt lgkmcnt(9)
    v_mfma_f32_16x16x32_bf16 v[64:67], v[32:35], v[128:131], 0
    ds_read_b64_tr_b16 v[40:41], v13 offset:0
    s_waitcnt lgkmcnt(7)
    v_mfma_f32_16x16x32_bf16 v[64:67], v[36:39], v[132:135], v[64:67]
    ds_read_b64_tr_b16 v[42:43], v13 offset:4096
    s_waitcnt lgkmcnt(7)
    v_mfma_f32_16x16x32_bf16 v[68:71], v[32:35], v[136:139], 0
    ds_read_b64_tr_b16 v[44:45], v13 offset:8192
    s_waitcnt lgkmcnt(7)
    v_mfma_f32_16x16x32_bf16 v[68:71], v[36:39], v[140:143], v[68:71]
    ds_read_b64_tr_b16 v[46:47], v13 offset:12288
    s_waitcnt lgkmcnt(7)
    v_mfma_f32_16x16x32_bf16 v[72:75], v[32:35], v[144:147], 0
    ds_read_b64_tr_b16 v[48:49], v14 offset:0
    s_waitcnt lgkmcnt(7)
    v_mfma_f32_16x16x32_bf16 v[72:75], v[36:39], v[148:151], v[72:75]
    ds_read_b64_tr_b16 v[50:51], v14 offset:4096
    s_waitcnt lgkmcnt(7)
    v_mfma_f32_16x16x32_bf16 v[76:79], v[32:35], v[152:155], 0
    ds_read_b64_tr_b16 v[52:53], v14 offset:8192
    s_waitcnt lgkmcnt(7)
    v_mfma_f32_16x16x32_bf16 v[76:79], v[36:39], v[156:159], v[76:79]
    ds_read_b64_tr_b16 v[54:55], v14 offset:12288
    s_waitcnt lgkmcnt(6)
    v_mfma_f32_16x16x32_bf16 v[80:83], v[40:43], v[128:131], 0
    ds_read_b64_tr_b16 v[56:57], v15 offset:0
    s_waitcnt lgkmcnt(5)
    v_mfma_f32_16x16x32_bf16 v[80:83], v[44:47], v[132:135], v[80:83]
    ds_read_b64_tr_b16 v[58:59], v15 offset:4096
    v_mfma_f32_16x16x32_bf16 v[84:87], v[40:43], v[136:139], 0
    ds_read_b64_tr_b16 v[60:61], v15 offset:8192
    v_mfma_f32_16x16x32_bf16 v[84:87], v[44:47], v[140:143], v[84:87]
    ds_read_b64_tr_b16 v[62:63], v15 offset:12288
    v_mfma_f32_16x16x32_bf16 v[88:91], v[40:43], v[144:147], 0
    s_add_u32 s26, s26, 49152
    s_cmp_eq_u32 s26, 147456
    s_cselect_b32 s26, 0, s26
    s_cmp_eq_u32 s26, 98304
    s_cselect_b32 s27, s32, s33
    v_mfma_f32_16x16x32_bf16 v[88:91], v[44:47], v[148:151], v[88:91]
    v_add_u32 v10, s27, v10
    v_add_u32 v12, s27, v12
    v_add_u32 v13, s27, v13
    v_mfma_f32_16x16x32_bf16 v[92:95], v[40:43], v[152:155], 0
    v_add_u32 v14, s27, v14
    v_add_u32 v15, s27, v15
    v_mfma_f32_16x16x32_bf16 v[92:95], v[44:47], v[156:159], v[92:95]
    s_waitcnt vmcnt(8) lgkmcnt(0)
    s_barrier
    s_add_u32 m0, s26, s30
    v_mfma_f32_16x16x32_bf16 v[96:99], v[48:51], v[128:131], 0
    ds_read_b128 v[160:163], v10 offset:0
    buffer_load_dwordx4 v8, s[12:15], s25 offen offset:0 lds
    v_mfma_f32_16x16x32_bf16 v[96:99], v[52:55], v[132:135], v[96:99]
    ds_read_b64_tr_b16 v[32:33], v12 offset:0
    v_mfma_f32_16x16x32_bf16 v[100:103], v[48:51], v[136:139], 0
    ds_read_b64_tr_b16 v[34:35], v12 offset:4096
    v_mfma_f32_16x16x32_bf16 v[100:103], v[52:55], v[140:143], v[100:103]
    ds_read_b128 v[164:167], v10 offset:1024
    v_mfma_f32_16x16x32_bf16 v[104:107], v[48:51], v[144:147], 0
    ds_read_b64_tr_b16 v[36:37], v12 offset:8192
    buffer_load_dwordx4 v9, s[12:15], s25 offen offset:1024 lds
    v_mfma_f32_16x16x32_bf16 v[104:107], v[52:55], v[148:151], v[104:107]
    ds_read_b64_tr_b16 v[38:39], v12 offset:12288
    v_mfma_f32_16x16x32_bf16 v[108:111], v[48:51], v[152:155], 0
    ds_read_b128 v[168:171], v10 offset:2048
    v_mfma_f32_16x16x32_bf16 v[108:111], v[52:55], v[156:159], v[108:111]
    ds_read_b128 v[172:175], v10 offset:3072
    v_mfma_f32_16x16x32_bf16 v[112:115], v[56:59], v[128:131], 0
    ds_read_b128 v[176:179], v10 offset:4096
    s_add_u32 m0, s26, s29
    v_mfma_f32_16x16x32_bf16 v[112:115], v[60:63], v[132:135], v[112:115]
    ds_read_b128 v[180:183], v10 offset:5120
    buffer_load_dwordx4 v4, s[8:11], s24 offen offset:0 sc1 lds
    v_mfma_f32_16x16x32_bf16 v[116:119], v[56:59], v[136:139], 0
    ds_read_b128 v[184:187], v10 offset:6144
    v_mfma_f32_16x16x32_bf16 v[116:119], v[60:63], v[140:143], v[116:119]
    ds_read_b128 v[188:191], v10 offset:7168
    v_mfma_f32_16x16x32_bf16 v[120:123], v[56:59], v[144:147], 0
    ds_read_b64_tr_b16 v[40:41], v13 offset:0
    v_mfma_f32_16x16x32_bf16 v[120:123], v[60:63], v[148:151], v[120:123]
    ds_read_b64_tr_b16 v[42:43], v13 offset:4096
    v_mfma_f32_16x16x32_bf16 v[124:127], v[56:59], v[152:155], 0
    ds_read_b64_tr_b16 v[44:45], v13 offset:8192
    buffer_load_dwordx4 v4, s[8:11], s24 offen offset:1024 sc1 lds
    v_mfma_f32_16x16x32_bf16 v[124:127], v[60:63], v[156:159], v[124:127]
    ds_read_b64_tr_b16 v[46:47], v13 offset:12288
    s_waitcnt lgkmcnt(13)
    v_mfma_f32_16x16x32_bf16 v[64:67], v[32:35], v[160:163], v[64:67]
    ds_read_b64_tr_b16 v[48:49], v14 offset:0
    s_waitcnt lgkmcnt(11)
    v_mfma_f32_16x16x32_bf16 v[64:67], v[36:39], v[164:167], v[64:67]
    ds_read_b64_tr_b16 v[50:51], v14 offset:4096
    s_waitcnt lgkmcnt(11)
    v_mfma_f32_16x16x32_bf16 v[68:71], v[32:35], v[168:171], v[68:71]
    ds_read_b64_tr_b16 v[52:53], v14 offset:8192
    s_waitcnt lgkmcnt(11)
    v_mfma_f32_16x16x32_bf16 v[68:71], v[36:39], v[172:175], v[68:71]
    ds_read_b64_tr_b16 v[54:55], v14 offset:12288
    s_waitcnt lgkmcnt(11)
    v_mfma_f32_16x16x32_bf16 v[72:75], v[32:35], v[176:179], v[72:75]
    ds_read_b64_tr_b16 v[56:57], v15 offset:0
    buffer_load_dwordx4 v4, s[8:11], s24 offen offset:2048 sc1 lds
    s_waitcnt lgkmcnt(11)
    v_mfma_f32_16x16x32_bf16 v[72:75], v[36:39], v[180:183], v[72:75]
    ds_read_b64_tr_b16 v[58:59], v15 offset:4096
    s_waitcnt lgkmcnt(11)
    v_mfma_f32_16x16x32_bf16 v[76:79], v[32:35], v[184:187], v[76:79]
    ds_read_b64_tr_b16 v[60:61], v15 offset:8192
    s_waitcnt lgkmcnt(11)
    v_mfma_f32_16x16x32_bf16 v[76:79], v[36:39], v[188:191], v[76:79]
    ds_read_b64_tr_b16 v[62:63], v15 offset:12288
    s_waitcnt lgkmcnt(10)
    v_mfma_f32_16x16x32_bf16 v[80:83], v[40:43], v[160:163], v[80:83]
    s_waitcnt lgkmcnt(8)
    v_mfma_f32_16x16x32_bf16 v[80:83], v[44:47], v[164:167], v[80:83]
    v_mfma_f32_16x16x32_bf16 v[84:87], v[40:43], v[168:171], v[84:87]
    buffer_load_dwordx4 v4, s[8:11], s24 offen offset:3072 sc1 lds
    v_mfma_f32_16x16x32_bf16 v[84:87], v[44:47], v[172:175], v[84:87]
    s_add_u32 s24, s24, 4096
    s_add_u32 s25, s25, s31
    v_mfma_f32_16x16x32_bf16 v[88:91], v[40:43], v[176:179], v[88:91]
    s_add_u32 s26, s26, 49152
    s_cmp_eq_u32 s26, 147456
    s_cselect_b32 s26, 0, s26
    s_cmp_eq_u32 s26, 98304
    s_cselect_b32 s27, s32, s33
    v_mfma_f32_16x16x32_bf16 v[88:91], v[44:47], v[180:183], v[88:91]
    v_add_u32 v10, s27, v10
    v_add_u32 v12, s27, v12
    v_add_u32 v13, s27, v13
    v_mfma_f32_16x16x32_bf16 v[92:95], v[40:43], v[184:187], v[92:95]
    v_add_u32 v14, s27, v14
    v_add_u32 v15, s27, v15
    v_mfma_f32_16x16x32_bf16 v[92:95], v[44:47], v[188:191], v[92:95]
    s_waitcnt vmcnt(6) lgkmcnt(0)
    s_barrier
    s_add_u32 m0, s26, s30
    v_mfma_f32_16x16x32_bf16 v[96:99], v[48:51], v[160:163], v[96:99]
    ds_read_b128 v[128:131], v10 offset:0
    buffer_load_dwordx4 v8, s[12:15], s25 offen offset:0 lds
    v_mfma_f32_16x16x32_bf16 v[96:99], v[52:55], v[164:167], v[96:99]
    ds_read_b64_tr_b16 v[32:33], v12 offset:0
    v_mfma_f32_16x16x32_bf16 v[100:103], v[48:51], v[168:171], v[100:103]
    ds_read_b64_tr_b16 v[34:35], v12 offset:4096
    v_mfma_f32_16x16x32_bf16 v[100:103], v[52:55], v[172:175], v[100:103]
    ds_read_b128 v[132:135], v10 offset:1024
    v_mfma_f32_16x16x32_bf16 v[104:107], v[48:51], v[176:179], v[104:107]
    ds_read_b64_tr_b16 v[36:37], v12 offset:8192
    buffer_load_dwordx4 v9, s[12:15], s25 offen offset:1024 lds
    v_mfma_f32_16x16x32_bf16 v[104:107], v[52:55], v[180:183], v[104:107]
    ds_read_b64_tr_b16 v[38:39], v12 offset:12288
    v_mfma_f32_16x16x32_bf16 v[108:111], v[48:51], v[184:187], v[108:111]
    ds_read_b128 v[136:139], v10 offset:2048
    v_mfma_f32_16x16x32_bf16 v[108:111], v[52:55], v[188:191], v[108:111]
    ds_read_b128 v[140:143], v10 offset:3072
    v_mfma_f32_16x16x32_bf16 v[112:115], v[56:59], v[160:163], v[112:115]
    ds_read_b128 v[144:147], v10 offset:4096
    s_add_u32 m0, s26, s29
    v_mfma_f32_16x16x32_bf16 v[112:115], v[60:63], v[164:167], v[112:115]
    ds_read_b128 v[148:151], v10 offset:5120
    buffer_load_dwordx4 v4, s[8:11], s24 offen offset:0 sc1 lds
    v_mfma_f32_16x16x32_bf16 v[116:119], v[56:59], v[168:171], v[116:119]
    ds_read_b128 v[152:155], v10 offset:6144
    v_mfma_f32_16x16x32_bf16 v[116:119], v[60:63], v[172:175], v[116:119]
    ds_read_b128 v[156:159], v10 offset:7168
    v_mfma_f32_16x16x32_bf16 v[120:123], v[56:59], v[176:179], v[120:123]
    ds_read_b64_tr_b16 v[40:41], v13 offset:0
    v_mfma_f32_16x16x32_bf16 v[120:123], v[60:63], v[180:183], v[120:123]
    ds_read_b64_tr_b16 v[42:43], v13 offset:4096
    v_mfma_f32_16x16x32_bf16 v[124:127], v[56:59], v[184:187], v[124:127]
    ds_read_b64_tr_b16 v[44:45], v13 offset:8192
    buffer_load_dwordx4 v4, s[8:11], s24 offen offset:1024 sc1 lds
    v_mfma_f32_16x16x32_bf16 v[124:127], v[60:63], v[188:191], v[124:127]
    ds_read_b64_tr_b16 v[46:47], v13 offset:12288
    s_waitcnt lgkmcnt(13)
    v_mfma_f32_16x16x32_bf16 v[64:67], v[32:35], v[128:131], v[64:67]
    ds_read_b64_tr_b16 v[48:49], v14 offset:0
    s_waitcnt lgkmcnt(11)
    v_mfma_f32_16x16x32_bf16 v[64:67], v[36:39], v[132:135], v[64:67]
    ds_read_b64_tr_b16 v[50:51], v14 offset:4096
    s_waitcnt lgkmcnt(11)
    v_mfma_f32_16x16x32_bf16 v[68:71], v[32:35], v[136:139], v[68:71]
    ds_read_b64_tr_b16 v[52:53], v14 offset:8192
    s_waitcnt lgkmcnt(11)
    v_mfma_f32_16x16x32_bf16 v[68:71], v[36:39], v[140:143], v[68:71]
    ds_read_b64_tr_b16 v[54:55], v14 offset:12288
    s_waitcnt lgkmcnt(11)
    v_mfma_f32_16x16x32_bf16 v[72:75], v[32:35], v[144:147], v[72:75]
    ds_read_b64_tr_b16 v[56:57], v15 offset:0
    buffer_load_dwordx4 v4, s[8:11], s24 offen offset:2048 sc1 lds
    s_waitcnt lgkmcnt(11)
    v_mfma_f32_16x16x32_bf16 v[72:75], v[36:39], v[148:151], v[72:75]
    ds_read_b64_tr_b16 v[58:59], v15 offset:4096
    s_waitcnt lgkmcnt(11)
    v_mfma_f32_16x16x32_bf16 v[76:79], v[32:35], v[152:155], v[76:79]
    ds_read_b64_tr_b16 v[60:61], v15 offset:8192
    s_waitcnt lgkmcnt(11)
    v_mfma_f32_16x16x32_bf16 v[76:79], v[36:39], v[156:159], v[76:79]
    ds_read_b64_tr_b16 v[62:63], v15 offset:12288
    s_waitcnt lgkmcnt(10)
    v_mfma_f32_16x16x32_bf16 v[80:83], v[40:43], v[128:131], v[80:83]
    s_waitcnt lgkmcnt(8)
    v_mfma_f32_16x16x32_bf16 v[80:83], v[44:47], v[132:135], v[80:83]
    v_mfma_f32_16x16x32_bf16 v[84:87], v[40:43], v[136:139], v[84:87]
    buffer_load_dwordx4 v4, s[8:11], s24 offen offset:3072 sc1 lds
    v_mfma_f32_16x16x32_bf16 v[84:87], v[44:47], v[140:143], v[84:87]
    s_add_u32 s24, s24, 4096
    s_add_u32 s25, s25, s31
    v_mfma_f32_16x16x32_bf16 v[88:91], v[40:43], v[144:147], v[88:91]
    s_add_u32 s26, s26, 49152
    s_cmp_eq_u32 s26, 147456
    s_cselect_b32 s26, 0, s26
    s_cmp_eq_u32 s26, 98304
    s_cselect_b32 s27, s32, s33
    v_mfma_f32_16x16x32_bf16 v[88:91], v[44:47], v[148:151], v[88:91]
    v_add_u32 v10, s27, v10
    v_add_u32 v12, s27, v12
    v_add_u32 v13, s27, v13
    v_mfma_f32_16x16x32_bf16 v[92:95], v[40:43], v[152:155], v[92:95]
    v_add_u32 v14, s27, v14
    v_add_u32 v15, s27, v15
    v_mfma_f32_16x16x32_bf16 v[92:95], v[44:47], v[156:159], v[92:95]
    s_waitcnt vmcnt(6) lgkmcnt(0)
    s_barrier
    s_add_u32 m0, s26, s30
    v_mfma_f32_16x16x32_bf16 v[96:99], v[48:51], v[128:131], v[96:99]
    ds_read_b128 v[160:163], v10 offset:0
    buffer_load_dwordx4 v8, s[12:15], s25 offen offset:0 lds
    v_mfma_f32_16x16x32_bf16 v[96:99], v[52:55], v[132:135], v[96:99]
    ds_read_b64_tr_b16 v[32:33], v12 offset:0
    buffer_load_dwordx4 v9, s[12:15], s25 offen offset:1024 lds
    v_mfma_f32_16x16x32_bf16 v[100:103], v[48:51], v[136:139], v[100:103]
    ds_read_b64_tr_b16 v[34:35], v12 offset:4096
    v_mfma_f32_16x16x32_bf16 v[100:103], v[52:55], v[140:143], v[100:103]
    ds_read_b128 v[164:167], v10 offset:1024
    s_add_u32 m0, s26, s29
    v_mfma_f32_16x16x32_bf16 v[104:107], v[48:51], v[144:147], v[104:107]
    ds_read_b64_tr_b16 v[36:37], v12 offset:8192
    buffer_load_dwordx4 v4, s[8:11], s24 offen offset:0 sc1 lds
    v_mfma_f32_16x16x32_bf16 v[104:107], v[52:55], v[148:151], v[104:107]
    ds_read_b64_tr_b16 v[38:39], v12 offset:12288
    buffer_load_dwordx4 v4, s[8:11], s24 offen offset:1024 sc1 lds
    v_mfma_f32_16x16x32_bf16 v[108:111], v[48:51], v[152:155], v[108:111]
    ds_read_b128 v[168:171], v10 offset:2048
    buffer_load_dwordx4 v4, s[8:11], s24 offen offset:2048 sc1 lds
    v_mfma_f32_16x16x32_bf16 v[108:111], v[52:55], v[156:159], v[108:111]
    ds_read_b128 v[172:175], v10 offset:3072
    v_mfma_f32_16x16x32_bf16 v[112:115], v[56:59], v[128:131], v[112:115]
    ds_read_b128 v[176:179], v10 offset:4096
    buffer_load_dwordx4 v4, s[8:11], s24 offen offset:3072 sc1 lds
    v_mfma_f32_16x16x32_bf16 v[112:115], v[60:63], v[132:135], v[112:115]
    ds_read_b128 v[180:183], v10 offset:5120
    s_add_u32 s24, s24, 4096
    s_add_u32 s25, s25, s31
    v_mfma_f32_16x16x32_bf16 v[116:119], v[56:59], v[136:139], v[116:119]
    ds_read_b128 v[184:187], v10 offset:6144
    v_mfma_f32_16x16x32_bf16 v[116:119], v[60:63], v[140:143], v[116:119]
    ds_read_b128 v[188:191], v10 offset:7168
    v_mfma_f32_16x16x32_bf16 v[120:123], v[56:59], v[144:147], v[120:123]
    ds_read_b64_tr_b16 v[40:41], v13 offset:0
    v_mfma_f32_16x16x32_bf16 v[120:123], v[60:63], v[148:151], v[120:123]
    ds_read_b64_tr_b16 v[42:43], v13 offset:4096
    v_mfma_f32_16x16x32_bf16 v[124:127], v[56:59], v[152:155], v[124:127]
    ds_read_b64_tr_b16 v[44:45], v13 offset:8192
    v_mfma_f32_16x16x32_bf16 v[124:127], v[60:63], v[156:159], v[124:127]
    ds_read_b64_tr_b16 v[46:47], v13 offset:12288
    s_waitcnt lgkmcnt(13)
    v_mfma_f32_16x16x32_bf16 v[64:67], v[32:35], v[160:163], v[64:67]
    ds_read_b64_tr_b16 v[48:49], v14 offset:0
    s_waitcnt lgkmcnt(11)
    v_mfma_f32_16x16x32_bf16 v[64:67], v[36:39], v[164:167], v[64:67]
    ds_read_b64_tr_b16 v[50:51], v14 offset:4096
    s_waitcnt lgkmcnt(11)
    v_mfma_f32_16x16x32_bf16 v[68:71], v[32:35], v[168:171], v[68:71]
    ds_read_b64_tr_b16 v[52:53], v14 offset:8192
    s_waitcnt lgkmcnt(11)
    v_mfma_f32_16x16x32_bf16 v[68:71], v[36:39], v[172:175], v[68:71]
    ds_read_b64_tr_b16 v[54:55], v14 offset:12288
    s_waitcnt lgkmcnt(11)
    v_mfma_f32_16x16x32_bf16 v[72:75], v[32:35], v[176:179], v[72:75]
    ds_read_b64_tr_b16 v[56:57], v15 offset:0
    s_waitcnt lgkmcnt(11)
    v_mfma_f32_16x16x32_bf16 v[72:75], v[36:39], v[180:183], v[72:75]
    ds_read_b64_tr_b16 v[58:59], v15 offset:4096
    s_waitcnt lgkmcnt(11)
    v_mfma_f32_16x16x32_bf16 v[76:79], v[32:35], v[184:187], v[76:79]
    ds_read_b64_tr_b16 v[60:61], v15 offset:8192
    s_waitcnt lgkmcnt(11)
    v_mfma_f32_16x16x32_bf16 v[76:79], v[36:39], v[188:191], v[76:79]
    ds_read_b64_tr_b16 v[62:63], v15 offset:12288
    s_waitcnt lgkmcnt(10)
    v_mfma_f32_16x16x32_bf16 v[80:83], v[40:43], v[160:163], v[80:83]
    s_waitcnt lgkmcnt(8)
    v_mfma_f32_16x16x32_bf16 v[80:83], v[44:47], v[164:167], v[80:83]
    v_mfma_f32_16x16x32_bf16 v[84:87], v[40:43], v[168:171], v[84:87]
    v_mfma_f32_16x16x32_bf16 v[84:87], v[44:47], v[172:175], v[84:87]
    v_mfma_f32_16x16x32_bf16 v[88:91], v[40:43], v[176:179], v[88:91]
    s_add_u32 s26, s26, 49152
    s_cmp_eq_u32 s26, 147456
    s_cselect_b32 s26, 0, s26
    s_cmp_eq_u32 s26, 98304
    s_cselect_b32 s27, s32, s33
    v_mfma_f32_16x16x32_bf16 v[88:91], v[44:47], v[180:183], v[88:91]
    v_add_u32 v10, s27, v10
    v_add_u32 v12, s27, v12
    v_add_u32 v13, s27, v13
    v_mfma_f32_16x16x32_bf16 v[92:95], v[40:43], v[184:187], v[92:95]
    v_add_u32 v14, s27, v14
    v_add_u32 v15, s27, v15
    v_mfma_f32_16x16x32_bf16 v[92:95], v[44:47], v[188:191], v[92:95]
    s_waitcnt vmcnt(0) lgkmcnt(0)
    s_barrier
    s_cmp_lg_u32 s20, 0
    s_cbranch_scc1 L_nfo_6033
    s_add_u32 s48, s37, 32
    s_lshl_b32 s48, s48, 8
    s_add_u32 s48, s48, 42860544
    v_mov_b32 v30, 0
    v_mov_b32 v31, 1
    s_mov_b64 exec, 1
    buffer_atomic_add v31, v30, s[16:19], s48 offen
    s_mov_b64 exec, -1
L_nfo_6033:
    s_mov_b32 s28, 4
.p2align 6
L_loopk3S_6034:
    s_add_u32 m0, s26, s30
    v_mfma_f32_16x16x32_bf16 v[96:99], v[48:51], v[160:163], v[96:99]
    ds_read_b128 v[128:131], v10 offset:0
    buffer_load_dwordx4 v8, s[12:15], s25 offen offset:0 lds
    v_mfma_f32_16x16x32_bf16 v[96:99], v[52:55], v[164:167], v[96:99]
    ds_read_b64_tr_b16 v[32:33], v12 offset:0
    v_mfma_f32_16x16x32_bf16 v[100:103], v[48:51], v[168:171], v[100:103]
    ds_read_b64_tr_b16 v[34:35], v12 offset:4096
    v_mfma_f32_16x16x32_bf16 v[100:103], v[52:55], v[172:175], v[100:103]
    ds_read_b128 v[132:135], v10 offset:1024
    v_mfma_f32_16x16x32_bf16 v[104:107], v[48:51], v[176:179], v[104:107]
    ds_read_b64_tr_b16 v[36:37], v12 offset:8192
    buffer_load_dwordx4 v9, s[12:15], s25 offen offset:1024 lds
    v_mfma_f32_16x16x32_bf16 v[104:107], v[52:55], v[180:183], v[104:107]
    ds_read_b64_tr_b16 v[38:39], v12 offset:12288
    v_mfma_f32_16x16x32_bf16 v[108:111], v[48:51], v[184:187], v[108:111]
    ds_read_b128 v[136:139], v10 offset:2048
    v_mfma_f32_16x16x32_bf16 v[108:111], v[52:55], v[188:191], v[108:111]
    ds_read_b128 v[140:143], v10 offset:3072
    v_mfma_f32_16x16x32_bf16 v[112:115], v[56:59], v[160:163], v[112:115]
    ds_read_b128 v[144:147], v10 offset:4096
    s_add_u32 m0, s26, s29
    v_mfma_f32_16x16x32_bf16 v[112:115], v[60:63], v[164:167], v[112:115]
    ds_read_b128 v[148:151], v10 offset:5120
    buffer_load_dwordx4 v4, s[8:11], s24 offen offset:0 sc1 lds
    v_mfma_f32_16x16x32_bf16 v[116:119], v[56:59], v[168:171], v[116:119]
    ds_read_b128 v[152:155], v10 offset:6144
    v_mfma_f32_16x16x32_bf16 v[116:119], v[60:63], v[172:175], v[116:119]
    ds_read_b128 v[156:159], v10 offset:7168
    v_mfma_f32_16x16x32_bf16 v[120:123], v[56:59], v[176:179], v[120:123]
    ds_read_b64_tr_b16 v[40:41], v13 offset:0
    v_mfma_f32_16x16x32_bf16 v[120:123], v[60:63], v[180:183], v[120:123]
    ds_read_b64_tr_b16 v[42:43], v13 offset:4096
    v_mfma_f32_16x16x32_bf16 v[124:127], v[56:59], v[184:187], v[124:127]
    ds_read_b64_tr_b16 v[44:45], v13 offset:8192
    buffer_load_dwordx4 v4, s[8:11], s24 offen offset:1024 sc1 lds
    v_mfma_f32_16x16x32_bf16 v[124:127], v[60:63], v[188:191], v[124:127]
    ds_read_b64_tr_b16 v[46:47], v13 offset:12288
    s_waitcnt lgkmcnt(13)
    v_mfma_f32_16x16x32_bf16 v[64:67], v[32:35], v[128:131], v[64:67]
    ds_read_b64_tr_b16 v[48:49], v14 offset:0
    s_waitcnt lgkmcnt(11)
    v_mfma_f32_16x16x32_bf16 v[64:67], v[36:39], v[132:135], v[64:67]
    ds_read_b64_tr_b16 v[50:51], v14 offset:4096
    s_waitcnt lgkmcnt(11)
    v_mfma_f32_16x16x32_bf16 v[68:71], v[32:35], v[136:139], v[68:71]
    ds_read_b64_tr_b16 v[52:53], v14 offset:8192
    s_waitcnt lgkmcnt(11)
    v_mfma_f32_16x16x32_bf16 v[68:71], v[36:39], v[140:143], v[68:71]
    ds_read_b64_tr_b16 v[54:55], v14 offset:12288
    s_waitcnt lgkmcnt(11)
    v_mfma_f32_16x16x32_bf16 v[72:75], v[32:35], v[144:147], v[72:75]
    ds_read_b64_tr_b16 v[56:57], v15 offset:0
    buffer_load_dwordx4 v4, s[8:11], s24 offen offset:2048 sc1 lds
    s_waitcnt lgkmcnt(11)
    v_mfma_f32_16x16x32_bf16 v[72:75], v[36:39], v[148:151], v[72:75]
    ds_read_b64_tr_b16 v[58:59], v15 offset:4096
    s_waitcnt lgkmcnt(11)
    v_mfma_f32_16x16x32_bf16 v[76:79], v[32:35], v[152:155], v[76:79]
    ds_read_b64_tr_b16 v[60:61], v15 offset:8192
    s_waitcnt lgkmcnt(11)
    v_mfma_f32_16x16x32_bf16 v[76:79], v[36:39], v[156:159], v[76:79]
    ds_read_b64_tr_b16 v[62:63], v15 offset:12288
    s_waitcnt lgkmcnt(10)
    v_mfma_f32_16x16x32_bf16 v[80:83], v[40:43], v[128:131], v[80:83]
    s_waitcnt lgkmcnt(8)
    v_mfma_f32_16x16x32_bf16 v[80:83], v[44:47], v[132:135], v[80:83]
    v_mfma_f32_16x16x32_bf16 v[84:87], v[40:43], v[136:139], v[84:87]
    buffer_load_dwordx4 v4, s[8:11], s24 offen offset:3072 sc1 lds
    v_mfma_f32_16x16x32_bf16 v[84:87], v[44:47], v[140:143], v[84:87]
    s_add_u32 s24, s24, 4096
    s_add_u32 s25, s25, s31
    v_mfma_f32_16x16x32_bf16 v[88:91], v[40:43], v[144:147], v[88:91]
    s_add_u32 s26, s26, 49152
    s_cmp_eq_u32 s26, 147456
    s_cselect_b32 s26, 0, s26
    s_cmp_eq_u32 s26, 98304
    s_cselect_b32 s27, s32, s33
    v_mfma_f32_16x16x32_bf16 v[88:91], v[44:47], v[148:151], v[88:91]
    v_add_u32 v10, s27, v10
    v_add_u32 v12, s27, v12
    v_add_u32 v13, s27, v13
    v_mfma_f32_16x16x32_bf16 v[92:95], v[40:43], v[152:155], v[92:95]
    v_add_u32 v14, s27, v14
    v_add_u32 v15, s27, v15
    v_mfma_f32_16x16x32_bf16 v[92:95], v[44:47], v[156:159], v[92:95]
    s_waitcnt vmcnt(6) lgkmcnt(0)
    s_barrier
    s_add_u32 m0, s26, s30
    v_mfma_f32_16x16x32_bf16 v[96:99], v[48:51], v[128:131], v[96:99]
    ds_read_b128 v[160:163], v10 offset:0
    buffer_load_dwordx4 v8, s[12:15], s25 offen offset:0 lds
    v_mfma_f32_16x16x32_bf16 v[96:99], v[52:55], v[132:135], v[96:99]
    ds_read_b64_tr_b16 v[32:33], v12 offset:0
    v_mfma_f32_16x16x32_bf16 v[100:103], v[48:51], v[136:139], v[100:103]
    ds_read_b64_tr_b16 v[34:35], v12 offset:4096
    v_mfma_f32_16x16x32_bf16 v[100:103], v[52:55], v[140:143], v[100:103]
    ds_read_b128 v[164:167], v10 offset:1024
    v_mfma_f32_16x16x32_bf16 v[104:107], v[48:51], v[144:147], v[104:107]
    ds_read_b64_tr_b16 v[36:37], v12 offset:8192
    buffer_load_dwordx4 v9, s[12:15], s25 offen offset:1024 lds
    v_mfma_f32_16x16x32_bf16 v[104:107], v[52:55], v[148:151], v[104:107]
    ds_read_b64_tr_b16 v[38:39], v12 offset:12288
    v_mfma_f32_16x16x32_bf16 v[108:111], v[48:51], v[152:155], v[108:111]
    ds_read_b128 v[168:171], v10 offset:2048
    v_mfma_f32_16x16x32_bf16 v[108:111], v[52:55], v[156:159], v[108:111]
    ds_read_b128 v[172:175], v10 offset:3072
    v_mfma_f32_16x16x32_bf16 v[112:115], v[56:59], v[128:131], v[112:115]
    ds_read_b128 v[176:179], v10 offset:4096
    s_add_u32 m0, s26, s29
    v_mfma_f32_16x16x32_bf16 v[112:115], v[60:63], v[132:135], v[112:115]
    ds_read_b128 v[180:183], v10 offset:5120
    buffer_load_dwordx4 v4, s[8:11], s24 offen offset:0 sc1 lds
    v_mfma_f32_16x16x32_bf16 v[116:119], v[56:59], v[136:139], v[116:119]
    ds_read_b128 v[184:187], v10 offset:6144
    v_mfma_f32_16x16x32_bf16 v[116:119], v[60:63], v[140:143], v[116:119]
    ds_read_b128 v[188:191], v10 offset:7168
    v_mfma_f32_16x16x32_bf16 v[120:123], v[56:59], v[144:147], v[120:123]
    ds_read_b64_tr_b16 v[40:41], v13 offset:0
    v_mfma_f32_16x16x32_bf16 v[120:123], v[60:63], v[148:151], v[120:123]
    ds_read_b64_tr_b16 v[42:43], v13 offset:4096
    v_mfma_f32_16x16x32_bf16 v[124:127], v[56:59], v[152:155], v[124:127]
    ds_read_b64_tr_b16 v[44:45], v13 offset:8192
    buffer_load_dwordx4 v4, s[8:11], s24 offen offset:1024 sc1 lds
    v_mfma_f32_16x16x32_bf16 v[124:127], v[60:63], v[156:159], v[124:127]
    ds_read_b64_tr_b16 v[46:47], v13 offset:12288
    s_waitcnt lgkmcnt(13)
    v_mfma_f32_16x16x32_bf16 v[64:67], v[32:35], v[160:163], v[64:67]
    ds_read_b64_tr_b16 v[48:49], v14 offset:0
    s_waitcnt lgkmcnt(11)
    v_mfma_f32_16x16x32_bf16 v[64:67], v[36:39], v[164:167], v[64:67]
    ds_read_b64_tr_b16 v[50:51], v14 offset:4096
    s_waitcnt lgkmcnt(11)
    v_mfma_f32_16x16x32_bf16 v[68:71], v[32:35], v[168:171], v[68:71]
    ds_read_b64_tr_b16 v[52:53], v14 offset:8192
    s_waitcnt lgkmcnt(11)
    v_mfma_f32_16x16x32_bf16 v[68:71], v[36:39], v[172:175], v[68:71]
    ds_read_b64_tr_b16 v[54:55], v14 offset:12288
    s_waitcnt lgkmcnt(11)
    v_mfma_f32_16x16x32_bf16 v[72:75], v[32:35], v[176:179], v[72:75]
    ds_read_b64_tr_b16 v[56:57], v15 offset:0
    buffer_load_dwordx4 v4, s[8:11], s24 offen offset:2048 sc1 lds
    s_waitcnt lgkmcnt(11)
    v_mfma_f32_16x16x32_bf16 v[72:75], v[36:39], v[180:183], v[72:75]
    ds_read_b64_tr_b16 v[58:59], v15 offset:4096
    s_waitcnt lgkmcnt(11)
    v_mfma_f32_16x16x32_bf16 v[76:79], v[32:35], v[184:187], v[76:79]
    ds_read_b64_tr_b16 v[60:61], v15 offset:8192
    s_waitcnt lgkmcnt(11)
    v_mfma_f32_16x16x32_bf16 v[76:79], v[36:39], v[188:191], v[76:79]
    ds_read_b64_tr_b16 v[62:63], v15 offset:12288
    s_waitcnt lgkmcnt(10)
    v_mfma_f32_16x16x32_bf16 v[80:83], v[40:43], v[160:163], v[80:83]
    s_waitcnt lgkmcnt(8)
    v_mfma_f32_16x16x32_bf16 v[80:83], v[44:47], v[164:167], v[80:83]
    v_mfma_f32_16x16x32_bf16 v[84:87], v[40:43], v[168:171], v[84:87]
    buffer_load_dwordx4 v4, s[8:11], s24 offen offset:3072 sc1 lds
    v_mfma_f32_16x16x32_bf16 v[84:87], v[44:47], v[172:175], v[84:87]
    s_add_u32 s24, s24, 4096
    s_add_u32 s25, s25, s31
    v_mfma_f32_16x16x32_bf16 v[88:91], v[40:43], v[176:179], v[88:91]
    s_add_u32 s26, s26, 49152
    s_cmp_eq_u32 s26, 147456
    s_cselect_b32 s26, 0, s26
    s_cmp_eq_u32 s26, 98304
    s_cselect_b32 s27, s32, s33
    v_mfma_f32_16x16x32_bf16 v[88:91], v[44:47], v[180:183], v[88:91]
    v_add_u32 v10, s27, v10
    v_add_u32 v12, s27, v12
    v_add_u32 v13, s27, v13
    v_mfma_f32_16x16x32_bf16 v[92:95], v[40:43], v[184:187], v[92:95]
    v_add_u32 v14, s27, v14
    v_add_u32 v15, s27, v15
    s_sub_u32 s28, s28, 1
    s_cmp_lg_u32 s28, 0
    v_mfma_f32_16x16x32_bf16 v[92:95], v[44:47], v[188:191], v[92:95]
    s_waitcnt vmcnt(6) lgkmcnt(0)
    s_barrier
    s_cbranch_scc1 L_loopk3S_6034
    s_add_u32 m0, s26, s30
    v_mfma_f32_16x16x32_bf16 v[96:99], v[48:51], v[160:163], v[96:99]
    ds_read_b128 v[128:131], v10 offset:0
    buffer_load_dwordx4 v8, s[12:15], s25 offen offset:0 lds
    s_lshl_b32 s48, s21, 1
    v_mfma_f32_16x16x32_bf16 v[96:99], v[52:55], v[164:167], v[96:99]
    ds_read_b64_tr_b16 v[32:33], v12 offset:0
    s_add_u32 s48, s48, s46
    v_mfma_f32_16x16x32_bf16 v[100:103], v[48:51], v[168:171], v[100:103]
    ds_read_b64_tr_b16 v[34:35], v12 offset:4096
    s_mul_i32 s48, s48, 229376
    v_mfma_f32_16x16x32_bf16 v[100:103], v[52:55], v[172:175], v[100:103]
    ds_read_b128 v[132:135], v10 offset:1024
    v_mfma_f32_16x16x32_bf16 v[104:107], v[48:51], v[176:179], v[104:107]
    ds_read_b64_tr_b16 v[36:37], v12 offset:8192
    buffer_load_dwordx4 v9, s[12:15], s25 offen offset:1024 lds
    s_lshl_b32 s49, s44, 1
    v_mfma_f32_16x16x32_bf16 v[104:107], v[52:55], v[180:183], v[104:107]
    ds_read_b64_tr_b16 v[38:39], v12 offset:12288
    s_add_u32 s49, s49, s22
    v_mfma_f32_16x16x32_bf16 v[108:111], v[48:51], v[184:187], v[108:111]
    ds_read_b128 v[136:139], v10 offset:2048
    s_lshl_b32 s49, s49, 12
    v_mfma_f32_16x16x32_bf16 v[108:111], v[52:55], v[188:191], v[108:111]
    ds_read_b128 v[140:143], v10 offset:3072
    v_mfma_f32_16x16x32_bf16 v[112:115], v[56:59], v[160:163], v[112:115]
    ds_read_b128 v[144:147], v10 offset:4096
    s_add_u32 m0, s26, s29
    s_add_u32 s48, s48, s49
    v_mfma_f32_16x16x32_bf16 v[112:115], v[60:63], v[164:167], v[112:115]
    ds_read_b128 v[148:151], v10 offset:5120
    buffer_load_dwordx4 v4, s[8:11], s24 offen offset:0 sc1 lds
    s_add_u32 s48, s48, 25165824
    v_mfma_f32_16x16x32_bf16 v[116:119], v[56:59], v[168:171], v[116:119]
    ds_read_b128 v[152:155], v10 offset:6144
    v_lshlrev_b32 v28, 4, v1
    v_mfma_f32_16x16x32_bf16 v[116:119], v[60:63], v[172:175], v[116:119]
    ds_read_b128 v[156:159], v10 offset:7168
    v_mfma_f32_16x16x32_bf16 v[120:123], v[56:59], v[176:179], v[120:123]
    ds_read_b64_tr_b16 v[40:41], v13 offset:0
    v_add_u32 v29, 2048, v28
    v_mfma_f32_16x16x32_bf16 v[120:123], v[60:63], v[180:183], v[120:123]
    ds_read_b64_tr_b16 v[42:43], v13 offset:4096
    v_add_u32 v30, 229376, v28
    v_mfma_f32_16x16x32_bf16 v[124:127], v[56:59], v[184:187], v[124:127]
    ds_read_b64_tr_b16 v[44:45], v13 offset:8192
    buffer_load_dwordx4 v4, s[8:11], s24 offen offset:1024 sc1 lds
    v_add_u32 v31, 229376, v29
    v_mfma_f32_16x16x32_bf16 v[124:127], v[60:63], v[188:191], v[124:127]
    ds_read_b64_tr_b16 v[46:47], v13 offset:12288
    s_waitcnt lgkmcnt(13)
    v_mfma_f32_16x16x32_bf16 v[64:67], v[32:35], v[128:131], v[64:67]
    ds_read_b64_tr_b16 v[48:49], v14 offset:0
    s_lshl_b32 s51, s42, 8
    s_lshl_b32 s52, s21, 6
    s_add_u32 s51, s51, s52
    s_lshl_b32 s51, s51, 3
    s_add_u32 s53, s51, 42041344
    s_add_u32 s51, s51, 42336260
    s_waitcnt lgkmcnt(11)
    v_mfma_f32_16x16x32_bf16 v[64:67], v[36:39], v[132:135], v[64:67]
    ds_read_b64_tr_b16 v[50:51], v14 offset:4096
    v_lshlrev_b32 v19, 3, v2
    s_waitcnt lgkmcnt(11)
    v_mfma_f32_16x16x32_bf16 v[68:71], v[32:35], v[136:139], v[68:71]
    ds_read_b64_tr_b16 v[52:53], v14 offset:8192
    buffer_load_dword v220, v19, s[16:19], s51 offen offset:0 sc1
    s_waitcnt lgkmcnt(11)
    v_mfma_f32_16x16x32_bf16 v[68:71], v[36:39], v[140:143], v[68:71]
    ds_read_b64_tr_b16 v[54:55], v14 offset:12288
    s_waitcnt lgkmcnt(11)
    v_mfma_f32_16x16x32_bf16 v[72:75], v[32:35], v[144:147], v[72:75]
    ds_read_b64_tr_b16 v[56:57], v15 offset:0
    buffer_load_dwordx4 v4, s[8:11], s24 offen offset:2048 sc1 lds
    buffer_load_dword v221, v19, s[16:19], s51 offen offset:128 sc1
    s_waitcnt lgkmcnt(11)
    v_mfma_f32_16x16x32_bf16 v[72:75], v[36:39], v[148:151], v[72:75]
    ds_read_b64_tr_b16 v[58:59], v15 offset:4096
    buffer_load_dword v222, v19, s[16:19], s51 offen offset:256 sc1
    s_waitcnt lgkmcnt(11)
    v_mfma_f32_16x16x32_bf16 v[76:79], v[32:35], v[152:155], v[76:79]
    ds_read_b64_tr_b16 v[60:61], v15 offset:8192
    buffer_load_dword v223, v19, s[16:19], s51 offen offset:384 sc1
    s_waitcnt lgkmcnt(11)
    v_mfma_f32_16x16x32_bf16 v[76:79], v[36:39], v[156:159], v[76:79]
    ds_read_b64_tr_b16 v[62:63], v15 offset:12288
    s_waitcnt lgkmcnt(10)
    v_mfma_f32_16x16x32_bf16 v[80:83], v[40:43], v[128:131], v[80:83]
    s_lshl_b32 s54, s44, 9
    s_lshl_b32 s52, s22, 8
    s_add_u32 s54, s54, s52
    s_add_u32 s54, s54, 42008576
    s_waitcnt lgkmcnt(8)
    v_mfma_f32_16x16x32_bf16 v[80:83], v[44:47], v[132:135], v[80:83]
    v_lshlrev_b32 v18, 4, v3
    v_mfma_f32_16x16x32_bf16 v[84:87], v[40:43], v[136:139], v[84:87]
    buffer_load_dwordx4 v4, s[8:11], s24 offen offset:3072 sc1 lds
    v_mfma_f32_16x16x32_bf16 v[84:87], v[44:47], v[140:143], v[84:87]
    s_add_u32 s24, s24, 4096
    s_add_u32 s25, s25, s31
    v_mfma_f32_16x16x32_bf16 v[88:91], v[40:43], v[144:147], v[88:91]
    s_add_u32 s26, s26, 49152
    s_cmp_eq_u32 s26, 147456
    s_cselect_b32 s26, 0, s26
    s_cmp_eq_u32 s26, 98304
    s_cselect_b32 s27, s32, s33
    v_mfma_f32_16x16x32_bf16 v[88:91], v[44:47], v[148:151], v[88:91]
    v_add_u32 v10, s27, v10
    v_add_u32 v12, s27, v12
    v_add_u32 v13, s27, v13
    v_mfma_f32_16x16x32_bf16 v[92:95], v[40:43], v[152:155], v[92:95]
    v_add_u32 v14, s27, v14
    v_add_u32 v15, s27, v15
    v_mfma_f32_16x16x32_bf16 v[92:95], v[44:47], v[156:159], v[92:95]
    s_lshr_b32 s38, s40, 1
    s_lshl_b32 s38, s38, 1
    s_bfe_u32 s50, s41, 0x10001
    s_add_u32 s38, s38, s50
    s_add_u32 s38, s38, 32
    s_lshl_b32 s38, s38, 8
    s_add_u32 s38, s38, 42860544
    s_mov_b32 s34, 42872832
    v_mov_b32 v24, 0
    s_cmp_lg_u32 s20, 0
    s_cbranch_scc1 L_np3_6035
    buffer_load_dword v25, v24, s[16:19], s38 offen sc1
    buffer_load_dword v26, v24, s[16:19], s34 offen sc1
L_np3_6035:
    s_waitcnt vmcnt(10) lgkmcnt(0)
    s_barrier
    s_add_u32 m0, s26, s30
    v_mfma_f32_16x16x32_bf16 v[96:99], v[48:51], v[128:131], v[96:99]
    ds_read_b128 v[160:163], v10 offset:0
    buffer_load_dwordx4 v8, s[12:15], s25 offen offset:0 lds
    v_mfma_f32_16x16x32_bf16 v[96:99], v[52:55], v[132:135], v[96:99]
    ds_read_b64_tr_b16 v[32:33], v12 offset:0
    v_mfma_f32_16x16x32_bf16 v[100:103], v[48:51], v[136:139], v[100:103]
    ds_read_b64_tr_b16 v[34:35], v12 offset:4096
    v_mfma_f32_16x16x32_bf16 v[100:103], v[52:55], v[140:143], v[100:103]
    ds_read_b128 v[164:167], v10 offset:1024
    v_mfma_f32_16x16x32_bf16 v[104:107], v[48:51], v[144:147], v[104:107]
    ds_read_b64_tr_b16 v[36:37], v12 offset:8192
    buffer_load_dwordx4 v9, s[12:15], s25 offen offset:1024 lds
    v_mfma_f32_16x16x32_bf16 v[104:107], v[52:55], v[148:151], v[104:107]
    ds_read_b64_tr_b16 v[38:39], v12 offset:12288
    v_mfma_f32_16x16x32_bf16 v[108:111], v[48:51], v[152:155], v[108:111]
    ds_read_b128 v[168:171], v10 offset:2048
    v_mfma_f32_16x16x32_bf16 v[108:111], v[52:55], v[156:159], v[108:111]
    ds_read_b128 v[172:175], v10 offset:3072
    v_mfma_f32_16x16x32_bf16 v[112:115], v[56:59], v[128:131], v[112:115]
    ds_read_b128 v[176:179], v10 offset:4096
    s_add_u32 m0, s26, s29
    v_mfma_f32_16x16x32_bf16 v[112:115], v[60:63], v[132:135], v[112:115]
    ds_read_b128 v[180:183], v10 offset:5120
    buffer_load_dwordx4 v4, s[8:11], s24 offen offset:0 sc1 lds
    v_mfma_f32_16x16x32_bf16 v[116:119], v[56:59], v[136:139], v[116:119]
    ds_read_b128 v[184:187], v10 offset:6144
    v_mfma_f32_16x16x32_bf16 v[116:119], v[60:63], v[140:143], v[116:119]
    ds_read_b128 v[188:191], v10 offset:7168
    v_mfma_f32_16x16x32_bf16 v[120:123], v[56:59], v[144:147], v[120:123]
    ds_read_b64_tr_b16 v[40:41], v13 offset:0
    v_mfma_f32_16x16x32_bf16 v[120:123], v[60:63], v[148:151], v[120:123]
    ds_read_b64_tr_b16 v[42:43], v13 offset:4096
    v_mfma_f32_16x16x32_bf16 v[124:127], v[56:59], v[152:155], v[124:127]
    ds_read_b64_tr_b16 v[44:45], v13 offset:8192
    buffer_load_dwordx4 v4, s[8:11], s24 offen offset:1024 sc1 lds
    v_mfma_f32_16x16x32_bf16 v[124:127], v[60:63], v[156:159], v[124:127]
    ds_read_b64_tr_b16 v[46:47], v13 offset:12288
    s_waitcnt lgkmcnt(13)
    v_mfma_f32_16x16x32_bf16 v[64:67], v[32:35], v[160:163], v[64:67]
    ds_read_b64_tr_b16 v[48:49], v14 offset:0
    s_waitcnt lgkmcnt(11)
    v_mfma_f32_16x16x32_bf16 v[64:67], v[36:39], v[164:167], v[64:67]
    ds_read_b64_tr_b16 v[50:51], v14 offset:4096
    s_waitcnt lgkmcnt(11)
    v_mfma_f32_16x16x32_bf16 v[68:71], v[32:35], v[168:171], v[68:71]
    ds_read_b64_tr_b16 v[52:53], v14 offset:8192
    s_waitcnt lgkmcnt(11)
    v_mfma_f32_16x16x32_bf16 v[68:71], v[36:39], v[172:175], v[68:71]
    ds_read_b64_tr_b16 v[54:55], v14 offset:12288
    s_waitcnt lgkmcnt(11)
    v_mfma_f32_16x16x32_bf16 v[72:75], v[32:35], v[176:179], v[72:75]
    ds_read_b64_tr_b16 v[56:57], v15 offset:0
    buffer_load_dwordx4 v4, s[8:11], s24 offen offset:2048 sc1 lds
    s_waitcnt lgkmcnt(11)
    v_mfma_f32_16x16x32_bf16 v[72:75], v[36:39], v[180:183], v[72:75]
    ds_read_b64_tr_b16 v[58:59], v15 offset:4096
    s_waitcnt lgkmcnt(11)
    v_mfma_f32_16x16x32_bf16 v[76:79], v[32:35], v[184:187], v[76:79]
    ds_read_b64_tr_b16 v[60:61], v15 offset:8192
    s_waitcnt lgkmcnt(11)
    v_mfma_f32_16x16x32_bf16 v[76:79], v[36:39], v[188:191], v[76:79]
    ds_read_b64_tr_b16 v[62:63], v15 offset:12288
    s_waitcnt lgkmcnt(10)
    v_mfma_f32_16x16x32_bf16 v[80:83], v[40:43], v[160:163], v[80:83]
    s_waitcnt lgkmcnt(8)
    v_mfma_f32_16x16x32_bf16 v[80:83], v[44:47], v[164:167], v[80:83]
    v_mfma_f32_16x16x32_bf16 v[84:87], v[40:43], v[168:171], v[84:87]
    buffer_load_dwordx4 v4, s[8:11], s24 offen offset:3072 sc1 lds
    v_mfma_f32_16x16x32_bf16 v[84:87], v[44:47], v[172:175], v[84:87]
    s_add_u32 s24, s24, 4096
    s_add_u32 s25, s25, s31
    v_mfma_f32_16x16x32_bf16 v[88:91], v[40:43], v[176:179], v[88:91]
    s_add_u32 s26, s26, 49152
    s_cmp_eq_u32 s26, 147456
    s_cselect_b32 s26, 0, s26
    s_cmp_eq_u32 s26, 98304
    s_cselect_b32 s27, s32, s33
    v_mfma_f32_16x16x32_bf16 v[88:91], v[44:47], v[180:183], v[88:91]
    v_add_u32 v10, s27, v10
    v_add_u32 v12, s27, v12
    v_add_u32 v13, s27, v13
    v_mfma_f32_16x16x32_bf16 v[92:95], v[40:43], v[184:187], v[92:95]
    v_add_u32 v14, s27, v14
    v_add_u32 v15, s27, v15
    v_mfma_f32_16x16x32_bf16 v[92:95], v[44:47], v[188:191], v[92:95]
    s_cmp_lg_u32 s20, 0
    s_cbranch_scc1 L_nc3_6036
    s_waitcnt vmcnt(6)
    s_mov_b32 s91, 0
L_spo_6037:
    v_readfirstlane_b32 s90, v25
    s_cmp_ge_u32 s90, 32
    s_cbranch_scc1 L_spoko_6038
    s_add_u32 s91, s91, 1
    s_cmp_ge_u32 s91, 4194304
    s_cbranch_scc1 L_spoko_6038
    s_sleep 4
    buffer_load_dword v25, v24, s[16:19], s38 offen sc1
    s_waitcnt vmcnt(0)
    s_branch L_spo_6037
L_spoko_6038:
    s_mov_b32 s91, 0
L_spcs_6039:
    v_readfirstlane_b32 s90, v26
    s_cmp_ge_u32 s90, 32
    s_cbranch_scc1 L_spokcs_6040
    s_add_u32 s91, s91, 1
    s_cmp_ge_u32 s91, 4194304
    s_cbranch_scc1 L_spokcs_6040
    s_sleep 4
    buffer_load_dword v26, v24, s[16:19], s34 offen sc1
    s_waitcnt vmcnt(0)
    s_branch L_spcs_6039
L_spokcs_6040:
L_nc3_6036:
    s_waitcnt vmcnt(6) lgkmcnt(0)
    s_barrier
    v_mfma_f32_16x16x32_bf16 v[96:99], v[48:51], v[160:163], v[96:99]
    ds_read_b128 v[128:131], v10 offset:0
    buffer_load_dwordx2 v[208:209], v19, s[16:19], s53 offen offset:0 sc1
    v_mfma_f32_16x16x32_bf16 v[96:99], v[52:55], v[164:167], v[96:99]
    ds_read_b64_tr_b16 v[32:33], v12 offset:0
    v_mfma_f32_16x16x32_bf16 v[100:103], v[48:51], v[168:171], v[100:103]
    ds_read_b64_tr_b16 v[34:35], v12 offset:4096
    v_mfma_f32_16x16x32_bf16 v[100:103], v[52:55], v[172:175], v[100:103]
    ds_read_b128 v[132:135], v10 offset:1024
    buffer_load_dwordx2 v[210:211], v19, s[16:19], s53 offen offset:128 sc1
    v_mfma_f32_16x16x32_bf16 v[104:107], v[48:51], v[176:179], v[104:107]
    ds_read_b64_tr_b16 v[36:37], v12 offset:8192
    v_mfma_f32_16x16x32_bf16 v[104:107], v[52:55], v[180:183], v[104:107]
    ds_read_b64_tr_b16 v[38:39], v12 offset:12288
    v_mfma_f32_16x16x32_bf16 v[108:111], v[48:51], v[184:187], v[108:111]
    ds_read_b128 v[136:139], v10 offset:2048
    buffer_load_dwordx2 v[212:213], v19, s[16:19], s53 offen offset:256 sc1
    v_mfma_f32_16x16x32_bf16 v[108:111], v[52:55], v[188:191], v[108:111]
    ds_read_b128 v[140:143], v10 offset:3072
    v_mfma_f32_16x16x32_bf16 v[112:115], v[56:59], v[160:163], v[112:115]
    ds_read_b128 v[144:147], v10 offset:4096
    v_mfma_f32_16x16x32_bf16 v[112:115], v[60:63], v[164:167], v[112:115]
    ds_read_b128 v[148:151], v10 offset:5120
    v_mfma_f32_16x16x32_bf16 v[116:119], v[56:59], v[168:171], v[116:119]
    ds_read_b128 v[152:155], v10 offset:6144
    buffer_load_dwordx2 v[214:215], v19, s[16:19], s53 offen offset:384 sc1
    v_mfma_f32_16x16x32_bf16 v[116:119], v[60:63], v[172:175], v[116:119]
    ds_read_b128 v[156:159], v10 offset:7168
    v_mfma_f32_16x16x32_bf16 v[120:123], v[56:59], v[176:179], v[120:123]
    ds_read_b64_tr_b16 v[40:41], v13 offset:0
    v_mfma_f32_16x16x32_bf16 v[120:123], v[60:63], v[180:183], v[120:123]
    ds_read_b64_tr_b16 v[42:43], v13 offset:4096
    buffer_load_dwordx4 v[192:195], v18, s[16:19], s54 offen offset:0 sc1
    v_mfma_f32_16x16x32_bf16 v[124:127], v[56:59], v[184:187], v[124:127]
    ds_read_b64_tr_b16 v[44:45], v13 offset:8192
    v_mfma_f32_16x16x32_bf16 v[124:127], v[60:63], v[188:191], v[124:127]
    ds_read_b64_tr_b16 v[46:47], v13 offset:12288
    s_waitcnt lgkmcnt(13)
    v_mfma_f32_16x16x32_bf16 v[64:67], v[32:35], v[128:131], v[64:67]
    ds_read_b64_tr_b16 v[48:49], v14 offset:0
    buffer_load_dwordx4 v[196:199], v18, s[16:19], s54 offen offset:64 sc1
    s_waitcnt lgkmcnt(11)
    v_mfma_f32_16x16x32_bf16 v[64:67], v[36:39], v[132:135], v[64:67]
    ds_read_b64_tr_b16 v[50:51], v14 offset:4096
    s_waitcnt lgkmcnt(11)
    v_mfma_f32_16x16x32_bf16 v[68:71], v[32:35], v[136:139], v[68:71]
    ds_read_b64_tr_b16 v[52:53], v14 offset:8192
    s_waitcnt lgkmcnt(11)
    v_mfma_f32_16x16x32_bf16 v[68:71], v[36:39], v[140:143], v[68:71]
    ds_read_b64_tr_b16 v[54:55], v14 offset:12288
    s_waitcnt lgkmcnt(11)
    v_mfma_f32_16x16x32_bf16 v[72:75], v[32:35], v[144:147], v[72:75]
    ds_read_b64_tr_b16 v[56:57], v15 offset:0
    buffer_load_dwordx4 v[200:203], v18, s[16:19], s54 offen offset:128 sc1
    s_waitcnt lgkmcnt(11)
    v_mfma_f32_16x16x32_bf16 v[72:75], v[36:39], v[148:151], v[72:75]
    ds_read_b64_tr_b16 v[58:59], v15 offset:4096
    s_waitcnt lgkmcnt(11)
    v_mfma_f32_16x16x32_bf16 v[76:79], v[32:35], v[152:155], v[76:79]
    ds_read_b64_tr_b16 v[60:61], v15 offset:8192
    s_waitcnt lgkmcnt(11)
    v_mfma_f32_16x16x32_bf16 v[76:79], v[36:39], v[156:159], v[76:79]
    ds_read_b64_tr_b16 v[62:63], v15 offset:12288
    buffer_load_dwordx4 v[204:207], v18, s[16:19], s54 offen offset:192 sc1
    s_waitcnt lgkmcnt(10)
    v_mfma_f32_16x16x32_bf16 v[80:83], v[40:43], v[128:131], v[80:83]
    s_waitcnt lgkmcnt(8)
    v_mfma_f32_16x16x32_bf16 v[80:83], v[44:47], v[132:135], v[80:83]
    v_mfma_f32_16x16x32_bf16 v[84:87], v[40:43], v[136:139], v[84:87]
    v_mfma_f32_16x16x32_bf16 v[84:87], v[44:47], v[140:143], v[84:87]
    v_mfma_f32_16x16x32_bf16 v[88:91], v[40:43], v[144:147], v[88:91]
    s_add_u32 s26, s26, 49152
    s_cmp_eq_u32 s26, 147456
    s_cselect_b32 s26, 0, s26
    s_cmp_eq_u32 s26, 98304
    s_cselect_b32 s27, s32, s33
    v_mfma_f32_16x16x32_bf16 v[88:91], v[44:47], v[148:151], v[88:91]
    v_add_u32 v10, s27, v10
    v_add_u32 v12, s27, v12
    v_add_u32 v13, s27, v13
    v_mfma_f32_16x16x32_bf16 v[92:95], v[40:43], v[152:155], v[92:95]
    v_add_u32 v14, s27, v14
    v_add_u32 v15, s27, v15
    v_mfma_f32_16x16x32_bf16 v[92:95], v[44:47], v[156:159], v[92:95]
    s_waitcnt vmcnt(8) lgkmcnt(0)
    s_barrier
    v_mfma_f32_16x16x32_bf16 v[96:99], v[48:51], v[128:131], v[96:99]
    ds_read_b128 v[160:163], v10 offset:0
    s_and_b32 s43, s40, 1
    s_lshr_b32 s42, s40, 1
    v_mfma_f32_16x16x32_bf16 v[96:99], v[52:55], v[132:135], v[96:99]
    ds_read_b64_tr_b16 v[32:33], v12 offset:0
    s_lshl_b32 s42, s42, 2
    s_and_b32 s44, s41, 3
    v_mfma_f32_16x16x32_bf16 v[100:103], v[48:51], v[136:139], v[100:103]
    ds_read_b64_tr_b16 v[34:35], v12 offset:4096
    s_add_u32 s42, s42, s44
    v_mfma_f32_16x16x32_bf16 v[100:103], v[52:55], v[140:143], v[100:103]
    ds_read_b128 v[164:167], v10 offset:1024
    s_lshr_b32 s44, s41, 2
    s_lshl_b32 s47, s42, 3
    v_mfma_f32_16x16x32_bf16 v[104:107], v[48:51], v[144:147], v[104:107]
    ds_read_b64_tr_b16 v[36:37], v12 offset:8192
    s_add_u32 s47, s47, s44
    v_mfma_f32_16x16x32_bf16 v[104:107], v[52:55], v[148:151], v[104:107]
    ds_read_b64_tr_b16 v[38:39], v12 offset:12288
    v_lshlrev_b32 v224, 4, v1
    s_lshl_b32 s55, s42, 2
    v_mfma_f32_16x16x32_bf16 v[108:111], v[48:51], v[152:155], v[108:111]
    ds_read_b128 v[168:171], v10 offset:2048
    s_lshr_b32 s56, s20, 1
    v_mfma_f32_16x16x32_bf16 v[108:111], v[52:55], v[156:159], v[108:111]
    ds_read_b128 v[172:175], v10 offset:3072
    s_add_u32 s55, s55, s56
    s_lshl_b32 s57, s22, 11
    v_mfma_f32_16x16x32_bf16 v[112:115], v[56:59], v[128:131], v[112:115]
    ds_read_b128 v[176:179], v10 offset:4096
    s_mul_i32 s56, s55, 229376
    v_mfma_f32_16x16x32_bf16 v[112:115], v[60:63], v[132:135], v[112:115]
    ds_read_b128 v[180:183], v10 offset:5120
    s_add_u32 s56, s56, s57
    s_add_u32 s56, s56, 25165824
    v_mfma_f32_16x16x32_bf16 v[116:119], v[56:59], v[136:139], v[116:119]
    ds_read_b128 v[184:187], v10 offset:6144
    v_add_u32 v7, s56, v224
    s_lshl_b32 s56, s55, 16
    v_mfma_f32_16x16x32_bf16 v[116:119], v[60:63], v[140:143], v[116:119]
    ds_read_b128 v[188:191], v10 offset:7168
    s_add_u32 s56, s56, s57
    v_mfma_f32_16x16x32_bf16 v[120:123], v[56:59], v[144:147], v[120:123]
    ds_read_b64_tr_b16 v[40:41], v13 offset:0
    s_add_u32 s56, s56, 20971520
    v_add_u32 v4, s56, v224
    v_mfma_f32_16x16x32_bf16 v[120:123], v[60:63], v[148:151], v[120:123]
    ds_read_b64_tr_b16 v[42:43], v13 offset:4096
    v_lshlrev_b32 v225, 1, v3
    v_mfma_f32_16x16x32_bf16 v[124:127], v[56:59], v[152:155], v[124:127]
    ds_read_b64_tr_b16 v[44:45], v13 offset:8192
    v_xor_b32 v225, v2, v225
    v_xor_b32 v226, 8, v225
    v_mfma_f32_16x16x32_bf16 v[124:127], v[60:63], v[156:159], v[124:127]
    ds_read_b64_tr_b16 v[46:47], v13 offset:12288
    s_lshl_b32 s55, s20, 3
    s_waitcnt lgkmcnt(13)
    v_mfma_f32_16x16x32_bf16 v[64:67], v[32:35], v[160:163], v[64:67]
    ds_read_b64_tr_b16 v[48:49], v14 offset:0
    v_add_u32 v227, s55, v3
    v_lshlrev_b32 v227, 11, v227
    s_waitcnt lgkmcnt(11)
    v_mfma_f32_16x16x32_bf16 v[64:67], v[36:39], v[164:167], v[64:67]
    ds_read_b64_tr_b16 v[50:51], v14 offset:4096
    s_lshl_b32 s55, s44, 1
    s_add_u32 s56, s55, 1
    s_waitcnt lgkmcnt(11)
    v_mfma_f32_16x16x32_bf16 v[68:71], v[32:35], v[168:171], v[68:71]
    ds_read_b64_tr_b16 v[52:53], v14 offset:8192
    s_cmp_eq_u32 s22, 0
    s_cselect_b32 s45, s55, s56
    s_lshl_b32 s55, s55, 7
    s_lshl_b32 s56, s56, 7
    s_waitcnt lgkmcnt(11)
    v_mfma_f32_16x16x32_bf16 v[68:71], v[36:39], v[172:175], v[68:71]
    ds_read_b64_tr_b16 v[54:55], v14 offset:12288
    v_and_b32 v228, 7, v225
    v_lshl_add_u32 v227, v228, 4, v227
    s_waitcnt lgkmcnt(11)
    v_mfma_f32_16x16x32_bf16 v[72:75], v[32:35], v[176:179], v[72:75]
    ds_read_b64_tr_b16 v[56:57], v15 offset:0
    v_mov_b32 v228, s55
    s_waitcnt lgkmcnt(11)
    v_mfma_f32_16x16x32_bf16 v[72:75], v[36:39], v[180:183], v[72:75]
    ds_read_b64_tr_b16 v[58:59], v15 offset:4096
    v_mov_b32 v229, s56
    v_cmp_gt_u32 vcc, 8, v225
    s_nop 1
    v_cndmask_b32 v230, v229, v228, vcc
    v_cndmask_b32 v231, v228, v229, vcc
    s_waitcnt lgkmcnt(11)
    v_mfma_f32_16x16x32_bf16 v[76:79], v[32:35], v[184:187], v[76:79]
    ds_read_b64_tr_b16 v[60:61], v15 offset:8192
    v_add_u32 v5, v227, v230
    s_waitcnt lgkmcnt(11)
    v_mfma_f32_16x16x32_bf16 v[76:79], v[36:39], v[188:191], v[76:79]
    ds_read_b64_tr_b16 v[62:63], v15 offset:12288
    v_add_u32 v231, v227, v231
    v_add_u32 v6, 7168, v231
    s_waitcnt lgkmcnt(10)
    v_mfma_f32_16x16x32_bf16 v[80:83], v[40:43], v[160:163], v[80:83]
    s_lshl_b32 s29, s20, 11
    s_waitcnt lgkmcnt(8)
    v_mfma_f32_16x16x32_bf16 v[80:83], v[44:47], v[164:167], v[80:83]
    s_mul_i32 s24, s43, 32768
    s_mul_i32 s25, s43, 1048576
    v_mfma_f32_16x16x32_bf16 v[84:87], v[40:43], v[168:171], v[84:87]
    s_mov_b32 s12, s70
    s_mov_b32 s13, s71
    s_mov_b32 s14, 2097152
    s_mov_b32 s15, 0x00020000
    v_mfma_f32_16x16x32_bf16 v[84:87], v[44:47], v[172:175], v[84:87]
    v_mfma_f32_16x16x32_bf16 v[88:91], v[40:43], v[176:179], v[88:91]
    v_mfma_f32_16x16x32_bf16 v[88:91], v[44:47], v[180:183], v[88:91]
    v_mfma_f32_16x16x32_bf16 v[92:95], v[40:43], v[184:187], v[92:95]
    v_mfma_f32_16x16x32_bf16 v[92:95], v[44:47], v[188:191], v[92:95]
    s_waitcnt lgkmcnt(0)
    s_barrier
    v_mfma_f32_16x16x32_bf16 v[96:99], v[48:51], v[160:163], v[96:99]
    s_add_u32 m0, s29, 0
    s_nop 0
    buffer_load_dwordx4 v4, s[16:19], s24 offen sc1 lds
    buffer_load_dwordx4 v4, s[16:19], s24 offen offset:1024 sc1 lds
    s_add_u32 m0, s29, 16384
    s_nop 0
    buffer_load_dwordx4 v5, s[12:15], s25 offen lds
    v_mfma_f32_16x16x32_bf16 v[96:99], v[52:55], v[164:167], v[96:99]
    buffer_load_dwordx4 v6, s[12:15], s25 offen offset:1024 lds
    s_add_u32 s24, s24, 4096
    s_add_u32 s25, s25, 131072
    s_add_u32 m0, s29, 32768
    v_mfma_f32_16x16x32_bf16 v[100:103], v[48:51], v[168:171], v[100:103]
    buffer_load_dwordx4 v4, s[16:19], s24 offen sc1 lds
    buffer_load_dwordx4 v4, s[16:19], s24 offen offset:1024 sc1 lds
    s_add_u32 m0, s29, 49152
    s_nop 0
    buffer_load_dwordx4 v5, s[12:15], s25 offen lds
    v_mfma_f32_16x16x32_bf16 v[100:103], v[52:55], v[172:175], v[100:103]
    buffer_load_dwordx4 v6, s[12:15], s25 offen offset:1024 lds
    s_add_u32 s24, s24, 4096
    s_add_u32 s25, s25, 131072
    s_add_u32 m0, s29, 65536
    v_mfma_f32_16x16x32_bf16 v[104:107], v[48:51], v[176:179], v[104:107]
    buffer_load_dwordx4 v4, s[16:19], s24 offen sc1 lds
    buffer_load_dwordx4 v4, s[16:19], s24 offen offset:1024 sc1 lds
    s_add_u32 m0, s29, 81920
    s_nop 0
    buffer_load_dwordx4 v5, s[12:15], s25 offen lds
    buffer_load_dwordx4 v6, s[12:15], s25 offen offset:1024 lds
    v_mfma_f32_16x16x32_bf16 v[104:107], v[52:55], v[180:183], v[104:107]
    s_add_u32 s24, s24, 4096
    s_add_u32 s25, s25, 131072
    s_lshr_b32 s23, s20, 2
    s_bfe_u32 s21, s20, 0x10001
    v_mfma_f32_16x16x32_bf16 v[108:111], v[48:51], v[184:187], v[108:111]
    v_lshlrev_b32 v20, 4, v1
    s_lshl_b32 s49, s21, 13
    s_lshl_b32 s57, s23, 10
    s_add_u32 s49, s49, s57
    v_mfma_f32_16x16x32_bf16 v[108:111], v[52:55], v[188:191], v[108:111]
    v_add_u32 v8, s49, v20
    v_add_u32 v9, 65536, v8
    v_bfe_u32 v22, v1, 2, 2
    v_lshl_add_u32 v22, v3, 2, v22
    v_mfma_f32_16x16x32_bf16 v[112:115], v[56:59], v[160:163], v[112:115]
    v_and_b32 v23, 7, v22
    s_lshl_b32 s49, s22, 2
    v_xor_b32 v23, s49, v23
    v_lshlrev_b32 v22, 8, v22
    v_lshl_add_u32 v22, v23, 5, v22
    v_mfma_f32_16x16x32_bf16 v[112:115], v[60:63], v[164:167], v[112:115]
    v_and_b32 v23, 3, v1
    v_lshl_add_u32 v22, v23, 3, v22
    s_lshl_b32 s49, s23, 13
    s_add_u32 s49, s49, 16384
    v_mfma_f32_16x16x32_bf16 v[116:119], v[56:59], v[168:171], v[116:119]
    v_add_u32 v10, s49, v22
    v_xor_b32 v11, 32, v10
    v_xor_b32 v12, 64, v10
    v_xor_b32 v13, 96, v10
    v_mfma_f32_16x16x32_bf16 v[116:119], v[60:63], v[172:175], v[116:119]
    v_add_u32 v14, 65536, v10
    v_add_u32 v15, 65536, v11
    v_add_u32 v16, 65536, v12
    v_add_u32 v17, 65536, v13
    v_mfma_f32_16x16x32_bf16 v[120:123], v[56:59], v[176:179], v[120:123]
    s_cmp_eq_u32 s43, 0
    s_cselect_b32 s28, 7, 6
    s_lshl_b32 s49, s42, 7
    s_lshl_b32 s57, s21, 6
    s_add_u32 s46, s49, s57
    s_lshl_b32 s50, s42, 2
    v_mfma_f32_16x16x32_bf16 v[120:123], v[60:63], v[180:183], v[120:123]
    s_lshl_b32 s51, s21, 1
    s_add_u32 s50, s50, s51
    s_lshl_b32 s50, s50, 16
    s_lshl_b32 s51, s45, 12
    v_mfma_f32_16x16x32_bf16 v[124:127], v[56:59], v[184:187], v[124:127]
    s_add_u32 s50, s50, s51
    s_lshl_b32 s51, s23, 10
    s_add_u32 s50, s50, s51
    s_add_u32 s36, s50, 16777216
    v_mfma_f32_16x16x32_bf16 v[124:127], v[60:63], v[188:191], v[124:127]
    s_add_u32 s37, s36, 65536
    s_lshr_b32 s38, s42, 1
    s_lshl_b32 s38, s38, 8
    s_add_u32 s38, s38, 42860544
    s_waitcnt vmcnt(12)
    v_mul_f32 v224, 3222493025, v209
    v_mul_f32 v226, v209, v209
    v_rcp_f32 v228, v209
    v_mul_f32 v226, v226, v224
    v_mul_f32 v226, 1027024659, v226
    v_sub_f32 v230, 0, v208
    v_mov_b32 v225, v224
    v_mov_b32 v227, v226
    v_mov_b32 v229, v228
    v_mov_b32 v231, v230
    v_mov_b32 v232, v220
    v_mov_b32 v233, v220
    v_pk_fma_f32 v[64:65], v[230:231], v[192:193], v[64:65]
    v_pk_fma_f32 v[66:67], v[230:231], v[194:195], v[66:67]
    v_pk_fma_f32 v[80:81], v[230:231], v[196:197], v[80:81]
    v_pk_fma_f32 v[82:83], v[230:231], v[198:199], v[82:83]
    v_pk_fma_f32 v[96:97], v[230:231], v[200:201], v[96:97]
    v_pk_fma_f32 v[98:99], v[230:231], v[202:203], v[98:99]
    v_pk_fma_f32 v[112:113], v[230:231], v[204:205], v[112:113]
    v_pk_fma_f32 v[114:115], v[230:231], v[206:207], v[114:115]
    v_pk_mul_f32 v[32:33], v[64:65], v[64:65]
    v_pk_mul_f32 v[34:35], v[66:67], v[66:67]
    v_pk_mul_f32 v[36:37], v[80:81], v[80:81]
    v_pk_mul_f32 v[38:39], v[82:83], v[82:83]
    v_pk_mul_f32 v[40:41], v[96:97], v[96:97]
    v_pk_mul_f32 v[42:43], v[98:99], v[98:99]
    v_pk_mul_f32 v[44:45], v[112:113], v[112:113]
    v_pk_mul_f32 v[46:47], v[114:115], v[114:115]
    v_pk_fma_f32 v[32:33], v[32:33], v[226:227], v[224:225]
    v_pk_fma_f32 v[34:35], v[34:35], v[226:227], v[224:225]
    v_pk_fma_f32 v[36:37], v[36:37], v[226:227], v[224:225]
    v_pk_fma_f32 v[38:39], v[38:39], v[226:227], v[224:225]
    v_pk_fma_f32 v[40:41], v[40:41], v[226:227], v[224:225]
    v_pk_fma_f32 v[42:43], v[42:43], v[226:227], v[224:225]
    v_pk_fma_f32 v[44:45], v[44:45], v[226:227], v[224:225]
    v_pk_fma_f32 v[46:47], v[46:47], v[226:227], v[224:225]
    v_pk_mul_f32 v[32:33], v[32:33], v[64:65]
    v_pk_mul_f32 v[34:35], v[34:35], v[66:67]
    v_pk_mul_f32 v[36:37], v[36:37], v[80:81]
    v_pk_mul_f32 v[38:39], v[38:39], v[82:83]
    v_pk_mul_f32 v[40:41], v[40:41], v[96:97]
    v_pk_mul_f32 v[42:43], v[42:43], v[98:99]
    v_pk_mul_f32 v[44:45], v[44:45], v[112:113]
    v_pk_mul_f32 v[46:47], v[46:47], v[114:115]
    v_exp_f32 v32, v32
    v_exp_f32 v33, v33
    v_exp_f32 v34, v34
    v_exp_f32 v35, v35
    v_exp_f32 v36, v36
    v_exp_f32 v37, v37
    v_exp_f32 v38, v38
    v_exp_f32 v39, v39
    v_exp_f32 v40, v40
    v_exp_f32 v41, v41
    v_exp_f32 v42, v42
    v_exp_f32 v43, v43
    v_exp_f32 v44, v44
    v_exp_f32 v45, v45
    v_exp_f32 v46, v46
    v_exp_f32 v47, v47
    v_pk_mul_f32 v[64:65], v[64:65], v[232:233]
    v_pk_mul_f32 v[66:67], v[66:67], v[232:233]
    v_pk_mul_f32 v[80:81], v[80:81], v[232:233]
    v_pk_mul_f32 v[82:83], v[82:83], v[232:233]
    v_pk_mul_f32 v[96:97], v[96:97], v[232:233]
    v_pk_mul_f32 v[98:99], v[98:99], v[232:233]
    v_pk_mul_f32 v[112:113], v[112:113], v[232:233]
    v_pk_mul_f32 v[114:115], v[114:115], v[232:233]
    s_nop 0
    v_pk_fma_f32 v[32:33], v[32:33], v[228:229], v[228:229]
    v_pk_fma_f32 v[34:35], v[34:35], v[228:229], v[228:229]
    v_pk_fma_f32 v[36:37], v[36:37], v[228:229], v[228:229]
    v_pk_fma_f32 v[38:39], v[38:39], v[228:229], v[228:229]
    v_pk_fma_f32 v[40:41], v[40:41], v[228:229], v[228:229]
    v_pk_fma_f32 v[42:43], v[42:43], v[228:229], v[228:229]
    v_pk_fma_f32 v[44:45], v[44:45], v[228:229], v[228:229]
    v_pk_fma_f32 v[46:47], v[46:47], v[228:229], v[228:229]
    v_rcp_f32 v32, v32
    v_rcp_f32 v33, v33
    v_rcp_f32 v34, v34
    v_rcp_f32 v35, v35
    v_rcp_f32 v36, v36
    v_rcp_f32 v37, v37
    v_rcp_f32 v38, v38
    v_rcp_f32 v39, v39
    v_rcp_f32 v40, v40
    v_rcp_f32 v41, v41
    v_rcp_f32 v42, v42
    v_rcp_f32 v43, v43
    v_rcp_f32 v44, v44
    v_rcp_f32 v45, v45
    v_rcp_f32 v46, v46
    v_rcp_f32 v47, v47
    s_nop 0
    v_pk_mul_f32 v[64:65], v[64:65], v[32:33]
    v_pk_mul_f32 v[66:67], v[66:67], v[34:35]
    v_pk_mul_f32 v[80:81], v[80:81], v[36:37]
    v_pk_mul_f32 v[82:83], v[82:83], v[38:39]
    v_pk_mul_f32 v[96:97], v[96:97], v[40:41]
    v_pk_mul_f32 v[98:99], v[98:99], v[42:43]
    v_pk_mul_f32 v[112:113], v[112:113], v[44:45]
    v_pk_mul_f32 v[114:115], v[114:115], v[46:47]
    v_cvt_pk_bf16_f32 v48, v64, v65
    v_cvt_pk_bf16_f32 v49, v66, v67
    v_cvt_pk_bf16_f32 v50, v80, v81
    v_cvt_pk_bf16_f32 v51, v82, v83
    v_cvt_pk_bf16_f32 v52, v96, v97
    v_cvt_pk_bf16_f32 v53, v98, v99
    v_cvt_pk_bf16_f32 v54, v112, v113
    v_cvt_pk_bf16_f32 v55, v114, v115
    buffer_store_dwordx4 v[48:51], v28, s[16:19], s48 offen offset:0 sc1
    buffer_store_dwordx4 v[52:55], v28, s[16:19], s48 offen offset:1024 sc1
    v_mul_f32 v224, 3222493025, v211
    v_mul_f32 v226, v211, v211
    v_rcp_f32 v228, v211
    v_mul_f32 v226, v226, v224
    v_mul_f32 v226, 1027024659, v226
    v_sub_f32 v230, 0, v210
    v_mov_b32 v225, v224
    v_mov_b32 v227, v226
    v_mov_b32 v229, v228
    v_mov_b32 v231, v230
    v_mov_b32 v232, v221
    v_mov_b32 v233, v221
    v_pk_fma_f32 v[68:69], v[230:231], v[192:193], v[68:69]
    v_pk_fma_f32 v[70:71], v[230:231], v[194:195], v[70:71]
    v_pk_fma_f32 v[84:85], v[230:231], v[196:197], v[84:85]
    v_pk_fma_f32 v[86:87], v[230:231], v[198:199], v[86:87]
    v_pk_fma_f32 v[100:101], v[230:231], v[200:201], v[100:101]
    v_pk_fma_f32 v[102:103], v[230:231], v[202:203], v[102:103]
    v_pk_fma_f32 v[116:117], v[230:231], v[204:205], v[116:117]
    v_pk_fma_f32 v[118:119], v[230:231], v[206:207], v[118:119]
    v_pk_mul_f32 v[32:33], v[68:69], v[68:69]
    v_pk_mul_f32 v[34:35], v[70:71], v[70:71]
    v_pk_mul_f32 v[36:37], v[84:85], v[84:85]
    v_pk_mul_f32 v[38:39], v[86:87], v[86:87]
    v_pk_mul_f32 v[40:41], v[100:101], v[100:101]
    v_pk_mul_f32 v[42:43], v[102:103], v[102:103]
    v_pk_mul_f32 v[44:45], v[116:117], v[116:117]
    v_pk_mul_f32 v[46:47], v[118:119], v[118:119]
    v_pk_fma_f32 v[32:33], v[32:33], v[226:227], v[224:225]
    v_pk_fma_f32 v[34:35], v[34:35], v[226:227], v[224:225]
    v_pk_fma_f32 v[36:37], v[36:37], v[226:227], v[224:225]
    v_pk_fma_f32 v[38:39], v[38:39], v[226:227], v[224:225]
    v_pk_fma_f32 v[40:41], v[40:41], v[226:227], v[224:225]
    v_pk_fma_f32 v[42:43], v[42:43], v[226:227], v[224:225]
    v_pk_fma_f32 v[44:45], v[44:45], v[226:227], v[224:225]
    v_pk_fma_f32 v[46:47], v[46:47], v[226:227], v[224:225]
    v_pk_mul_f32 v[32:33], v[32:33], v[68:69]
    v_pk_mul_f32 v[34:35], v[34:35], v[70:71]
    v_pk_mul_f32 v[36:37], v[36:37], v[84:85]
    v_pk_mul_f32 v[38:39], v[38:39], v[86:87]
    v_pk_mul_f32 v[40:41], v[40:41], v[100:101]
    v_pk_mul_f32 v[42:43], v[42:43], v[102:103]
    v_pk_mul_f32 v[44:45], v[44:45], v[116:117]
    v_pk_mul_f32 v[46:47], v[46:47], v[118:119]
    v_exp_f32 v32, v32
    v_exp_f32 v33, v33
    v_exp_f32 v34, v34
    v_exp_f32 v35, v35
    v_exp_f32 v36, v36
    v_exp_f32 v37, v37
    v_exp_f32 v38, v38
    v_exp_f32 v39, v39
    v_exp_f32 v40, v40
    v_exp_f32 v41, v41
    v_exp_f32 v42, v42
    v_exp_f32 v43, v43
    v_exp_f32 v44, v44
    v_exp_f32 v45, v45
    v_exp_f32 v46, v46
    v_exp_f32 v47, v47
    v_pk_mul_f32 v[68:69], v[68:69], v[232:233]
    v_pk_mul_f32 v[70:71], v[70:71], v[232:233]
    v_pk_mul_f32 v[84:85], v[84:85], v[232:233]
    v_pk_mul_f32 v[86:87], v[86:87], v[232:233]
    v_pk_mul_f32 v[100:101], v[100:101], v[232:233]
    v_pk_mul_f32 v[102:103], v[102:103], v[232:233]
    v_pk_mul_f32 v[116:117], v[116:117], v[232:233]
    v_pk_mul_f32 v[118:119], v[118:119], v[232:233]
    s_nop 0
    v_pk_fma_f32 v[32:33], v[32:33], v[228:229], v[228:229]
    v_pk_fma_f32 v[34:35], v[34:35], v[228:229], v[228:229]
    v_pk_fma_f32 v[36:37], v[36:37], v[228:229], v[228:229]
    v_pk_fma_f32 v[38:39], v[38:39], v[228:229], v[228:229]
    v_pk_fma_f32 v[40:41], v[40:41], v[228:229], v[228:229]
    v_pk_fma_f32 v[42:43], v[42:43], v[228:229], v[228:229]
    v_pk_fma_f32 v[44:45], v[44:45], v[228:229], v[228:229]
    v_pk_fma_f32 v[46:47], v[46:47], v[228:229], v[228:229]
    v_rcp_f32 v32, v32
    v_rcp_f32 v33, v33
    v_rcp_f32 v34, v34
    v_rcp_f32 v35, v35
    v_rcp_f32 v36, v36
    v_rcp_f32 v37, v37
    v_rcp_f32 v38, v38
    v_rcp_f32 v39, v39
    v_rcp_f32 v40, v40
    v_rcp_f32 v41, v41
    v_rcp_f32 v42, v42
    v_rcp_f32 v43, v43
    v_rcp_f32 v44, v44
    v_rcp_f32 v45, v45
    v_rcp_f32 v46, v46
    v_rcp_f32 v47, v47
    s_nop 0
    v_pk_mul_f32 v[68:69], v[68:69], v[32:33]
    v_pk_mul_f32 v[70:71], v[70:71], v[34:35]
    v_pk_mul_f32 v[84:85], v[84:85], v[36:37]
    v_pk_mul_f32 v[86:87], v[86:87], v[38:39]
    v_pk_mul_f32 v[100:101], v[100:101], v[40:41]
    v_pk_mul_f32 v[102:103], v[102:103], v[42:43]
    v_pk_mul_f32 v[116:117], v[116:117], v[44:45]
    v_pk_mul_f32 v[118:119], v[118:119], v[46:47]
    v_cvt_pk_bf16_f32 v56, v68, v69
    v_cvt_pk_bf16_f32 v57, v70, v71
    v_cvt_pk_bf16_f32 v58, v84, v85
    v_cvt_pk_bf16_f32 v59, v86, v87
    v_cvt_pk_bf16_f32 v60, v100, v101
    v_cvt_pk_bf16_f32 v61, v102, v103
    v_cvt_pk_bf16_f32 v62, v116, v117
    v_cvt_pk_bf16_f32 v63, v118, v119
    buffer_store_dwordx4 v[56:59], v29, s[16:19], s48 offen offset:0 sc1
    buffer_store_dwordx4 v[60:63], v29, s[16:19], s48 offen offset:1024 sc1
    v_mul_f32 v224, 3222493025, v213
    v_mul_f32 v226, v213, v213
    v_rcp_f32 v228, v213
    v_mul_f32 v226, v226, v224
    v_mul_f32 v226, 1027024659, v226
    v_sub_f32 v230, 0, v212
    v_mov_b32 v225, v224
    v_mov_b32 v227, v226
    v_mov_b32 v229, v228
    v_mov_b32 v231, v230
    v_mov_b32 v232, v222
    v_mov_b32 v233, v222
    v_pk_fma_f32 v[72:73], v[230:231], v[192:193], v[72:73]
    v_pk_fma_f32 v[74:75], v[230:231], v[194:195], v[74:75]
    v_pk_fma_f32 v[88:89], v[230:231], v[196:197], v[88:89]
    v_pk_fma_f32 v[90:91], v[230:231], v[198:199], v[90:91]
    v_pk_fma_f32 v[104:105], v[230:231], v[200:201], v[104:105]
    v_pk_fma_f32 v[106:107], v[230:231], v[202:203], v[106:107]
    v_pk_fma_f32 v[120:121], v[230:231], v[204:205], v[120:121]
    v_pk_fma_f32 v[122:123], v[230:231], v[206:207], v[122:123]
    v_pk_mul_f32 v[32:33], v[72:73], v[72:73]
    v_pk_mul_f32 v[34:35], v[74:75], v[74:75]
    v_pk_mul_f32 v[36:37], v[88:89], v[88:89]
    v_pk_mul_f32 v[38:39], v[90:91], v[90:91]
    v_pk_mul_f32 v[40:41], v[104:105], v[104:105]
    v_pk_mul_f32 v[42:43], v[106:107], v[106:107]
    v_pk_mul_f32 v[44:45], v[120:121], v[120:121]
    v_pk_mul_f32 v[46:47], v[122:123], v[122:123]
    v_pk_fma_f32 v[32:33], v[32:33], v[226:227], v[224:225]
    v_pk_fma_f32 v[34:35], v[34:35], v[226:227], v[224:225]
    v_pk_fma_f32 v[36:37], v[36:37], v[226:227], v[224:225]
    v_pk_fma_f32 v[38:39], v[38:39], v[226:227], v[224:225]
    v_pk_fma_f32 v[40:41], v[40:41], v[226:227], v[224:225]
    v_pk_fma_f32 v[42:43], v[42:43], v[226:227], v[224:225]
    v_pk_fma_f32 v[44:45], v[44:45], v[226:227], v[224:225]
    v_pk_fma_f32 v[46:47], v[46:47], v[226:227], v[224:225]
    v_pk_mul_f32 v[32:33], v[32:33], v[72:73]
    v_pk_mul_f32 v[34:35], v[34:35], v[74:75]
    v_pk_mul_f32 v[36:37], v[36:37], v[88:89]
    v_pk_mul_f32 v[38:39], v[38:39], v[90:91]
    v_pk_mul_f32 v[40:41], v[40:41], v[104:105]
    v_pk_mul_f32 v[42:43], v[42:43], v[106:107]
    v_pk_mul_f32 v[44:45], v[44:45], v[120:121]
    v_pk_mul_f32 v[46:47], v[46:47], v[122:123]
    v_exp_f32 v32, v32
    v_exp_f32 v33, v33
    v_exp_f32 v34, v34
    v_exp_f32 v35, v35
    v_exp_f32 v36, v36
    v_exp_f32 v37, v37
    v_exp_f32 v38, v38
    v_exp_f32 v39, v39
    v_exp_f32 v40, v40
    v_exp_f32 v41, v41
    v_exp_f32 v42, v42
    v_exp_f32 v43, v43
    v_exp_f32 v44, v44
    v_exp_f32 v45, v45
    v_exp_f32 v46, v46
    v_exp_f32 v47, v47
    v_pk_mul_f32 v[72:73], v[72:73], v[232:233]
    v_pk_mul_f32 v[74:75], v[74:75], v[232:233]
    v_pk_mul_f32 v[88:89], v[88:89], v[232:233]
    v_pk_mul_f32 v[90:91], v[90:91], v[232:233]
    v_pk_mul_f32 v[104:105], v[104:105], v[232:233]
    v_pk_mul_f32 v[106:107], v[106:107], v[232:233]
    v_pk_mul_f32 v[120:121], v[120:121], v[232:233]
    v_pk_mul_f32 v[122:123], v[122:123], v[232:233]
    s_nop 0
    v_pk_fma_f32 v[32:33], v[32:33], v[228:229], v[228:229]
    v_pk_fma_f32 v[34:35], v[34:35], v[228:229], v[228:229]
    v_pk_fma_f32 v[36:37], v[36:37], v[228:229], v[228:229]
    v_pk_fma_f32 v[38:39], v[38:39], v[228:229], v[228:229]
    v_pk_fma_f32 v[40:41], v[40:41], v[228:229], v[228:229]
    v_pk_fma_f32 v[42:43], v[42:43], v[228:229], v[228:229]
    v_pk_fma_f32 v[44:45], v[44:45], v[228:229], v[228:229]
    v_pk_fma_f32 v[46:47], v[46:47], v[228:229], v[228:229]
    v_rcp_f32 v32, v32
    v_rcp_f32 v33, v33
    v_rcp_f32 v34, v34
    v_rcp_f32 v35, v35
    v_rcp_f32 v36, v36
    v_rcp_f32 v37, v37
    v_rcp_f32 v38, v38
    v_rcp_f32 v39, v39
    v_rcp_f32 v40, v40
    v_rcp_f32 v41, v41
    v_rcp_f32 v42, v42
    v_rcp_f32 v43, v43
    v_rcp_f32 v44, v44
    v_rcp_f32 v45, v45
    v_rcp_f32 v46, v46
    v_rcp_f32 v47, v47
    s_nop 0
    v_pk_mul_f32 v[72:73], v[72:73], v[32:33]
    v_pk_mul_f32 v[74:75], v[74:75], v[34:35]
    v_pk_mul_f32 v[88:89], v[88:89], v[36:37]
    v_pk_mul_f32 v[90:91], v[90:91], v[38:39]
    v_pk_mul_f32 v[104:105], v[104:105], v[40:41]
    v_pk_mul_f32 v[106:107], v[106:107], v[42:43]
    v_pk_mul_f32 v[120:121], v[120:121], v[44:45]
    v_pk_mul_f32 v[122:123], v[122:123], v[46:47]
    v_cvt_pk_bf16_f32 v48, v72, v73
    v_cvt_pk_bf16_f32 v49, v74, v75
    v_cvt_pk_bf16_f32 v50, v88, v89
    v_cvt_pk_bf16_f32 v51, v90, v91
    v_cvt_pk_bf16_f32 v52, v104, v105
    v_cvt_pk_bf16_f32 v53, v106, v107
    v_cvt_pk_bf16_f32 v54, v120, v121
    v_cvt_pk_bf16_f32 v55, v122, v123
    buffer_store_dwordx4 v[48:51], v30, s[16:19], s48 offen offset:0 sc1
    buffer_store_dwordx4 v[52:55], v30, s[16:19], s48 offen offset:1024 sc1
    v_mul_f32 v224, 3222493025, v215
    v_mul_f32 v226, v215, v215
    v_rcp_f32 v228, v215
    v_mul_f32 v226, v226, v224
    v_mul_f32 v226, 1027024659, v226
    v_sub_f32 v230, 0, v214
    v_mov_b32 v225, v224
    v_mov_b32 v227, v226
    v_mov_b32 v229, v228
    v_mov_b32 v231, v230
    v_mov_b32 v232, v223
    v_mov_b32 v233, v223
    v_pk_fma_f32 v[76:77], v[230:231], v[192:193], v[76:77]
    v_pk_fma_f32 v[78:79], v[230:231], v[194:195], v[78:79]
    v_pk_fma_f32 v[92:93], v[230:231], v[196:197], v[92:93]
    v_pk_fma_f32 v[94:95], v[230:231], v[198:199], v[94:95]
    v_pk_fma_f32 v[108:109], v[230:231], v[200:201], v[108:109]
    v_pk_fma_f32 v[110:111], v[230:231], v[202:203], v[110:111]
    v_pk_fma_f32 v[124:125], v[230:231], v[204:205], v[124:125]
    v_pk_fma_f32 v[126:127], v[230:231], v[206:207], v[126:127]
    v_pk_mul_f32 v[32:33], v[76:77], v[76:77]
    v_pk_mul_f32 v[34:35], v[78:79], v[78:79]
    v_pk_mul_f32 v[36:37], v[92:93], v[92:93]
    v_pk_mul_f32 v[38:39], v[94:95], v[94:95]
    v_pk_mul_f32 v[40:41], v[108:109], v[108:109]
    v_pk_mul_f32 v[42:43], v[110:111], v[110:111]
    v_pk_mul_f32 v[44:45], v[124:125], v[124:125]
    v_pk_mul_f32 v[46:47], v[126:127], v[126:127]
    v_pk_fma_f32 v[32:33], v[32:33], v[226:227], v[224:225]
    v_pk_fma_f32 v[34:35], v[34:35], v[226:227], v[224:225]
    v_pk_fma_f32 v[36:37], v[36:37], v[226:227], v[224:225]
    v_pk_fma_f32 v[38:39], v[38:39], v[226:227], v[224:225]
    v_pk_fma_f32 v[40:41], v[40:41], v[226:227], v[224:225]
    v_pk_fma_f32 v[42:43], v[42:43], v[226:227], v[224:225]
    v_pk_fma_f32 v[44:45], v[44:45], v[226:227], v[224:225]
    v_pk_fma_f32 v[46:47], v[46:47], v[226:227], v[224:225]
    v_pk_mul_f32 v[32:33], v[32:33], v[76:77]
    v_pk_mul_f32 v[34:35], v[34:35], v[78:79]
    v_pk_mul_f32 v[36:37], v[36:37], v[92:93]
    v_pk_mul_f32 v[38:39], v[38:39], v[94:95]
    v_pk_mul_f32 v[40:41], v[40:41], v[108:109]
    v_pk_mul_f32 v[42:43], v[42:43], v[110:111]
    v_pk_mul_f32 v[44:45], v[44:45], v[124:125]
    v_pk_mul_f32 v[46:47], v[46:47], v[126:127]
    v_exp_f32 v32, v32
    v_exp_f32 v33, v33
    v_exp_f32 v34, v34
    v_exp_f32 v35, v35
    v_exp_f32 v36, v36
    v_exp_f32 v37, v37
    v_exp_f32 v38, v38
    v_exp_f32 v39, v39
    v_exp_f32 v40, v40
    v_exp_f32 v41, v41
    v_exp_f32 v42, v42
    v_exp_f32 v43, v43
    v_exp_f32 v44, v44
    v_exp_f32 v45, v45
    v_exp_f32 v46, v46
    v_exp_f32 v47, v47
    v_pk_mul_f32 v[76:77], v[76:77], v[232:233]
    v_pk_mul_f32 v[78:79], v[78:79], v[232:233]
    v_pk_mul_f32 v[92:93], v[92:93], v[232:233]
    v_pk_mul_f32 v[94:95], v[94:95], v[232:233]
    v_pk_mul_f32 v[108:109], v[108:109], v[232:233]
    v_pk_mul_f32 v[110:111], v[110:111], v[232:233]
    v_pk_mul_f32 v[124:125], v[124:125], v[232:233]
    v_pk_mul_f32 v[126:127], v[126:127], v[232:233]
    s_nop 0
    v_pk_fma_f32 v[32:33], v[32:33], v[228:229], v[228:229]
    v_pk_fma_f32 v[34:35], v[34:35], v[228:229], v[228:229]
    v_pk_fma_f32 v[36:37], v[36:37], v[228:229], v[228:229]
    v_pk_fma_f32 v[38:39], v[38:39], v[228:229], v[228:229]
    v_pk_fma_f32 v[40:41], v[40:41], v[228:229], v[228:229]
    v_pk_fma_f32 v[42:43], v[42:43], v[228:229], v[228:229]
    v_pk_fma_f32 v[44:45], v[44:45], v[228:229], v[228:229]
    v_pk_fma_f32 v[46:47], v[46:47], v[228:229], v[228:229]
    v_rcp_f32 v32, v32
    v_rcp_f32 v33, v33
    v_rcp_f32 v34, v34
    v_rcp_f32 v35, v35
    v_rcp_f32 v36, v36
    v_rcp_f32 v37, v37
    v_rcp_f32 v38, v38
    v_rcp_f32 v39, v39
    v_rcp_f32 v40, v40
    v_rcp_f32 v41, v41
    v_rcp_f32 v42, v42
    v_rcp_f32 v43, v43
    v_rcp_f32 v44, v44
    v_rcp_f32 v45, v45
    v_rcp_f32 v46, v46
    v_rcp_f32 v47, v47
    s_nop 0
    v_pk_mul_f32 v[76:77], v[76:77], v[32:33]
    v_pk_mul_f32 v[78:79], v[78:79], v[34:35]
    v_pk_mul_f32 v[92:93], v[92:93], v[36:37]
    v_pk_mul_f32 v[94:95], v[94:95], v[38:39]
    v_pk_mul_f32 v[108:109], v[108:109], v[40:41]
    v_pk_mul_f32 v[110:111], v[110:111], v[42:43]
    v_pk_mul_f32 v[124:125], v[124:125], v[44:45]
    v_pk_mul_f32 v[126:127], v[126:127], v[46:47]
    v_cvt_pk_bf16_f32 v56, v76, v77
    v_cvt_pk_bf16_f32 v57, v78, v79
    v_cvt_pk_bf16_f32 v58, v92, v93
    v_cvt_pk_bf16_f32 v59, v94, v95
    v_cvt_pk_bf16_f32 v60, v108, v109
    v_cvt_pk_bf16_f32 v61, v110, v111
    v_cvt_pk_bf16_f32 v62, v124, v125
    v_cvt_pk_bf16_f32 v63, v126, v127
    buffer_store_dwordx4 v[56:59], v31, s[16:19], s48 offen offset:0 sc1
    buffer_store_dwordx4 v[60:63], v31, s[16:19], s48 offen offset:1024 sc1
    s_branch L_ka_p4
L_ka_skip3:
    s_mov_b32 s39, 0
    v_and_b32 v2, 15, v1
    v_lshrrev_b32 v3, 4, v1
    s_waitcnt vmcnt(0) lgkmcnt(0)
    s_barrier
    s_cmp_lg_u32 s20, 0
    s_cbranch_scc1 L_nfo2_6041
    s_add_u32 s48, s37, 32
    s_lshl_b32 s48, s48, 8
    s_add_u32 s48, s48, 42860544
    v_mov_b32 v30, 0
    v_mov_b32 v31, 1
    s_mov_b64 exec, 1
    buffer_atomic_add v31, v30, s[16:19], s48 offen
    s_mov_b64 exec, -1
L_nfo2_6041:
    s_lshr_b32 s50, s40, 1
    s_lshl_b32 s50, s50, 3
    s_add_u32 s50, s50, s60
    s_sub_u32 s50, s50, 56
    s_mov_b32 s96, s68
    s_mov_b32 s97, s69
    s_mov_b32 s98, 7340032
    s_mov_b32 s99, 0x00020000
    v_mul_u32_u24 v16, 147, v1
    v_lshrrev_b32 v16, 11, v16
    v_mul_u32_u24 v17, 14, v16
    v_sub_u32 v17, v1, v17
    v_mul_u32_u24 v18, 7168, v16
    v_lshl_add_u32 v18, v17, 4, v18
    v_cmp_le_u32 vcc, 56, v1
    v_mov_b32 v19, 0x7fffffff
    s_mul_i32 s51, s20, 917504
    v_cndmask_b32 v18, v18, v19, vcc
    s_mul_i32 s52, s50, 224
    s_add_u32 s51, s51, s52
    v_mov_b32 v28, 0x00003f80
    v_mov_b32 v29, 0x3f800000
    v_mov_b32 v32, 0
    v_mov_b32 v33, 0
    v_mov_b32 v34, 0
    v_mov_b32 v35, 0
    v_mov_b32 v36, 0
    v_mov_b32 v37, 0
    v_mov_b32 v38, 0
    v_mov_b32 v39, 0
    buffer_load_dwordx4 v[64:67], v18, s[96:99], s51 offen
    s_add_u32 s51, s51, 28672
    buffer_load_dwordx4 v[68:71], v18, s[96:99], s51 offen
    s_add_u32 s51, s51, 28672
    buffer_load_dwordx4 v[72:75], v18, s[96:99], s51 offen
    s_add_u32 s51, s51, 28672
    buffer_load_dwordx4 v[76:79], v18, s[96:99], s51 offen
    s_add_u32 s51, s51, 28672
    buffer_load_dwordx4 v[80:83], v18, s[96:99], s51 offen
    s_add_u32 s51, s51, 28672
    buffer_load_dwordx4 v[84:87], v18, s[96:99], s51 offen
    s_add_u32 s51, s51, 28672
    buffer_load_dwordx4 v[88:91], v18, s[96:99], s51 offen
    s_add_u32 s51, s51, 28672
    buffer_load_dwordx4 v[92:95], v18, s[96:99], s51 offen
    s_add_u32 s51, s51, 28672
    buffer_load_dwordx4 v[96:99], v18, s[96:99], s51 offen
    s_add_u32 s51, s51, 28672
    buffer_load_dwordx4 v[100:103], v18, s[96:99], s51 offen
    s_add_u32 s51, s51, 28672
    buffer_load_dwordx4 v[104:107], v18, s[96:99], s51 offen
    s_add_u32 s51, s51, 28672
    buffer_load_dwordx4 v[108:111], v18, s[96:99], s51 offen
    s_add_u32 s51, s51, 28672
    buffer_load_dwordx4 v[112:115], v18, s[96:99], s51 offen
    s_add_u32 s51, s51, 28672
    buffer_load_dwordx4 v[116:119], v18, s[96:99], s51 offen
    s_add_u32 s51, s51, 28672
    buffer_load_dwordx4 v[120:123], v18, s[96:99], s51 offen
    s_add_u32 s51, s51, 28672
    buffer_load_dwordx4 v[124:127], v18, s[96:99], s51 offen
    s_add_u32 s51, s51, 28672
    buffer_load_dwordx4 v[128:131], v18, s[96:99], s51 offen
    s_add_u32 s51, s51, 28672
    buffer_load_dwordx4 v[132:135], v18, s[96:99], s51 offen
    s_add_u32 s51, s51, 28672
    buffer_load_dwordx4 v[136:139], v18, s[96:99], s51 offen
    s_add_u32 s51, s51, 28672
    buffer_load_dwordx4 v[140:143], v18, s[96:99], s51 offen
    s_add_u32 s51, s51, 28672
    buffer_load_dwordx4 v[144:147], v18, s[96:99], s51 offen
    s_add_u32 s51, s51, 28672
    buffer_load_dwordx4 v[148:151], v18, s[96:99], s51 offen
    s_add_u32 s51, s51, 28672
    buffer_load_dwordx4 v[152:155], v18, s[96:99], s51 offen
    s_add_u32 s51, s51, 28672
    buffer_load_dwordx4 v[156:159], v18, s[96:99], s51 offen
    s_add_u32 s51, s51, 28672
    buffer_load_dwordx4 v[160:163], v18, s[96:99], s51 offen
    s_add_u32 s51, s51, 28672
    buffer_load_dwordx4 v[164:167], v18, s[96:99], s51 offen
    s_add_u32 s51, s51, 28672
    buffer_load_dwordx4 v[168:171], v18, s[96:99], s51 offen
    s_add_u32 s51, s51, 28672
    buffer_load_dwordx4 v[172:175], v18, s[96:99], s51 offen
    s_add_u32 s51, s51, 28672
    buffer_load_dwordx4 v[176:179], v18, s[96:99], s51 offen
    s_add_u32 s51, s51, 28672
    buffer_load_dwordx4 v[180:183], v18, s[96:99], s51 offen
    s_add_u32 s51, s51, 28672
    buffer_load_dwordx4 v[184:187], v18, s[96:99], s51 offen
    s_add_u32 s51, s51, 28672
    buffer_load_dwordx4 v[188:191], v18, s[96:99], s51 offen
    s_add_u32 s51, s51, 28672
    s_waitcnt vmcnt(28)
    v_dot2_f32_bf16 v32, v64, v28, v32
    v_dot2_f32_bf16 v33, v64, v29, v33
    v_dot2_f32_bf16 v34, v65, v28, v34
    v_dot2_f32_bf16 v35, v65, v29, v35
    v_dot2_f32_bf16 v36, v66, v28, v36
    v_dot2_f32_bf16 v37, v66, v29, v37
    v_dot2_f32_bf16 v38, v67, v28, v38
    v_dot2_f32_bf16 v39, v67, v29, v39
    v_dot2_f32_bf16 v32, v68, v28, v32
    v_dot2_f32_bf16 v33, v68, v29, v33
    v_dot2_f32_bf16 v34, v69, v28, v34
    v_dot2_f32_bf16 v35, v69, v29, v35
    v_dot2_f32_bf16 v36, v70, v28, v36
    v_dot2_f32_bf16 v37, v70, v29, v37
    v_dot2_f32_bf16 v38, v71, v28, v38
    v_dot2_f32_bf16 v39, v71, v29, v39
    v_dot2_f32_bf16 v32, v72, v28, v32
    v_dot2_f32_bf16 v33, v72, v29, v33
    v_dot2_f32_bf16 v34, v73, v28, v34
    v_dot2_f32_bf16 v35, v73, v29, v35
    v_dot2_f32_bf16 v36, v74, v28, v36
    v_dot2_f32_bf16 v37, v74, v29, v37
    v_dot2_f32_bf16 v38, v75, v28, v38
    v_dot2_f32_bf16 v39, v75, v29, v39
    v_dot2_f32_bf16 v32, v76, v28, v32
    v_dot2_f32_bf16 v33, v76, v29, v33
    v_dot2_f32_bf16 v34, v77, v28, v34
    v_dot2_f32_bf16 v35, v77, v29, v35
    v_dot2_f32_bf16 v36, v78, v28, v36
    v_dot2_f32_bf16 v37, v78, v29, v37
    v_dot2_f32_bf16 v38, v79, v28, v38
    v_dot2_f32_bf16 v39, v79, v29, v39
    s_waitcnt vmcnt(24)
    v_dot2_f32_bf16 v32, v80, v28, v32
    v_dot2_f32_bf16 v33, v80, v29, v33
    v_dot2_f32_bf16 v34, v81, v28, v34
    v_dot2_f32_bf16 v35, v81, v29, v35
    v_dot2_f32_bf16 v36, v82, v28, v36
    v_dot2_f32_bf16 v37, v82, v29, v37
    v_dot2_f32_bf16 v38, v83, v28, v38
    v_dot2_f32_bf16 v39, v83, v29, v39
    v_dot2_f32_bf16 v32, v84, v28, v32
    v_dot2_f32_bf16 v33, v84, v29, v33
    v_dot2_f32_bf16 v34, v85, v28, v34
    v_dot2_f32_bf16 v35, v85, v29, v35
    v_dot2_f32_bf16 v36, v86, v28, v36
    v_dot2_f32_bf16 v37, v86, v29, v37
    v_dot2_f32_bf16 v38, v87, v28, v38
    v_dot2_f32_bf16 v39, v87, v29, v39
    v_dot2_f32_bf16 v32, v88, v28, v32
    v_dot2_f32_bf16 v33, v88, v29, v33
    v_dot2_f32_bf16 v34, v89, v28, v34
    v_dot2_f32_bf16 v35, v89, v29, v35
    v_dot2_f32_bf16 v36, v90, v28, v36
    v_dot2_f32_bf16 v37, v90, v29, v37
    v_dot2_f32_bf16 v38, v91, v28, v38
    v_dot2_f32_bf16 v39, v91, v29, v39
    v_dot2_f32_bf16 v32, v92, v28, v32
    v_dot2_f32_bf16 v33, v92, v29, v33
    v_dot2_f32_bf16 v34, v93, v28, v34
    v_dot2_f32_bf16 v35, v93, v29, v35
    v_dot2_f32_bf16 v36, v94, v28, v36
    v_dot2_f32_bf16 v37, v94, v29, v37
    v_dot2_f32_bf16 v38, v95, v28, v38
    v_dot2_f32_bf16 v39, v95, v29, v39
    s_waitcnt vmcnt(20)
    v_dot2_f32_bf16 v32, v96, v28, v32
    v_dot2_f32_bf16 v33, v96, v29, v33
    v_dot2_f32_bf16 v34, v97, v28, v34
    v_dot2_f32_bf16 v35, v97, v29, v35
    v_dot2_f32_bf16 v36, v98, v28, v36
    v_dot2_f32_bf16 v37, v98, v29, v37
    v_dot2_f32_bf16 v38, v99, v28, v38
    v_dot2_f32_bf16 v39, v99, v29, v39
    v_dot2_f32_bf16 v32, v100, v28, v32
    v_dot2_f32_bf16 v33, v100, v29, v33
    v_dot2_f32_bf16 v34, v101, v28, v34
    v_dot2_f32_bf16 v35, v101, v29, v35
    v_dot2_f32_bf16 v36, v102, v28, v36
    v_dot2_f32_bf16 v37, v102, v29, v37
    v_dot2_f32_bf16 v38, v103, v28, v38
    v_dot2_f32_bf16 v39, v103, v29, v39
    v_dot2_f32_bf16 v32, v104, v28, v32
    v_dot2_f32_bf16 v33, v104, v29, v33
    v_dot2_f32_bf16 v34, v105, v28, v34
    v_dot2_f32_bf16 v35, v105, v29, v35
    v_dot2_f32_bf16 v36, v106, v28, v36
    v_dot2_f32_bf16 v37, v106, v29, v37
    v_dot2_f32_bf16 v38, v107, v28, v38
    v_dot2_f32_bf16 v39, v107, v29, v39
    v_dot2_f32_bf16 v32, v108, v28, v32
    v_dot2_f32_bf16 v33, v108, v29, v33
    v_dot2_f32_bf16 v34, v109, v28, v34
    v_dot2_f32_bf16 v35, v109, v29, v35
    v_dot2_f32_bf16 v36, v110, v28, v36
    v_dot2_f32_bf16 v37, v110, v29, v37
    v_dot2_f32_bf16 v38, v111, v28, v38
    v_dot2_f32_bf16 v39, v111, v29, v39
    s_waitcnt vmcnt(16)
    v_dot2_f32_bf16 v32, v112, v28, v32
    v_dot2_f32_bf16 v33, v112, v29, v33
    v_dot2_f32_bf16 v34, v113, v28, v34
    v_dot2_f32_bf16 v35, v113, v29, v35
    v_dot2_f32_bf16 v36, v114, v28, v36
    v_dot2_f32_bf16 v37, v114, v29, v37
    v_dot2_f32_bf16 v38, v115, v28, v38
    v_dot2_f32_bf16 v39, v115, v29, v39
    v_dot2_f32_bf16 v32, v116, v28, v32
    v_dot2_f32_bf16 v33, v116, v29, v33
    v_dot2_f32_bf16 v34, v117, v28, v34
    v_dot2_f32_bf16 v35, v117, v29, v35
    v_dot2_f32_bf16 v36, v118, v28, v36
    v_dot2_f32_bf16 v37, v118, v29, v37
    v_dot2_f32_bf16 v38, v119, v28, v38
    v_dot2_f32_bf16 v39, v119, v29, v39
    v_dot2_f32_bf16 v32, v120, v28, v32
    v_dot2_f32_bf16 v33, v120, v29, v33
    v_dot2_f32_bf16 v34, v121, v28, v34
    v_dot2_f32_bf16 v35, v121, v29, v35
    v_dot2_f32_bf16 v36, v122, v28, v36
    v_dot2_f32_bf16 v37, v122, v29, v37
    v_dot2_f32_bf16 v38, v123, v28, v38
    v_dot2_f32_bf16 v39, v123, v29, v39
    v_dot2_f32_bf16 v32, v124, v28, v32
    v_dot2_f32_bf16 v33, v124, v29, v33
    v_dot2_f32_bf16 v34, v125, v28, v34
    v_dot2_f32_bf16 v35, v125, v29, v35
    v_dot2_f32_bf16 v36, v126, v28, v36
    v_dot2_f32_bf16 v37, v126, v29, v37
    v_dot2_f32_bf16 v38, v127, v28, v38
    v_dot2_f32_bf16 v39, v127, v29, v39
    s_waitcnt vmcnt(12)
    v_dot2_f32_bf16 v32, v128, v28, v32
    v_dot2_f32_bf16 v33, v128, v29, v33
    v_dot2_f32_bf16 v34, v129, v28, v34
    v_dot2_f32_bf16 v35, v129, v29, v35
    v_dot2_f32_bf16 v36, v130, v28, v36
    v_dot2_f32_bf16 v37, v130, v29, v37
    v_dot2_f32_bf16 v38, v131, v28, v38
    v_dot2_f32_bf16 v39, v131, v29, v39
    v_dot2_f32_bf16 v32, v132, v28, v32
    v_dot2_f32_bf16 v33, v132, v29, v33
    v_dot2_f32_bf16 v34, v133, v28, v34
    v_dot2_f32_bf16 v35, v133, v29, v35
    v_dot2_f32_bf16 v36, v134, v28, v36
    v_dot2_f32_bf16 v37, v134, v29, v37
    v_dot2_f32_bf16 v38, v135, v28, v38
    v_dot2_f32_bf16 v39, v135, v29, v39
    v_dot2_f32_bf16 v32, v136, v28, v32
    v_dot2_f32_bf16 v33, v136, v29, v33
    v_dot2_f32_bf16 v34, v137, v28, v34
    v_dot2_f32_bf16 v35, v137, v29, v35
    v_dot2_f32_bf16 v36, v138, v28, v36
    v_dot2_f32_bf16 v37, v138, v29, v37
    v_dot2_f32_bf16 v38, v139, v28, v38
    v_dot2_f32_bf16 v39, v139, v29, v39
    v_dot2_f32_bf16 v32, v140, v28, v32
    v_dot2_f32_bf16 v33, v140, v29, v33
    v_dot2_f32_bf16 v34, v141, v28, v34
    v_dot2_f32_bf16 v35, v141, v29, v35
    v_dot2_f32_bf16 v36, v142, v28, v36
    v_dot2_f32_bf16 v37, v142, v29, v37
    v_dot2_f32_bf16 v38, v143, v28, v38
    v_dot2_f32_bf16 v39, v143, v29, v39
    s_waitcnt vmcnt(8)
    v_dot2_f32_bf16 v32, v144, v28, v32
    v_dot2_f32_bf16 v33, v144, v29, v33
    v_dot2_f32_bf16 v34, v145, v28, v34
    v_dot2_f32_bf16 v35, v145, v29, v35
    v_dot2_f32_bf16 v36, v146, v28, v36
    v_dot2_f32_bf16 v37, v146, v29, v37
    v_dot2_f32_bf16 v38, v147, v28, v38
    v_dot2_f32_bf16 v39, v147, v29, v39
    v_dot2_f32_bf16 v32, v148, v28, v32
    v_dot2_f32_bf16 v33, v148, v29, v33
    v_dot2_f32_bf16 v34, v149, v28, v34
    v_dot2_f32_bf16 v35, v149, v29, v35
    v_dot2_f32_bf16 v36, v150, v28, v36
    v_dot2_f32_bf16 v37, v150, v29, v37
    v_dot2_f32_bf16 v38, v151, v28, v38
    v_dot2_f32_bf16 v39, v151, v29, v39
    v_dot2_f32_bf16 v32, v152, v28, v32
    v_dot2_f32_bf16 v33, v152, v29, v33
    v_dot2_f32_bf16 v34, v153, v28, v34
    v_dot2_f32_bf16 v35, v153, v29, v35
    v_dot2_f32_bf16 v36, v154, v28, v36
    v_dot2_f32_bf16 v37, v154, v29, v37
    v_dot2_f32_bf16 v38, v155, v28, v38
    v_dot2_f32_bf16 v39, v155, v29, v39
    v_dot2_f32_bf16 v32, v156, v28, v32
    v_dot2_f32_bf16 v33, v156, v29, v33
    v_dot2_f32_bf16 v34, v157, v28, v34
    v_dot2_f32_bf16 v35, v157, v29, v35
    v_dot2_f32_bf16 v36, v158, v28, v36
    v_dot2_f32_bf16 v37, v158, v29, v37
    v_dot2_f32_bf16 v38, v159, v28, v38
    v_dot2_f32_bf16 v39, v159, v29, v39
    s_waitcnt vmcnt(4)
    v_dot2_f32_bf16 v32, v160, v28, v32
    v_dot2_f32_bf16 v33, v160, v29, v33
    v_dot2_f32_bf16 v34, v161, v28, v34
    v_dot2_f32_bf16 v35, v161, v29, v35
    v_dot2_f32_bf16 v36, v162, v28, v36
    v_dot2_f32_bf16 v37, v162, v29, v37
    v_dot2_f32_bf16 v38, v163, v28, v38
    v_dot2_f32_bf16 v39, v163, v29, v39
    v_dot2_f32_bf16 v32, v164, v28, v32
    v_dot2_f32_bf16 v33, v164, v29, v33
    v_dot2_f32_bf16 v34, v165, v28, v34
    v_dot2_f32_bf16 v35, v165, v29, v35
    v_dot2_f32_bf16 v36, v166, v28, v36
    v_dot2_f32_bf16 v37, v166, v29, v37
    v_dot2_f32_bf16 v38, v167, v28, v38
    v_dot2_f32_bf16 v39, v167, v29, v39
    v_dot2_f32_bf16 v32, v168, v28, v32
    v_dot2_f32_bf16 v33, v168, v29, v33
    v_dot2_f32_bf16 v34, v169, v28, v34
    v_dot2_f32_bf16 v35, v169, v29, v35
    v_dot2_f32_bf16 v36, v170, v28, v36
    v_dot2_f32_bf16 v37, v170, v29, v37
    v_dot2_f32_bf16 v38, v171, v28, v38
    v_dot2_f32_bf16 v39, v171, v29, v39
    v_dot2_f32_bf16 v32, v172, v28, v32
    v_dot2_f32_bf16 v33, v172, v29, v33
    v_dot2_f32_bf16 v34, v173, v28, v34
    v_dot2_f32_bf16 v35, v173, v29, v35
    v_dot2_f32_bf16 v36, v174, v28, v36
    v_dot2_f32_bf16 v37, v174, v29, v37
    v_dot2_f32_bf16 v38, v175, v28, v38
    v_dot2_f32_bf16 v39, v175, v29, v39
    s_waitcnt vmcnt(0)
    v_dot2_f32_bf16 v32, v176, v28, v32
    v_dot2_f32_bf16 v33, v176, v29, v33
    v_dot2_f32_bf16 v34, v177, v28, v34
    v_dot2_f32_bf16 v35, v177, v29, v35
    v_dot2_f32_bf16 v36, v178, v28, v36
    v_dot2_f32_bf16 v37, v178, v29, v37
    v_dot2_f32_bf16 v38, v179, v28, v38
    v_dot2_f32_bf16 v39, v179, v29, v39
    v_dot2_f32_bf16 v32, v180, v28, v32
    v_dot2_f32_bf16 v33, v180, v29, v33
    v_dot2_f32_bf16 v34, v181, v28, v34
    v_dot2_f32_bf16 v35, v181, v29, v35
    v_dot2_f32_bf16 v36, v182, v28, v36
    v_dot2_f32_bf16 v37, v182, v29, v37
    v_dot2_f32_bf16 v38, v183, v28, v38
    v_dot2_f32_bf16 v39, v183, v29, v39
    v_dot2_f32_bf16 v32, v184, v28, v32
    v_dot2_f32_bf16 v33, v184, v29, v33
    v_dot2_f32_bf16 v34, v185, v28, v34
    v_dot2_f32_bf16 v35, v185, v29, v35
    v_dot2_f32_bf16 v36, v186, v28, v36
    v_dot2_f32_bf16 v37, v186, v29, v37
    v_dot2_f32_bf16 v38, v187, v28, v38
    v_dot2_f32_bf16 v39, v187, v29, v39
    v_dot2_f32_bf16 v32, v188, v28, v32
    v_dot2_f32_bf16 v33, v188, v29, v33
    v_dot2_f32_bf16 v34, v189, v28, v34
    v_dot2_f32_bf16 v35, v189, v29, v35
    v_dot2_f32_bf16 v36, v190, v28, v36
    v_dot2_f32_bf16 v37, v190, v29, v37
    v_dot2_f32_bf16 v38, v191, v28, v38
    v_dot2_f32_bf16 v39, v191, v29, v39
    v_mul_u32_u24 v19, 448, v16
    v_lshl_add_u32 v19, v17, 5, v19
    s_mul_i32 s51, s20, 1792
    v_add_u32 v19, s51, v19
    v_lshlrev_b32 v20, 5, v1
    v_add_u32 v20, 32768, v20
    v_cndmask_b32 v19, v19, v20, vcc
    ds_write_b128 v19, v[32:35]
    ds_write_b128 v19, v[36:39] offset:16
    s_lshr_b32 s38, s50, 2
    s_add_u32 s38, s38, 16
    s_lshl_b32 s38, s38, 8
    s_add_u32 s38, s38, 42860544
    s_cmp_lg_u32 s20, 0
    s_cbranch_scc1 L_sv_w
    v_mov_b32 v24, 0
    v_mov_b32 v25, 0
    s_nop 0
    s_mov_b32 s91, 0
L_spsvx_6042:
    v_readfirstlane_b32 s90, v25
    s_cmp_ge_u32 s90, 32
    s_cbranch_scc1 L_spoksvx_6043
    s_add_u32 s91, s91, 1
    s_cmp_ge_u32 s91, 4194304
    s_cbranch_scc1 L_spoksvx_6043
    s_sleep 4
    buffer_load_dword v25, v24, s[16:19], s38 offen sc1
    s_waitcnt vmcnt(0)
    s_branch L_spsvx_6042
L_spoksvx_6043:
L_sv_w:
    s_waitcnt lgkmcnt(0)
    s_barrier
    s_lshl_b32 s51, s50, 9
    s_lshl_b32 s52, s20, 16
    s_add_u32 s51, s51, s52
    s_add_u32 s51, s51, 44040192
    v_lshlrev_b32 v21, 3, v1
    buffer_load_dwordx2 v[40:41], v21, s[16:19], s51 offen sc1
    s_add_u32 s51, s51, 16384
    buffer_load_dwordx2 v[42:43], v21, s[16:19], s51 offen sc1
    s_add_u32 s51, s51, 16384
    buffer_load_dwordx2 v[44:45], v21, s[16:19], s51 offen sc1
    s_add_u32 s51, s51, 16384
    buffer_load_dwordx2 v[46:47], v21, s[16:19], s51 offen sc1
    s_add_u32 s51, s51, 16384
    v_and_b32 v22, 127, v0
    v_lshlrev_b32 v22, 2, v22
    ds_read_b32 v64, v22 offset:0
    ds_read_b32 v65, v22 offset:448
    ds_read_b32 v66, v22 offset:896
    ds_read_b32 v67, v22 offset:1344
    ds_read_b32 v68, v22 offset:1792
    ds_read_b32 v69, v22 offset:2240
    ds_read_b32 v70, v22 offset:2688
    ds_read_b32 v71, v22 offset:3136
    ds_read_b32 v72, v22 offset:3584
    ds_read_b32 v73, v22 offset:4032
    ds_read_b32 v74, v22 offset:4480
    ds_read_b32 v75, v22 offset:4928
    ds_read_b32 v76, v22 offset:5376
    ds_read_b32 v77, v22 offset:5824
    ds_read_b32 v78, v22 offset:6272
    ds_read_b32 v79, v22 offset:6720
    ds_read_b32 v80, v22 offset:7168
    ds_read_b32 v81, v22 offset:7616
    ds_read_b32 v82, v22 offset:8064
    ds_read_b32 v83, v22 offset:8512
    ds_read_b32 v84, v22 offset:8960
    ds_read_b32 v85, v22 offset:9408
    ds_read_b32 v86, v22 offset:9856
    ds_read_b32 v87, v22 offset:10304
    ds_read_b32 v88, v22 offset:10752
    ds_read_b32 v89, v22 offset:11200
    ds_read_b32 v90, v22 offset:11648
    ds_read_b32 v91, v22 offset:12096
    ds_read_b32 v92, v22 offset:12544
    ds_read_b32 v93, v22 offset:12992
    ds_read_b32 v94, v22 offset:13440
    ds_read_b32 v95, v22 offset:13888
    s_waitcnt lgkmcnt(0)
    v_add_f32 v64, v64, v80
    v_add_f32 v65, v65, v81
    v_add_f32 v66, v66, v82
    v_add_f32 v67, v67, v83
    v_add_f32 v68, v68, v84
    v_add_f32 v69, v69, v85
    v_add_f32 v70, v70, v86
    v_add_f32 v71, v71, v87
    v_add_f32 v72, v72, v88
    v_add_f32 v73, v73, v89
    v_add_f32 v74, v74, v90
    v_add_f32 v75, v75, v91
    v_add_f32 v76, v76, v92
    v_add_f32 v77, v77, v93
    v_add_f32 v78, v78, v94
    v_add_f32 v79, v79, v95
    v_add_f32 v64, v64, v72
    v_add_f32 v65, v65, v73
    v_add_f32 v66, v66, v74
    v_add_f32 v67, v67, v75
    v_add_f32 v68, v68, v76
    v_add_f32 v69, v69, v77
    v_add_f32 v70, v70, v78
    v_add_f32 v71, v71, v79
    v_add_f32 v64, v64, v68
    v_add_f32 v65, v65, v69
    v_add_f32 v66, v66, v70
    v_add_f32 v67, v67, v71
    v_add_f32 v64, v64, v66
    v_add_f32 v65, v65, v67
    v_add_f32 v64, v64, v65
    v_mov_b32 v23, 112
    v_cmp_lt_u32 vcc, v0, v23
    v_mov_b32 v23, 0x7fffffff
    s_mul_i32 s51, s50, 448
    s_add_u32 s51, s51, 42008576
    v_cndmask_b32 v22, v23, v22, vcc
    s_waitcnt vmcnt(0)
    buffer_store_dword v64, v22, s[16:19], s51 offen sc1
    v_add_f32 v40, v40, v42
    v_add_f32 v41, v41, v43
    v_add_f32 v40, v40, v44
    v_add_f32 v41, v41, v45
    v_add_f32 v40, v40, v46
    v_add_f32 v41, v41, v47
    s_lshl_b32 s51, s20, 9
    s_add_u32 s51, s51, 65536
    v_add_u32 v23, s51, v21
    ds_write_b64 v23, v[40:41]
    s_waitcnt lgkmcnt(0)
    s_barrier
    v_add_u32 v23, 65536, v21
    ds_read_b64 v[64:65], v23 offset:0
    ds_read_b64 v[66:67], v23 offset:512
    ds_read_b64 v[68:69], v23 offset:1024
    ds_read_b64 v[70:71], v23 offset:1536
    ds_read_b64 v[72:73], v23 offset:2048
    ds_read_b64 v[74:75], v23 offset:2560
    ds_read_b64 v[76:77], v23 offset:3072
    ds_read_b64 v[78:79], v23 offset:3584
    s_waitcnt lgkmcnt(0)
    v_add_f32 v64, v64, v66
    v_add_f32 v65, v65, v67
    v_add_f32 v64, v64, v68
    v_add_f32 v65, v65, v69
    v_add_f32 v64, v64, v70
    v_add_f32 v65, v65, v71
    v_add_f32 v64, v64, v72
    v_add_f32 v65, v65, v73
    v_add_f32 v64, v64, v74
    v_add_f32 v65, v65, v75
    v_add_f32 v64, v64, v76
    v_add_f32 v65, v65, v77
    v_add_f32 v64, v64, v78
    v_add_f32 v65, v65, v79
    v_mul_f32 v64, 981467136, v64
    v_mul_f32 v65, 981467136, v65
    v_fma_f32 v65, -v64, v64, v65
    v_max_f32 v65, 0, v65
    v_add_f32 v65, 925353388, v65
    v_rsq_f32 v65, v65
    s_lshl_b32 s51, s50, 9
    s_add_u32 s51, s51, 42041344
    s_cmp_lg_u32 s20, 0
    s_cbranch_scc1 L_sv_ns
    buffer_store_dwordx2 v[64:65], v21, s[16:19], s51 offen sc1
L_sv_ns:
    s_waitcnt vmcnt(0)
    s_barrier
    s_cmp_lg_u32 s20, 0
    s_cbranch_scc1 L_nfcs_6044
    s_mov_b32 s48, 42872832
    v_mov_b32 v30, 0
    v_mov_b32 v31, 1
    s_mov_b64 exec, 1
    buffer_atomic_add v31, v30, s[16:19], s48 offen
    s_mov_b64 exec, -1
L_nfcs_6044:
    s_lshl_b32 s51, s50, 3
    s_add_u32 s51, s51, s20
    v_lshlrev_b32 v26, 6, v1
    s_mov_b32 s96, s72
    s_mov_b32 s97, s73
    s_mov_b32 s98, 7340032
    s_lshl_b32 s52, s51, 12
    s_add_u32 s53, s52, 0
    buffer_load_dword v27, v26, s[96:99], s53 offen
    s_add_u32 s53, s52, 3145728
    buffer_load_dword v27, v26, s[96:99], s53 offen
    s_add_u32 s53, s52, 1048576
    buffer_load_dword v27, v26, s[96:99], s53 offen
    s_add_u32 s53, s52, 4194304
    buffer_load_dword v27, v26, s[96:99], s53 offen
    s_add_u32 s53, s52, 2097152
    buffer_load_dword v27, v26, s[96:99], s53 offen
    s_add_u32 s53, s52, 5242880
    buffer_load_dword v27, v26, s[96:99], s53 offen
    s_add_u32 s53, s52, 6291456
    buffer_load_dword v27, v26, s[96:99], s53 offen
    s_and_b32 s43, s40, 1
    s_lshr_b32 s42, s40, 1
    s_lshl_b32 s42, s42, 2
    s_and_b32 s44, s41, 3
    s_add_u32 s42, s42, s44
    s_lshr_b32 s44, s41, 2
    s_lshl_b32 s47, s42, 3
    s_add_u32 s47, s47, s44
    v_lshlrev_b32 v224, 4, v1
    s_lshl_b32 s55, s42, 2
    s_lshr_b32 s56, s20, 1
    s_add_u32 s55, s55, s56
    s_lshl_b32 s57, s22, 11
    s_mul_i32 s56, s55, 229376
    s_add_u32 s56, s56, s57
    s_add_u32 s56, s56, 25165824
    v_add_u32 v7, s56, v224
    s_lshl_b32 s56, s55, 16
    s_add_u32 s56, s56, s57
    s_add_u32 s56, s56, 20971520
    v_add_u32 v4, s56, v224
    v_lshlrev_b32 v225, 1, v3
    v_xor_b32 v225, v2, v225
    v_xor_b32 v226, 8, v225
    s_lshl_b32 s55, s20, 3
    v_add_u32 v227, s55, v3
    v_lshlrev_b32 v227, 11, v227
    s_lshl_b32 s55, s44, 1
    s_add_u32 s56, s55, 1
    s_cmp_eq_u32 s22, 0
    s_cselect_b32 s45, s55, s56
    s_lshl_b32 s55, s55, 7
    s_lshl_b32 s56, s56, 7
    v_and_b32 v228, 7, v225
    v_lshl_add_u32 v227, v228, 4, v227
    v_mov_b32 v228, s55
    v_mov_b32 v229, s56
    v_cmp_gt_u32 vcc, 8, v225
    s_nop 1
    v_cndmask_b32 v230, v229, v228, vcc
    v_cndmask_b32 v231, v228, v229, vcc
    v_add_u32 v5, v227, v230
    v_add_u32 v231, v227, v231
    v_add_u32 v6, 7168, v231
    s_lshl_b32 s29, s20, 11
    s_mul_i32 s24, s43, 32768
    s_mul_i32 s25, s43, 1048576
    s_mov_b32 s12, s70
    s_mov_b32 s13, s71
    s_mov_b32 s14, 2097152
    s_mov_b32 s15, 0x00020000
    s_lshr_b32 s38, s42, 1
    s_add_u32 s38, s38, 32
    s_lshl_b32 s38, s38, 8
    s_add_u32 s38, s38, 42860544
    s_cmp_lg_u32 s20, 0
    s_cbranch_scc1 L_ka_w
    v_mov_b32 v24, 0
    v_mov_b32 v25, 0
    s_nop 0
    s_mov_b32 s91, 0
L_spo3_6045:
    v_readfirstlane_b32 s90, v25
    s_cmp_ge_u32 s90, 32
    s_cbranch_scc1 L_spoko3_6046
    s_add_u32 s91, s91, 1
    s_cmp_ge_u32 s91, 4194304
    s_cbranch_scc1 L_spoko3_6046
    s_sleep 4
    buffer_load_dword v25, v24, s[16:19], s38 offen sc1
    s_waitcnt vmcnt(0)
    s_branch L_spo3_6045
L_spoko3_6046:
L_ka_w:
    s_barrier
    s_add_u32 m0, s29, 0
    s_nop 0
    buffer_load_dwordx4 v4, s[16:19], s24 offen sc1 lds
    buffer_load_dwordx4 v4, s[16:19], s24 offen offset:1024 sc1 lds
    s_add_u32 m0, s29, 16384
    s_nop 0
    buffer_load_dwordx4 v5, s[12:15], s25 offen lds
    buffer_load_dwordx4 v6, s[12:15], s25 offen offset:1024 lds
    s_add_u32 s24, s24, 4096
    s_add_u32 s25, s25, 131072
    s_add_u32 m0, s29, 32768
    s_nop 0
    buffer_load_dwordx4 v4, s[16:19], s24 offen sc1 lds
    buffer_load_dwordx4 v4, s[16:19], s24 offen offset:1024 sc1 lds
    s_add_u32 m0, s29, 49152
    s_nop 0
    buffer_load_dwordx4 v5, s[12:15], s25 offen lds
    buffer_load_dwordx4 v6, s[12:15], s25 offen offset:1024 lds
    s_add_u32 s24, s24, 4096
    s_add_u32 s25, s25, 131072
    s_add_u32 m0, s29, 65536
    s_nop 0
    buffer_load_dwordx4 v4, s[16:19], s24 offen sc1 lds
    buffer_load_dwordx4 v4, s[16:19], s24 offen offset:1024 sc1 lds
    s_add_u32 m0, s29, 81920
    s_nop 0
    buffer_load_dwordx4 v5, s[12:15], s25 offen lds
    buffer_load_dwordx4 v6, s[12:15], s25 offen offset:1024 lds
    s_add_u32 s24, s24, 4096
    s_add_u32 s25, s25, 131072
    s_lshr_b32 s23, s20, 2
    s_bfe_u32 s21, s20, 0x10001
    v_lshlrev_b32 v20, 4, v1
    s_lshl_b32 s49, s21, 13
    s_lshl_b32 s57, s23, 10
    s_add_u32 s49, s49, s57
    v_add_u32 v8, s49, v20
    v_add_u32 v9, 65536, v8
    v_bfe_u32 v22, v1, 2, 2
    v_lshl_add_u32 v22, v3, 2, v22
    v_and_b32 v23, 7, v22
    s_lshl_b32 s49, s22, 2
    v_xor_b32 v23, s49, v23
    v_lshlrev_b32 v22, 8, v22
    v_lshl_add_u32 v22, v23, 5, v22
    v_and_b32 v23, 3, v1
    v_lshl_add_u32 v22, v23, 3, v22
    s_lshl_b32 s49, s23, 13
    s_add_u32 s49, s49, 16384
    v_add_u32 v10, s49, v22
    v_xor_b32 v11, 32, v10
    v_xor_b32 v12, 64, v10
    v_xor_b32 v13, 96, v10
    v_add_u32 v14, 65536, v10
    v_add_u32 v15, 65536, v11
    v_add_u32 v16, 65536, v12
    v_add_u32 v17, 65536, v13
    s_cmp_eq_u32 s43, 0
    s_cselect_b32 s28, 7, 6
    s_lshl_b32 s49, s42, 7
    s_lshl_b32 s57, s21, 6
    s_add_u32 s46, s49, s57
    s_lshl_b32 s50, s42, 2
    s_lshl_b32 s51, s21, 1
    s_add_u32 s50, s50, s51
    s_lshl_b32 s50, s50, 16
    s_lshl_b32 s51, s45, 12
    s_add_u32 s50, s50, s51
    s_lshl_b32 s51, s23, 10
    s_add_u32 s50, s50, s51
    s_add_u32 s36, s50, 16777216
    s_add_u32 s37, s36, 65536
    s_lshr_b32 s38, s42, 1
    s_lshl_b32 s38, s38, 8
    s_add_u32 s38, s38, 42860544
L_ka_p4:
    v_mov_b32 v18, 0
    s_waitcnt vmcnt(0) lgkmcnt(0)
    s_barrier
    s_cmp_ge_u32 s60, 56
    s_cbranch_scc1 L_nosig3_6047
    s_cmp_lg_u32 s20, 0
    s_cbranch_scc1 L_nosig3_6047
    s_lshl_b32 s48, s39, 8
    s_add_u32 s48, s48, 42860544
    v_mov_b32 v19, 1
    s_mov_b64 exec, 1
    buffer_atomic_add v19, v18, s[16:19], s48 offen
    s_mov_b64 exec, -1
L_nosig3_6047:
    ds_read_b128 v[32:35], v8 offset:0
    ds_read_b64_tr_b16 v[128:129], v10 offset:0
    ds_read_b64_tr_b16 v[130:131], v10 offset:4096
    ds_read_b128 v[36:39], v8 offset:2048
    ds_read_b128 v[40:43], v8 offset:4096
    ds_read_b128 v[44:47], v8 offset:6144
    ds_read_b64_tr_b16 v[132:133], v11 offset:0
    ds_read_b64_tr_b16 v[134:135], v11 offset:4096
    ds_read_b64_tr_b16 v[136:137], v12 offset:0
    ds_read_b64_tr_b16 v[138:139], v12 offset:4096
    ds_read_b64_tr_b16 v[140:141], v13 offset:0
    ds_read_b64_tr_b16 v[142:143], v13 offset:4096
    s_add_u32 m0, s29, 98304
    s_nop 0
    buffer_load_dwordx4 v4, s[16:19], s24 offen sc1 lds
    buffer_load_dwordx4 v4, s[16:19], s24 offen offset:1024 sc1 lds
    s_add_u32 m0, s29, 114688
    s_nop 0
    buffer_load_dwordx4 v5, s[12:15], s25 offen lds
    buffer_load_dwordx4 v6, s[12:15], s25 offen offset:1024 lds
    s_add_u32 s24, s24, 4096
    s_add_u32 s25, s25, 131072
    s_waitcnt lgkmcnt(0)
    s_barrier
    s_add_u32 m0, s29, 0
    v_mfma_f32_16x16x32_bf16 v[64:67], v[128:131], v[32:35], 0
    ds_read_b128 v[48:51], v8 offset:32768
    v_mfma_f32_16x16x32_bf16 v[68:71], v[128:131], v[36:39], 0
    ds_read_b64_tr_b16 v[144:145], v10 offset:32768
    buffer_load_dwordx4 v4, s[16:19], s24 offen sc1 lds
    v_mfma_f32_16x16x32_bf16 v[72:75], v[128:131], v[40:43], 0
    ds_read_b64_tr_b16 v[146:147], v10 offset:36864
    v_mfma_f32_16x16x32_bf16 v[76:79], v[128:131], v[44:47], 0
    ds_read_b128 v[52:55], v8 offset:34816
    v_mfma_f32_16x16x32_bf16 v[80:83], v[132:135], v[32:35], 0
    ds_read_b128 v[56:59], v8 offset:36864
    buffer_load_dwordx4 v4, s[16:19], s24 offen offset:1024 sc1 lds
    v_mfma_f32_16x16x32_bf16 v[84:87], v[132:135], v[36:39], 0
    ds_read_b128 v[60:63], v8 offset:38912
    v_mfma_f32_16x16x32_bf16 v[88:91], v[132:135], v[40:43], 0
    ds_read_b64_tr_b16 v[148:149], v11 offset:32768
    s_add_u32 m0, s29, 16384
    v_mfma_f32_16x16x32_bf16 v[92:95], v[132:135], v[44:47], 0
    ds_read_b64_tr_b16 v[150:151], v11 offset:36864
    v_mfma_f32_16x16x32_bf16 v[96:99], v[136:139], v[32:35], 0
    ds_read_b64_tr_b16 v[152:153], v12 offset:32768
    buffer_load_dwordx4 v5, s[12:15], s25 offen lds
    v_mfma_f32_16x16x32_bf16 v[100:103], v[136:139], v[36:39], 0
    ds_read_b64_tr_b16 v[154:155], v12 offset:36864
    v_mfma_f32_16x16x32_bf16 v[104:107], v[136:139], v[40:43], 0
    ds_read_b64_tr_b16 v[156:157], v13 offset:32768
    v_mfma_f32_16x16x32_bf16 v[108:111], v[136:139], v[44:47], 0
    ds_read_b64_tr_b16 v[158:159], v13 offset:36864
    buffer_load_dwordx4 v6, s[12:15], s25 offen offset:1024 lds
    v_mfma_f32_16x16x32_bf16 v[112:115], v[140:143], v[32:35], 0
    s_add_u32 s24, s24, 4096
    s_add_u32 s25, s25, 131072
    v_mfma_f32_16x16x32_bf16 v[116:119], v[140:143], v[36:39], 0
    v_mfma_f32_16x16x32_bf16 v[120:123], v[140:143], v[40:43], 0
    v_mfma_f32_16x16x32_bf16 v[124:127], v[140:143], v[44:47], 0
    s_waitcnt lgkmcnt(0)
    s_barrier
    s_add_u32 m0, s29, 32768
    v_mfma_f32_16x16x32_bf16 v[64:67], v[144:147], v[48:51], v[64:67]
    ds_read_b128 v[32:35], v9 offset:0
    v_mfma_f32_16x16x32_bf16 v[68:71], v[144:147], v[52:55], v[68:71]
    ds_read_b64_tr_b16 v[128:129], v14 offset:0
    buffer_load_dwordx4 v4, s[16:19], s24 offen sc1 lds
    v_mfma_f32_16x16x32_bf16 v[72:75], v[144:147], v[56:59], v[72:75]
    ds_read_b64_tr_b16 v[130:131], v14 offset:4096
    v_mfma_f32_16x16x32_bf16 v[76:79], v[144:147], v[60:63], v[76:79]
    ds_read_b128 v[36:39], v9 offset:2048
    v_mfma_f32_16x16x32_bf16 v[80:83], v[148:151], v[48:51], v[80:83]
    ds_read_b128 v[40:43], v9 offset:4096
    buffer_load_dwordx4 v4, s[16:19], s24 offen offset:1024 sc1 lds
    v_mfma_f32_16x16x32_bf16 v[84:87], v[148:151], v[52:55], v[84:87]
    ds_read_b128 v[44:47], v9 offset:6144
    v_mfma_f32_16x16x32_bf16 v[88:91], v[148:151], v[56:59], v[88:91]
    ds_read_b64_tr_b16 v[132:133], v15 offset:0
    s_add_u32 m0, s29, 49152
    v_mfma_f32_16x16x32_bf16 v[92:95], v[148:151], v[60:63], v[92:95]
    ds_read_b64_tr_b16 v[134:135], v15 offset:4096
    v_mfma_f32_16x16x32_bf16 v[96:99], v[152:155], v[48:51], v[96:99]
    ds_read_b64_tr_b16 v[136:137], v16 offset:0
    buffer_load_dwordx4 v5, s[12:15], s25 offen lds
    v_mfma_f32_16x16x32_bf16 v[100:103], v[152:155], v[52:55], v[100:103]
    ds_read_b64_tr_b16 v[138:139], v16 offset:4096
    v_mfma_f32_16x16x32_bf16 v[104:107], v[152:155], v[56:59], v[104:107]
    ds_read_b64_tr_b16 v[140:141], v17 offset:0
    v_mfma_f32_16x16x32_bf16 v[108:111], v[152:155], v[60:63], v[108:111]
    ds_read_b64_tr_b16 v[142:143], v17 offset:4096
    buffer_load_dwordx4 v6, s[12:15], s25 offen offset:1024 lds
    v_mfma_f32_16x16x32_bf16 v[112:115], v[156:159], v[48:51], v[112:115]
    s_add_u32 s24, s24, 4096
    s_add_u32 s25, s25, 131072
    v_mfma_f32_16x16x32_bf16 v[116:119], v[156:159], v[52:55], v[116:119]
    v_mfma_f32_16x16x32_bf16 v[120:123], v[156:159], v[56:59], v[120:123]
    v_mfma_f32_16x16x32_bf16 v[124:127], v[156:159], v[60:63], v[124:127]
    s_waitcnt vmcnt(8) lgkmcnt(0)
    s_barrier
    s_add_u32 m0, s29, 65536
    v_mfma_f32_16x16x32_bf16 v[64:67], v[128:131], v[32:35], v[64:67]
    ds_read_b128 v[48:51], v9 offset:32768
    v_mfma_f32_16x16x32_bf16 v[68:71], v[128:131], v[36:39], v[68:71]
    ds_read_b64_tr_b16 v[144:145], v14 offset:32768
    buffer_load_dwordx4 v4, s[16:19], s24 offen sc1 lds
    v_mfma_f32_16x16x32_bf16 v[72:75], v[128:131], v[40:43], v[72:75]
    ds_read_b64_tr_b16 v[146:147], v14 offset:36864
    v_mfma_f32_16x16x32_bf16 v[76:79], v[128:131], v[44:47], v[76:79]
    ds_read_b128 v[52:55], v9 offset:34816
    v_mfma_f32_16x16x32_bf16 v[80:83], v[132:135], v[32:35], v[80:83]
    ds_read_b128 v[56:59], v9 offset:36864
    buffer_load_dwordx4 v4, s[16:19], s24 offen offset:1024 sc1 lds
    v_mfma_f32_16x16x32_bf16 v[84:87], v[132:135], v[36:39], v[84:87]
    ds_read_b128 v[60:63], v9 offset:38912
    v_mfma_f32_16x16x32_bf16 v[88:91], v[132:135], v[40:43], v[88:91]
    ds_read_b64_tr_b16 v[148:149], v15 offset:32768
    s_add_u32 m0, s29, 81920
    v_mfma_f32_16x16x32_bf16 v[92:95], v[132:135], v[44:47], v[92:95]
    ds_read_b64_tr_b16 v[150:151], v15 offset:36864
    v_mfma_f32_16x16x32_bf16 v[96:99], v[136:139], v[32:35], v[96:99]
    ds_read_b64_tr_b16 v[152:153], v16 offset:32768
    buffer_load_dwordx4 v5, s[12:15], s25 offen lds
    v_mfma_f32_16x16x32_bf16 v[100:103], v[136:139], v[36:39], v[100:103]
    ds_read_b64_tr_b16 v[154:155], v16 offset:36864
    v_mfma_f32_16x16x32_bf16 v[104:107], v[136:139], v[40:43], v[104:107]
    ds_read_b64_tr_b16 v[156:157], v17 offset:32768
    v_mfma_f32_16x16x32_bf16 v[108:111], v[136:139], v[44:47], v[108:111]
    ds_read_b64_tr_b16 v[158:159], v17 offset:36864
    buffer_load_dwordx4 v6, s[12:15], s25 offen offset:1024 lds
    v_mfma_f32_16x16x32_bf16 v[112:115], v[140:143], v[32:35], v[112:115]
    s_add_u32 s24, s24, 4096
    s_add_u32 s25, s25, 131072
    v_mfma_f32_16x16x32_bf16 v[116:119], v[140:143], v[36:39], v[116:119]
    v_mfma_f32_16x16x32_bf16 v[120:123], v[140:143], v[40:43], v[120:123]
    v_mfma_f32_16x16x32_bf16 v[124:127], v[140:143], v[44:47], v[124:127]
    s_cmp_lg_u32 s20, 0
    s_cbranch_scc1 L_nopoll_6048
    buffer_load_dword v19, v18, s[16:19], s38 offen sc1
L_nopoll_6048:
    s_waitcnt vmcnt(8) lgkmcnt(0)
    s_barrier
    s_add_u32 m0, s29, 98304
    v_mfma_f32_16x16x32_bf16 v[64:67], v[144:147], v[48:51], v[64:67]
    ds_read_b128 v[32:35], v8 offset:0
    v_mfma_f32_16x16x32_bf16 v[68:71], v[144:147], v[52:55], v[68:71]
    ds_read_b64_tr_b16 v[128:129], v10 offset:0
    buffer_load_dwordx4 v4, s[16:19], s24 offen sc1 lds
    v_mfma_f32_16x16x32_bf16 v[72:75], v[144:147], v[56:59], v[72:75]
    ds_read_b64_tr_b16 v[130:131], v10 offset:4096
    v_mfma_f32_16x16x32_bf16 v[76:79], v[144:147], v[60:63], v[76:79]
    ds_read_b128 v[36:39], v8 offset:2048
    v_mfma_f32_16x16x32_bf16 v[80:83], v[148:151], v[48:51], v[80:83]
    ds_read_b128 v[40:43], v8 offset:4096
    buffer_load_dwordx4 v4, s[16:19], s24 offen offset:1024 sc1 lds
    v_mfma_f32_16x16x32_bf16 v[84:87], v[148:151], v[52:55], v[84:87]
    ds_read_b128 v[44:47], v8 offset:6144
    v_mfma_f32_16x16x32_bf16 v[88:91], v[148:151], v[56:59], v[88:91]
    ds_read_b64_tr_b16 v[132:133], v11 offset:0
    s_add_u32 m0, s29, 114688
    v_mfma_f32_16x16x32_bf16 v[92:95], v[148:151], v[60:63], v[92:95]
    ds_read_b64_tr_b16 v[134:135], v11 offset:4096
    v_mfma_f32_16x16x32_bf16 v[96:99], v[152:155], v[48:51], v[96:99]
    ds_read_b64_tr_b16 v[136:137], v12 offset:0
    buffer_load_dwordx4 v5, s[12:15], s25 offen lds
    v_mfma_f32_16x16x32_bf16 v[100:103], v[152:155], v[52:55], v[100:103]
    ds_read_b64_tr_b16 v[138:139], v12 offset:4096
    v_mfma_f32_16x16x32_bf16 v[104:107], v[152:155], v[56:59], v[104:107]
    ds_read_b64_tr_b16 v[140:141], v13 offset:0
    v_mfma_f32_16x16x32_bf16 v[108:111], v[152:155], v[60:63], v[108:111]
    ds_read_b64_tr_b16 v[142:143], v13 offset:4096
    buffer_load_dwordx4 v6, s[12:15], s25 offen offset:1024 lds
    v_mfma_f32_16x16x32_bf16 v[112:115], v[156:159], v[48:51], v[112:115]
    s_add_u32 s24, s24, 4096
    s_add_u32 s25, s25, 131072
    v_mfma_f32_16x16x32_bf16 v[116:119], v[156:159], v[52:55], v[116:119]
    v_mfma_f32_16x16x32_bf16 v[120:123], v[156:159], v[56:59], v[120:123]
    v_mfma_f32_16x16x32_bf16 v[124:127], v[156:159], v[60:63], v[124:127]
    s_cmp_lg_u32 s20, 0
    s_cbranch_scc1 L_nochk_6049
    s_waitcnt vmcnt(4)
    s_mov_b32 s91, 0
L_sph3_6050:
    v_readfirstlane_b32 s90, v19
    s_cmp_ge_u32 s90, 28
    s_cbranch_scc1 L_spokh3_6051
    s_add_u32 s91, s91, 1
    s_cmp_ge_u32 s91, 4194304
    s_cbranch_scc1 L_spokh3_6051
    s_sleep 4
    buffer_load_dword v19, v18, s[16:19], s38 offen sc1
    s_waitcnt vmcnt(0)
    s_branch L_sph3_6050
L_spokh3_6051:
L_nochk_6049:
    s_waitcnt vmcnt(8) lgkmcnt(0)
    s_barrier
    v_mov_b32 v4, v7
    s_mov_b32 s12, s72
    s_mov_b32 s13, s73
    s_mov_b32 s14, 7340032
    s_cmp_eq_u32 s43, 0
    s_cselect_b32 s24, 106496, 0
    s_cselect_b32 s25, 3407872, 0
.p2align 6
L_p4_loop:
    s_add_u32 m0, s29, 0
    v_mfma_f32_16x16x32_bf16 v[64:67], v[128:131], v[32:35], v[64:67]
    ds_read_b128 v[48:51], v8 offset:32768
    v_mfma_f32_16x16x32_bf16 v[68:71], v[128:131], v[36:39], v[68:71]
    ds_read_b64_tr_b16 v[144:145], v10 offset:32768
    buffer_load_dwordx4 v4, s[16:19], s24 offen sc1 lds
    v_mfma_f32_16x16x32_bf16 v[72:75], v[128:131], v[40:43], v[72:75]
    ds_read_b64_tr_b16 v[146:147], v10 offset:36864
    v_mfma_f32_16x16x32_bf16 v[76:79], v[128:131], v[44:47], v[76:79]
    ds_read_b128 v[52:55], v8 offset:34816
    v_mfma_f32_16x16x32_bf16 v[80:83], v[132:135], v[32:35], v[80:83]
    ds_read_b128 v[56:59], v8 offset:36864
    buffer_load_dwordx4 v4, s[16:19], s24 offen offset:1024 sc1 lds
    v_mfma_f32_16x16x32_bf16 v[84:87], v[132:135], v[36:39], v[84:87]
    ds_read_b128 v[60:63], v8 offset:38912
    v_mfma_f32_16x16x32_bf16 v[88:91], v[132:135], v[40:43], v[88:91]
    ds_read_b64_tr_b16 v[148:149], v11 offset:32768
    s_add_u32 m0, s29, 16384
    v_mfma_f32_16x16x32_bf16 v[92:95], v[132:135], v[44:47], v[92:95]
    ds_read_b64_tr_b16 v[150:151], v11 offset:36864
    v_mfma_f32_16x16x32_bf16 v[96:99], v[136:139], v[32:35], v[96:99]
    ds_read_b64_tr_b16 v[152:153], v12 offset:32768
    buffer_load_dwordx4 v5, s[12:15], s25 offen lds
    v_mfma_f32_16x16x32_bf16 v[100:103], v[136:139], v[36:39], v[100:103]
    ds_read_b64_tr_b16 v[154:155], v12 offset:36864
    v_mfma_f32_16x16x32_bf16 v[104:107], v[136:139], v[40:43], v[104:107]
    ds_read_b64_tr_b16 v[156:157], v13 offset:32768
    v_mfma_f32_16x16x32_bf16 v[108:111], v[136:139], v[44:47], v[108:111]
    ds_read_b64_tr_b16 v[158:159], v13 offset:36864
    buffer_load_dwordx4 v6, s[12:15], s25 offen offset:1024 lds
    v_mfma_f32_16x16x32_bf16 v[112:115], v[140:143], v[32:35], v[112:115]
    s_add_u32 s24, s24, 4096
    s_add_u32 s25, s25, 131072
    v_mfma_f32_16x16x32_bf16 v[116:119], v[140:143], v[36:39], v[116:119]
    v_mfma_f32_16x16x32_bf16 v[120:123], v[140:143], v[40:43], v[120:123]
    v_mfma_f32_16x16x32_bf16 v[124:127], v[140:143], v[44:47], v[124:127]
    s_waitcnt vmcnt(8) lgkmcnt(0)
    s_barrier
    s_add_u32 m0, s29, 32768
    v_mfma_f32_16x16x32_bf16 v[64:67], v[144:147], v[48:51], v[64:67]
    ds_read_b128 v[32:35], v9 offset:0
    v_mfma_f32_16x16x32_bf16 v[68:71], v[144:147], v[52:55], v[68:71]
    ds_read_b64_tr_b16 v[128:129], v14 offset:0
    buffer_load_dwordx4 v4, s[16:19], s24 offen sc1 lds
    v_mfma_f32_16x16x32_bf16 v[72:75], v[144:147], v[56:59], v[72:75]
    ds_read_b64_tr_b16 v[130:131], v14 offset:4096
    v_mfma_f32_16x16x32_bf16 v[76:79], v[144:147], v[60:63], v[76:79]
    ds_read_b128 v[36:39], v9 offset:2048
    v_mfma_f32_16x16x32_bf16 v[80:83], v[148:151], v[48:51], v[80:83]
    ds_read_b128 v[40:43], v9 offset:4096
    buffer_load_dwordx4 v4, s[16:19], s24 offen offset:1024 sc1 lds
    v_mfma_f32_16x16x32_bf16 v[84:87], v[148:151], v[52:55], v[84:87]
    ds_read_b128 v[44:47], v9 offset:6144
    v_mfma_f32_16x16x32_bf16 v[88:91], v[148:151], v[56:59], v[88:91]
    ds_read_b64_tr_b16 v[132:133], v15 offset:0
    s_add_u32 m0, s29, 49152
    v_mfma_f32_16x16x32_bf16 v[92:95], v[148:151], v[60:63], v[92:95]
    ds_read_b64_tr_b16 v[134:135], v15 offset:4096
    v_mfma_f32_16x16x32_bf16 v[96:99], v[152:155], v[48:51], v[96:99]
    ds_read_b64_tr_b16 v[136:137], v16 offset:0
    buffer_load_dwordx4 v5, s[12:15], s25 offen lds
    v_mfma_f32_16x16x32_bf16 v[100:103], v[152:155], v[52:55], v[100:103]
    ds_read_b64_tr_b16 v[138:139], v16 offset:4096
    v_mfma_f32_16x16x32_bf16 v[104:107], v[152:155], v[56:59], v[104:107]
    ds_read_b64_tr_b16 v[140:141], v17 offset:0
    v_mfma_f32_16x16x32_bf16 v[108:111], v[152:155], v[60:63], v[108:111]
    ds_read_b64_tr_b16 v[142:143], v17 offset:4096
    buffer_load_dwordx4 v6, s[12:15], s25 offen offset:1024 lds
    v_mfma_f32_16x16x32_bf16 v[112:115], v[156:159], v[48:51], v[112:115]
    s_add_u32 s24, s24, 4096
    s_add_u32 s25, s25, 131072
    v_mfma_f32_16x16x32_bf16 v[116:119], v[156:159], v[52:55], v[116:119]
    v_mfma_f32_16x16x32_bf16 v[120:123], v[156:159], v[56:59], v[120:123]
    v_mfma_f32_16x16x32_bf16 v[124:127], v[156:159], v[60:63], v[124:127]
    s_waitcnt vmcnt(8) lgkmcnt(0)
    s_barrier
    s_add_u32 m0, s29, 65536
    v_mfma_f32_16x16x32_bf16 v[64:67], v[128:131], v[32:35], v[64:67]
    ds_read_b128 v[48:51], v9 offset:32768
    v_mfma_f32_16x16x32_bf16 v[68:71], v[128:131], v[36:39], v[68:71]
    ds_read_b64_tr_b16 v[144:145], v14 offset:32768
    buffer_load_dwordx4 v4, s[16:19], s24 offen sc1 lds
    v_mfma_f32_16x16x32_bf16 v[72:75], v[128:131], v[40:43], v[72:75]
    ds_read_b64_tr_b16 v[146:147], v14 offset:36864
    v_mfma_f32_16x16x32_bf16 v[76:79], v[128:131], v[44:47], v[76:79]
    ds_read_b128 v[52:55], v9 offset:34816
    v_mfma_f32_16x16x32_bf16 v[80:83], v[132:135], v[32:35], v[80:83]
    ds_read_b128 v[56:59], v9 offset:36864
    buffer_load_dwordx4 v4, s[16:19], s24 offen offset:1024 sc1 lds
    v_mfma_f32_16x16x32_bf16 v[84:87], v[132:135], v[36:39], v[84:87]
    ds_read_b128 v[60:63], v9 offset:38912
    v_mfma_f32_16x16x32_bf16 v[88:91], v[132:135], v[40:43], v[88:91]
    ds_read_b64_tr_b16 v[148:149], v15 offset:32768
    s_add_u32 m0, s29, 81920
    v_mfma_f32_16x16x32_bf16 v[92:95], v[132:135], v[44:47], v[92:95]
    ds_read_b64_tr_b16 v[150:151], v15 offset:36864
    v_mfma_f32_16x16x32_bf16 v[96:99], v[136:139], v[32:35], v[96:99]
    ds_read_b64_tr_b16 v[152:153], v16 offset:32768
    buffer_load_dwordx4 v5, s[12:15], s25 offen lds
    v_mfma_f32_16x16x32_bf16 v[100:103], v[136:139], v[36:39], v[100:103]
    ds_read_b64_tr_b16 v[154:155], v16 offset:36864
    v_mfma_f32_16x16x32_bf16 v[104:107], v[136:139], v[40:43], v[104:107]
    ds_read_b64_tr_b16 v[156:157], v17 offset:32768
    v_mfma_f32_16x16x32_bf16 v[108:111], v[136:139], v[44:47], v[108:111]
    ds_read_b64_tr_b16 v[158:159], v17 offset:36864
    buffer_load_dwordx4 v6, s[12:15], s25 offen offset:1024 lds
    v_mfma_f32_16x16x32_bf16 v[112:115], v[140:143], v[32:35], v[112:115]
    s_add_u32 s24, s24, 4096
    s_add_u32 s25, s25, 131072
    v_mfma_f32_16x16x32_bf16 v[116:119], v[140:143], v[36:39], v[116:119]
    v_mfma_f32_16x16x32_bf16 v[120:123], v[140:143], v[40:43], v[120:123]
    v_mfma_f32_16x16x32_bf16 v[124:127], v[140:143], v[44:47], v[124:127]
    s_waitcnt vmcnt(8) lgkmcnt(0)
    s_barrier
    s_add_u32 m0, s29, 98304
    v_mfma_f32_16x16x32_bf16 v[64:67], v[144:147], v[48:51], v[64:67]
    ds_read_b128 v[32:35], v8 offset:0
    v_mfma_f32_16x16x32_bf16 v[68:71], v[144:147], v[52:55], v[68:71]
    ds_read_b64_tr_b16 v[128:129], v10 offset:0
    buffer_load_dwordx4 v4, s[16:19], s24 offen sc1 lds
    v_mfma_f32_16x16x32_bf16 v[72:75], v[144:147], v[56:59], v[72:75]
    ds_read_b64_tr_b16 v[130:131], v10 offset:4096
    v_mfma_f32_16x16x32_bf16 v[76:79], v[144:147], v[60:63], v[76:79]
    ds_read_b128 v[36:39], v8 offset:2048
    v_mfma_f32_16x16x32_bf16 v[80:83], v[148:151], v[48:51], v[80:83]
    ds_read_b128 v[40:43], v8 offset:4096
    buffer_load_dwordx4 v4, s[16:19], s24 offen offset:1024 sc1 lds
    v_mfma_f32_16x16x32_bf16 v[84:87], v[148:151], v[52:55], v[84:87]
    ds_read_b128 v[44:47], v8 offset:6144
    v_mfma_f32_16x16x32_bf16 v[88:91], v[148:151], v[56:59], v[88:91]
    ds_read_b64_tr_b16 v[132:133], v11 offset:0
    s_add_u32 m0, s29, 114688
    v_mfma_f32_16x16x32_bf16 v[92:95], v[148:151], v[60:63], v[92:95]
    ds_read_b64_tr_b16 v[134:135], v11 offset:4096
    v_mfma_f32_16x16x32_bf16 v[96:99], v[152:155], v[48:51], v[96:99]
    ds_read_b64_tr_b16 v[136:137], v12 offset:0
    buffer_load_dwordx4 v5, s[12:15], s25 offen lds
    v_mfma_f32_16x16x32_bf16 v[100:103], v[152:155], v[52:55], v[100:103]
    ds_read_b64_tr_b16 v[138:139], v12 offset:4096
    v_mfma_f32_16x16x32_bf16 v[104:107], v[152:155], v[56:59], v[104:107]
    ds_read_b64_tr_b16 v[140:141], v13 offset:0
    v_mfma_f32_16x16x32_bf16 v[108:111], v[152:155], v[60:63], v[108:111]
    ds_read_b64_tr_b16 v[142:143], v13 offset:4096
    buffer_load_dwordx4 v6, s[12:15], s25 offen offset:1024 lds
    v_mfma_f32_16x16x32_bf16 v[112:115], v[156:159], v[48:51], v[112:115]
    s_add_u32 s24, s24, 4096
    s_add_u32 s25, s25, 131072
    v_mfma_f32_16x16x32_bf16 v[116:119], v[156:159], v[52:55], v[116:119]
    v_mfma_f32_16x16x32_bf16 v[120:123], v[156:159], v[56:59], v[120:123]
    s_sub_u32 s28, s28, 1
    s_cmp_lg_u32 s28, 0
    v_mfma_f32_16x16x32_bf16 v[124:127], v[156:159], v[60:63], v[124:127]
    s_waitcnt vmcnt(8) lgkmcnt(0)
    s_barrier
    s_cbranch_scc1 L_p4_loop
    s_lshl_b32 s56, s47, 15
    s_lshl_b32 s49, s20, 12
    s_add_u32 s56, s56, s49
    s_add_u32 s56, s56, 46137344
    s_mov_b32 s52, 0
    s_lshl_b32 s53, s47, 8
    s_add_u32 s53, s53, 42893312
    s_mov_b32 s55, 0
    s_add_u32 m0, s29, 0
    v_mfma_f32_16x16x32_bf16 v[64:67], v[128:131], v[32:35], v[64:67]
    ds_read_b128 v[48:51], v8 offset:32768
    v_mfma_f32_16x16x32_bf16 v[68:71], v[128:131], v[36:39], v[68:71]
    ds_read_b64_tr_b16 v[144:145], v10 offset:32768
    buffer_load_dwordx4 v4, s[16:19], s24 offen sc1 lds
    v_mfma_f32_16x16x32_bf16 v[72:75], v[128:131], v[40:43], v[72:75]
    ds_read_b64_tr_b16 v[146:147], v10 offset:36864
    v_mfma_f32_16x16x32_bf16 v[76:79], v[128:131], v[44:47], v[76:79]
    ds_read_b128 v[52:55], v8 offset:34816
    v_mfma_f32_16x16x32_bf16 v[80:83], v[132:135], v[32:35], v[80:83]
    ds_read_b128 v[56:59], v8 offset:36864
    buffer_load_dwordx4 v4, s[16:19], s24 offen offset:1024 sc1 lds
    v_mfma_f32_16x16x32_bf16 v[84:87], v[132:135], v[36:39], v[84:87]
    ds_read_b128 v[60:63], v8 offset:38912
    v_mfma_f32_16x16x32_bf16 v[88:91], v[132:135], v[40:43], v[88:91]
    ds_read_b64_tr_b16 v[148:149], v11 offset:32768
    s_add_u32 m0, s29, 16384
    v_mfma_f32_16x16x32_bf16 v[92:95], v[132:135], v[44:47], v[92:95]
    ds_read_b64_tr_b16 v[150:151], v11 offset:36864
    v_mfma_f32_16x16x32_bf16 v[96:99], v[136:139], v[32:35], v[96:99]
    ds_read_b64_tr_b16 v[152:153], v12 offset:32768
    buffer_load_dwordx4 v5, s[12:15], s25 offen lds
    v_mfma_f32_16x16x32_bf16 v[100:103], v[136:139], v[36:39], v[100:103]
    ds_read_b64_tr_b16 v[154:155], v12 offset:36864
    v_mfma_f32_16x16x32_bf16 v[104:107], v[136:139], v[40:43], v[104:107]
    ds_read_b64_tr_b16 v[156:157], v13 offset:32768
    v_mfma_f32_16x16x32_bf16 v[108:111], v[136:139], v[44:47], v[108:111]
    ds_read_b64_tr_b16 v[158:159], v13 offset:36864
    buffer_load_dwordx4 v6, s[12:15], s25 offen offset:1024 lds
    v_mfma_f32_16x16x32_bf16 v[112:115], v[140:143], v[32:35], v[112:115]
    s_add_u32 s24, s24, 4096
    s_add_u32 s25, s25, 131072
    v_mfma_f32_16x16x32_bf16 v[116:119], v[140:143], v[36:39], v[116:119]
    v_mfma_f32_16x16x32_bf16 v[120:123], v[140:143], v[40:43], v[120:123]
    v_mfma_f32_16x16x32_bf16 v[124:127], v[140:143], v[44:47], v[124:127]
    s_waitcnt vmcnt(8) lgkmcnt(0)
    s_barrier
    s_add_u32 m0, s29, 32768
    v_mfma_f32_16x16x32_bf16 v[64:67], v[144:147], v[48:51], v[64:67]
    ds_read_b128 v[32:35], v9 offset:0
    v_mfma_f32_16x16x32_bf16 v[68:71], v[144:147], v[52:55], v[68:71]
    ds_read_b64_tr_b16 v[128:129], v14 offset:0
    buffer_load_dwordx4 v4, s[16:19], s24 offen sc1 lds
    v_mfma_f32_16x16x32_bf16 v[72:75], v[144:147], v[56:59], v[72:75]
    ds_read_b64_tr_b16 v[130:131], v14 offset:4096
    v_mfma_f32_16x16x32_bf16 v[76:79], v[144:147], v[60:63], v[76:79]
    ds_read_b128 v[36:39], v9 offset:2048
    v_mfma_f32_16x16x32_bf16 v[80:83], v[148:151], v[48:51], v[80:83]
    ds_read_b128 v[40:43], v9 offset:4096
    buffer_load_dwordx4 v4, s[16:19], s24 offen offset:1024 sc1 lds
    v_mfma_f32_16x16x32_bf16 v[84:87], v[148:151], v[52:55], v[84:87]
    ds_read_b128 v[44:47], v9 offset:6144
    v_mfma_f32_16x16x32_bf16 v[88:91], v[148:151], v[56:59], v[88:91]
    ds_read_b64_tr_b16 v[132:133], v15 offset:0
    s_add_u32 m0, s29, 49152
    v_mfma_f32_16x16x32_bf16 v[92:95], v[148:151], v[60:63], v[92:95]
    ds_read_b64_tr_b16 v[134:135], v15 offset:4096
    v_mfma_f32_16x16x32_bf16 v[96:99], v[152:155], v[48:51], v[96:99]
    ds_read_b64_tr_b16 v[136:137], v16 offset:0
    buffer_load_dwordx4 v5, s[12:15], s25 offen lds
    v_mfma_f32_16x16x32_bf16 v[100:103], v[152:155], v[52:55], v[100:103]
    ds_read_b64_tr_b16 v[138:139], v16 offset:4096
    v_mfma_f32_16x16x32_bf16 v[104:107], v[152:155], v[56:59], v[104:107]
    ds_read_b64_tr_b16 v[140:141], v17 offset:0
    v_mfma_f32_16x16x32_bf16 v[108:111], v[152:155], v[60:63], v[108:111]
    ds_read_b64_tr_b16 v[142:143], v17 offset:4096
    buffer_load_dwordx4 v6, s[12:15], s25 offen offset:1024 lds
    v_mfma_f32_16x16x32_bf16 v[112:115], v[156:159], v[48:51], v[112:115]
    s_add_u32 s24, s24, 4096
    s_add_u32 s25, s25, 131072
    v_mfma_f32_16x16x32_bf16 v[116:119], v[156:159], v[52:55], v[116:119]
    v_mfma_f32_16x16x32_bf16 v[120:123], v[156:159], v[56:59], v[120:123]
    v_mfma_f32_16x16x32_bf16 v[124:127], v[156:159], v[60:63], v[124:127]
    s_waitcnt vmcnt(8) lgkmcnt(0)
    s_barrier
    v_mfma_f32_16x16x32_bf16 v[64:67], v[128:131], v[32:35], v[64:67]
    ds_read_b128 v[48:51], v9 offset:32768
    v_mfma_f32_16x16x32_bf16 v[68:71], v[128:131], v[36:39], v[68:71]
    ds_read_b64_tr_b16 v[144:145], v14 offset:32768
    v_mfma_f32_16x16x32_bf16 v[72:75], v[128:131], v[40:43], v[72:75]
    ds_read_b64_tr_b16 v[146:147], v14 offset:36864
    v_mfma_f32_16x16x32_bf16 v[76:79], v[128:131], v[44:47], v[76:79]
    ds_read_b128 v[52:55], v9 offset:34816
    v_mfma_f32_16x16x32_bf16 v[80:83], v[132:135], v[32:35], v[80:83]
    ds_read_b128 v[56:59], v9 offset:36864
    v_mfma_f32_16x16x32_bf16 v[84:87], v[132:135], v[36:39], v[84:87]
    ds_read_b128 v[60:63], v9 offset:38912
    v_mfma_f32_16x16x32_bf16 v[88:91], v[132:135], v[40:43], v[88:91]
    ds_read_b64_tr_b16 v[148:149], v15 offset:32768
    v_mfma_f32_16x16x32_bf16 v[92:95], v[132:135], v[44:47], v[92:95]
    ds_read_b64_tr_b16 v[150:151], v15 offset:36864
    buffer_load_dword v19, v18, s[16:19], s53 offen sc1
    v_mfma_f32_16x16x32_bf16 v[96:99], v[136:139], v[32:35], v[96:99]
    ds_read_b64_tr_b16 v[152:153], v16 offset:32768
    v_mfma_f32_16x16x32_bf16 v[100:103], v[136:139], v[36:39], v[100:103]
    ds_read_b64_tr_b16 v[154:155], v16 offset:36864
    v_mfma_f32_16x16x32_bf16 v[104:107], v[136:139], v[40:43], v[104:107]
    ds_read_b64_tr_b16 v[156:157], v17 offset:32768
    v_mfma_f32_16x16x32_bf16 v[108:111], v[136:139], v[44:47], v[108:111]
    ds_read_b64_tr_b16 v[158:159], v17 offset:36864
    v_mfma_f32_16x16x32_bf16 v[112:115], v[140:143], v[32:35], v[112:115]
    v_mfma_f32_16x16x32_bf16 v[116:119], v[140:143], v[36:39], v[116:119]
    v_mfma_f32_16x16x32_bf16 v[120:123], v[140:143], v[40:43], v[120:123]
    v_mfma_f32_16x16x32_bf16 v[124:127], v[140:143], v[44:47], v[124:127]
    s_waitcnt vmcnt(5) lgkmcnt(0)
    s_barrier
    v_mfma_f32_16x16x32_bf16 v[64:67], v[144:147], v[48:51], v[64:67]
    ds_read_b128 v[32:35], v8 offset:0
    v_mfma_f32_16x16x32_bf16 v[68:71], v[144:147], v[52:55], v[68:71]
    ds_read_b64_tr_b16 v[128:129], v10 offset:0
    v_mfma_f32_16x16x32_bf16 v[72:75], v[144:147], v[56:59], v[72:75]
    ds_read_b64_tr_b16 v[130:131], v10 offset:4096
    v_mfma_f32_16x16x32_bf16 v[76:79], v[144:147], v[60:63], v[76:79]
    ds_read_b128 v[36:39], v8 offset:2048
    v_mfma_f32_16x16x32_bf16 v[80:83], v[148:151], v[48:51], v[80:83]
    ds_read_b128 v[40:43], v8 offset:4096
    v_mfma_f32_16x16x32_bf16 v[84:87], v[148:151], v[52:55], v[84:87]
    ds_read_b128 v[44:47], v8 offset:6144
    v_mfma_f32_16x16x32_bf16 v[88:91], v[148:151], v[56:59], v[88:91]
    ds_read_b64_tr_b16 v[132:133], v11 offset:0
    v_mfma_f32_16x16x32_bf16 v[92:95], v[148:151], v[60:63], v[92:95]
    ds_read_b64_tr_b16 v[134:135], v11 offset:4096
    v_mfma_f32_16x16x32_bf16 v[96:99], v[152:155], v[48:51], v[96:99]
    ds_read_b64_tr_b16 v[136:137], v12 offset:0
    v_mfma_f32_16x16x32_bf16 v[100:103], v[152:155], v[52:55], v[100:103]
    ds_read_b64_tr_b16 v[138:139], v12 offset:4096
    v_mfma_f32_16x16x32_bf16 v[104:107], v[152:155], v[56:59], v[104:107]
    ds_read_b64_tr_b16 v[140:141], v13 offset:0
    v_mfma_f32_16x16x32_bf16 v[108:111], v[152:155], v[60:63], v[108:111]
    ds_read_b64_tr_b16 v[142:143], v13 offset:4096
    v_mfma_f32_16x16x32_bf16 v[112:115], v[156:159], v[48:51], v[112:115]
    v_mfma_f32_16x16x32_bf16 v[116:119], v[156:159], v[52:55], v[116:119]
    v_mfma_f32_16x16x32_bf16 v[120:123], v[156:159], v[56:59], v[120:123]
    v_mfma_f32_16x16x32_bf16 v[124:127], v[156:159], v[60:63], v[124:127]
    s_waitcnt vmcnt(0)
    s_waitcnt lgkmcnt(0)
    s_barrier
    s_cmp_eq_u32 s43, 0
    s_cbranch_scc0 L_p4_noearly
    buffer_load_dwordx4 v[176:179], v20, s[16:19], s36 offen offset:0 sc1
    buffer_load_dwordx4 v[180:183], v20, s[16:19], s36 offen offset:2048 sc1
    buffer_load_dwordx4 v[184:187], v20, s[16:19], s37 offen offset:0 sc1
    buffer_load_dwordx4 v[188:191], v20, s[16:19], s37 offen offset:2048 sc1
    s_lshl_b32 s48, s46, 3
    s_add_u32 s48, s48, 42336260
    v_lshlrev_b32 v21, 3, v2
    buffer_load_dword v24, v21, s[16:19], s48 offen offset:0 sc1
    buffer_load_dword v25, v21, s[16:19], s48 offen offset:128 sc1
    buffer_load_dword v26, v21, s[16:19], s48 offen offset:256 sc1
    buffer_load_dword v27, v21, s[16:19], s48 offen offset:384 sc1
    v_readfirstlane_b32 s54, v19
    s_lshr_b32 s54, s54, s52
    s_and_b32 s55, s54, 1
    s_cbranch_scc0 L_p4_noearly
    buffer_load_dwordx4 v[160:163], v20, s[16:19], s56 offen offset:0 sc1
    buffer_load_dwordx4 v[164:167], v20, s[16:19], s56 offen offset:1024 sc1
    buffer_load_dwordx4 v[168:171], v20, s[16:19], s56 offen offset:2048 sc1
    buffer_load_dwordx4 v[172:175], v20, s[16:19], s56 offen offset:3072 sc1
L_p4_noearly:
    v_mfma_f32_16x16x32_bf16 v[64:67], v[128:131], v[32:35], v[64:67]
    ds_read_b128 v[48:51], v8 offset:32768
    v_mfma_f32_16x16x32_bf16 v[68:71], v[128:131], v[36:39], v[68:71]
    ds_read_b64_tr_b16 v[144:145], v10 offset:32768
    v_mfma_f32_16x16x32_bf16 v[72:75], v[128:131], v[40:43], v[72:75]
    ds_read_b64_tr_b16 v[146:147], v10 offset:36864
    v_mfma_f32_16x16x32_bf16 v[76:79], v[128:131], v[44:47], v[76:79]
    ds_read_b128 v[52:55], v8 offset:34816
    v_mfma_f32_16x16x32_bf16 v[80:83], v[132:135], v[32:35], v[80:83]
    ds_read_b128 v[56:59], v8 offset:36864
    v_mfma_f32_16x16x32_bf16 v[84:87], v[132:135], v[36:39], v[84:87]
    ds_read_b128 v[60:63], v8 offset:38912
    v_mfma_f32_16x16x32_bf16 v[88:91], v[132:135], v[40:43], v[88:91]
    ds_read_b64_tr_b16 v[148:149], v11 offset:32768
    v_mfma_f32_16x16x32_bf16 v[92:95], v[132:135], v[44:47], v[92:95]
    ds_read_b64_tr_b16 v[150:151], v11 offset:36864
    v_mfma_f32_16x16x32_bf16 v[96:99], v[136:139], v[32:35], v[96:99]
    ds_read_b64_tr_b16 v[152:153], v12 offset:32768
    v_mfma_f32_16x16x32_bf16 v[100:103], v[136:139], v[36:39], v[100:103]
    ds_read_b64_tr_b16 v[154:155], v12 offset:36864
    v_mfma_f32_16x16x32_bf16 v[104:107], v[136:139], v[40:43], v[104:107]
    ds_read_b64_tr_b16 v[156:157], v13 offset:32768
    v_mfma_f32_16x16x32_bf16 v[108:111], v[136:139], v[44:47], v[108:111]
    ds_read_b64_tr_b16 v[158:159], v13 offset:36864
    v_mfma_f32_16x16x32_bf16 v[112:115], v[140:143], v[32:35], v[112:115]
    v_mfma_f32_16x16x32_bf16 v[116:119], v[140:143], v[36:39], v[116:119]
    v_mfma_f32_16x16x32_bf16 v[120:123], v[140:143], v[40:43], v[120:123]
    v_mfma_f32_16x16x32_bf16 v[124:127], v[140:143], v[44:47], v[124:127]
    s_waitcnt lgkmcnt(9)
    v_mfma_f32_16x16x32_bf16 v[64:67], v[144:147], v[48:51], v[64:67]
    s_waitcnt lgkmcnt(8)
    v_mfma_f32_16x16x32_bf16 v[68:71], v[144:147], v[52:55], v[68:71]
    s_waitcnt lgkmcnt(7)
    v_mfma_f32_16x16x32_bf16 v[72:75], v[144:147], v[56:59], v[72:75]
    s_waitcnt lgkmcnt(6)
    v_mfma_f32_16x16x32_bf16 v[76:79], v[144:147], v[60:63], v[76:79]
    s_waitcnt lgkmcnt(4)
    v_mfma_f32_16x16x32_bf16 v[80:83], v[148:151], v[48:51], v[80:83]
    v_mfma_f32_16x16x32_bf16 v[84:87], v[148:151], v[52:55], v[84:87]
    v_mfma_f32_16x16x32_bf16 v[88:91], v[148:151], v[56:59], v[88:91]
    v_mfma_f32_16x16x32_bf16 v[92:95], v[148:151], v[60:63], v[92:95]
    s_waitcnt lgkmcnt(2)
    v_mfma_f32_16x16x32_bf16 v[96:99], v[152:155], v[48:51], v[96:99]
    v_mfma_f32_16x16x32_bf16 v[100:103], v[152:155], v[52:55], v[100:103]
    v_mfma_f32_16x16x32_bf16 v[104:107], v[152:155], v[56:59], v[104:107]
    v_mfma_f32_16x16x32_bf16 v[108:111], v[152:155], v[60:63], v[108:111]
    s_waitcnt lgkmcnt(0)
    v_mfma_f32_16x16x32_bf16 v[112:115], v[156:159], v[48:51], v[112:115]
    v_mfma_f32_16x16x32_bf16 v[116:119], v[156:159], v[52:55], v[116:119]
    v_mfma_f32_16x16x32_bf16 v[120:123], v[156:159], v[56:59], v[120:123]
    v_mfma_f32_16x16x32_bf16 v[124:127], v[156:159], v[60:63], v[124:127]
    s_barrier
    s_nop 3
    s_lshl_b32 s48, s20, 13
    v_add_u32 v21, s48, v20
    s_xor_b32 s48, s20, 4
    s_lshl_b32 s48, s48, 13
    v_add_u32 v22, s48, v20
    s_cmp_eq_u32 s23, 0
    s_cbranch_scc0 L_p4_x1
    ds_write_b128 v21, v[96:99] offset:0
    ds_write_b128 v21, v[100:103] offset:1024
    ds_write_b128 v21, v[104:107] offset:2048
    ds_write_b128 v21, v[108:111] offset:3072
    ds_write_b128 v21, v[112:115] offset:4096
    ds_write_b128 v21, v[116:119] offset:5120
    ds_write_b128 v21, v[120:123] offset:6144
    ds_write_b128 v21, v[124:127] offset:7168
    s_branch L_p4_x2
L_p4_x1:
    ds_write_b128 v21, v[64:67] offset:0
    ds_write_b128 v21, v[68:71] offset:1024
    ds_write_b128 v21, v[72:75] offset:2048
    ds_write_b128 v21, v[76:79] offset:3072
    ds_write_b128 v21, v[80:83] offset:4096
    ds_write_b128 v21, v[84:87] offset:5120
    ds_write_b128 v21, v[88:91] offset:6144
    ds_write_b128 v21, v[92:95] offset:7168
    s_waitcnt lgkmcnt(0)
    v_mov_b32 v64, v96
    v_mov_b32 v65, v97
    v_mov_b32 v66, v98
    v_mov_b32 v67, v99
    v_mov_b32 v68, v100
    v_mov_b32 v69, v101
    v_mov_b32 v70, v102
    v_mov_b32 v71, v103
    v_mov_b32 v72, v104
    v_mov_b32 v73, v105
    v_mov_b32 v74, v106
    v_mov_b32 v75, v107
    v_mov_b32 v76, v108
    v_mov_b32 v77, v109
    v_mov_b32 v78, v110
    v_mov_b32 v79, v111
    v_mov_b32 v80, v112
    v_mov_b32 v81, v113
    v_mov_b32 v82, v114
    v_mov_b32 v83, v115
    v_mov_b32 v84, v116
    v_mov_b32 v85, v117
    v_mov_b32 v86, v118
    v_mov_b32 v87, v119
    v_mov_b32 v88, v120
    v_mov_b32 v89, v121
    v_mov_b32 v90, v122
    v_mov_b32 v91, v123
    v_mov_b32 v92, v124
    v_mov_b32 v93, v125
    v_mov_b32 v94, v126
    v_mov_b32 v95, v127
L_p4_x2:
    s_waitcnt lgkmcnt(0)
    s_barrier
    ds_read_b128 v[96:99], v22 offset:0
    ds_read_b128 v[100:103], v22 offset:1024
    ds_read_b128 v[104:107], v22 offset:2048
    ds_read_b128 v[108:111], v22 offset:3072
    ds_read_b128 v[112:115], v22 offset:4096
    ds_read_b128 v[116:119], v22 offset:5120
    ds_read_b128 v[120:123], v22 offset:6144
    ds_read_b128 v[124:127], v22 offset:7168
    s_cmp_eq_u32 s43, 0
    s_cbranch_scc1 L_p4_main_ep
    s_waitcnt lgkmcnt(0)
    v_add_f32 v64, v64, v96
    v_add_f32 v65, v65, v97
    v_add_f32 v66, v66, v98
    v_add_f32 v67, v67, v99
    v_add_f32 v80, v80, v112
    v_add_f32 v81, v81, v113
    v_add_f32 v82, v82, v114
    v_add_f32 v83, v83, v115
    v_cvt_pk_bf16_f32 v32, v64, v65
    v_cvt_pk_bf16_f32 v33, v66, v67
    v_cvt_pk_bf16_f32 v34, v80, v81
    v_cvt_pk_bf16_f32 v35, v82, v83
    buffer_store_dwordx4 v[32:35], v20, s[16:19], s56 offen offset:0 sc1
    v_add_f32 v68, v68, v100
    v_add_f32 v69, v69, v101
    v_add_f32 v70, v70, v102
    v_add_f32 v71, v71, v103
    v_add_f32 v84, v84, v116
    v_add_f32 v85, v85, v117
    v_add_f32 v86, v86, v118
    v_add_f32 v87, v87, v119
    v_cvt_pk_bf16_f32 v36, v68, v69
    v_cvt_pk_bf16_f32 v37, v70, v71
    v_cvt_pk_bf16_f32 v38, v84, v85
    v_cvt_pk_bf16_f32 v39, v86, v87
    buffer_store_dwordx4 v[36:39], v20, s[16:19], s56 offen offset:1024 sc1
    v_add_f32 v72, v72, v104
    v_add_f32 v73, v73, v105
    v_add_f32 v74, v74, v106
    v_add_f32 v75, v75, v107
    v_add_f32 v88, v88, v120
    v_add_f32 v89, v89, v121
    v_add_f32 v90, v90, v122
    v_add_f32 v91, v91, v123
    v_cvt_pk_bf16_f32 v40, v72, v73
    v_cvt_pk_bf16_f32 v41, v74, v75
    v_cvt_pk_bf16_f32 v42, v88, v89
    v_cvt_pk_bf16_f32 v43, v90, v91
    buffer_store_dwordx4 v[40:43], v20, s[16:19], s56 offen offset:2048 sc1
    v_add_f32 v76, v76, v108
    v_add_f32 v77, v77, v109
    v_add_f32 v78, v78, v110
    v_add_f32 v79, v79, v111
    v_add_f32 v92, v92, v124
    v_add_f32 v93, v93, v125
    v_add_f32 v94, v94, v126
    v_add_f32 v95, v95, v127
    v_cvt_pk_bf16_f32 v44, v76, v77
    v_cvt_pk_bf16_f32 v45, v78, v79
    v_cvt_pk_bf16_f32 v46, v92, v93
    v_cvt_pk_bf16_f32 v47, v94, v95
    buffer_store_dwordx4 v[44:47], v20, s[16:19], s56 offen offset:3072 sc1
    s_waitcnt vmcnt(0)
    s_barrier
    s_cmp_lg_u32 s20, 0
    s_cbranch_scc1 L_p4_fin
    s_lshl_b32 s48, 1, s52
    v_mov_b32 v19, s48
    s_mov_b64 exec, 1
    buffer_atomic_or v19, v18, s[16:19], s53 offen
    s_branch L_p4_fin
L_p4_main_ep:
    s_cmp_eq_u32 s55, 1
    s_cbranch_scc1 L_p4_have
    buffer_load_dword v19, v18, s[16:19], s53 offen sc1
    s_waitcnt vmcnt(1) lgkmcnt(0)
L_p4_have:
    s_waitcnt vmcnt(4) lgkmcnt(0)
    v_add_f32 v64, v64, v96
    v_add_f32 v65, v65, v97
    v_add_f32 v66, v66, v98
    v_add_f32 v67, v67, v99
    v_add_f32 v68, v68, v100
    v_add_f32 v69, v69, v101
    v_add_f32 v70, v70, v102
    v_add_f32 v71, v71, v103
    v_add_f32 v72, v72, v104
    v_add_f32 v73, v73, v105
    v_add_f32 v74, v74, v106
    v_add_f32 v75, v75, v107
    v_add_f32 v76, v76, v108
    v_add_f32 v77, v77, v109
    v_add_f32 v78, v78, v110
    v_add_f32 v79, v79, v111
    v_add_f32 v80, v80, v112
    v_add_f32 v81, v81, v113
    v_add_f32 v82, v82, v114
    v_add_f32 v83, v83, v115
    v_add_f32 v84, v84, v116
    v_add_f32 v85, v85, v117
    v_add_f32 v86, v86, v118
    v_add_f32 v87, v87, v119
    v_add_f32 v88, v88, v120
    v_add_f32 v89, v89, v121
    v_add_f32 v90, v90, v122
    v_add_f32 v91, v91, v123
    v_add_f32 v92, v92, v124
    v_add_f32 v93, v93, v125
    v_add_f32 v94, v94, v126
    v_add_f32 v95, v95, v127
    v_lshlrev_b32 v48, 16, v176
    v_and_b32 v49, 0xffff0000, v176
    v_fma_f32 v64, v48, v24, v64
    v_fma_f32 v65, v49, v24, v65
    v_lshlrev_b32 v48, 16, v177
    v_and_b32 v49, 0xffff0000, v177
    v_fma_f32 v66, v48, v24, v66
    v_fma_f32 v67, v49, v24, v67
    v_lshlrev_b32 v48, 16, v178
    v_and_b32 v49, 0xffff0000, v178
    v_fma_f32 v80, v48, v24, v80
    v_fma_f32 v81, v49, v24, v81
    v_lshlrev_b32 v48, 16, v179
    v_and_b32 v49, 0xffff0000, v179
    v_fma_f32 v82, v48, v24, v82
    v_fma_f32 v83, v49, v24, v83
    v_lshlrev_b32 v48, 16, v180
    v_and_b32 v49, 0xffff0000, v180
    v_fma_f32 v68, v48, v25, v68
    v_fma_f32 v69, v49, v25, v69
    v_lshlrev_b32 v48, 16, v181
    v_and_b32 v49, 0xffff0000, v181
    v_fma_f32 v70, v48, v25, v70
    v_fma_f32 v71, v49, v25, v71
    v_lshlrev_b32 v48, 16, v182
    v_and_b32 v49, 0xffff0000, v182
    v_fma_f32 v84, v48, v25, v84
    v_fma_f32 v85, v49, v25, v85
    v_lshlrev_b32 v48, 16, v183
    v_and_b32 v49, 0xffff0000, v183
    v_fma_f32 v86, v48, v25, v86
    v_fma_f32 v87, v49, v25, v87
    v_lshlrev_b32 v48, 16, v184
    v_and_b32 v49, 0xffff0000, v184
    v_fma_f32 v72, v48, v26, v72
    v_fma_f32 v73, v49, v26, v73
    v_lshlrev_b32 v48, 16, v185
    v_and_b32 v49, 0xffff0000, v185
    v_fma_f32 v74, v48, v26, v74
    v_fma_f32 v75, v49, v26, v75
    v_lshlrev_b32 v48, 16, v186
    v_and_b32 v49, 0xffff0000, v186
    v_fma_f32 v88, v48, v26, v88
    v_fma_f32 v89, v49, v26, v89
    v_lshlrev_b32 v48, 16, v187
    v_and_b32 v49, 0xffff0000, v187
    v_fma_f32 v90, v48, v26, v90
    v_fma_f32 v91, v49, v26, v91
    v_lshlrev_b32 v48, 16, v188
    v_and_b32 v49, 0xffff0000, v188
    v_fma_f32 v76, v48, v27, v76
    v_fma_f32 v77, v49, v27, v77
    v_lshlrev_b32 v48, 16, v189
    v_and_b32 v49, 0xffff0000, v189
    v_fma_f32 v78, v48, v27, v78
    v_fma_f32 v79, v49, v27, v79
    v_lshlrev_b32 v48, 16, v190
    v_and_b32 v49, 0xffff0000, v190
    v_fma_f32 v92, v48, v27, v92
    v_fma_f32 v93, v49, v27, v93
    v_lshlrev_b32 v48, 16, v191
    v_and_b32 v49, 0xffff0000, v191
    v_fma_f32 v94, v48, v27, v94
    v_fma_f32 v95, v49, v27, v95
    s_cmp_eq_u32 s55, 1
    s_cbranch_scc1 L_p4_have3
    s_mov_b32 s91, 0
L_p4_poll:
    s_waitcnt vmcnt(0)
    v_readfirstlane_b32 s54, v19
    s_lshr_b32 s54, s54, s52
    s_and_b32 s54, s54, 1
    s_cbranch_scc1 L_p4_pollok
    s_add_u32 s91, s91, 1
    s_cmp_ge_u32 s91, 4194304
    s_cbranch_scc1 L_p4_pollok
    s_sleep 1
    buffer_load_dword v19, v18, s[16:19], s53 offen sc1
    s_branch L_p4_poll
L_p4_pollok:
    buffer_load_dwordx4 v[160:163], v20, s[16:19], s56 offen offset:0 sc1
    buffer_load_dwordx4 v[164:167], v20, s[16:19], s56 offen offset:1024 sc1
    buffer_load_dwordx4 v[168:171], v20, s[16:19], s56 offen offset:2048 sc1
    buffer_load_dwordx4 v[172:175], v20, s[16:19], s56 offen offset:3072 sc1
L_p4_have3:
    s_mov_b32 s8, s58
    s_mov_b32 s9, s59
    s_mov_b32 s10, 4194304
    s_mov_b32 s11, 0x00020000
    v_lshrrev_b32 v48, 1, v3
    v_and_b32 v49, 1, v3
    v_lshl_add_u32 v48, v49, 1, v48
    v_lshlrev_b32 v48, 4, v48
    v_lshl_add_u32 v48, v2, 11, v48
    s_lshl_b32 s50, s46, 11
    s_lshl_b32 s51, s45, 7
    s_add_u32 s50, s50, s51
    s_lshl_b32 s51, s23, 6
    s_add_u32 s50, s50, s51
    s_waitcnt vmcnt(0)
    v_lshlrev_b32 v50, 16, v160
    v_and_b32 v51, 0xffff0000, v160
    v_add_f32 v64, v64, v50
    v_add_f32 v65, v65, v51
    v_lshlrev_b32 v50, 16, v161
    v_and_b32 v51, 0xffff0000, v161
    v_add_f32 v66, v66, v50
    v_add_f32 v67, v67, v51
    v_lshlrev_b32 v50, 16, v162
    v_and_b32 v51, 0xffff0000, v162
    v_add_f32 v80, v80, v50
    v_add_f32 v81, v81, v51
    v_lshlrev_b32 v50, 16, v163
    v_and_b32 v51, 0xffff0000, v163
    v_add_f32 v82, v82, v50
    v_add_f32 v83, v83, v51
    v_cvt_pk_bf16_f32 v32, v64, v65
    v_cvt_pk_bf16_f32 v33, v66, v67
    v_cvt_pk_bf16_f32 v34, v80, v81
    v_cvt_pk_bf16_f32 v35, v82, v83
    s_nop 1
    v_permlane16_swap_b32 v32, v34
    v_permlane16_swap_b32 v33, v35
    s_nop 1
    buffer_store_dwordx4 v[32:35], v48, s[8:11], s50 offen nt
    s_add_u32 s50, s50, 32768
    v_lshlrev_b32 v50, 16, v164
    v_and_b32 v51, 0xffff0000, v164
    v_add_f32 v68, v68, v50
    v_add_f32 v69, v69, v51
    v_lshlrev_b32 v50, 16, v165
    v_and_b32 v51, 0xffff0000, v165
    v_add_f32 v70, v70, v50
    v_add_f32 v71, v71, v51
    v_lshlrev_b32 v50, 16, v166
    v_and_b32 v51, 0xffff0000, v166
    v_add_f32 v84, v84, v50
    v_add_f32 v85, v85, v51
    v_lshlrev_b32 v50, 16, v167
    v_and_b32 v51, 0xffff0000, v167
    v_add_f32 v86, v86, v50
    v_add_f32 v87, v87, v51
    v_cvt_pk_bf16_f32 v36, v68, v69
    v_cvt_pk_bf16_f32 v37, v70, v71
    v_cvt_pk_bf16_f32 v38, v84, v85
    v_cvt_pk_bf16_f32 v39, v86, v87
    s_nop 1
    v_permlane16_swap_b32 v36, v38
    v_permlane16_swap_b32 v37, v39
    s_nop 1
    buffer_store_dwordx4 v[36:39], v48, s[8:11], s50 offen nt
    s_add_u32 s50, s50, 32768
    v_lshlrev_b32 v50, 16, v168
    v_and_b32 v51, 0xffff0000, v168
    v_add_f32 v72, v72, v50
    v_add_f32 v73, v73, v51
    v_lshlrev_b32 v50, 16, v169
    v_and_b32 v51, 0xffff0000, v169
    v_add_f32 v74, v74, v50
    v_add_f32 v75, v75, v51
    v_lshlrev_b32 v50, 16, v170
    v_and_b32 v51, 0xffff0000, v170
    v_add_f32 v88, v88, v50
    v_add_f32 v89, v89, v51
    v_lshlrev_b32 v50, 16, v171
    v_and_b32 v51, 0xffff0000, v171
    v_add_f32 v90, v90, v50
    v_add_f32 v91, v91, v51
    v_cvt_pk_bf16_f32 v40, v72, v73
    v_cvt_pk_bf16_f32 v41, v74, v75
    v_cvt_pk_bf16_f32 v42, v88, v89
    v_cvt_pk_bf16_f32 v43, v90, v91
    s_nop 1
    v_permlane16_swap_b32 v40, v42
    v_permlane16_swap_b32 v41, v43
    s_nop 1
    buffer_store_dwordx4 v[40:43], v48, s[8:11], s50 offen nt
    s_add_u32 s50, s50, 32768
    v_lshlrev_b32 v50, 16, v172
    v_and_b32 v51, 0xffff0000, v172
    v_add_f32 v76, v76, v50
    v_add_f32 v77, v77, v51
    v_lshlrev_b32 v50, 16, v173
    v_and_b32 v51, 0xffff0000, v173
    v_add_f32 v78, v78, v50
    v_add_f32 v79, v79, v51
    v_lshlrev_b32 v50, 16, v174
    v_and_b32 v51, 0xffff0000, v174
    v_add_f32 v92, v92, v50
    v_add_f32 v93, v93, v51
    v_lshlrev_b32 v50, 16, v175
    v_and_b32 v51, 0xffff0000, v175
    v_add_f32 v94, v94, v50
    v_add_f32 v95, v95, v51
    v_cvt_pk_bf16_f32 v44, v76, v77
    v_cvt_pk_bf16_f32 v45, v78, v79
    v_cvt_pk_bf16_f32 v46, v92, v93
    v_cvt_pk_bf16_f32 v47, v94, v95
    s_nop 1
    v_permlane16_swap_b32 v44, v46
    v_permlane16_swap_b32 v45, v47
    s_nop 1
    buffer_store_dwordx4 v[44:47], v48, s[8:11], s50 offen nt
    s_add_u32 s50, s50, 32768
L_p4_fin:
L_ka_end:
    s_endpgm
L_pa_fallback:
    s_lshl_b32 s52, s36, 18
    s_add_u32 s52, s52, 4194304
    s_mov_b32 s53, s52
    s_mov_b32 s54, 64
    v_mov_b32 v18, 0xff800000
L_pa_fb1:
    buffer_load_dwordx4 v[148:151], v15, s[16:19], s53 offen sc1
    buffer_load_dwordx4 v[152:155], v15, s[16:19], s53 offen offset:1024 sc1
    s_waitcnt vmcnt(0)
    v_mfma_f32_32x32x16_bf16 v[64:79], v[148:151], v[32:35], 0
    v_mfma_f32_32x32x16_bf16 v[64:79], v[152:155], v[36:39], v[64:79]
    s_nop 7
    s_nop 7
    v_max3_f32 v18, v18, v64, v65
    v_max3_f32 v18, v18, v66, v67
    v_max3_f32 v18, v18, v68, v69
    v_max3_f32 v18, v18, v70, v71
    v_max3_f32 v18, v18, v72, v73
    v_max3_f32 v18, v18, v74, v75
    v_max3_f32 v18, v18, v76, v77
    v_max3_f32 v18, v18, v78, v79
    s_add_u32 s53, s53, 4096
    s_sub_u32 s54, s54, 1
    s_cmp_lg_u32 s54, 0
    s_cbranch_scc1 L_pa_fb1
    v_mov_b32 v19, v18
    s_nop 1
    v_permlane32_swap_b32 v18, v19
    s_nop 1
    v_max_f32 v18, v18, v19
    v_sub_f32 v48, 0, v18
    v_sub_f32 v49, 0, v18
    v_sub_f32 v50, 0, v18
    v_sub_f32 v51, 0, v18
    v_sub_f32 v52, 0, v18
    v_sub_f32 v53, 0, v18
    v_sub_f32 v54, 0, v18
    v_sub_f32 v55, 0, v18
    v_sub_f32 v56, 0, v18
    v_sub_f32 v57, 0, v18
    v_sub_f32 v58, 0, v18
    v_sub_f32 v59, 0, v18
    v_sub_f32 v60, 0, v18
    v_sub_f32 v61, 0, v18
    v_sub_f32 v62, 0, v18
    v_sub_f32 v63, 0, v18
    v_mov_b32 v104, 0
    v_mov_b32 v105, 0
    v_mov_b32 v106, 0
    v_mov_b32 v107, 0
    v_mov_b32 v108, 0
    v_mov_b32 v109, 0
    v_mov_b32 v110, 0
    v_mov_b32 v111, 0
    v_mov_b32 v112, 0
    v_mov_b32 v113, 0
    v_mov_b32 v114, 0
    v_mov_b32 v115, 0
    v_mov_b32 v116, 0
    v_mov_b32 v117, 0
    v_mov_b32 v118, 0
    v_mov_b32 v119, 0
    v_mov_b32 v136, 0
    v_mov_b32 v137, 0
    v_mov_b32 v138, 0
    v_mov_b32 v139, 0
    s_mov_b32 s53, s52
    s_mov_b32 s54, 64
L_pa_fb2:
    buffer_load_dwordx4 v[148:151], v15, s[16:19], s53 offen offset:0 sc1
    buffer_load_dwordx4 v[164:167], v15, s[16:19], s53 offen offset:2048 sc1
    buffer_load_dwordx4 v[152:155], v15, s[16:19], s53 offen offset:1024 sc1
    buffer_load_dwordx4 v[168:171], v15, s[16:19], s53 offen offset:3072 sc1
    s_waitcnt vmcnt(0)
    v_mfma_f32_32x32x16_bf16 v[64:79], v[148:151], v[32:35], v[48:63]
    v_mfma_f32_32x32x16_bf16 v[64:79], v[152:155], v[36:39], v[64:79]
    s_nop 7
    s_nop 7
    v_exp_f32 v64, v64
    v_exp_f32 v65, v65
    v_exp_f32 v66, v66
    v_exp_f32 v67, v67
    v_exp_f32 v68, v68
    v_exp_f32 v69, v69
    v_exp_f32 v70, v70
    v_exp_f32 v71, v71
    v_exp_f32 v72, v72
    v_exp_f32 v73, v73
    v_exp_f32 v74, v74
    v_exp_f32 v75, v75
    v_exp_f32 v76, v76
    v_exp_f32 v77, v77
    v_exp_f32 v78, v78
    v_exp_f32 v79, v79
    s_nop 0
    v_cvt_pk_bf16_f32 v96, v64, v65
    v_cvt_pk_bf16_f32 v97, v66, v67
    v_cvt_pk_bf16_f32 v98, v68, v69
    v_cvt_pk_bf16_f32 v99, v70, v71
    v_cvt_pk_bf16_f32 v100, v72, v73
    v_cvt_pk_bf16_f32 v101, v74, v75
    v_cvt_pk_bf16_f32 v102, v76, v77
    v_cvt_pk_bf16_f32 v103, v78, v79
    s_nop 1
    v_mfma_f32_32x32x16_bf16 v[104:119], v[164:167], v[96:99], v[104:119]
    v_mfma_f32_16x16x32_bf16 v[136:139], v[144:147], v[96:99], v[136:139]
    v_mfma_f32_32x32x16_bf16 v[104:119], v[168:171], v[100:103], v[104:119]
    v_mfma_f32_16x16x32_bf16 v[136:139], v[144:147], v[100:103], v[136:139]
    s_add_u32 s53, s53, 4096
    s_sub_u32 s54, s54, 1
    s_cmp_lg_u32 s54, 0
    s_cbranch_scc1 L_pa_fb2
    s_nop 7
    s_nop 7
    s_branch L_pa_fin
L_end_gated_mix__mha_block__mixer_s_mlp__prompt_kernel:
L_code_end:
.section .rodata,"a"
.p2align 6
.amdhsa_kernel gated_mix__mha_block__mixer_s_mlp__prompt_kernel
  .amdhsa_next_free_vgpr 240
  .amdhsa_next_free_sgpr 102
  .amdhsa_accum_offset 240
  .amdhsa_group_segment_fixed_size 0
  .amdhsa_kernarg_size 96
  .amdhsa_user_sgpr_count 2
  .amdhsa_user_sgpr_kernarg_segment_ptr 1
  .amdhsa_system_sgpr_workgroup_id_x 1
.end_amdhsa_kernel
```
